```python
import torch

def _softmax(x, axis=-1):
    return torch.softmax(x, dim=axis)
def _gelu(x):
    return torch.nn.functional.gelu(x, approximate="tanh")
def _silu(x):
    return torch.nn.functional.silu(x)
def _sigmoid(x):
    return torch.sigmoid(x)
def _layernorm(x, axis=-1, eps=1e-5):
    m = x.mean(dim=axis, keepdim=True)
    v = x.var(dim=axis, keepdim=True, unbiased=False)
    return (x - m) / torch.sqrt(v + eps)
def _scatter_add(tgt, idx, src, axis=0):
    return tgt.clone().index_add_(axis, idx, src)
def _segment_sum(src, seg, n):
    out = torch.zeros((n,) + src.shape[1:], dtype=src.dtype)
    return out.index_add_(0, seg, src)
def _pad(x, pw):
    flat = tuple(v for pair in reversed(pw) for v in pair)
    return torch.nn.functional.pad(x, flat)

kernel_name = 'standalone__mha_softmax__near_ridge'

def setup_inputs():

    _w = (lambda a: (lambda t: t.to(torch.bfloat16) if t.is_floating_point() else t)(torch.as_tensor(a)))
    B, H, Sq, Sk, D = 32, 16, 384, 384, 256
    return {
        "q": _w((lambda *s: torch.randn(*s, dtype=torch.bfloat16) * 0.8)(B, H, Sq, D)),
        "k": _w((lambda *s: torch.randn(*s, dtype=torch.bfloat16) * 0.8)(B, H, Sk, D)),
        "v": _w((lambda *s: torch.randn(*s, dtype=torch.bfloat16) * 0.05)(B, H, Sk, D)),
    }

def reference(q, k, v):
    scale = q.shape[-1] ** -0.5
    scores = torch.einsum("bhqd,bhkd->bhqk", q, k) * scale
    p = _softmax(scores, axis=-1)
    return torch.einsum("bhqk,bhkd->bhqd", p, v)
```

```asm
; @launch grid=(256,1,1) block=(256,1,1) lds=163840
.amdgcn_target "amdgcn-amd-amdhsa--gfx950"
.text
.globl standalone__mha_softmax__near_ridge_kernel
.p2align 8
.type standalone__mha_softmax__near_ridge_kernel,@function
standalone__mha_softmax__near_ridge_kernel:
    s_cmp_ge_u32 s2, 256
    s_cbranch_scc1 L_end
    s_load_dwordx4 s[40:43], s[0:1], 0
    s_load_dwordx4 s[44:47], s[0:1], 16
    v_lshrrev_b32 v1, 6, v0
    v_and_b32 v0, 63, v0
    v_readfirstlane_b32 s35, v1
    v_bfe_u32 v2, v0, 4, 1
    v_lshlrev_b32 v2, 2, v2
    v_lshrrev_b32 v3, 5, v0
    v_xor_b32 v2, v2, v3
    v_and_b32 v3, 7, v0
    v_xor_b32 v2, v2, v3
    v_lshlrev_b32 v2, 4, v2
    v_lshrrev_b32 v3, 3, v0
    v_lshl_add_u32 v252, v3, 9, v2
    v_xor_b32 v253, 32, v252
    s_lshl_b32 s30, s35, 12
    s_add_u32 s31, s30, 65536
    s_mul_i32 s36, s2, 393216
    s_sub_u32 s36, s36, 4096
    s_lshl_b32 s37, s35, 7
    s_add_u32 s24, s36, s37
    s_add_u32 s48, s36, s30
    s_lshl_b32 s37, s35, 15
    s_add_u32 s28, s36, s37
    s_and_b32 s37, s37, 0x8000
    s_lshr_b32 s38, s35, 1
    s_lshl_b32 s38, s38, 12
    s_add_u32 s37, s37, s38
    s_add_u32 s74, s36, s37
    s_and_b32 s37, s35, 1
    s_lshl_b32 s37, s37, 12
    s_add_u32 s36, s36, s37
    s_lshr_b32 s37, s35, 1
    s_lshl_b32 s37, s37, 7
    s_add_u32 s26, s36, s37
    s_add_u32 s25, s24, 196608
    s_add_u32 s27, s26, 196608
    s_add_u32 s29, s28, 196608
    s_add_u32 s49, s48, 196608
    s_add_u32 s75, s74, 196608
    s_waitcnt lgkmcnt(0)
    s_mov_b32 s8, s40
    s_and_b32 s9, s41, 0xffff
    s_mov_b32 s10, 100663296
    s_mov_b32 s11, 0x00020000
    s_mov_b32 s12, s42
    s_and_b32 s13, s43, 0xffff
    s_mov_b32 s14, 100663296
    s_mov_b32 s15, 0x00020000
    s_mov_b32 s16, s44
    s_and_b32 s17, s45, 0xffff
    s_mov_b32 s18, 100663296
    s_mov_b32 s19, 0x00020000
    s_mov_b32 s20, s46
    s_and_b32 s21, s47, 0xffff
    s_mov_b32 s22, 100663296
    s_mov_b32 s23, 0x00020000
    s_getreg_b32 s36, hwreg(HW_REG_XCC_ID)
    s_bitcmp0_b32 s36, 0
    s_cselect_b32 s76, 9, 0
    s_bitcmp1_b32 s2, 3
    s_cselect_b32 s36, 0, 0
    s_add_u32 s76, s76, s36
    s_add_u32 s35, s28, 4096
    buffer_load_dwordx4 a[160:163], v252, s[8:11], s35 offen nt
    s_add_u32 s35, s28, 4096
    buffer_load_dwordx4 v[40:43], v252, s[8:11], s35 offen offset:128 nt
    s_cmp_ge_u32 s76, 1
    s_cbranch_scc0 L_stg2
    s_waitcnt vmcnt(0)
L_stg2:
    s_add_u32 m0, s31, 0
    s_add_u32 s35, s28, 4352
    buffer_load_dwordx4 v252, s[8:11], s35 offen nt lds
    s_add_u32 m0, s31, 16384
    s_add_u32 s35, s28, 4480
    buffer_load_dwordx4 v252, s[8:11], s35 offen nt lds
    s_cmp_ge_u32 s76, 2
    s_cbranch_scc0 L_stg4
    s_waitcnt vmcnt(0)
L_stg4:
    s_add_u32 s35, s28, 8192
    buffer_load_dwordx4 a[164:167], v253, s[8:11], s35 offen nt
    s_add_u32 s35, s28, 8192
    buffer_load_dwordx4 v[44:47], v253, s[8:11], s35 offen offset:128 nt
    s_cmp_ge_u32 s76, 3
    s_cbranch_scc0 L_stg6
    s_waitcnt vmcnt(0)
L_stg6:
    s_add_u32 m0, s31, 0
    s_add_u32 s35, s28, 7424
    buffer_load_dwordx4 v253, s[8:11], s35 offen offset:1024 nt lds
    s_add_u32 m0, s31, 16384
    s_add_u32 s35, s28, 7552
    buffer_load_dwordx4 v253, s[8:11], s35 offen offset:1024 nt lds
    s_cmp_ge_u32 s76, 4
    s_cbranch_scc0 L_stg8
    s_waitcnt vmcnt(0)
L_stg8:
    s_add_u32 s35, s28, 12288
    buffer_load_dwordx4 v[32:35], v252, s[8:11], s35 offen nt
    s_add_u32 s35, s28, 12288
    buffer_load_dwordx4 a[168:171], v252, s[8:11], s35 offen offset:128 nt
    s_cmp_ge_u32 s76, 5
    s_cbranch_scc0 L_stg10
    s_waitcnt vmcnt(0)
L_stg10:
    s_add_u32 m0, s31, 0
    s_add_u32 s35, s28, 10496
    buffer_load_dwordx4 v252, s[8:11], s35 offen offset:2048 nt lds
    s_add_u32 m0, s31, 16384
    s_add_u32 s35, s28, 10624
    buffer_load_dwordx4 v252, s[8:11], s35 offen offset:2048 nt lds
    s_cmp_ge_u32 s76, 6
    s_cbranch_scc0 L_stg12
    s_waitcnt vmcnt(0)
L_stg12:
    s_add_u32 s35, s28, 16384
    buffer_load_dwordx4 v[36:39], v253, s[8:11], s35 offen nt
    s_add_u32 s35, s28, 16384
    buffer_load_dwordx4 a[172:175], v253, s[8:11], s35 offen offset:128 nt
    s_cmp_ge_u32 s76, 7
    s_cbranch_scc0 L_stg14
    s_waitcnt vmcnt(0)
L_stg14:
    s_add_u32 m0, s31, 0
    s_add_u32 s35, s28, 13568
    buffer_load_dwordx4 v253, s[8:11], s35 offen offset:3072 nt lds
    s_add_u32 m0, s31, 16384
    s_add_u32 s35, s28, 13696
    buffer_load_dwordx4 v253, s[8:11], s35 offen offset:3072 nt lds
    s_cmp_ge_u32 s76, 8
    s_cbranch_scc0 L_stg16
    s_waitcnt vmcnt(0)
L_stg16:
    s_getpc_b64 s[52:53]
L_pc:
    s_bfe_u32 s36, s2, 0x50003
    s_lshl_b32 s36, s36, 12
    s_lshr_b32 s37, s30, 2
    s_add_u32 s36, s36, s37
    s_min_u32 s36, s36, L_end - L_pc - 1024
    v_lshl_add_u32 v5, v0, 4, s36
    global_load_dwordx4 v[8:11], v5, s[52:53]
    s_add_u32 m0, s30, 0
    s_add_u32 s35, s24, 4096
    buffer_load_dwordx4 v252, s[12:15], s35 offen nt lds
    s_add_u32 s35, s24, 35840
    buffer_load_dwordx4 v253, s[12:15], s35 offen offset:1024 nt lds
    s_cmp_ge_u32 s76, 9
    s_cbranch_scc0 L_stg18
    s_waitcnt vmcnt(0)
L_stg18:
    s_add_u32 s35, s24, 67584
    buffer_load_dwordx4 v252, s[12:15], s35 offen offset:2048 nt lds
    s_add_u32 s35, s24, 99328
    buffer_load_dwordx4 v253, s[12:15], s35 offen offset:3072 nt lds
    s_add_u32 s35, s28, 20480
    buffer_load_dwordx4 v[48:51], v252, s[8:11], s35 offen nt
    s_add_u32 s35, s28, 20480
    buffer_load_dwordx4 a[176:179], v252, s[8:11], s35 offen offset:128 nt
    s_add_u32 m0, s31, 32768
    s_add_u32 s35, s28, 20736
    buffer_load_dwordx4 v252, s[8:11], s35 offen nt lds
    s_add_u32 m0, s31, 81920
    s_add_u32 s35, s28, 20864
    buffer_load_dwordx4 v252, s[8:11], s35 offen nt lds
    s_add_u32 s35, s28, 24576
    buffer_load_dwordx4 v[52:55], v253, s[8:11], s35 offen nt
    s_add_u32 s35, s28, 24576
    buffer_load_dwordx4 a[180:183], v253, s[8:11], s35 offen offset:128 nt
    s_add_u32 m0, s31, 32768
    s_add_u32 s35, s28, 23808
    buffer_load_dwordx4 v253, s[8:11], s35 offen offset:1024 nt lds
    s_add_u32 m0, s31, 81920
    s_add_u32 s35, s28, 23936
    buffer_load_dwordx4 v253, s[8:11], s35 offen offset:1024 nt lds
    s_add_u32 s35, s28, 28672
    buffer_load_dwordx4 v[56:59], v252, s[8:11], s35 offen nt
    s_add_u32 s35, s28, 28672
    buffer_load_dwordx4 v[64:67], v252, s[8:11], s35 offen offset:128 nt
    s_add_u32 m0, s31, 32768
    s_add_u32 s35, s28, 26880
    buffer_load_dwordx4 v252, s[8:11], s35 offen offset:2048 nt lds
    s_add_u32 m0, s31, 81920
    s_add_u32 s35, s28, 27008
    buffer_load_dwordx4 v252, s[8:11], s35 offen offset:2048 nt lds
    s_add_u32 s35, s28, 32768
    buffer_load_dwordx4 v[60:63], v253, s[8:11], s35 offen nt
    s_add_u32 s35, s28, 32768
    buffer_load_dwordx4 v[68:71], v253, s[8:11], s35 offen offset:128 nt
    s_add_u32 m0, s31, 32768
    s_add_u32 s35, s28, 29952
    buffer_load_dwordx4 v253, s[8:11], s35 offen offset:3072 nt lds
    s_add_u32 m0, s31, 81920
    s_add_u32 s35, s28, 30080
    buffer_load_dwordx4 v253, s[8:11], s35 offen offset:3072 nt lds
    s_mov_b32 s32, 0x3db8aa3b
    s_mov_b32 s33, 0x42800000
    s_mov_b32 s34, 0x00800080
    v_mov_b32 v236, 0
    s_mov_b32 s36, 0x3f803f80
    v_writelane_b32 v236, s36, 0
    v_writelane_b32 v236, s36, 5
    v_writelane_b32 v236, s36, 10
    v_mov_b32 v237, v236
    v_mbcnt_lo_u32_b32 v248, -1, 0
    v_mbcnt_hi_u32_b32 v248, -1, v248
    v_bfe_u32 v244, v248, 2, 2
    v_bfe_u32 v249, v248, 1, 1
    v_lshl_add_u32 v244, v249, 2, v244
    v_lshlrev_b32 v244, 4, v244
    v_and_b32 v249, 31, v248
    v_lshl_add_u32 v244, v249, 7, v244
    v_lshrrev_b32 v248, 5, v248
    v_lshlrev_b32 v248, 4, v248
    v_xor_b32 v244, v244, v248
    v_xor_b32 v245, 32, v244
    v_xor_b32 v246, 64, v244
    v_xor_b32 v247, 96, v244
    v_add_u32 v248, s31, v244
    v_add_u32 v249, s31, v245
    v_add_u32 v250, s31, v246
    v_add_u32 v251, s31, v247
    v_mbcnt_lo_u32_b32 v241, -1, 0
    v_mbcnt_hi_u32_b32 v241, -1, v241
    s_sub_u32 s36, s31, 32768
    v_lshl_add_u32 v241, v241, 4, s36
    v_subrev_u32 v248, 16384, v248
    v_subrev_u32 v249, 16384, v249
    v_subrev_u32 v250, 16384, v250
    v_subrev_u32 v251, 16384, v251
    s_waitcnt vmcnt(36)
    ds_write_b128 v241, a[160:163] offset:16384
    s_waitcnt vmcnt(32)
    ds_write_b128 v241, a[164:167] offset:17408
    s_waitcnt vmcnt(28)
    ds_write_b128 v241, v[32:35] offset:18432
    s_waitcnt vmcnt(24)
    ds_write_b128 v241, v[36:39] offset:19456
    ds_read_b128 a[0:3], v248
    ds_read_b128 a[4:7], v249
    ds_read_b128 a[8:11], v250
    ds_read_b128 a[12:15], v251
    ds_write_b128 v241, v[40:43] offset:16384
    ds_write_b128 v241, v[44:47] offset:17408
    ds_write_b128 v241, a[168:171] offset:18432
    s_waitcnt vmcnt(23)
    ds_write_b128 v241, a[172:175] offset:19456
    ds_read_b128 a[16:19], v248
    ds_read_b128 a[20:23], v249
    ds_read_b128 a[24:27], v250
    s_waitcnt lgkmcnt(13)
    ds_read_b128 a[28:31], v251
    v_add_u32 v248, 16384, v248
    v_add_u32 v249, 16384, v249
    v_add_u32 v250, 16384, v250
    v_add_u32 v251, 16384, v251
    s_waitcnt vmcnt(16)
    s_barrier
    ds_read_b128 a[96:99], v244
    s_waitcnt lgkmcnt(13)
    ds_read_b128 a[128:131], v244 offset:8192
    ds_read_b128 a[100:103], v245
    s_waitcnt lgkmcnt(13)
    ds_read_b128 a[132:135], v245 offset:8192
    ds_read_b128 a[104:107], v246
    s_waitcnt lgkmcnt(13)
    ds_read_b128 a[136:139], v246 offset:8192
    ds_read_b128 a[108:111], v247
    s_waitcnt lgkmcnt(13)
    ds_read_b128 a[140:143], v247 offset:8192
    ds_read_b128 a[112:115], v244 offset:4096
    s_waitcnt lgkmcnt(13)
    ds_read_b128 a[144:147], v244 offset:12288
    ds_read_b128 a[116:119], v245 offset:4096
    s_waitcnt lgkmcnt(13)
    ds_read_b128 a[148:151], v245 offset:12288
    ds_read_b128 a[120:123], v246 offset:4096
    s_waitcnt lgkmcnt(13)
    ds_read_b128 a[152:155], v246 offset:12288
    ds_read_b128 a[124:127], v247 offset:4096
    s_waitcnt lgkmcnt(13)
    ds_read_b128 a[156:159], v247 offset:12288
    ds_read_b128 a[248:251], v248
    s_waitcnt lgkmcnt(13)
    ds_read_b128 a[252:255], v249
    v_mfma_f32_32x32x16_bf16 v[0:15], a[96:99], a[0:3], 0
    s_add_u32 s35, s74, 135168
    buffer_load_dwordx4 v[72:75], v252, s[8:11], s35 offen nt
    s_waitcnt lgkmcnt(1)
    v_mfma_f32_32x32x16_bf16 v[0:15], a[128:131], a[248:251], v[0:15]
    ds_read_b128 a[248:251], v250
    s_add_u32 s35, s74, 135168
    buffer_load_dwordx4 v[80:83], v252, s[8:11], s35 offen offset:128 nt
    v_mfma_f32_32x32x16_bf16 v[0:15], a[100:103], a[4:7], v[0:15]
    s_add_u32 m0, s31, 65536
    s_add_u32 s35, s74, 135424
    buffer_load_dwordx4 v252, s[8:11], s35 offen nt lds
    s_waitcnt lgkmcnt(1)
    v_mfma_f32_32x32x16_bf16 v[0:15], a[132:135], a[252:255], v[0:15]
    ds_read_b128 a[252:255], v251
    s_add_u32 m0, s31, 49152
    s_add_u32 s35, s74, 135552
    buffer_load_dwordx4 v252, s[8:11], s35 offen nt lds
    v_mfma_f32_32x32x16_bf16 v[0:15], a[104:107], a[8:11], v[0:15]
    s_add_u32 s35, s74, 143360
    buffer_load_dwordx4 v[76:79], v253, s[8:11], s35 offen nt
    s_waitcnt lgkmcnt(1)
    v_mfma_f32_32x32x16_bf16 v[0:15], a[136:139], a[248:251], v[0:15]
    ds_read_b128 a[248:251], v248 offset:16384
    s_add_u32 s35, s74, 143360
    buffer_load_dwordx4 v[84:87], v253, s[8:11], s35 offen offset:128 nt
    v_mfma_f32_32x32x16_bf16 v[0:15], a[108:111], a[12:15], v[0:15]
    s_add_u32 m0, s31, 65536
    s_add_u32 s35, s74, 142592
    buffer_load_dwordx4 v253, s[8:11], s35 offen offset:1024 nt lds
    s_waitcnt lgkmcnt(1)
    v_mfma_f32_32x32x16_bf16 v[0:15], a[140:143], a[252:255], v[0:15]
    ds_read_b128 a[252:255], v249 offset:16384
    s_add_u32 m0, s31, 49152
    s_add_u32 s35, s74, 142720
    buffer_load_dwordx4 v253, s[8:11], s35 offen offset:1024 nt lds
    v_mfma_f32_32x32x16_bf16 v[0:15], a[112:115], a[16:19], v[0:15]
    s_add_u32 s35, s74, 151552
    buffer_load_dwordx4 a[184:187], v252, s[8:11], s35 offen nt
    s_waitcnt lgkmcnt(1)
    v_mfma_f32_32x32x16_bf16 v[0:15], a[144:147], a[248:251], v[0:15]
    ds_read_b128 a[248:251], v250 offset:16384
    s_add_u32 s35, s74, 151552
    buffer_load_dwordx4 v[88:91], v252, s[8:11], s35 offen offset:128 nt
    v_mfma_f32_32x32x16_bf16 v[0:15], a[116:119], a[20:23], v[0:15]
    s_add_u32 m0, s31, 65536
    s_add_u32 s35, s74, 149760
    buffer_load_dwordx4 v252, s[8:11], s35 offen offset:2048 nt lds
    s_waitcnt lgkmcnt(1)
    v_mfma_f32_32x32x16_bf16 v[0:15], a[148:151], a[252:255], v[0:15]
    ds_read_b128 a[252:255], v251 offset:16384
    s_add_u32 m0, s31, 49152
    s_add_u32 s35, s74, 149888
    buffer_load_dwordx4 v252, s[8:11], s35 offen offset:2048 nt lds
    v_mfma_f32_32x32x16_bf16 v[0:15], a[120:123], a[24:27], v[0:15]
    s_add_u32 s35, s74, 159744
    buffer_load_dwordx4 a[188:191], v253, s[8:11], s35 offen nt
    s_waitcnt lgkmcnt(1)
    v_mfma_f32_32x32x16_bf16 v[0:15], a[152:155], a[248:251], v[0:15]
    s_add_u32 s35, s74, 159744
    buffer_load_dwordx4 v[92:95], v253, s[8:11], s35 offen offset:128 nt
    v_mfma_f32_32x32x16_bf16 v[0:15], a[124:127], a[28:31], v[0:15]
    s_add_u32 m0, s31, 65536
    s_add_u32 s35, s74, 156928
    buffer_load_dwordx4 v253, s[8:11], s35 offen offset:3072 nt lds
    s_waitcnt lgkmcnt(0)
    v_mfma_f32_32x32x16_bf16 v[0:15], a[156:159], a[252:255], v[0:15]
    s_add_u32 m0, s31, 49152
    s_add_u32 s35, s74, 157056
    buffer_load_dwordx4 v253, s[8:11], s35 offen offset:3072 nt lds
    s_add_u32 m0, s30, 16384
    s_add_u32 s35, s24, 8192
    buffer_load_dwordx4 v252, s[12:15], s35 offen nt lds
    s_add_u32 s35, s24, 39936
    buffer_load_dwordx4 v253, s[12:15], s35 offen offset:1024 nt lds
    s_add_u32 s35, s24, 71680
    buffer_load_dwordx4 v252, s[12:15], s35 offen offset:2048 nt lds
    s_add_u32 s35, s24, 103424
    buffer_load_dwordx4 v253, s[12:15], s35 offen offset:3072 nt lds
    s_add_u32 m0, s30, 32768
    s_add_u32 s35, s24, 12288
    buffer_load_dwordx4 v252, s[12:15], s35 offen nt lds
    s_add_u32 s35, s24, 44032
    buffer_load_dwordx4 v253, s[12:15], s35 offen offset:1024 nt lds
    s_add_u32 s35, s24, 75776
    buffer_load_dwordx4 v252, s[12:15], s35 offen offset:2048 nt lds
    s_add_u32 s35, s24, 107520
    buffer_load_dwordx4 v253, s[12:15], s35 offen offset:3072 nt lds
    v_subrev_u32 v248, 16384, v248
    v_subrev_u32 v249, 16384, v249
    v_subrev_u32 v250, 16384, v250
    v_subrev_u32 v251, 16384, v251
    s_waitcnt vmcnt(39)
    ds_write_b128 v241, v[48:51] offset:16384
    s_waitcnt vmcnt(35)
    ds_write_b128 v241, v[52:55] offset:17408
    s_waitcnt vmcnt(31)
    ds_write_b128 v241, v[56:59] offset:18432
    s_waitcnt vmcnt(27)
    ds_write_b128 v241, v[60:63] offset:19456
    ds_read_b128 a[32:35], v248
    ds_read_b128 a[36:39], v249
    ds_read_b128 a[40:43], v250
    ds_read_b128 a[44:47], v251
    ds_write_b128 v241, a[176:179] offset:16384
    ds_write_b128 v241, a[180:183] offset:17408
    ds_write_b128 v241, v[64:67] offset:18432
    s_waitcnt vmcnt(26)
    ds_write_b128 v241, v[68:71] offset:19456
    ds_read_b128 a[48:51], v248
    ds_read_b128 a[52:55], v249
    ds_read_b128 a[56:59], v250
    s_waitcnt lgkmcnt(13)
    ds_read_b128 a[60:63], v251
    s_waitcnt vmcnt(23)
    ds_write_b128 v241, v[72:75] offset:16384
    s_waitcnt lgkmcnt(13)
    s_waitcnt vmcnt(19)
    ds_write_b128 v241, v[76:79] offset:17408
    s_waitcnt vmcnt(15)
    ds_write_b128 v241, a[184:187] offset:18432
    s_waitcnt lgkmcnt(13)
    s_waitcnt vmcnt(11)
    ds_write_b128 v241, a[188:191] offset:19456
    ds_read_b128 a[64:67], v248
    s_waitcnt lgkmcnt(13)
    ds_read_b128 a[68:71], v249
    ds_read_b128 a[72:75], v250
    s_waitcnt lgkmcnt(13)
    ds_read_b128 a[76:79], v251
    ds_write_b128 v241, v[80:83] offset:16384
    s_waitcnt lgkmcnt(13)
    ds_write_b128 v241, v[84:87] offset:17408
    ds_write_b128 v241, v[88:91] offset:18432
    s_waitcnt lgkmcnt(13)
    s_waitcnt vmcnt(10)
    ds_write_b128 v241, v[92:95] offset:19456
    ds_read_b128 a[80:83], v248
    s_waitcnt lgkmcnt(13)
    ds_read_b128 a[84:87], v249
    ds_read_b128 a[88:91], v250
    s_waitcnt lgkmcnt(13)
    ds_read_b128 a[92:95], v251
    v_add_u32 v248, 16384, v248
    v_add_u32 v249, 16384, v249
    v_add_u32 v250, 16384, v250
    v_add_u32 v251, 16384, v251
    s_waitcnt lgkmcnt(0)
    v_add_u32 v248, 32768, v248
    v_add_u32 v249, 32768, v249
    v_add_u32 v250, 32768, v250
    v_add_u32 v251, 32768, v251
    ds_read_b128 a[248:251], v248
    ds_read_b128 a[252:255], v249
    v_mfma_f32_32x32x16_bf16 v[16:31], a[96:99], a[32:35], 0
    s_add_u32 m0, s30, 49152
    s_add_u32 s35, s24, 16384
    buffer_load_dwordx4 v252, s[12:15], s35 offen nt lds
    v_max_f32 v241, v0, v1
    s_waitcnt lgkmcnt(1)
    v_mfma_f32_32x32x16_bf16 v[16:31], a[128:131], a[248:251], v[16:31]
    ds_read_b128 a[248:251], v250
    s_add_u32 s35, s24, 48128
    buffer_load_dwordx4 v253, s[12:15], s35 offen offset:1024 nt lds
    v_max3_f32 v241, v2, v3, v241
    v_max3_f32 v241, v4, v5, v241
    v_mfma_f32_32x32x16_bf16 v[16:31], a[100:103], a[36:39], v[16:31]
    s_add_u32 s35, s24, 79872
    buffer_load_dwordx4 v252, s[12:15], s35 offen offset:2048 nt lds
    v_max3_f32 v241, v6, v7, v241
    v_max3_f32 v241, v8, v9, v241
    s_waitcnt lgkmcnt(1)
    v_mfma_f32_32x32x16_bf16 v[16:31], a[132:135], a[252:255], v[16:31]
    ds_read_b128 a[252:255], v251
    s_add_u32 s35, s24, 111616
    buffer_load_dwordx4 v253, s[12:15], s35 offen offset:3072 nt lds
    v_max3_f32 v241, v10, v11, v241
    v_max3_f32 v241, v12, v13, v241
    v_mfma_f32_32x32x16_bf16 v[16:31], a[104:107], a[40:43], v[16:31]
    v_max3_f32 v241, v14, v15, v241
    v_mul_f32 v238, s32, v241
    v_ceil_f32 v238, v238
    v_fma_f32 v0, v0, s32, -v238
    s_waitcnt lgkmcnt(1)
    v_mfma_f32_32x32x16_bf16 v[16:31], a[136:139], a[248:251], v[16:31]
    ds_read_b128 a[248:251], v248 offset:49152
    v_fma_f32 v1, v1, s32, -v238
    v_fma_f32 v2, v2, s32, -v238
    v_fma_f32 v3, v3, s32, -v238
    v_fma_f32 v4, v4, s32, -v238
    v_mfma_f32_32x32x16_bf16 v[16:31], a[108:111], a[44:47], v[16:31]
    v_fma_f32 v5, v5, s32, -v238
    v_exp_f32 v0, v0
    v_fma_f32 v6, v6, s32, -v238
    v_exp_f32 v1, v1
    s_waitcnt lgkmcnt(1)
    v_mfma_f32_32x32x16_bf16 v[16:31], a[140:143], a[252:255], v[16:31]
    ds_read_b128 a[252:255], v249 offset:49152
    v_fma_f32 v7, v7, s32, -v238
    v_exp_f32 v2, v2
    v_fma_f32 v8, v8, s32, -v238
    v_exp_f32 v3, v3
    v_mfma_f32_32x32x16_bf16 v[16:31], a[112:115], a[48:51], v[16:31]
    v_fma_f32 v9, v9, s32, -v238
    v_cvt_pk_bf16_f32 v0, v0, v1
    v_accvgpr_write_b32 a160, v0
    v_exp_f32 v4, v4
    s_waitcnt lgkmcnt(1)
    v_mfma_f32_32x32x16_bf16 v[16:31], a[144:147], a[248:251], v[16:31]
    ds_read_b128 a[248:251], v250 offset:49152
    v_fma_f32 v10, v10, s32, -v238
    v_exp_f32 v5, v5
    v_fma_f32 v11, v11, s32, -v238
    v_cvt_pk_bf16_f32 v2, v2, v3
    v_mfma_f32_32x32x16_bf16 v[16:31], a[116:119], a[52:55], v[16:31]
    v_accvgpr_write_b32 a161, v2
    v_exp_f32 v6, v6
    v_fma_f32 v12, v12, s32, -v238
    s_waitcnt lgkmcnt(1)
    v_mfma_f32_32x32x16_bf16 v[16:31], a[148:151], a[252:255], v[16:31]
    ds_read_b128 a[252:255], v251 offset:49152
    v_exp_f32 v7, v7
    v_fma_f32 v13, v13, s32, -v238
    v_cvt_pk_bf16_f32 v4, v4, v5
    v_accvgpr_write_b32 a162, v4
    v_mfma_f32_32x32x16_bf16 v[16:31], a[120:123], a[56:59], v[16:31]
    v_exp_f32 v8, v8
    v_fma_f32 v14, v14, s32, -v238
    v_exp_f32 v9, v9
    s_waitcnt lgkmcnt(1)
    v_mfma_f32_32x32x16_bf16 v[16:31], a[152:155], a[248:251], v[16:31]
    s_waitcnt vmcnt(13)
    ds_read_b128 a[248:251], v248 offset:32768
    v_fma_f32 v15, v15, s32, -v238
    v_cvt_pk_bf16_f32 v6, v6, v7
    v_accvgpr_write_b32 a163, v6
    v_mfma_f32_32x32x16_bf16 v[16:31], a[124:127], a[60:63], v[16:31]
    s_waitcnt vmcnt(8)
    s_barrier
    s_add_u32 m0, s30, 0
    s_add_u32 s35, s24, 135168
    buffer_load_dwordx4 v252, s[12:15], s35 offen nt lds
    v_exp_f32 v10, v10
    v_exp_f32 v11, v11
    s_waitcnt lgkmcnt(1)
    v_mfma_f32_32x32x16_bf16 v[16:31], a[156:159], a[252:255], v[16:31]
    ds_read_b128 a[252:255], v249 offset:32768
    s_add_u32 s35, s24, 166912
    buffer_load_dwordx4 v253, s[12:15], s35 offen offset:1024 nt lds
    v_cvt_pk_bf16_f32 v8, v8, v9
    v_accvgpr_write_b32 a164, v8
    v_exp_f32 v12, v12
    v_exp_f32 v13, v13
    v_cvt_pk_bf16_f32 v10, v10, v11
    v_accvgpr_write_b32 a165, v10
    v_exp_f32 v14, v14
    v_exp_f32 v15, v15
    v_mfma_f32_4x4x4_16b_bf16 v[232:235], v[236:237], a[160:161], 0 cbsz:4 abid:0
    v_cvt_pk_bf16_f32 v12, v12, v13
    v_accvgpr_write_b32 a166, v12
    v_mfma_f32_4x4x4_16b_bf16 v[232:235], v[236:237], a[162:163], v[232:235] cbsz:4 abid:0
    v_cvt_pk_bf16_f32 v14, v14, v15
    v_accvgpr_write_b32 a167, v14
    v_mfma_f32_4x4x4_16b_bf16 v[232:235], v[236:237], a[164:165], v[232:235] cbsz:4 abid:0
    v_mfma_f32_32x32x16_bf16 v[0:15], a[96:99], a[64:67], 0
    ds_read_b128 a[96:99], v244 offset:16384
    s_add_u32 s35, s24, 18432
    buffer_load_dwordx4 v252, s[12:15], s35 offen offset:2048 nt lds
    v_max_f32 v242, v16, v17
    s_waitcnt lgkmcnt(2)
    v_mfma_f32_32x32x16_bf16 v[0:15], a[128:131], a[248:251], v[0:15]
    ds_read_b128 a[248:251], v250 offset:32768
    ds_read_b128 a[128:131], v244 offset:24576
    s_add_u32 s35, s24, 50176
    buffer_load_dwordx4 v253, s[12:15], s35 offen offset:3072 nt lds
    v_max3_f32 v242, v18, v19, v242
    v_mfma_f32_32x32x16_bf16 v[0:15], a[100:103], a[68:71], v[0:15]
    ds_read_b128 a[100:103], v245 offset:16384
    v_max3_f32 v242, v20, v21, v242
    v_max3_f32 v242, v22, v23, v242
    v_max3_f32 v242, v24, v25, v242
    s_waitcnt lgkmcnt(4)
    v_mfma_f32_32x32x16_bf16 v[0:15], a[132:135], a[252:255], v[0:15]
    ds_read_b128 a[252:255], v251 offset:32768
    ds_read_b128 a[132:135], v245 offset:24576
    v_max3_f32 v242, v26, v27, v242
    v_max3_f32 v242, v28, v29, v242
    v_max3_f32 v242, v30, v31, v242
    v_mfma_f32_32x32x16_bf16 v[0:15], a[104:107], a[72:75], v[0:15]
    ds_read_b128 a[104:107], v246 offset:16384
    v_mul_f32 v239, s32, v242
    v_ceil_f32 v239, v239
    v_fma_f32 v16, v16, s32, -v239
    v_fma_f32 v17, v17, s32, -v239
    s_waitcnt lgkmcnt(5)
    v_mfma_f32_32x32x16_bf16 v[0:15], a[136:139], a[248:251], v[0:15]
    ds_read_b128 a[248:251], v248 offset:16384
    ds_read_b128 a[136:139], v246 offset:24576
    v_fma_f32 v18, v18, s32, -v239
    v_fma_f32 v19, v19, s32, -v239
    v_fma_f32 v20, v20, s32, -v239
    v_mfma_f32_32x32x16_bf16 v[0:15], a[108:111], a[76:79], v[0:15]
    ds_read_b128 a[108:111], v247 offset:16384
    v_fma_f32 v21, v21, s32, -v239
    v_exp_f32 v16, v16
    v_fma_f32 v22, v22, s32, -v239
    s_waitcnt lgkmcnt(5)
    v_mfma_f32_32x32x16_bf16 v[0:15], a[140:143], a[252:255], v[0:15]
    ds_read_b128 a[252:255], v249 offset:16384
    ds_read_b128 a[140:143], v247 offset:24576
    v_exp_f32 v17, v17
    v_fma_f32 v23, v23, s32, -v239
    v_exp_f32 v18, v18
    v_mfma_f32_32x32x16_bf16 v[0:15], a[112:115], a[80:83], v[0:15]
    ds_read_b128 a[112:115], v244 offset:20480
    v_fma_f32 v24, v24, s32, -v239
    v_exp_f32 v19, v19
    v_fma_f32 v25, v25, s32, -v239
    s_waitcnt lgkmcnt(5)
    v_mfma_f32_32x32x16_bf16 v[0:15], a[144:147], a[248:251], v[0:15]
    ds_read_b128 a[248:251], v250 offset:16384
    ds_read_b128 a[144:147], v244 offset:28672
    v_cvt_pk_bf16_f32 v32, v16, v17
    v_exp_f32 v20, v20
    v_fma_f32 v26, v26, s32, -v239
    v_mfma_f32_32x32x16_bf16 v[0:15], a[116:119], a[84:87], v[0:15]
    ds_read_b128 a[116:119], v245 offset:20480
    v_exp_f32 v21, v21
    v_fma_f32 v27, v27, s32, -v239
    v_cvt_pk_bf16_f32 v33, v18, v19
    s_waitcnt lgkmcnt(5)
    v_mfma_f32_32x32x16_bf16 v[0:15], a[148:151], a[252:255], v[0:15]
    ds_read_b128 a[252:255], v251 offset:16384
    ds_read_b128 a[148:151], v245 offset:28672
    v_exp_f32 v22, v22
    v_fma_f32 v28, v28, s32, -v239
    v_exp_f32 v23, v23
    v_mfma_f32_32x32x16_bf16 v[0:15], a[120:123], a[88:91], v[0:15]
    ds_read_b128 a[120:123], v246 offset:20480
    v_fma_f32 v29, v29, s32, -v239
    v_cvt_pk_bf16_f32 v34, v20, v21
    v_exp_f32 v24, v24
    s_waitcnt lgkmcnt(5)
    v_mfma_f32_32x32x16_bf16 v[0:15], a[152:155], a[248:251], v[0:15]
    v_subrev_u32 v248, 32768, v248
    v_subrev_u32 v249, 32768, v249
    v_subrev_u32 v250, 32768, v250
    v_subrev_u32 v251, 32768, v251
    ds_read_b128 a[248:251], v248
    ds_read_b128 a[152:155], v246 offset:28672
    v_fma_f32 v30, v30, s32, -v239
    v_mfma_f32_32x32x16_bf16 v[0:15], a[124:127], a[92:95], v[0:15]
    ds_read_b128 a[124:127], v247 offset:20480
    v_exp_f32 v25, v25
    v_fma_f32 v31, v31, s32, -v239
    v_cvt_pk_bf16_f32 v35, v22, v23
    v_exp_f32 v26, v26
    s_waitcnt lgkmcnt(5)
    v_mfma_f32_32x32x16_bf16 v[0:15], a[156:159], a[252:255], v[0:15]
    ds_read_b128 a[252:255], v249
    ds_read_b128 a[156:159], v247 offset:28672
    v_exp_f32 v27, v27
    v_cvt_pk_bf16_f32 v36, v24, v25
    v_exp_f32 v28, v28
    v_mfma_f32_4x4x4_16b_bf16 v[232:235], v[236:237], a[166:167], v[232:235] cbsz:4 abid:0
    v_exp_f32 v29, v29
    v_cvt_pk_bf16_f32 v37, v26, v27
    v_mfma_f32_4x4x4_16b_bf16 v[232:235], v[236:237], v[32:33], v[232:235] cbsz:4 abid:1
    v_exp_f32 v30, v30
    v_exp_f32 v31, v31
    v_mfma_f32_4x4x4_16b_bf16 v[232:235], v[236:237], v[34:35], v[232:235] cbsz:4 abid:1
    v_cvt_pk_bf16_f32 v38, v28, v29
    v_cvt_pk_bf16_f32 v39, v30, v31
    v_mfma_f32_4x4x4_16b_bf16 v[232:235], v[236:237], v[36:37], v[232:235] cbsz:4 abid:1
    v_mfma_f32_32x32x16_bf16 v[16:31], a[96:99], a[0:3], 0
    s_waitcnt lgkmcnt(0)
    s_waitcnt vmcnt(8)
    s_barrier
    s_add_u32 m0, s30, 16384
    s_add_u32 s35, s24, 139264
    buffer_load_dwordx4 v252, s[12:15], s35 offen nt lds
    v_mfma_f32_32x32x16_bf16 v[16:31], a[128:131], a[248:251], v[16:31]
    ds_read_b128 a[248:251], v250
    s_add_u32 s35, s24, 171008
    buffer_load_dwordx4 v253, s[12:15], s35 offen offset:1024 nt lds
    v_max_f32 v243, v0, v1
    v_max3_f32 v243, v2, v3, v243
    v_mfma_f32_32x32x16_bf16 v[16:31], a[100:103], a[4:7], v[16:31]
    s_add_u32 s35, s24, 22528
    buffer_load_dwordx4 v252, s[12:15], s35 offen offset:2048 nt lds
    v_max3_f32 v243, v4, v5, v243
    v_max3_f32 v243, v6, v7, v243
    v_mfma_f32_32x32x16_bf16 v[16:31], a[132:135], a[252:255], v[16:31]
    ds_read_b128 a[252:255], v251
    s_add_u32 s35, s24, 54272
    buffer_load_dwordx4 v253, s[12:15], s35 offen offset:3072 nt lds
    v_max3_f32 v243, v8, v9, v243
    v_max3_f32 v243, v10, v11, v243
    v_mfma_f32_32x32x16_bf16 v[16:31], a[104:107], a[8:11], v[16:31]
    v_max3_f32 v243, v12, v13, v243
    v_max3_f32 v243, v14, v15, v243
    v_mul_f32 v240, s32, v243
    v_ceil_f32 v240, v240
    s_waitcnt lgkmcnt(1)
    v_mfma_f32_32x32x16_bf16 v[16:31], a[136:139], a[248:251], v[16:31]
    ds_read_b128 a[248:251], v248 offset:16384
    v_fma_f32 v0, v0, s32, -v240
    v_fma_f32 v1, v1, s32, -v240
    v_fma_f32 v2, v2, s32, -v240
    v_fma_f32 v3, v3, s32, -v240
    v_mfma_f32_32x32x16_bf16 v[16:31], a[108:111], a[12:15], v[16:31]
    v_fma_f32 v4, v4, s32, -v240
    v_fma_f32 v5, v5, s32, -v240
    v_exp_f32 v0, v0
    s_waitcnt lgkmcnt(1)
    v_mfma_f32_32x32x16_bf16 v[16:31], a[140:143], a[252:255], v[16:31]
    ds_read_b128 a[252:255], v249 offset:16384
    v_fma_f32 v6, v6, s32, -v240
    v_exp_f32 v1, v1
    v_fma_f32 v7, v7, s32, -v240
    v_mfma_f32_32x32x16_bf16 v[16:31], a[112:115], a[16:19], v[16:31]
    v_exp_f32 v2, v2
    v_fma_f32 v8, v8, s32, -v240
    v_exp_f32 v3, v3
    s_waitcnt lgkmcnt(1)
    v_mfma_f32_32x32x16_bf16 v[16:31], a[144:147], a[248:251], v[16:31]
    ds_read_b128 a[248:251], v250 offset:16384
    v_fma_f32 v9, v9, s32, -v240
    v_cvt_pk_bf16_f32 v40, v0, v1
    v_exp_f32 v4, v4
    v_mfma_f32_32x32x16_bf16 v[16:31], a[116:119], a[20:23], v[16:31]
    v_fma_f32 v10, v10, s32, -v240
    v_exp_f32 v5, v5
    v_fma_f32 v11, v11, s32, -v240
    s_waitcnt lgkmcnt(1)
    v_mfma_f32_32x32x16_bf16 v[16:31], a[148:151], a[252:255], v[16:31]
    ds_read_b128 a[252:255], v251 offset:16384
    v_cvt_pk_bf16_f32 v41, v2, v3
    v_exp_f32 v6, v6
    v_fma_f32 v12, v12, s32, -v240
    v_mfma_f32_32x32x16_bf16 v[16:31], a[120:123], a[24:27], v[16:31]
    v_exp_f32 v7, v7
    v_fma_f32 v13, v13, s32, -v240
    v_cvt_pk_bf16_f32 v42, v4, v5
    s_waitcnt lgkmcnt(1)
    v_mfma_f32_32x32x16_bf16 v[16:31], a[152:155], a[248:251], v[16:31]
    v_add_u32 v248, 32768, v248
    v_add_u32 v249, 32768, v249
    v_add_u32 v250, 32768, v250
    v_add_u32 v251, 32768, v251
    ds_read_b128 a[248:251], v248
    v_exp_f32 v8, v8
    v_mfma_f32_32x32x16_bf16 v[16:31], a[124:127], a[28:31], v[16:31]
    v_fma_f32 v14, v14, s32, -v240
    v_exp_f32 v9, v9
    v_fma_f32 v15, v15, s32, -v240
    v_cvt_pk_bf16_f32 v43, v6, v7
    s_waitcnt lgkmcnt(1)
    v_mfma_f32_32x32x16_bf16 v[16:31], a[156:159], a[252:255], v[16:31]
    ds_read_b128 a[252:255], v249
    v_exp_f32 v10, v10
    v_exp_f32 v11, v11
    v_cvt_pk_bf16_f32 v44, v8, v9
    v_exp_f32 v12, v12
    v_mfma_f32_4x4x4_16b_bf16 v[232:235], v[236:237], v[38:39], v[232:235] cbsz:4 abid:1
    v_exp_f32 v13, v13
    v_cvt_pk_bf16_f32 v45, v10, v11
    v_mfma_f32_4x4x4_16b_bf16 v[232:235], v[236:237], v[40:41], v[232:235] cbsz:4 abid:2
    v_exp_f32 v14, v14
    v_exp_f32 v15, v15
    v_mfma_f32_4x4x4_16b_bf16 v[232:235], v[236:237], v[42:43], v[232:235] cbsz:4 abid:2
    v_cvt_pk_bf16_f32 v46, v12, v13
    v_cvt_pk_bf16_f32 v47, v14, v15
    v_mfma_f32_4x4x4_16b_bf16 v[232:235], v[236:237], v[44:45], v[232:235] cbsz:4 abid:2
    v_mfma_f32_32x32x16_bf16 v[0:15], a[96:99], a[32:35], 0
    v_max3_f32 v241, v16, v17, v241
    v_max3_f32 v241, v18, v19, v241
    v_max3_f32 v241, v20, v21, v241
    v_max3_f32 v241, v22, v23, v241
    s_waitcnt lgkmcnt(1)
    v_mfma_f32_32x32x16_bf16 v[0:15], a[128:131], a[248:251], v[0:15]
    ds_read_b128 a[248:251], v250
    v_max3_f32 v241, v24, v25, v241
    v_max3_f32 v241, v26, v27, v241
    v_max3_f32 v241, v28, v29, v241
    v_max3_f32 v241, v30, v31, v241
    v_mfma_f32_32x32x16_bf16 v[0:15], a[100:103], a[36:39], v[0:15]
    v_fma_f32 v254, v241, s32, -v238
    v_cmp_lt_f32 vcc, s33, v254
    v_fma_f32 v16, v16, s32, -v238
    v_fma_f32 v17, v17, s32, -v238
    s_waitcnt lgkmcnt(1)
    v_mfma_f32_32x32x16_bf16 v[0:15], a[132:135], a[252:255], v[0:15]
    ds_read_b128 a[252:255], v251
    v_fma_f32 v18, v18, s32, -v238
    v_fma_f32 v19, v19, s32, -v238
    v_fma_f32 v20, v20, s32, -v238
    v_fma_f32 v21, v21, s32, -v238
    v_mfma_f32_32x32x16_bf16 v[0:15], a[104:107], a[40:43], v[0:15]
    s_cbranch_vccnz L_stub_0_0_1
L_back_0_0_1:
    v_exp_f32 v16, v16
    v_fma_f32 v22, v22, s32, -v238
    v_exp_f32 v17, v17
    s_waitcnt lgkmcnt(1)
    v_mfma_f32_32x32x16_bf16 v[0:15], a[136:139], a[248:251], v[0:15]
    ds_read_b128 a[248:251], v248 offset:49152
    v_fma_f32 v23, v23, s32, -v238
    v_exp_f32 v18, v18
    v_fma_f32 v24, v24, s32, -v238
    v_mfma_f32_32x32x16_bf16 v[0:15], a[108:111], a[44:47], v[0:15]
    v_exp_f32 v19, v19
    v_fma_f32 v25, v25, s32, -v238
    v_cvt_pk_bf16_f32 v16, v16, v17
    s_waitcnt lgkmcnt(1)
    v_mfma_f32_32x32x16_bf16 v[0:15], a[140:143], a[252:255], v[0:15]
    ds_read_b128 a[252:255], v249 offset:49152
    v_accvgpr_write_b32 a168, v16
    v_exp_f32 v20, v20
    v_fma_f32 v26, v26, s32, -v238
    v_mfma_f32_32x32x16_bf16 v[0:15], a[112:115], a[48:51], v[0:15]
    v_exp_f32 v21, v21
    v_fma_f32 v27, v27, s32, -v238
    v_cvt_pk_bf16_f32 v18, v18, v19
    s_waitcnt lgkmcnt(1)
    v_mfma_f32_32x32x16_bf16 v[0:15], a[144:147], a[248:251], v[0:15]
    ds_read_b128 a[248:251], v250 offset:49152
    v_accvgpr_write_b32 a169, v18
    v_exp_f32 v22, v22
    v_fma_f32 v28, v28, s32, -v238
    v_mfma_f32_32x32x16_bf16 v[0:15], a[116:119], a[52:55], v[0:15]
    v_exp_f32 v23, v23
    v_fma_f32 v29, v29, s32, -v238
    v_cvt_pk_bf16_f32 v20, v20, v21
    s_waitcnt lgkmcnt(1)
    v_mfma_f32_32x32x16_bf16 v[0:15], a[148:151], a[252:255], v[0:15]
    ds_read_b128 a[252:255], v251 offset:49152
    v_accvgpr_write_b32 a170, v20
    v_exp_f32 v24, v24
    v_fma_f32 v30, v30, s32, -v238
    v_mfma_f32_32x32x16_bf16 v[0:15], a[120:123], a[56:59], v[0:15]
    v_exp_f32 v25, v25
    v_fma_f32 v31, v31, s32, -v238
    v_cvt_pk_bf16_f32 v22, v22, v23
    s_waitcnt lgkmcnt(1)
    v_mfma_f32_32x32x16_bf16 v[0:15], a[152:155], a[248:251], v[0:15]
    ds_read_b128 a[248:251], v248 offset:32768
    v_accvgpr_write_b32 a171, v22
    v_exp_f32 v26, v26
    v_exp_f32 v27, v27
    v_mfma_f32_32x32x16_bf16 v[0:15], a[124:127], a[60:63], v[0:15]
    v_cvt_pk_bf16_f32 v24, v24, v25
    v_accvgpr_write_b32 a172, v24
    v_exp_f32 v28, v28
    s_waitcnt lgkmcnt(1)
    v_mfma_f32_32x32x16_bf16 v[0:15], a[156:159], a[252:255], v[0:15]
    ds_read_b128 a[252:255], v249 offset:32768
    v_exp_f32 v29, v29
    v_cvt_pk_bf16_f32 v26, v26, v27
    v_accvgpr_write_b32 a173, v26
    v_mfma_f32_4x4x4_16b_bf16 v[232:235], v[236:237], v[46:47], v[232:235] cbsz:4 abid:2
    v_exp_f32 v30, v30
    v_exp_f32 v31, v31
    v_mfma_f32_4x4x4_16b_bf16 v[232:235], v[236:237], a[168:169], v[232:235] cbsz:4 abid:0
    v_cvt_pk_bf16_f32 v28, v28, v29
    v_accvgpr_write_b32 a174, v28
    v_mfma_f32_4x4x4_16b_bf16 v[232:235], v[236:237], a[170:171], v[232:235] cbsz:4 abid:0
    v_cvt_pk_bf16_f32 v30, v30, v31
    v_accvgpr_write_b32 a175, v30
    v_mfma_f32_4x4x4_16b_bf16 v[232:235], v[236:237], a[172:173], v[232:235] cbsz:4 abid:0
    v_mfma_f32_32x32x16_bf16 v[16:31], a[96:99], a[64:67], 0
    ds_read_b128 a[96:99], v244 offset:32768
    v_max3_f32 v242, v0, v1, v242
    v_max3_f32 v242, v2, v3, v242
    v_max3_f32 v242, v4, v5, v242
    s_waitcnt lgkmcnt(2)
    v_mfma_f32_32x32x16_bf16 v[16:31], a[128:131], a[248:251], v[16:31]
    ds_read_b128 a[248:251], v250 offset:32768
    ds_read_b128 a[128:131], v244 offset:40960
    v_max3_f32 v242, v6, v7, v242
    v_max3_f32 v242, v8, v9, v242
    v_max3_f32 v242, v10, v11, v242
    v_mfma_f32_32x32x16_bf16 v[16:31], a[100:103], a[68:71], v[16:31]
    ds_read_b128 a[100:103], v245 offset:32768
    v_max3_f32 v242, v12, v13, v242
    v_max3_f32 v242, v14, v15, v242
    v_fma_f32 v254, v242, s32, -v239
    v_cmp_lt_f32 vcc, s33, v254
    s_waitcnt lgkmcnt(4)
    v_mfma_f32_32x32x16_bf16 v[16:31], a[132:135], a[252:255], v[16:31]
    ds_read_b128 a[252:255], v251 offset:32768
    ds_read_b128 a[132:135], v245 offset:40960
    v_fma_f32 v0, v0, s32, -v239
    v_fma_f32 v1, v1, s32, -v239
    v_fma_f32 v2, v2, s32, -v239
    v_mfma_f32_32x32x16_bf16 v[16:31], a[104:107], a[72:75], v[16:31]
    ds_read_b128 a[104:107], v246 offset:32768
    v_fma_f32 v3, v3, s32, -v239
    v_fma_f32 v4, v4, s32, -v239
    v_fma_f32 v5, v5, s32, -v239
    s_waitcnt lgkmcnt(5)
    v_mfma_f32_32x32x16_bf16 v[16:31], a[136:139], a[248:251], v[16:31]
    ds_read_b128 a[248:251], v248 offset:16384
    ds_read_b128 a[136:139], v246 offset:40960
    s_cbranch_vccnz L_stub_0_1_1
L_back_0_1_1:
    v_exp_f32 v0, v0
    v_fma_f32 v6, v6, s32, -v239
    v_mfma_f32_32x32x16_bf16 v[16:31], a[108:111], a[76:79], v[16:31]
    ds_read_b128 a[108:111], v247 offset:32768
    v_exp_f32 v1, v1
    v_fma_f32 v7, v7, s32, -v239
    v_exp_f32 v2, v2
    s_waitcnt lgkmcnt(5)
    v_mfma_f32_32x32x16_bf16 v[16:31], a[140:143], a[252:255], v[16:31]
    ds_read_b128 a[252:255], v249 offset:16384
    ds_read_b128 a[140:143], v247 offset:40960
    v_fma_f32 v8, v8, s32, -v239
    v_exp_f32 v3, v3
    v_mfma_f32_32x32x16_bf16 v[16:31], a[112:115], a[80:83], v[16:31]
    ds_read_b128 a[112:115], v244 offset:36864
    v_fma_f32 v9, v9, s32, -v239
    v_cvt_pk_bf16_f32 v48, v0, v1
    v_exp_f32 v4, v4
    s_waitcnt lgkmcnt(5)
    v_mfma_f32_32x32x16_bf16 v[16:31], a[144:147], a[248:251], v[16:31]
    ds_read_b128 a[248:251], v250 offset:16384
    ds_read_b128 a[144:147], v244 offset:45056
    v_fma_f32 v10, v10, s32, -v239
    v_exp_f32 v5, v5
    v_fma_f32 v11, v11, s32, -v239
    v_mfma_f32_32x32x16_bf16 v[16:31], a[116:119], a[84:87], v[16:31]
    ds_read_b128 a[116:119], v245 offset:36864
    v_cvt_pk_bf16_f32 v49, v2, v3
    v_exp_f32 v6, v6
    v_fma_f32 v12, v12, s32, -v239
    s_waitcnt lgkmcnt(5)
    v_mfma_f32_32x32x16_bf16 v[16:31], a[148:151], a[252:255], v[16:31]
    ds_read_b128 a[252:255], v251 offset:16384
    ds_read_b128 a[148:151], v245 offset:45056
    v_exp_f32 v7, v7
    v_fma_f32 v13, v13, s32, -v239
    v_mfma_f32_32x32x16_bf16 v[16:31], a[120:123], a[88:91], v[16:31]
    ds_read_b128 a[120:123], v246 offset:36864
    v_cvt_pk_bf16_f32 v50, v4, v5
    v_exp_f32 v8, v8
    v_fma_f32 v14, v14, s32, -v239
    s_waitcnt lgkmcnt(5)
    v_mfma_f32_32x32x16_bf16 v[16:31], a[152:155], a[248:251], v[16:31]
    v_subrev_u32 v248, 32768, v248
    v_subrev_u32 v249, 32768, v249
    v_subrev_u32 v250, 32768, v250
    v_subrev_u32 v251, 32768, v251
    ds_read_b128 a[248:251], v248
    ds_read_b128 a[152:155], v246 offset:45056
    v_mfma_f32_32x32x16_bf16 v[16:31], a[124:127], a[92:95], v[16:31]
    ds_read_b128 a[124:127], v247 offset:36864
    v_exp_f32 v9, v9
    v_fma_f32 v15, v15, s32, -v239
    v_cvt_pk_bf16_f32 v51, v6, v7
    v_exp_f32 v10, v10
    s_waitcnt lgkmcnt(5)
    v_mfma_f32_32x32x16_bf16 v[16:31], a[156:159], a[252:255], v[16:31]
    ds_read_b128 a[252:255], v249
    ds_read_b128 a[156:159], v247 offset:45056
    v_exp_f32 v11, v11
    v_cvt_pk_bf16_f32 v52, v8, v9
    v_exp_f32 v12, v12
    v_mfma_f32_4x4x4_16b_bf16 v[232:235], v[236:237], a[174:175], v[232:235] cbsz:4 abid:0
    v_exp_f32 v13, v13
    v_cvt_pk_bf16_f32 v53, v10, v11
    v_mfma_f32_4x4x4_16b_bf16 v[232:235], v[236:237], v[48:49], v[232:235] cbsz:4 abid:1
    v_exp_f32 v14, v14
    v_exp_f32 v15, v15
    v_mfma_f32_4x4x4_16b_bf16 v[232:235], v[236:237], v[50:51], v[232:235] cbsz:4 abid:1
    v_cvt_pk_bf16_f32 v54, v12, v13
    v_cvt_pk_bf16_f32 v55, v14, v15
    v_mfma_f32_4x4x4_16b_bf16 v[232:235], v[236:237], v[52:53], v[232:235] cbsz:4 abid:1
    v_mfma_f32_32x32x16_bf16 v[0:15], a[96:99], a[0:3], 0
    s_waitcnt lgkmcnt(0)
    s_waitcnt vmcnt(8)
    s_barrier
    s_add_u32 m0, s30, 32768
    s_add_u32 s35, s24, 143360
    buffer_load_dwordx4 v252, s[12:15], s35 offen nt lds
    v_mfma_f32_32x32x16_bf16 v[0:15], a[128:131], a[248:251], v[0:15]
    ds_read_b128 a[248:251], v250
    s_add_u32 s35, s24, 175104
    buffer_load_dwordx4 v253, s[12:15], s35 offen offset:1024 nt lds
    v_max3_f32 v243, v16, v17, v243
    v_max3_f32 v243, v18, v19, v243
    v_mfma_f32_32x32x16_bf16 v[0:15], a[100:103], a[4:7], v[0:15]
    s_add_u32 s35, s24, 26624
    buffer_load_dwordx4 v252, s[12:15], s35 offen offset:2048 nt lds
    v_max3_f32 v243, v20, v21, v243
    v_max3_f32 v243, v22, v23, v243
    v_mfma_f32_32x32x16_bf16 v[0:15], a[132:135], a[252:255], v[0:15]
    ds_read_b128 a[252:255], v251
    s_add_u32 s35, s24, 58368
    buffer_load_dwordx4 v253, s[12:15], s35 offen offset:3072 nt lds
    v_max3_f32 v243, v24, v25, v243
    v_max3_f32 v243, v26, v27, v243
    v_mfma_f32_32x32x16_bf16 v[0:15], a[104:107], a[8:11], v[0:15]
    v_max3_f32 v243, v28, v29, v243
    v_max3_f32 v243, v30, v31, v243
    v_fma_f32 v254, v243, s32, -v240
    v_cmp_lt_f32 vcc, s33, v254
    s_waitcnt lgkmcnt(1)
    v_mfma_f32_32x32x16_bf16 v[0:15], a[136:139], a[248:251], v[0:15]
    ds_read_b128 a[248:251], v248 offset:16384
    v_fma_f32 v16, v16, s32, -v240
    v_fma_f32 v17, v17, s32, -v240
    v_fma_f32 v18, v18, s32, -v240
    v_fma_f32 v19, v19, s32, -v240
    v_mfma_f32_32x32x16_bf16 v[0:15], a[108:111], a[12:15], v[0:15]
    v_fma_f32 v20, v20, s32, -v240
    v_fma_f32 v21, v21, s32, -v240
    s_cbranch_vccnz L_stub_0_2_1
L_back_0_2_1:
    v_exp_f32 v16, v16
    s_waitcnt lgkmcnt(1)
    v_mfma_f32_32x32x16_bf16 v[0:15], a[140:143], a[252:255], v[0:15]
    ds_read_b128 a[252:255], v249 offset:16384
    v_fma_f32 v22, v22, s32, -v240
    v_exp_f32 v17, v17
    v_fma_f32 v23, v23, s32, -v240
    v_mfma_f32_32x32x16_bf16 v[0:15], a[112:115], a[16:19], v[0:15]
    v_exp_f32 v18, v18
    v_fma_f32 v24, v24, s32, -v240
    v_exp_f32 v19, v19
    s_waitcnt lgkmcnt(1)
    v_mfma_f32_32x32x16_bf16 v[0:15], a[144:147], a[248:251], v[0:15]
    ds_read_b128 a[248:251], v250 offset:16384
    v_fma_f32 v25, v25, s32, -v240
    v_cvt_pk_bf16_f32 v56, v16, v17
    v_exp_f32 v20, v20
    v_mfma_f32_32x32x16_bf16 v[0:15], a[116:119], a[20:23], v[0:15]
    v_fma_f32 v26, v26, s32, -v240
    v_exp_f32 v21, v21
    v_fma_f32 v27, v27, s32, -v240
    s_waitcnt lgkmcnt(1)
    v_mfma_f32_32x32x16_bf16 v[0:15], a[148:151], a[252:255], v[0:15]
    ds_read_b128 a[252:255], v251 offset:16384
    v_cvt_pk_bf16_f32 v57, v18, v19
    v_exp_f32 v22, v22
    v_fma_f32 v28, v28, s32, -v240
    v_mfma_f32_32x32x16_bf16 v[0:15], a[120:123], a[24:27], v[0:15]
    v_exp_f32 v23, v23
    v_fma_f32 v29, v29, s32, -v240
    v_cvt_pk_bf16_f32 v58, v20, v21
    s_waitcnt lgkmcnt(1)
    v_mfma_f32_32x32x16_bf16 v[0:15], a[152:155], a[248:251], v[0:15]
    v_add_u32 v248, 32768, v248
    v_add_u32 v249, 32768, v249
    v_add_u32 v250, 32768, v250
    v_add_u32 v251, 32768, v251
    ds_read_b128 a[248:251], v248
    v_exp_f32 v24, v24
    v_mfma_f32_32x32x16_bf16 v[0:15], a[124:127], a[28:31], v[0:15]
    v_fma_f32 v30, v30, s32, -v240
    v_exp_f32 v25, v25
    v_fma_f32 v31, v31, s32, -v240
    v_cvt_pk_bf16_f32 v59, v22, v23
    s_waitcnt lgkmcnt(1)
    v_mfma_f32_32x32x16_bf16 v[0:15], a[156:159], a[252:255], v[0:15]
    ds_read_b128 a[252:255], v249
    v_exp_f32 v26, v26
    v_exp_f32 v27, v27
    v_cvt_pk_bf16_f32 v60, v24, v25
    v_exp_f32 v28, v28
    v_mfma_f32_4x4x4_16b_bf16 v[232:235], v[236:237], v[54:55], v[232:235] cbsz:4 abid:1
    v_exp_f32 v29, v29
    v_cvt_pk_bf16_f32 v61, v26, v27
    v_mfma_f32_4x4x4_16b_bf16 v[232:235], v[236:237], v[56:57], v[232:235] cbsz:4 abid:2
    v_exp_f32 v30, v30
    v_exp_f32 v31, v31
    v_mfma_f32_4x4x4_16b_bf16 v[232:235], v[236:237], v[58:59], v[232:235] cbsz:4 abid:2
    v_cvt_pk_bf16_f32 v62, v28, v29
    v_cvt_pk_bf16_f32 v63, v30, v31
    v_mfma_f32_4x4x4_16b_bf16 v[232:235], v[236:237], v[60:61], v[232:235] cbsz:4 abid:2
    v_mfma_f32_32x32x16_bf16 v[16:31], a[96:99], a[32:35], 0
    v_max3_f32 v241, v0, v1, v241
    v_max3_f32 v241, v2, v3, v241
    v_max3_f32 v241, v4, v5, v241
    v_max3_f32 v241, v6, v7, v241
    s_waitcnt lgkmcnt(1)
    v_mfma_f32_32x32x16_bf16 v[16:31], a[128:131], a[248:251], v[16:31]
    ds_read_b128 a[248:251], v250
    v_max3_f32 v241, v8, v9, v241
    v_max3_f32 v241, v10, v11, v241
    v_max3_f32 v241, v12, v13, v241
    v_max3_f32 v241, v14, v15, v241
    v_mfma_f32_32x32x16_bf16 v[16:31], a[100:103], a[36:39], v[16:31]
    v_fma_f32 v254, v241, s32, -v238
    v_cmp_lt_f32 vcc, s33, v254
    v_fma_f32 v0, v0, s32, -v238
    v_fma_f32 v1, v1, s32, -v238
    s_waitcnt lgkmcnt(1)
    v_mfma_f32_32x32x16_bf16 v[16:31], a[132:135], a[252:255], v[16:31]
    ds_read_b128 a[252:255], v251
    v_fma_f32 v2, v2, s32, -v238
    v_fma_f32 v3, v3, s32, -v238
    v_fma_f32 v4, v4, s32, -v238
    v_fma_f32 v5, v5, s32, -v238
    v_mfma_f32_32x32x16_bf16 v[16:31], a[104:107], a[40:43], v[16:31]
    s_cbranch_vccnz L_stub_0_0_2
L_back_0_0_2:
    v_exp_f32 v0, v0
    v_fma_f32 v6, v6, s32, -v238
    v_exp_f32 v1, v1
    s_waitcnt lgkmcnt(1)
    v_mfma_f32_32x32x16_bf16 v[16:31], a[136:139], a[248:251], v[16:31]
    ds_read_b128 a[248:251], v248 offset:49152
    v_fma_f32 v7, v7, s32, -v238
    v_exp_f32 v2, v2
    v_fma_f32 v8, v8, s32, -v238
    v_mfma_f32_32x32x16_bf16 v[16:31], a[108:111], a[44:47], v[16:31]
    v_exp_f32 v3, v3
    v_fma_f32 v9, v9, s32, -v238
    v_cvt_pk_bf16_f32 v0, v0, v1
    s_waitcnt lgkmcnt(1)
    v_mfma_f32_32x32x16_bf16 v[16:31], a[140:143], a[252:255], v[16:31]
    ds_read_b128 a[252:255], v249 offset:49152
    v_accvgpr_write_b32 a176, v0
    v_exp_f32 v4, v4
    v_fma_f32 v10, v10, s32, -v238
    v_mfma_f32_32x32x16_bf16 v[16:31], a[112:115], a[48:51], v[16:31]
    v_exp_f32 v5, v5
    v_fma_f32 v11, v11, s32, -v238
    v_cvt_pk_bf16_f32 v2, v2, v3
    s_waitcnt lgkmcnt(1)
    v_mfma_f32_32x32x16_bf16 v[16:31], a[144:147], a[248:251], v[16:31]
    ds_read_b128 a[248:251], v250 offset:49152
    v_accvgpr_write_b32 a177, v2
    v_exp_f32 v6, v6
    v_fma_f32 v12, v12, s32, -v238
    v_mfma_f32_32x32x16_bf16 v[16:31], a[116:119], a[52:55], v[16:31]
    v_exp_f32 v7, v7
    v_fma_f32 v13, v13, s32, -v238
    v_cvt_pk_bf16_f32 v4, v4, v5
    s_waitcnt lgkmcnt(1)
    v_mfma_f32_32x32x16_bf16 v[16:31], a[148:151], a[252:255], v[16:31]
    ds_read_b128 a[252:255], v251 offset:49152
    v_accvgpr_write_b32 a178, v4
    v_exp_f32 v8, v8
    v_fma_f32 v14, v14, s32, -v238
    v_mfma_f32_32x32x16_bf16 v[16:31], a[120:123], a[56:59], v[16:31]
    v_exp_f32 v9, v9
    v_fma_f32 v15, v15, s32, -v238
    v_cvt_pk_bf16_f32 v6, v6, v7
    s_waitcnt lgkmcnt(1)
    v_mfma_f32_32x32x16_bf16 v[16:31], a[152:155], a[248:251], v[16:31]
    ds_read_b128 a[248:251], v248 offset:32768
    v_accvgpr_write_b32 a179, v6
    v_exp_f32 v10, v10
    v_exp_f32 v11, v11
    v_mfma_f32_32x32x16_bf16 v[16:31], a[124:127], a[60:63], v[16:31]
    v_cvt_pk_bf16_f32 v8, v8, v9
    v_accvgpr_write_b32 a180, v8
    v_exp_f32 v12, v12
    s_waitcnt lgkmcnt(1)
    v_mfma_f32_32x32x16_bf16 v[16:31], a[156:159], a[252:255], v[16:31]
    ds_read_b128 a[252:255], v249 offset:32768
    v_exp_f32 v13, v13
    v_cvt_pk_bf16_f32 v10, v10, v11
    v_accvgpr_write_b32 a181, v10
    v_mfma_f32_4x4x4_16b_bf16 v[232:235], v[236:237], v[62:63], v[232:235] cbsz:4 abid:2
    v_exp_f32 v14, v14
    v_exp_f32 v15, v15
    v_mfma_f32_4x4x4_16b_bf16 v[232:235], v[236:237], a[176:177], v[232:235] cbsz:4 abid:0
    v_cvt_pk_bf16_f32 v12, v12, v13
    v_accvgpr_write_b32 a182, v12
    v_mfma_f32_4x4x4_16b_bf16 v[232:235], v[236:237], a[178:179], v[232:235] cbsz:4 abid:0
    v_cvt_pk_bf16_f32 v14, v14, v15
    v_accvgpr_write_b32 a183, v14
    v_mfma_f32_4x4x4_16b_bf16 v[232:235], v[236:237], a[180:181], v[232:235] cbsz:4 abid:0
    v_mfma_f32_32x32x16_bf16 v[0:15], a[96:99], a[64:67], 0
    ds_read_b128 a[96:99], v244 offset:49152
    v_max3_f32 v242, v16, v17, v242
    v_max3_f32 v242, v18, v19, v242
    v_max3_f32 v242, v20, v21, v242
    s_waitcnt lgkmcnt(2)
    v_mfma_f32_32x32x16_bf16 v[0:15], a[128:131], a[248:251], v[0:15]
    ds_read_b128 a[248:251], v250 offset:32768
    ds_read_b128 a[128:131], v244 offset:57344
    v_max3_f32 v242, v22, v23, v242
    v_max3_f32 v242, v24, v25, v242
    v_max3_f32 v242, v26, v27, v242
    v_mfma_f32_32x32x16_bf16 v[0:15], a[100:103], a[68:71], v[0:15]
    ds_read_b128 a[100:103], v245 offset:49152
    v_max3_f32 v242, v28, v29, v242
    v_max3_f32 v242, v30, v31, v242
    v_fma_f32 v254, v242, s32, -v239
    v_cmp_lt_f32 vcc, s33, v254
    s_waitcnt lgkmcnt(4)
    v_mfma_f32_32x32x16_bf16 v[0:15], a[132:135], a[252:255], v[0:15]
    ds_read_b128 a[252:255], v251 offset:32768
    ds_read_b128 a[132:135], v245 offset:57344
    v_fma_f32 v16, v16, s32, -v239
    v_fma_f32 v17, v17, s32, -v239
    v_fma_f32 v18, v18, s32, -v239
    v_mfma_f32_32x32x16_bf16 v[0:15], a[104:107], a[72:75], v[0:15]
    ds_read_b128 a[104:107], v246 offset:49152
    v_fma_f32 v19, v19, s32, -v239
    v_fma_f32 v20, v20, s32, -v239
    v_fma_f32 v21, v21, s32, -v239
    s_waitcnt lgkmcnt(5)
    v_mfma_f32_32x32x16_bf16 v[0:15], a[136:139], a[248:251], v[0:15]
    ds_read_b128 a[248:251], v248 offset:16384
    ds_read_b128 a[136:139], v246 offset:57344
    s_cbranch_vccnz L_stub_0_1_2
L_back_0_1_2:
    v_exp_f32 v16, v16
    v_fma_f32 v22, v22, s32, -v239
    v_mfma_f32_32x32x16_bf16 v[0:15], a[108:111], a[76:79], v[0:15]
    ds_read_b128 a[108:111], v247 offset:49152
    v_exp_f32 v17, v17
    v_fma_f32 v23, v23, s32, -v239
    v_exp_f32 v18, v18
    s_waitcnt lgkmcnt(5)
    v_mfma_f32_32x32x16_bf16 v[0:15], a[140:143], a[252:255], v[0:15]
    ds_read_b128 a[252:255], v249 offset:16384
    ds_read_b128 a[140:143], v247 offset:57344
    v_fma_f32 v24, v24, s32, -v239
    v_exp_f32 v19, v19
    v_mfma_f32_32x32x16_bf16 v[0:15], a[112:115], a[80:83], v[0:15]
    ds_read_b128 a[112:115], v244 offset:53248
    v_fma_f32 v25, v25, s32, -v239
    v_cvt_pk_bf16_f32 v64, v16, v17
    v_exp_f32 v20, v20
    s_waitcnt lgkmcnt(5)
    v_mfma_f32_32x32x16_bf16 v[0:15], a[144:147], a[248:251], v[0:15]
    ds_read_b128 a[248:251], v250 offset:16384
    ds_read_b128 a[144:147], v244 offset:61440
    v_fma_f32 v26, v26, s32, -v239
    v_exp_f32 v21, v21
    v_fma_f32 v27, v27, s32, -v239
    v_mfma_f32_32x32x16_bf16 v[0:15], a[116:119], a[84:87], v[0:15]
    ds_read_b128 a[116:119], v245 offset:53248
    v_cvt_pk_bf16_f32 v65, v18, v19
    v_exp_f32 v22, v22
    v_fma_f32 v28, v28, s32, -v239
    s_waitcnt lgkmcnt(5)
    v_mfma_f32_32x32x16_bf16 v[0:15], a[148:151], a[252:255], v[0:15]
    ds_read_b128 a[252:255], v251 offset:16384
    ds_read_b128 a[148:151], v245 offset:61440
    v_exp_f32 v23, v23
    v_fma_f32 v29, v29, s32, -v239
    v_mfma_f32_32x32x16_bf16 v[0:15], a[120:123], a[88:91], v[0:15]
    ds_read_b128 a[120:123], v246 offset:53248
    v_cvt_pk_bf16_f32 v66, v20, v21
    v_exp_f32 v24, v24
    v_fma_f32 v30, v30, s32, -v239
    s_waitcnt lgkmcnt(5)
    v_mfma_f32_32x32x16_bf16 v[0:15], a[152:155], a[248:251], v[0:15]
    v_subrev_u32 v248, 32768, v248
    v_subrev_u32 v249, 32768, v249
    v_subrev_u32 v250, 32768, v250
    v_subrev_u32 v251, 32768, v251
    ds_read_b128 a[248:251], v248
    ds_read_b128 a[152:155], v246 offset:61440
    v_mfma_f32_32x32x16_bf16 v[0:15], a[124:127], a[92:95], v[0:15]
    ds_read_b128 a[124:127], v247 offset:53248
    v_exp_f32 v25, v25
    v_fma_f32 v31, v31, s32, -v239
    v_cvt_pk_bf16_f32 v67, v22, v23
    v_exp_f32 v26, v26
    s_waitcnt lgkmcnt(5)
    v_mfma_f32_32x32x16_bf16 v[0:15], a[156:159], a[252:255], v[0:15]
    ds_read_b128 a[252:255], v249
    ds_read_b128 a[156:159], v247 offset:61440
    v_exp_f32 v27, v27
    v_cvt_pk_bf16_f32 v68, v24, v25
    v_exp_f32 v28, v28
    v_mfma_f32_4x4x4_16b_bf16 v[232:235], v[236:237], a[182:183], v[232:235] cbsz:4 abid:0
    v_exp_f32 v29, v29
    v_cvt_pk_bf16_f32 v69, v26, v27
    v_mfma_f32_4x4x4_16b_bf16 v[232:235], v[236:237], v[64:65], v[232:235] cbsz:4 abid:1
    v_exp_f32 v30, v30
    v_exp_f32 v31, v31
    v_mfma_f32_4x4x4_16b_bf16 v[232:235], v[236:237], v[66:67], v[232:235] cbsz:4 abid:1
    v_cvt_pk_bf16_f32 v70, v28, v29
    v_cvt_pk_bf16_f32 v71, v30, v31
    v_mfma_f32_4x4x4_16b_bf16 v[232:235], v[236:237], v[68:69], v[232:235] cbsz:4 abid:1
    v_mfma_f32_32x32x16_bf16 v[16:31], a[96:99], a[0:3], 0
    s_waitcnt lgkmcnt(0)
    s_waitcnt vmcnt(8)
    s_barrier
    s_add_u32 m0, s30, 49152
    s_add_u32 s35, s24, 147456
    buffer_load_dwordx4 v252, s[12:15], s35 offen nt lds
    v_mfma_f32_32x32x16_bf16 v[16:31], a[128:131], a[248:251], v[16:31]
    ds_read_b128 a[248:251], v250
    s_add_u32 s35, s24, 179200
    buffer_load_dwordx4 v253, s[12:15], s35 offen offset:1024 nt lds
    v_max3_f32 v243, v0, v1, v243
    v_max3_f32 v243, v2, v3, v243
    v_mfma_f32_32x32x16_bf16 v[16:31], a[100:103], a[4:7], v[16:31]
    s_add_u32 s35, s24, 30720
    buffer_load_dwordx4 v252, s[12:15], s35 offen offset:2048 nt lds
    v_max3_f32 v243, v4, v5, v243
    v_max3_f32 v243, v6, v7, v243
    v_mfma_f32_32x32x16_bf16 v[16:31], a[132:135], a[252:255], v[16:31]
    ds_read_b128 a[252:255], v251
    s_add_u32 s35, s24, 62464
    buffer_load_dwordx4 v253, s[12:15], s35 offen offset:3072 nt lds
    v_max3_f32 v243, v8, v9, v243
    v_max3_f32 v243, v10, v11, v243
    v_mfma_f32_32x32x16_bf16 v[16:31], a[104:107], a[8:11], v[16:31]
    v_max3_f32 v243, v12, v13, v243
    v_max3_f32 v243, v14, v15, v243
    v_fma_f32 v254, v243, s32, -v240
    v_cmp_lt_f32 vcc, s33, v254
    s_waitcnt lgkmcnt(1)
    v_mfma_f32_32x32x16_bf16 v[16:31], a[136:139], a[248:251], v[16:31]
    ds_read_b128 a[248:251], v248 offset:16384
    v_fma_f32 v0, v0, s32, -v240
    v_fma_f32 v1, v1, s32, -v240
    v_fma_f32 v2, v2, s32, -v240
    v_fma_f32 v3, v3, s32, -v240
    v_mfma_f32_32x32x16_bf16 v[16:31], a[108:111], a[12:15], v[16:31]
    v_fma_f32 v4, v4, s32, -v240
    v_fma_f32 v5, v5, s32, -v240
    s_cbranch_vccnz L_stub_0_2_2
L_back_0_2_2:
    v_exp_f32 v0, v0
    s_waitcnt lgkmcnt(1)
    v_mfma_f32_32x32x16_bf16 v[16:31], a[140:143], a[252:255], v[16:31]
    ds_read_b128 a[252:255], v249 offset:16384
    v_fma_f32 v6, v6, s32, -v240
    v_exp_f32 v1, v1
    v_fma_f32 v7, v7, s32, -v240
    v_mfma_f32_32x32x16_bf16 v[16:31], a[112:115], a[16:19], v[16:31]
    v_exp_f32 v2, v2
    v_fma_f32 v8, v8, s32, -v240
    v_exp_f32 v3, v3
    s_waitcnt lgkmcnt(1)
    v_mfma_f32_32x32x16_bf16 v[16:31], a[144:147], a[248:251], v[16:31]
    ds_read_b128 a[248:251], v250 offset:16384
    v_fma_f32 v9, v9, s32, -v240
    v_cvt_pk_bf16_f32 v72, v0, v1
    v_exp_f32 v4, v4
    v_mfma_f32_32x32x16_bf16 v[16:31], a[116:119], a[20:23], v[16:31]
    v_fma_f32 v10, v10, s32, -v240
    v_exp_f32 v5, v5
    v_fma_f32 v11, v11, s32, -v240
    s_waitcnt lgkmcnt(1)
    v_mfma_f32_32x32x16_bf16 v[16:31], a[148:151], a[252:255], v[16:31]
    ds_read_b128 a[252:255], v251 offset:16384
    v_cvt_pk_bf16_f32 v73, v2, v3
    v_exp_f32 v6, v6
    v_fma_f32 v12, v12, s32, -v240
    v_mfma_f32_32x32x16_bf16 v[16:31], a[120:123], a[24:27], v[16:31]
    v_exp_f32 v7, v7
    v_fma_f32 v13, v13, s32, -v240
    v_cvt_pk_bf16_f32 v74, v4, v5
    s_waitcnt lgkmcnt(1)
    v_mfma_f32_32x32x16_bf16 v[16:31], a[152:155], a[248:251], v[16:31]
    v_add_u32 v248, 32768, v248
    v_add_u32 v249, 32768, v249
    v_add_u32 v250, 32768, v250
    v_add_u32 v251, 32768, v251
    ds_read_b128 a[248:251], v248
    v_exp_f32 v8, v8
    v_mfma_f32_32x32x16_bf16 v[16:31], a[124:127], a[28:31], v[16:31]
    v_fma_f32 v14, v14, s32, -v240
    v_exp_f32 v9, v9
    v_fma_f32 v15, v15, s32, -v240
    v_cvt_pk_bf16_f32 v75, v6, v7
    s_waitcnt lgkmcnt(1)
    v_mfma_f32_32x32x16_bf16 v[16:31], a[156:159], a[252:255], v[16:31]
    ds_read_b128 a[252:255], v249
    v_exp_f32 v10, v10
    v_exp_f32 v11, v11
    v_cvt_pk_bf16_f32 v76, v8, v9
    v_exp_f32 v12, v12
    v_mfma_f32_4x4x4_16b_bf16 v[232:235], v[236:237], v[70:71], v[232:235] cbsz:4 abid:1
    v_exp_f32 v13, v13
    v_cvt_pk_bf16_f32 v77, v10, v11
    v_mfma_f32_4x4x4_16b_bf16 v[232:235], v[236:237], v[72:73], v[232:235] cbsz:4 abid:2
    v_exp_f32 v14, v14
    v_exp_f32 v15, v15
    v_mfma_f32_4x4x4_16b_bf16 v[232:235], v[236:237], v[74:75], v[232:235] cbsz:4 abid:2
    v_cvt_pk_bf16_f32 v78, v12, v13
    v_cvt_pk_bf16_f32 v79, v14, v15
    v_mfma_f32_4x4x4_16b_bf16 v[232:235], v[236:237], v[76:77], v[232:235] cbsz:4 abid:2
    v_mfma_f32_32x32x16_bf16 v[0:15], a[96:99], a[32:35], 0
    v_max3_f32 v241, v16, v17, v241
    v_max3_f32 v241, v18, v19, v241
    v_max3_f32 v241, v20, v21, v241
    v_max3_f32 v241, v22, v23, v241
    s_waitcnt lgkmcnt(1)
    v_mfma_f32_32x32x16_bf16 v[0:15], a[128:131], a[248:251], v[0:15]
    ds_read_b128 a[248:251], v250
    v_max3_f32 v241, v24, v25, v241
    v_max3_f32 v241, v26, v27, v241
    v_max3_f32 v241, v28, v29, v241
    v_max3_f32 v241, v30, v31, v241
    v_mfma_f32_32x32x16_bf16 v[0:15], a[100:103], a[36:39], v[0:15]
    v_fma_f32 v254, v241, s32, -v238
    v_cmp_lt_f32 vcc, s33, v254
    v_fma_f32 v16, v16, s32, -v238
    v_fma_f32 v17, v17, s32, -v238
    s_waitcnt lgkmcnt(1)
    v_mfma_f32_32x32x16_bf16 v[0:15], a[132:135], a[252:255], v[0:15]
    ds_read_b128 a[252:255], v251
    v_fma_f32 v18, v18, s32, -v238
    v_fma_f32 v19, v19, s32, -v238
    v_fma_f32 v20, v20, s32, -v238
    v_fma_f32 v21, v21, s32, -v238
    v_mfma_f32_32x32x16_bf16 v[0:15], a[104:107], a[40:43], v[0:15]
    s_cbranch_vccnz L_stub_0_0_3
L_back_0_0_3:
    v_exp_f32 v16, v16
    v_fma_f32 v22, v22, s32, -v238
    v_exp_f32 v17, v17
    s_waitcnt lgkmcnt(1)
    v_mfma_f32_32x32x16_bf16 v[0:15], a[136:139], a[248:251], v[0:15]
    ds_read_b128 a[248:251], v248 offset:49152
    v_fma_f32 v23, v23, s32, -v238
    v_exp_f32 v18, v18
    v_fma_f32 v24, v24, s32, -v238
    v_mfma_f32_32x32x16_bf16 v[0:15], a[108:111], a[44:47], v[0:15]
    v_exp_f32 v19, v19
    v_fma_f32 v25, v25, s32, -v238
    v_cvt_pk_bf16_f32 v16, v16, v17
    s_waitcnt lgkmcnt(1)
    v_mfma_f32_32x32x16_bf16 v[0:15], a[140:143], a[252:255], v[0:15]
    ds_read_b128 a[252:255], v249 offset:49152
    v_accvgpr_write_b32 a184, v16
    v_exp_f32 v20, v20
    v_fma_f32 v26, v26, s32, -v238
    v_mfma_f32_32x32x16_bf16 v[0:15], a[112:115], a[48:51], v[0:15]
    v_exp_f32 v21, v21
    v_fma_f32 v27, v27, s32, -v238
    v_cvt_pk_bf16_f32 v18, v18, v19
    s_waitcnt lgkmcnt(1)
    v_mfma_f32_32x32x16_bf16 v[0:15], a[144:147], a[248:251], v[0:15]
    ds_read_b128 a[248:251], v250 offset:49152
    v_accvgpr_write_b32 a185, v18
    v_exp_f32 v22, v22
    v_fma_f32 v28, v28, s32, -v238
    v_mfma_f32_32x32x16_bf16 v[0:15], a[116:119], a[52:55], v[0:15]
    v_exp_f32 v23, v23
    v_fma_f32 v29, v29, s32, -v238
    v_cvt_pk_bf16_f32 v20, v20, v21
    s_waitcnt lgkmcnt(1)
    v_mfma_f32_32x32x16_bf16 v[0:15], a[148:151], a[252:255], v[0:15]
    ds_read_b128 a[252:255], v251 offset:49152
    v_accvgpr_write_b32 a186, v20
    v_exp_f32 v24, v24
    v_fma_f32 v30, v30, s32, -v238
    v_mfma_f32_32x32x16_bf16 v[0:15], a[120:123], a[56:59], v[0:15]
    v_exp_f32 v25, v25
    v_fma_f32 v31, v31, s32, -v238
    v_cvt_pk_bf16_f32 v22, v22, v23
    s_waitcnt lgkmcnt(1)
    v_mfma_f32_32x32x16_bf16 v[0:15], a[152:155], a[248:251], v[0:15]
    ds_read_b128 a[248:251], v248 offset:32768
    v_accvgpr_write_b32 a187, v22
    v_exp_f32 v26, v26
    v_exp_f32 v27, v27
    v_mfma_f32_32x32x16_bf16 v[0:15], a[124:127], a[60:63], v[0:15]
    v_cvt_pk_bf16_f32 v24, v24, v25
    v_accvgpr_write_b32 a188, v24
    v_exp_f32 v28, v28
    s_waitcnt lgkmcnt(1)
    v_mfma_f32_32x32x16_bf16 v[0:15], a[156:159], a[252:255], v[0:15]
    ds_read_b128 a[252:255], v249 offset:32768
    v_exp_f32 v29, v29
    v_cvt_pk_bf16_f32 v26, v26, v27
    v_accvgpr_write_b32 a189, v26
    v_mfma_f32_4x4x4_16b_bf16 v[232:235], v[236:237], v[78:79], v[232:235] cbsz:4 abid:2
    v_exp_f32 v30, v30
    v_exp_f32 v31, v31
    v_mfma_f32_4x4x4_16b_bf16 v[232:235], v[236:237], a[184:185], v[232:235] cbsz:4 abid:0
    v_cvt_pk_bf16_f32 v28, v28, v29
    v_accvgpr_write_b32 a190, v28
    v_mfma_f32_4x4x4_16b_bf16 v[232:235], v[236:237], a[186:187], v[232:235] cbsz:4 abid:0
    v_cvt_pk_bf16_f32 v30, v30, v31
    v_accvgpr_write_b32 a191, v30
    v_mfma_f32_4x4x4_16b_bf16 v[232:235], v[236:237], a[188:189], v[232:235] cbsz:4 abid:0
    v_mfma_f32_32x32x16_bf16 v[16:31], a[96:99], a[64:67], 0
    ds_read_b128 a[96:99], v244
    v_max3_f32 v242, v0, v1, v242
    v_max3_f32 v242, v2, v3, v242
    v_max3_f32 v242, v4, v5, v242
    s_waitcnt lgkmcnt(2)
    v_mfma_f32_32x32x16_bf16 v[16:31], a[128:131], a[248:251], v[16:31]
    ds_read_b128 a[248:251], v250 offset:32768
    ds_read_b128 a[128:131], v244 offset:8192
    v_max3_f32 v242, v6, v7, v242
    v_max3_f32 v242, v8, v9, v242
    v_max3_f32 v242, v10, v11, v242
    v_mfma_f32_32x32x16_bf16 v[16:31], a[100:103], a[68:71], v[16:31]
    ds_read_b128 a[100:103], v245
    v_max3_f32 v242, v12, v13, v242
    v_max3_f32 v242, v14, v15, v242
    v_fma_f32 v254, v242, s32, -v239
    v_cmp_lt_f32 vcc, s33, v254
    s_waitcnt lgkmcnt(4)
    v_mfma_f32_32x32x16_bf16 v[16:31], a[132:135], a[252:255], v[16:31]
    ds_read_b128 a[252:255], v251 offset:32768
    ds_read_b128 a[132:135], v245 offset:8192
    v_fma_f32 v0, v0, s32, -v239
    v_fma_f32 v1, v1, s32, -v239
    v_fma_f32 v2, v2, s32, -v239
    v_mfma_f32_32x32x16_bf16 v[16:31], a[104:107], a[72:75], v[16:31]
    ds_read_b128 a[104:107], v246
    v_fma_f32 v3, v3, s32, -v239
    v_fma_f32 v4, v4, s32, -v239
    v_fma_f32 v5, v5, s32, -v239
    s_waitcnt lgkmcnt(5)
    v_mfma_f32_32x32x16_bf16 v[16:31], a[136:139], a[248:251], v[16:31]
    ds_read_b128 a[248:251], v248 offset:16384
    ds_read_b128 a[136:139], v246 offset:8192
    s_cbranch_vccnz L_stub_0_1_3
L_back_0_1_3:
    v_exp_f32 v0, v0
    v_fma_f32 v6, v6, s32, -v239
    v_mfma_f32_32x32x16_bf16 v[16:31], a[108:111], a[76:79], v[16:31]
    ds_read_b128 a[108:111], v247
    v_exp_f32 v1, v1
    v_fma_f32 v7, v7, s32, -v239
    v_exp_f32 v2, v2
    s_waitcnt lgkmcnt(5)
    v_mfma_f32_32x32x16_bf16 v[16:31], a[140:143], a[252:255], v[16:31]
    ds_read_b128 a[252:255], v249 offset:16384
    ds_read_b128 a[140:143], v247 offset:8192
    v_fma_f32 v8, v8, s32, -v239
    v_exp_f32 v3, v3
    v_mfma_f32_32x32x16_bf16 v[16:31], a[112:115], a[80:83], v[16:31]
    ds_read_b128 a[112:115], v244 offset:4096
    v_fma_f32 v9, v9, s32, -v239
    v_cvt_pk_bf16_f32 v80, v0, v1
    v_exp_f32 v4, v4
    s_waitcnt lgkmcnt(5)
    v_mfma_f32_32x32x16_bf16 v[16:31], a[144:147], a[248:251], v[16:31]
    ds_read_b128 a[248:251], v250 offset:16384
    ds_read_b128 a[144:147], v244 offset:12288
    v_fma_f32 v10, v10, s32, -v239
    v_exp_f32 v5, v5
    v_fma_f32 v11, v11, s32, -v239
    v_mfma_f32_32x32x16_bf16 v[16:31], a[116:119], a[84:87], v[16:31]
    ds_read_b128 a[116:119], v245 offset:4096
    v_cvt_pk_bf16_f32 v81, v2, v3
    v_exp_f32 v6, v6
    v_fma_f32 v12, v12, s32, -v239
    s_waitcnt lgkmcnt(5)
    v_mfma_f32_32x32x16_bf16 v[16:31], a[148:151], a[252:255], v[16:31]
    ds_read_b128 a[252:255], v251 offset:16384
    ds_read_b128 a[148:151], v245 offset:12288
    v_exp_f32 v7, v7
    v_fma_f32 v13, v13, s32, -v239
    v_mfma_f32_32x32x16_bf16 v[16:31], a[120:123], a[88:91], v[16:31]
    ds_read_b128 a[120:123], v246 offset:4096
    v_cvt_pk_bf16_f32 v82, v4, v5
    v_exp_f32 v8, v8
    v_fma_f32 v14, v14, s32, -v239
    s_waitcnt lgkmcnt(5)
    v_mfma_f32_32x32x16_bf16 v[16:31], a[152:155], a[248:251], v[16:31]
    v_subrev_u32 v248, 32768, v248
    v_subrev_u32 v249, 32768, v249
    v_subrev_u32 v250, 32768, v250
    v_subrev_u32 v251, 32768, v251
    ds_read_b128 a[248:251], v248
    ds_read_b128 a[152:155], v246 offset:12288
    v_mfma_f32_32x32x16_bf16 v[16:31], a[124:127], a[92:95], v[16:31]
    ds_read_b128 a[124:127], v247 offset:4096
    v_exp_f32 v9, v9
    v_fma_f32 v15, v15, s32, -v239
    v_cvt_pk_bf16_f32 v83, v6, v7
    v_exp_f32 v10, v10
    s_waitcnt lgkmcnt(5)
    v_mfma_f32_32x32x16_bf16 v[16:31], a[156:159], a[252:255], v[16:31]
    ds_read_b128 a[252:255], v249
    ds_read_b128 a[156:159], v247 offset:12288
    v_exp_f32 v11, v11
    v_cvt_pk_bf16_f32 v84, v8, v9
    v_exp_f32 v12, v12
    v_mfma_f32_4x4x4_16b_bf16 v[232:235], v[236:237], a[190:191], v[232:235] cbsz:4 abid:0
    v_exp_f32 v13, v13
    v_cvt_pk_bf16_f32 v85, v10, v11
    v_mfma_f32_4x4x4_16b_bf16 v[232:235], v[236:237], v[80:81], v[232:235] cbsz:4 abid:1
    v_exp_f32 v14, v14
    v_exp_f32 v15, v15
    v_mfma_f32_4x4x4_16b_bf16 v[232:235], v[236:237], v[82:83], v[232:235] cbsz:4 abid:1
    v_cvt_pk_bf16_f32 v86, v12, v13
    v_cvt_pk_bf16_f32 v87, v14, v15
    v_mfma_f32_4x4x4_16b_bf16 v[232:235], v[236:237], v[84:85], v[232:235] cbsz:4 abid:1
    v_mfma_f32_32x32x16_bf16 v[0:15], a[96:99], a[0:3], 0
    s_waitcnt lgkmcnt(0)
    s_waitcnt vmcnt(8)
    s_barrier
    s_add_u32 m0, s30, 0
    s_add_u32 s35, s24, 86016
    buffer_load_dwordx4 v252, s[12:15], s35 offen nt lds
    v_mfma_f32_32x32x16_bf16 v[0:15], a[128:131], a[248:251], v[0:15]
    ds_read_b128 a[248:251], v250
    s_add_u32 s35, s24, 117760
    buffer_load_dwordx4 v253, s[12:15], s35 offen offset:1024 nt lds
    v_max3_f32 v243, v16, v17, v243
    v_max3_f32 v243, v18, v19, v243
    v_mfma_f32_32x32x16_bf16 v[0:15], a[100:103], a[4:7], v[0:15]
    s_add_u32 s35, s24, 149504
    buffer_load_dwordx4 v252, s[12:15], s35 offen offset:2048 nt lds
    v_max3_f32 v243, v20, v21, v243
    v_max3_f32 v243, v22, v23, v243
    v_mfma_f32_32x32x16_bf16 v[0:15], a[132:135], a[252:255], v[0:15]
    ds_read_b128 a[252:255], v251
    s_add_u32 s35, s24, 181248
    buffer_load_dwordx4 v253, s[12:15], s35 offen offset:3072 nt lds
    v_max3_f32 v243, v24, v25, v243
    v_max3_f32 v243, v26, v27, v243
    v_mfma_f32_32x32x16_bf16 v[0:15], a[104:107], a[8:11], v[0:15]
    v_max3_f32 v243, v28, v29, v243
    v_max3_f32 v243, v30, v31, v243
    v_fma_f32 v254, v243, s32, -v240
    v_cmp_lt_f32 vcc, s33, v254
    s_waitcnt lgkmcnt(1)
    v_mfma_f32_32x32x16_bf16 v[0:15], a[136:139], a[248:251], v[0:15]
    ds_read_b128 a[248:251], v248 offset:16384
    v_fma_f32 v16, v16, s32, -v240
    v_fma_f32 v17, v17, s32, -v240
    v_fma_f32 v18, v18, s32, -v240
    v_fma_f32 v19, v19, s32, -v240
    v_mfma_f32_32x32x16_bf16 v[0:15], a[108:111], a[12:15], v[0:15]
    v_fma_f32 v20, v20, s32, -v240
    v_fma_f32 v21, v21, s32, -v240
    s_cbranch_vccnz L_stub_0_2_3
L_back_0_2_3:
    v_exp_f32 v16, v16
    s_waitcnt lgkmcnt(1)
    v_mfma_f32_32x32x16_bf16 v[0:15], a[140:143], a[252:255], v[0:15]
    ds_read_b128 a[252:255], v249 offset:16384
    v_fma_f32 v22, v22, s32, -v240
    v_exp_f32 v17, v17
    v_fma_f32 v23, v23, s32, -v240
    v_mfma_f32_32x32x16_bf16 v[0:15], a[112:115], a[16:19], v[0:15]
    v_exp_f32 v18, v18
    v_fma_f32 v24, v24, s32, -v240
    v_exp_f32 v19, v19
    s_waitcnt lgkmcnt(1)
    v_mfma_f32_32x32x16_bf16 v[0:15], a[144:147], a[248:251], v[0:15]
    ds_read_b128 a[248:251], v250 offset:16384
    v_fma_f32 v25, v25, s32, -v240
    v_cvt_pk_bf16_f32 v88, v16, v17
    v_exp_f32 v20, v20
    v_mfma_f32_32x32x16_bf16 v[0:15], a[116:119], a[20:23], v[0:15]
    v_fma_f32 v26, v26, s32, -v240
    v_exp_f32 v21, v21
    v_fma_f32 v27, v27, s32, -v240
    s_waitcnt lgkmcnt(1)
    v_mfma_f32_32x32x16_bf16 v[0:15], a[148:151], a[252:255], v[0:15]
    ds_read_b128 a[252:255], v251 offset:16384
    v_cvt_pk_bf16_f32 v89, v18, v19
    v_exp_f32 v22, v22
    v_fma_f32 v28, v28, s32, -v240
    v_mfma_f32_32x32x16_bf16 v[0:15], a[120:123], a[24:27], v[0:15]
    v_exp_f32 v23, v23
    v_fma_f32 v29, v29, s32, -v240
    v_cvt_pk_bf16_f32 v90, v20, v21
    s_waitcnt lgkmcnt(1)
    v_mfma_f32_32x32x16_bf16 v[0:15], a[152:155], a[248:251], v[0:15]
    v_add_u32 v248, 32768, v248
    v_add_u32 v249, 32768, v249
    v_add_u32 v250, 32768, v250
    v_add_u32 v251, 32768, v251
    ds_read_b128 a[248:251], v248
    v_exp_f32 v24, v24
    v_mfma_f32_32x32x16_bf16 v[0:15], a[124:127], a[28:31], v[0:15]
    v_fma_f32 v30, v30, s32, -v240
    v_exp_f32 v25, v25
    v_fma_f32 v31, v31, s32, -v240
    v_cvt_pk_bf16_f32 v91, v22, v23
    s_waitcnt lgkmcnt(1)
    v_mfma_f32_32x32x16_bf16 v[0:15], a[156:159], a[252:255], v[0:15]
    ds_read_b128 a[252:255], v249
    v_exp_f32 v26, v26
    v_exp_f32 v27, v27
    v_cvt_pk_bf16_f32 v92, v24, v25
    v_exp_f32 v28, v28
    v_mfma_f32_4x4x4_16b_bf16 v[232:235], v[236:237], v[86:87], v[232:235] cbsz:4 abid:1
    v_exp_f32 v29, v29
    v_cvt_pk_bf16_f32 v93, v26, v27
    v_mfma_f32_4x4x4_16b_bf16 v[232:235], v[236:237], v[88:89], v[232:235] cbsz:4 abid:2
    v_exp_f32 v30, v30
    v_exp_f32 v31, v31
    v_mfma_f32_4x4x4_16b_bf16 v[232:235], v[236:237], v[90:91], v[232:235] cbsz:4 abid:2
    v_cvt_pk_bf16_f32 v94, v28, v29
    v_cvt_pk_bf16_f32 v95, v30, v31
    v_mfma_f32_4x4x4_16b_bf16 v[232:235], v[236:237], v[92:93], v[232:235] cbsz:4 abid:2
    v_mfma_f32_32x32x16_bf16 v[16:31], a[96:99], a[32:35], 0
    v_max3_f32 v241, v0, v1, v241
    v_max3_f32 v241, v2, v3, v241
    v_max3_f32 v241, v4, v5, v241
    v_max3_f32 v241, v6, v7, v241
    s_waitcnt lgkmcnt(1)
    v_mfma_f32_32x32x16_bf16 v[16:31], a[128:131], a[248:251], v[16:31]
    ds_read_b128 a[248:251], v250
    v_max3_f32 v241, v8, v9, v241
    v_max3_f32 v241, v10, v11, v241
    v_max3_f32 v241, v12, v13, v241
    v_max3_f32 v241, v14, v15, v241
    v_mfma_f32_32x32x16_bf16 v[16:31], a[100:103], a[36:39], v[16:31]
    v_fma_f32 v254, v241, s32, -v238
    v_cmp_lt_f32 vcc, s33, v254
    v_fma_f32 v0, v0, s32, -v238
    v_fma_f32 v1, v1, s32, -v238
    s_waitcnt lgkmcnt(1)
    v_mfma_f32_32x32x16_bf16 v[16:31], a[132:135], a[252:255], v[16:31]
    ds_read_b128 a[252:255], v251
    v_fma_f32 v2, v2, s32, -v238
    v_fma_f32 v3, v3, s32, -v238
    v_fma_f32 v4, v4, s32, -v238
    v_fma_f32 v5, v5, s32, -v238
    v_mfma_f32_32x32x16_bf16 v[16:31], a[104:107], a[40:43], v[16:31]
    s_cbranch_vccnz L_stub_0_0_4
L_back_0_0_4:
    v_exp_f32 v0, v0
    v_fma_f32 v6, v6, s32, -v238
    v_exp_f32 v1, v1
    s_waitcnt lgkmcnt(1)
    v_mfma_f32_32x32x16_bf16 v[16:31], a[136:139], a[248:251], v[16:31]
    ds_read_b128 a[248:251], v248 offset:49152
    v_fma_f32 v7, v7, s32, -v238
    v_exp_f32 v2, v2
    v_fma_f32 v8, v8, s32, -v238
    v_mfma_f32_32x32x16_bf16 v[16:31], a[108:111], a[44:47], v[16:31]
    v_exp_f32 v3, v3
    v_fma_f32 v9, v9, s32, -v238
    v_cvt_pk_bf16_f32 v0, v0, v1
    s_waitcnt lgkmcnt(1)
    v_mfma_f32_32x32x16_bf16 v[16:31], a[140:143], a[252:255], v[16:31]
    ds_read_b128 a[252:255], v249 offset:49152
    v_accvgpr_write_b32 a192, v0
    v_exp_f32 v4, v4
    v_fma_f32 v10, v10, s32, -v238
    v_mfma_f32_32x32x16_bf16 v[16:31], a[112:115], a[48:51], v[16:31]
    v_exp_f32 v5, v5
    v_fma_f32 v11, v11, s32, -v238
    v_cvt_pk_bf16_f32 v2, v2, v3
    s_waitcnt lgkmcnt(1)
    v_mfma_f32_32x32x16_bf16 v[16:31], a[144:147], a[248:251], v[16:31]
    ds_read_b128 a[248:251], v250 offset:49152
    v_accvgpr_write_b32 a193, v2
    v_exp_f32 v6, v6
    v_fma_f32 v12, v12, s32, -v238
    v_mfma_f32_32x32x16_bf16 v[16:31], a[116:119], a[52:55], v[16:31]
    v_exp_f32 v7, v7
    v_fma_f32 v13, v13, s32, -v238
    v_cvt_pk_bf16_f32 v4, v4, v5
    s_waitcnt lgkmcnt(1)
    v_mfma_f32_32x32x16_bf16 v[16:31], a[148:151], a[252:255], v[16:31]
    ds_read_b128 a[252:255], v251 offset:49152
    v_accvgpr_write_b32 a194, v4
    v_exp_f32 v8, v8
    v_fma_f32 v14, v14, s32, -v238
    v_mfma_f32_32x32x16_bf16 v[16:31], a[120:123], a[56:59], v[16:31]
    v_exp_f32 v9, v9
    v_fma_f32 v15, v15, s32, -v238
    v_cvt_pk_bf16_f32 v6, v6, v7
    s_waitcnt lgkmcnt(1)
    v_mfma_f32_32x32x16_bf16 v[16:31], a[152:155], a[248:251], v[16:31]
    ds_read_b128 a[248:251], v248 offset:32768
    v_accvgpr_write_b32 a195, v6
    v_exp_f32 v10, v10
    v_exp_f32 v11, v11
    v_mfma_f32_32x32x16_bf16 v[16:31], a[124:127], a[60:63], v[16:31]
    v_cvt_pk_bf16_f32 v8, v8, v9
    v_accvgpr_write_b32 a196, v8
    v_exp_f32 v12, v12
    s_waitcnt lgkmcnt(1)
    v_mfma_f32_32x32x16_bf16 v[16:31], a[156:159], a[252:255], v[16:31]
    ds_read_b128 a[252:255], v249 offset:32768
    v_exp_f32 v13, v13
    v_cvt_pk_bf16_f32 v10, v10, v11
    v_accvgpr_write_b32 a197, v10
    v_mfma_f32_4x4x4_16b_bf16 v[232:235], v[236:237], v[94:95], v[232:235] cbsz:4 abid:2
    v_exp_f32 v14, v14
    v_exp_f32 v15, v15
    v_mfma_f32_4x4x4_16b_bf16 v[232:235], v[236:237], a[192:193], v[232:235] cbsz:4 abid:0
    v_cvt_pk_bf16_f32 v12, v12, v13
    v_accvgpr_write_b32 a198, v12
    v_mfma_f32_4x4x4_16b_bf16 v[232:235], v[236:237], a[194:195], v[232:235] cbsz:4 abid:0
    v_cvt_pk_bf16_f32 v14, v14, v15
    v_accvgpr_write_b32 a199, v14
    v_mfma_f32_4x4x4_16b_bf16 v[232:235], v[236:237], a[196:197], v[232:235] cbsz:4 abid:0
    v_mfma_f32_32x32x16_bf16 v[0:15], a[96:99], a[64:67], 0
    ds_read_b128 a[96:99], v244 offset:16384
    v_max3_f32 v242, v16, v17, v242
    v_max3_f32 v242, v18, v19, v242
    v_max3_f32 v242, v20, v21, v242
    s_waitcnt lgkmcnt(2)
    v_mfma_f32_32x32x16_bf16 v[0:15], a[128:131], a[248:251], v[0:15]
    ds_read_b128 a[248:251], v250 offset:32768
    ds_read_b128 a[128:131], v244 offset:24576
    v_max3_f32 v242, v22, v23, v242
    v_max3_f32 v242, v24, v25, v242
    v_max3_f32 v242, v26, v27, v242
    v_mfma_f32_32x32x16_bf16 v[0:15], a[100:103], a[68:71], v[0:15]
    ds_read_b128 a[100:103], v245 offset:16384
    v_max3_f32 v242, v28, v29, v242
    v_max3_f32 v242, v30, v31, v242
    v_fma_f32 v254, v242, s32, -v239
    v_cmp_lt_f32 vcc, s33, v254
    s_waitcnt lgkmcnt(4)
    v_mfma_f32_32x32x16_bf16 v[0:15], a[132:135], a[252:255], v[0:15]
    ds_read_b128 a[252:255], v251 offset:32768
    ds_read_b128 a[132:135], v245 offset:24576
    v_fma_f32 v16, v16, s32, -v239
    v_fma_f32 v17, v17, s32, -v239
    v_fma_f32 v18, v18, s32, -v239
    v_mfma_f32_32x32x16_bf16 v[0:15], a[104:107], a[72:75], v[0:15]
    ds_read_b128 a[104:107], v246 offset:16384
    v_fma_f32 v19, v19, s32, -v239
    v_fma_f32 v20, v20, s32, -v239
    v_fma_f32 v21, v21, s32, -v239
    s_waitcnt lgkmcnt(5)
    v_mfma_f32_32x32x16_bf16 v[0:15], a[136:139], a[248:251], v[0:15]
    ds_read_b128 a[248:251], v248 offset:16384
    ds_read_b128 a[136:139], v246 offset:24576
    s_cbranch_vccnz L_stub_0_1_4
L_back_0_1_4:
    v_exp_f32 v16, v16
    v_fma_f32 v22, v22, s32, -v239
    v_mfma_f32_32x32x16_bf16 v[0:15], a[108:111], a[76:79], v[0:15]
    ds_read_b128 a[108:111], v247 offset:16384
    v_exp_f32 v17, v17
    v_fma_f32 v23, v23, s32, -v239
    v_exp_f32 v18, v18
    s_waitcnt lgkmcnt(5)
    v_mfma_f32_32x32x16_bf16 v[0:15], a[140:143], a[252:255], v[0:15]
    ds_read_b128 a[252:255], v249 offset:16384
    ds_read_b128 a[140:143], v247 offset:24576
    v_fma_f32 v24, v24, s32, -v239
    v_exp_f32 v19, v19
    v_mfma_f32_32x32x16_bf16 v[0:15], a[112:115], a[80:83], v[0:15]
    ds_read_b128 a[112:115], v244 offset:20480
    v_fma_f32 v25, v25, s32, -v239
    v_cvt_pk_bf16_f32 v96, v16, v17
    v_exp_f32 v20, v20
    s_waitcnt lgkmcnt(5)
    v_mfma_f32_32x32x16_bf16 v[0:15], a[144:147], a[248:251], v[0:15]
    ds_read_b128 a[248:251], v250 offset:16384
    ds_read_b128 a[144:147], v244 offset:28672
    v_fma_f32 v26, v26, s32, -v239
    v_exp_f32 v21, v21
    v_fma_f32 v27, v27, s32, -v239
    v_mfma_f32_32x32x16_bf16 v[0:15], a[116:119], a[84:87], v[0:15]
    ds_read_b128 a[116:119], v245 offset:20480
    v_cvt_pk_bf16_f32 v97, v18, v19
    v_exp_f32 v22, v22
    v_fma_f32 v28, v28, s32, -v239
    s_waitcnt lgkmcnt(5)
    v_mfma_f32_32x32x16_bf16 v[0:15], a[148:151], a[252:255], v[0:15]
    ds_read_b128 a[252:255], v251 offset:16384
    ds_read_b128 a[148:151], v245 offset:28672
    v_exp_f32 v23, v23
    v_fma_f32 v29, v29, s32, -v239
    v_mfma_f32_32x32x16_bf16 v[0:15], a[120:123], a[88:91], v[0:15]
    ds_read_b128 a[120:123], v246 offset:20480
    v_cvt_pk_bf16_f32 v98, v20, v21
    v_exp_f32 v24, v24
    v_fma_f32 v30, v30, s32, -v239
    s_waitcnt lgkmcnt(5)
    v_mfma_f32_32x32x16_bf16 v[0:15], a[152:155], a[248:251], v[0:15]
    v_subrev_u32 v248, 32768, v248
    v_subrev_u32 v249, 32768, v249
    v_subrev_u32 v250, 32768, v250
    v_subrev_u32 v251, 32768, v251
    ds_read_b128 a[248:251], v248
    ds_read_b128 a[152:155], v246 offset:28672
    v_mfma_f32_32x32x16_bf16 v[0:15], a[124:127], a[92:95], v[0:15]
    ds_read_b128 a[124:127], v247 offset:20480
    v_exp_f32 v25, v25
    v_fma_f32 v31, v31, s32, -v239
    v_cvt_pk_bf16_f32 v99, v22, v23
    v_exp_f32 v26, v26
    s_waitcnt lgkmcnt(5)
    v_mfma_f32_32x32x16_bf16 v[0:15], a[156:159], a[252:255], v[0:15]
    ds_read_b128 a[252:255], v249
    ds_read_b128 a[156:159], v247 offset:28672
    v_exp_f32 v27, v27
    v_cvt_pk_bf16_f32 v100, v24, v25
    v_exp_f32 v28, v28
    v_mfma_f32_4x4x4_16b_bf16 v[232:235], v[236:237], a[198:199], v[232:235] cbsz:4 abid:0
    v_exp_f32 v29, v29
    v_cvt_pk_bf16_f32 v101, v26, v27
    v_mfma_f32_4x4x4_16b_bf16 v[232:235], v[236:237], v[96:97], v[232:235] cbsz:4 abid:1
    v_exp_f32 v30, v30
    v_exp_f32 v31, v31
    v_mfma_f32_4x4x4_16b_bf16 v[232:235], v[236:237], v[98:99], v[232:235] cbsz:4 abid:1
    v_cvt_pk_bf16_f32 v102, v28, v29
    v_cvt_pk_bf16_f32 v103, v30, v31
    v_mfma_f32_4x4x4_16b_bf16 v[232:235], v[236:237], v[100:101], v[232:235] cbsz:4 abid:1
    v_mfma_f32_32x32x16_bf16 v[16:31], a[96:99], a[0:3], 0
    s_waitcnt lgkmcnt(0)
    s_waitcnt vmcnt(8)
    s_barrier
    s_add_u32 m0, s30, 16384
    s_add_u32 s35, s24, 90112
    buffer_load_dwordx4 v252, s[12:15], s35 offen nt lds
    v_mfma_f32_32x32x16_bf16 v[16:31], a[128:131], a[248:251], v[16:31]
    ds_read_b128 a[248:251], v250
    s_add_u32 s35, s24, 121856
    buffer_load_dwordx4 v253, s[12:15], s35 offen offset:1024 nt lds
    v_max3_f32 v243, v0, v1, v243
    v_max3_f32 v243, v2, v3, v243
    v_mfma_f32_32x32x16_bf16 v[16:31], a[100:103], a[4:7], v[16:31]
    s_add_u32 s35, s24, 153600
    buffer_load_dwordx4 v252, s[12:15], s35 offen offset:2048 nt lds
    v_max3_f32 v243, v4, v5, v243
    v_max3_f32 v243, v6, v7, v243
    v_mfma_f32_32x32x16_bf16 v[16:31], a[132:135], a[252:255], v[16:31]
    ds_read_b128 a[252:255], v251
    s_add_u32 s35, s24, 185344
    buffer_load_dwordx4 v253, s[12:15], s35 offen offset:3072 nt lds
    v_max3_f32 v243, v8, v9, v243
    v_max3_f32 v243, v10, v11, v243
    v_mfma_f32_32x32x16_bf16 v[16:31], a[104:107], a[8:11], v[16:31]
    v_max3_f32 v243, v12, v13, v243
    v_max3_f32 v243, v14, v15, v243
    v_fma_f32 v254, v243, s32, -v240
    v_cmp_lt_f32 vcc, s33, v254
    s_waitcnt lgkmcnt(1)
    v_mfma_f32_32x32x16_bf16 v[16:31], a[136:139], a[248:251], v[16:31]
    ds_read_b128 a[248:251], v248 offset:16384
    v_fma_f32 v0, v0, s32, -v240
    v_fma_f32 v1, v1, s32, -v240
    v_fma_f32 v2, v2, s32, -v240
    v_fma_f32 v3, v3, s32, -v240
    v_mfma_f32_32x32x16_bf16 v[16:31], a[108:111], a[12:15], v[16:31]
    v_fma_f32 v4, v4, s32, -v240
    v_fma_f32 v5, v5, s32, -v240
    s_cbranch_vccnz L_stub_0_2_4
L_back_0_2_4:
    v_exp_f32 v0, v0
    s_waitcnt lgkmcnt(1)
    v_mfma_f32_32x32x16_bf16 v[16:31], a[140:143], a[252:255], v[16:31]
    ds_read_b128 a[252:255], v249 offset:16384
    v_fma_f32 v6, v6, s32, -v240
    v_exp_f32 v1, v1
    v_fma_f32 v7, v7, s32, -v240
    v_mfma_f32_32x32x16_bf16 v[16:31], a[112:115], a[16:19], v[16:31]
    v_exp_f32 v2, v2
    v_fma_f32 v8, v8, s32, -v240
    v_exp_f32 v3, v3
    s_waitcnt lgkmcnt(1)
    v_mfma_f32_32x32x16_bf16 v[16:31], a[144:147], a[248:251], v[16:31]
    ds_read_b128 a[248:251], v250 offset:16384
    v_fma_f32 v9, v9, s32, -v240
    v_cvt_pk_bf16_f32 v104, v0, v1
    v_exp_f32 v4, v4
    v_mfma_f32_32x32x16_bf16 v[16:31], a[116:119], a[20:23], v[16:31]
    v_fma_f32 v10, v10, s32, -v240
    v_exp_f32 v5, v5
    v_fma_f32 v11, v11, s32, -v240
    s_waitcnt lgkmcnt(1)
    v_mfma_f32_32x32x16_bf16 v[16:31], a[148:151], a[252:255], v[16:31]
    ds_read_b128 a[252:255], v251 offset:16384
    v_cvt_pk_bf16_f32 v105, v2, v3
    v_exp_f32 v6, v6
    v_fma_f32 v12, v12, s32, -v240
    v_mfma_f32_32x32x16_bf16 v[16:31], a[120:123], a[24:27], v[16:31]
    v_exp_f32 v7, v7
    v_fma_f32 v13, v13, s32, -v240
    v_cvt_pk_bf16_f32 v106, v4, v5
    s_waitcnt lgkmcnt(1)
    v_mfma_f32_32x32x16_bf16 v[16:31], a[152:155], a[248:251], v[16:31]
    v_add_u32 v248, 32768, v248
    v_add_u32 v249, 32768, v249
    v_add_u32 v250, 32768, v250
    v_add_u32 v251, 32768, v251
    ds_read_b128 a[248:251], v248
    v_exp_f32 v8, v8
    v_mfma_f32_32x32x16_bf16 v[16:31], a[124:127], a[28:31], v[16:31]
    v_fma_f32 v14, v14, s32, -v240
    v_exp_f32 v9, v9
    v_fma_f32 v15, v15, s32, -v240
    v_cvt_pk_bf16_f32 v107, v6, v7
    s_waitcnt lgkmcnt(1)
    v_mfma_f32_32x32x16_bf16 v[16:31], a[156:159], a[252:255], v[16:31]
    ds_read_b128 a[252:255], v249
    v_exp_f32 v10, v10
    v_exp_f32 v11, v11
    v_cvt_pk_bf16_f32 v108, v8, v9
    v_exp_f32 v12, v12
    v_mfma_f32_4x4x4_16b_bf16 v[232:235], v[236:237], v[102:103], v[232:235] cbsz:4 abid:1
    v_exp_f32 v13, v13
    v_cvt_pk_bf16_f32 v109, v10, v11
    v_mfma_f32_4x4x4_16b_bf16 v[232:235], v[236:237], v[104:105], v[232:235] cbsz:4 abid:2
    v_exp_f32 v14, v14
    v_exp_f32 v15, v15
    v_mfma_f32_4x4x4_16b_bf16 v[232:235], v[236:237], v[106:107], v[232:235] cbsz:4 abid:2
    v_cvt_pk_bf16_f32 v110, v12, v13
    v_cvt_pk_bf16_f32 v111, v14, v15
    v_mfma_f32_4x4x4_16b_bf16 v[232:235], v[236:237], v[108:109], v[232:235] cbsz:4 abid:2
    v_mfma_f32_32x32x16_bf16 v[0:15], a[96:99], a[32:35], 0
    v_max3_f32 v241, v16, v17, v241
    v_max3_f32 v241, v18, v19, v241
    v_max3_f32 v241, v20, v21, v241
    v_max3_f32 v241, v22, v23, v241
    s_waitcnt lgkmcnt(1)
    v_mfma_f32_32x32x16_bf16 v[0:15], a[128:131], a[248:251], v[0:15]
    ds_read_b128 a[248:251], v250
    v_max3_f32 v241, v24, v25, v241
    v_max3_f32 v241, v26, v27, v241
    v_max3_f32 v241, v28, v29, v241
    v_max3_f32 v241, v30, v31, v241
    v_mfma_f32_32x32x16_bf16 v[0:15], a[100:103], a[36:39], v[0:15]
    v_fma_f32 v254, v241, s32, -v238
    v_cmp_lt_f32 vcc, s33, v254
    v_fma_f32 v16, v16, s32, -v238
    v_fma_f32 v17, v17, s32, -v238
    s_waitcnt lgkmcnt(1)
    v_mfma_f32_32x32x16_bf16 v[0:15], a[132:135], a[252:255], v[0:15]
    ds_read_b128 a[252:255], v251
    v_fma_f32 v18, v18, s32, -v238
    v_fma_f32 v19, v19, s32, -v238
    v_fma_f32 v20, v20, s32, -v238
    v_fma_f32 v21, v21, s32, -v238
    v_mfma_f32_32x32x16_bf16 v[0:15], a[104:107], a[40:43], v[0:15]
    s_cbranch_vccnz L_stub_0_0_5
L_back_0_0_5:
    v_exp_f32 v16, v16
    v_fma_f32 v22, v22, s32, -v238
    v_exp_f32 v17, v17
    s_waitcnt lgkmcnt(1)
    v_mfma_f32_32x32x16_bf16 v[0:15], a[136:139], a[248:251], v[0:15]
    ds_read_b128 a[248:251], v248 offset:49152
    v_fma_f32 v23, v23, s32, -v238
    v_exp_f32 v18, v18
    v_fma_f32 v24, v24, s32, -v238
    v_mfma_f32_32x32x16_bf16 v[0:15], a[108:111], a[44:47], v[0:15]
    v_exp_f32 v19, v19
    v_fma_f32 v25, v25, s32, -v238
    v_cvt_pk_bf16_f32 v16, v16, v17
    s_waitcnt lgkmcnt(1)
    v_mfma_f32_32x32x16_bf16 v[0:15], a[140:143], a[252:255], v[0:15]
    ds_read_b128 a[252:255], v249 offset:49152
    v_accvgpr_write_b32 a200, v16
    v_exp_f32 v20, v20
    v_fma_f32 v26, v26, s32, -v238
    v_mfma_f32_32x32x16_bf16 v[0:15], a[112:115], a[48:51], v[0:15]
    v_exp_f32 v21, v21
    v_fma_f32 v27, v27, s32, -v238
    v_cvt_pk_bf16_f32 v18, v18, v19
    s_waitcnt lgkmcnt(1)
    v_mfma_f32_32x32x16_bf16 v[0:15], a[144:147], a[248:251], v[0:15]
    ds_read_b128 a[248:251], v250 offset:49152
    v_accvgpr_write_b32 a201, v18
    v_exp_f32 v22, v22
    v_fma_f32 v28, v28, s32, -v238
    v_mfma_f32_32x32x16_bf16 v[0:15], a[116:119], a[52:55], v[0:15]
    v_exp_f32 v23, v23
    v_fma_f32 v29, v29, s32, -v238
    v_cvt_pk_bf16_f32 v20, v20, v21
    s_waitcnt lgkmcnt(1)
    v_mfma_f32_32x32x16_bf16 v[0:15], a[148:151], a[252:255], v[0:15]
    ds_read_b128 a[252:255], v251 offset:49152
    v_accvgpr_write_b32 a202, v20
    v_exp_f32 v24, v24
    v_fma_f32 v30, v30, s32, -v238
    v_mfma_f32_32x32x16_bf16 v[0:15], a[120:123], a[56:59], v[0:15]
    v_exp_f32 v25, v25
    v_fma_f32 v31, v31, s32, -v238
    v_cvt_pk_bf16_f32 v22, v22, v23
    s_waitcnt lgkmcnt(1)
    v_mfma_f32_32x32x16_bf16 v[0:15], a[152:155], a[248:251], v[0:15]
    ds_read_b128 a[248:251], v248 offset:32768
    v_accvgpr_write_b32 a203, v22
    v_exp_f32 v26, v26
    v_exp_f32 v27, v27
    v_mfma_f32_32x32x16_bf16 v[0:15], a[124:127], a[60:63], v[0:15]
    v_cvt_pk_bf16_f32 v24, v24, v25
    v_accvgpr_write_b32 a204, v24
    v_exp_f32 v28, v28
    s_waitcnt lgkmcnt(1)
    v_mfma_f32_32x32x16_bf16 v[0:15], a[156:159], a[252:255], v[0:15]
    ds_read_b128 a[252:255], v249 offset:32768
    v_exp_f32 v29, v29
    v_cvt_pk_bf16_f32 v26, v26, v27
    v_accvgpr_write_b32 a205, v26
    v_mfma_f32_4x4x4_16b_bf16 v[232:235], v[236:237], v[110:111], v[232:235] cbsz:4 abid:2
    v_exp_f32 v30, v30
    v_exp_f32 v31, v31
    v_mfma_f32_4x4x4_16b_bf16 v[232:235], v[236:237], a[200:201], v[232:235] cbsz:4 abid:0
    v_cvt_pk_bf16_f32 v28, v28, v29
    v_accvgpr_write_b32 a206, v28
    v_mfma_f32_4x4x4_16b_bf16 v[232:235], v[236:237], a[202:203], v[232:235] cbsz:4 abid:0
    v_cvt_pk_bf16_f32 v30, v30, v31
    v_accvgpr_write_b32 a207, v30
    v_mfma_f32_4x4x4_16b_bf16 v[232:235], v[236:237], a[204:205], v[232:235] cbsz:4 abid:0
    v_mfma_f32_32x32x16_bf16 v[16:31], a[96:99], a[64:67], 0
    ds_read_b128 a[96:99], v244 offset:32768
    v_max3_f32 v242, v0, v1, v242
    v_max3_f32 v242, v2, v3, v242
    v_max3_f32 v242, v4, v5, v242
    s_waitcnt lgkmcnt(2)
    v_mfma_f32_32x32x16_bf16 v[16:31], a[128:131], a[248:251], v[16:31]
    ds_read_b128 a[248:251], v250 offset:32768
    ds_read_b128 a[128:131], v244 offset:40960
    v_max3_f32 v242, v6, v7, v242
    v_max3_f32 v242, v8, v9, v242
    v_max3_f32 v242, v10, v11, v242
    v_mfma_f32_32x32x16_bf16 v[16:31], a[100:103], a[68:71], v[16:31]
    ds_read_b128 a[100:103], v245 offset:32768
    v_max3_f32 v242, v12, v13, v242
    v_max3_f32 v242, v14, v15, v242
    v_fma_f32 v254, v242, s32, -v239
    v_cmp_lt_f32 vcc, s33, v254
    s_waitcnt lgkmcnt(4)
    v_mfma_f32_32x32x16_bf16 v[16:31], a[132:135], a[252:255], v[16:31]
    ds_read_b128 a[252:255], v251 offset:32768
    ds_read_b128 a[132:135], v245 offset:40960
    v_fma_f32 v0, v0, s32, -v239
    v_fma_f32 v1, v1, s32, -v239
    v_fma_f32 v2, v2, s32, -v239
    v_mfma_f32_32x32x16_bf16 v[16:31], a[104:107], a[72:75], v[16:31]
    ds_read_b128 a[104:107], v246 offset:32768
    v_fma_f32 v3, v3, s32, -v239
    v_fma_f32 v4, v4, s32, -v239
    v_fma_f32 v5, v5, s32, -v239
    s_waitcnt lgkmcnt(5)
    v_mfma_f32_32x32x16_bf16 v[16:31], a[136:139], a[248:251], v[16:31]
    ds_read_b128 a[248:251], v248 offset:16384
    ds_read_b128 a[136:139], v246 offset:40960
    s_cbranch_vccnz L_stub_0_1_5
L_back_0_1_5:
    v_exp_f32 v0, v0
    v_fma_f32 v6, v6, s32, -v239
    v_mfma_f32_32x32x16_bf16 v[16:31], a[108:111], a[76:79], v[16:31]
    ds_read_b128 a[108:111], v247 offset:32768
    v_exp_f32 v1, v1
    v_fma_f32 v7, v7, s32, -v239
    v_exp_f32 v2, v2
    s_waitcnt lgkmcnt(5)
    v_mfma_f32_32x32x16_bf16 v[16:31], a[140:143], a[252:255], v[16:31]
    ds_read_b128 a[252:255], v249 offset:16384
    ds_read_b128 a[140:143], v247 offset:40960
    v_fma_f32 v8, v8, s32, -v239
    v_exp_f32 v3, v3
    v_mfma_f32_32x32x16_bf16 v[16:31], a[112:115], a[80:83], v[16:31]
    ds_read_b128 a[112:115], v244 offset:36864
    v_fma_f32 v9, v9, s32, -v239
    v_cvt_pk_bf16_f32 v112, v0, v1
    v_exp_f32 v4, v4
    s_waitcnt lgkmcnt(5)
    v_mfma_f32_32x32x16_bf16 v[16:31], a[144:147], a[248:251], v[16:31]
    ds_read_b128 a[248:251], v250 offset:16384
    ds_read_b128 a[144:147], v244 offset:45056
    v_fma_f32 v10, v10, s32, -v239
    v_exp_f32 v5, v5
    v_fma_f32 v11, v11, s32, -v239
    v_mfma_f32_32x32x16_bf16 v[16:31], a[116:119], a[84:87], v[16:31]
    ds_read_b128 a[116:119], v245 offset:36864
    v_cvt_pk_bf16_f32 v113, v2, v3
    v_exp_f32 v6, v6
    v_fma_f32 v12, v12, s32, -v239
    s_waitcnt lgkmcnt(5)
    v_mfma_f32_32x32x16_bf16 v[16:31], a[148:151], a[252:255], v[16:31]
    ds_read_b128 a[252:255], v251 offset:16384
    ds_read_b128 a[148:151], v245 offset:45056
    v_exp_f32 v7, v7
    v_fma_f32 v13, v13, s32, -v239
    v_mfma_f32_32x32x16_bf16 v[16:31], a[120:123], a[88:91], v[16:31]
    ds_read_b128 a[120:123], v246 offset:36864
    v_cvt_pk_bf16_f32 v114, v4, v5
    v_exp_f32 v8, v8
    v_fma_f32 v14, v14, s32, -v239
    s_waitcnt lgkmcnt(5)
    v_mfma_f32_32x32x16_bf16 v[16:31], a[152:155], a[248:251], v[16:31]
    v_subrev_u32 v248, 32768, v248
    v_subrev_u32 v249, 32768, v249
    v_subrev_u32 v250, 32768, v250
    v_subrev_u32 v251, 32768, v251
    ds_read_b128 a[248:251], v248
    ds_read_b128 a[152:155], v246 offset:45056
    v_mfma_f32_32x32x16_bf16 v[16:31], a[124:127], a[92:95], v[16:31]
    ds_read_b128 a[124:127], v247 offset:36864
    v_exp_f32 v9, v9
    v_fma_f32 v15, v15, s32, -v239
    v_cvt_pk_bf16_f32 v115, v6, v7
    v_exp_f32 v10, v10
    s_waitcnt lgkmcnt(5)
    v_mfma_f32_32x32x16_bf16 v[16:31], a[156:159], a[252:255], v[16:31]
    ds_read_b128 a[252:255], v249
    ds_read_b128 a[156:159], v247 offset:45056
    v_exp_f32 v11, v11
    v_cvt_pk_bf16_f32 v116, v8, v9
    v_exp_f32 v12, v12
    v_mfma_f32_4x4x4_16b_bf16 v[232:235], v[236:237], a[206:207], v[232:235] cbsz:4 abid:0
    v_exp_f32 v13, v13
    v_cvt_pk_bf16_f32 v117, v10, v11
    v_mfma_f32_4x4x4_16b_bf16 v[232:235], v[236:237], v[112:113], v[232:235] cbsz:4 abid:1
    v_exp_f32 v14, v14
    v_exp_f32 v15, v15
    v_mfma_f32_4x4x4_16b_bf16 v[232:235], v[236:237], v[114:115], v[232:235] cbsz:4 abid:1
    v_cvt_pk_bf16_f32 v118, v12, v13
    v_cvt_pk_bf16_f32 v119, v14, v15
    v_mfma_f32_4x4x4_16b_bf16 v[232:235], v[236:237], v[116:117], v[232:235] cbsz:4 abid:1
    v_mfma_f32_32x32x16_bf16 v[0:15], a[96:99], a[0:3], 0
    s_waitcnt lgkmcnt(0)
    s_waitcnt vmcnt(8)
    s_barrier
    s_add_u32 m0, s30, 32768
    s_add_u32 s35, s24, 94208
    buffer_load_dwordx4 v252, s[12:15], s35 offen nt lds
    v_mfma_f32_32x32x16_bf16 v[0:15], a[128:131], a[248:251], v[0:15]
    ds_read_b128 a[248:251], v250
    s_add_u32 s35, s24, 125952
    buffer_load_dwordx4 v253, s[12:15], s35 offen offset:1024 nt lds
    v_max3_f32 v243, v16, v17, v243
    v_max3_f32 v243, v18, v19, v243
    v_mfma_f32_32x32x16_bf16 v[0:15], a[100:103], a[4:7], v[0:15]
    s_add_u32 s35, s24, 157696
    buffer_load_dwordx4 v252, s[12:15], s35 offen offset:2048 nt lds
    v_max3_f32 v243, v20, v21, v243
    v_max3_f32 v243, v22, v23, v243
    v_mfma_f32_32x32x16_bf16 v[0:15], a[132:135], a[252:255], v[0:15]
    ds_read_b128 a[252:255], v251
    s_add_u32 s35, s24, 189440
    buffer_load_dwordx4 v253, s[12:15], s35 offen offset:3072 nt lds
    v_max3_f32 v243, v24, v25, v243
    v_max3_f32 v243, v26, v27, v243
    v_mfma_f32_32x32x16_bf16 v[0:15], a[104:107], a[8:11], v[0:15]
    v_max3_f32 v243, v28, v29, v243
    v_max3_f32 v243, v30, v31, v243
    v_fma_f32 v254, v243, s32, -v240
    v_cmp_lt_f32 vcc, s33, v254
    s_waitcnt lgkmcnt(1)
    v_mfma_f32_32x32x16_bf16 v[0:15], a[136:139], a[248:251], v[0:15]
    ds_read_b128 a[248:251], v248 offset:16384
    v_fma_f32 v16, v16, s32, -v240
    v_fma_f32 v17, v17, s32, -v240
    v_fma_f32 v18, v18, s32, -v240
    v_fma_f32 v19, v19, s32, -v240
    v_mfma_f32_32x32x16_bf16 v[0:15], a[108:111], a[12:15], v[0:15]
    v_fma_f32 v20, v20, s32, -v240
    v_fma_f32 v21, v21, s32, -v240
    s_cbranch_vccnz L_stub_0_2_5
L_back_0_2_5:
    v_exp_f32 v16, v16
    s_waitcnt lgkmcnt(1)
    v_mfma_f32_32x32x16_bf16 v[0:15], a[140:143], a[252:255], v[0:15]
    ds_read_b128 a[252:255], v249 offset:16384
    v_fma_f32 v22, v22, s32, -v240
    v_exp_f32 v17, v17
    v_fma_f32 v23, v23, s32, -v240
    v_mfma_f32_32x32x16_bf16 v[0:15], a[112:115], a[16:19], v[0:15]
    v_exp_f32 v18, v18
    v_fma_f32 v24, v24, s32, -v240
    v_exp_f32 v19, v19
    s_waitcnt lgkmcnt(1)
    v_mfma_f32_32x32x16_bf16 v[0:15], a[144:147], a[248:251], v[0:15]
    ds_read_b128 a[248:251], v250 offset:16384
    v_fma_f32 v25, v25, s32, -v240
    v_cvt_pk_bf16_f32 v120, v16, v17
    v_exp_f32 v20, v20
    v_mfma_f32_32x32x16_bf16 v[0:15], a[116:119], a[20:23], v[0:15]
    v_fma_f32 v26, v26, s32, -v240
    v_exp_f32 v21, v21
    v_fma_f32 v27, v27, s32, -v240
    s_waitcnt lgkmcnt(1)
    v_mfma_f32_32x32x16_bf16 v[0:15], a[148:151], a[252:255], v[0:15]
    ds_read_b128 a[252:255], v251 offset:16384
    v_cvt_pk_bf16_f32 v121, v18, v19
    v_exp_f32 v22, v22
    v_fma_f32 v28, v28, s32, -v240
    v_mfma_f32_32x32x16_bf16 v[0:15], a[120:123], a[24:27], v[0:15]
    v_exp_f32 v23, v23
    v_fma_f32 v29, v29, s32, -v240
    v_cvt_pk_bf16_f32 v122, v20, v21
    s_waitcnt lgkmcnt(1)
    v_mfma_f32_32x32x16_bf16 v[0:15], a[152:155], a[248:251], v[0:15]
    v_add_u32 v248, 32768, v248
    v_add_u32 v249, 32768, v249
    v_add_u32 v250, 32768, v250
    v_add_u32 v251, 32768, v251
    ds_read_b128 a[248:251], v248
    v_exp_f32 v24, v24
    v_mfma_f32_32x32x16_bf16 v[0:15], a[124:127], a[28:31], v[0:15]
    v_fma_f32 v30, v30, s32, -v240
    v_exp_f32 v25, v25
    v_fma_f32 v31, v31, s32, -v240
    v_cvt_pk_bf16_f32 v123, v22, v23
    s_waitcnt lgkmcnt(1)
    v_mfma_f32_32x32x16_bf16 v[0:15], a[156:159], a[252:255], v[0:15]
    ds_read_b128 a[252:255], v249
    v_exp_f32 v26, v26
    v_exp_f32 v27, v27
    v_cvt_pk_bf16_f32 v124, v24, v25
    v_exp_f32 v28, v28
    v_mfma_f32_4x4x4_16b_bf16 v[232:235], v[236:237], v[118:119], v[232:235] cbsz:4 abid:1
    v_exp_f32 v29, v29
    v_cvt_pk_bf16_f32 v125, v26, v27
    v_mfma_f32_4x4x4_16b_bf16 v[232:235], v[236:237], v[120:121], v[232:235] cbsz:4 abid:2
    v_exp_f32 v30, v30
    v_exp_f32 v31, v31
    v_mfma_f32_4x4x4_16b_bf16 v[232:235], v[236:237], v[122:123], v[232:235] cbsz:4 abid:2
    v_cvt_pk_bf16_f32 v126, v28, v29
    v_cvt_pk_bf16_f32 v127, v30, v31
    v_mfma_f32_4x4x4_16b_bf16 v[232:235], v[236:237], v[124:125], v[232:235] cbsz:4 abid:2
    v_mfma_f32_32x32x16_bf16 v[16:31], a[96:99], a[32:35], 0
    v_max3_f32 v241, v0, v1, v241
    v_max3_f32 v241, v2, v3, v241
    v_max3_f32 v241, v4, v5, v241
    v_max3_f32 v241, v6, v7, v241
    s_waitcnt lgkmcnt(1)
    v_mfma_f32_32x32x16_bf16 v[16:31], a[128:131], a[248:251], v[16:31]
    ds_read_b128 a[248:251], v250
    v_max3_f32 v241, v8, v9, v241
    v_max3_f32 v241, v10, v11, v241
    v_max3_f32 v241, v12, v13, v241
    v_max3_f32 v241, v14, v15, v241
    v_mfma_f32_32x32x16_bf16 v[16:31], a[100:103], a[36:39], v[16:31]
    v_fma_f32 v254, v241, s32, -v238
    v_cmp_lt_f32 vcc, s33, v254
    v_fma_f32 v0, v0, s32, -v238
    v_fma_f32 v1, v1, s32, -v238
    s_waitcnt lgkmcnt(1)
    v_mfma_f32_32x32x16_bf16 v[16:31], a[132:135], a[252:255], v[16:31]
    ds_read_b128 a[252:255], v251
    v_fma_f32 v2, v2, s32, -v238
    v_fma_f32 v3, v3, s32, -v238
    v_fma_f32 v4, v4, s32, -v238
    v_fma_f32 v5, v5, s32, -v238
    v_mfma_f32_32x32x16_bf16 v[16:31], a[104:107], a[40:43], v[16:31]
    s_cbranch_vccnz L_stub_0_0_6
L_back_0_0_6:
    v_exp_f32 v0, v0
    v_fma_f32 v6, v6, s32, -v238
    v_exp_f32 v1, v1
    s_waitcnt lgkmcnt(1)
    v_mfma_f32_32x32x16_bf16 v[16:31], a[136:139], a[248:251], v[16:31]
    ds_read_b128 a[248:251], v248 offset:49152
    v_fma_f32 v7, v7, s32, -v238
    v_exp_f32 v2, v2
    v_fma_f32 v8, v8, s32, -v238
    v_mfma_f32_32x32x16_bf16 v[16:31], a[108:111], a[44:47], v[16:31]
    v_exp_f32 v3, v3
    v_fma_f32 v9, v9, s32, -v238
    v_cvt_pk_bf16_f32 v0, v0, v1
    s_waitcnt lgkmcnt(1)
    v_mfma_f32_32x32x16_bf16 v[16:31], a[140:143], a[252:255], v[16:31]
    ds_read_b128 a[252:255], v249 offset:49152
    v_accvgpr_write_b32 a208, v0
    v_exp_f32 v4, v4
    v_fma_f32 v10, v10, s32, -v238
    v_mfma_f32_32x32x16_bf16 v[16:31], a[112:115], a[48:51], v[16:31]
    v_exp_f32 v5, v5
    v_fma_f32 v11, v11, s32, -v238
    v_cvt_pk_bf16_f32 v2, v2, v3
    s_waitcnt lgkmcnt(1)
    v_mfma_f32_32x32x16_bf16 v[16:31], a[144:147], a[248:251], v[16:31]
    ds_read_b128 a[248:251], v250 offset:49152
    v_accvgpr_write_b32 a209, v2
    v_exp_f32 v6, v6
    v_fma_f32 v12, v12, s32, -v238
    v_mfma_f32_32x32x16_bf16 v[16:31], a[116:119], a[52:55], v[16:31]
    v_exp_f32 v7, v7
    v_fma_f32 v13, v13, s32, -v238
    v_cvt_pk_bf16_f32 v4, v4, v5
    s_waitcnt lgkmcnt(1)
    v_mfma_f32_32x32x16_bf16 v[16:31], a[148:151], a[252:255], v[16:31]
    ds_read_b128 a[252:255], v251 offset:49152
    v_accvgpr_write_b32 a210, v4
    v_exp_f32 v8, v8
    v_fma_f32 v14, v14, s32, -v238
    v_mfma_f32_32x32x16_bf16 v[16:31], a[120:123], a[56:59], v[16:31]
    v_exp_f32 v9, v9
    v_fma_f32 v15, v15, s32, -v238
    v_cvt_pk_bf16_f32 v6, v6, v7
    s_waitcnt lgkmcnt(1)
    v_mfma_f32_32x32x16_bf16 v[16:31], a[152:155], a[248:251], v[16:31]
    ds_read_b128 a[248:251], v248 offset:32768
    v_accvgpr_write_b32 a211, v6
    v_exp_f32 v10, v10
    v_exp_f32 v11, v11
    v_mfma_f32_32x32x16_bf16 v[16:31], a[124:127], a[60:63], v[16:31]
    v_cvt_pk_bf16_f32 v8, v8, v9
    v_accvgpr_write_b32 a212, v8
    v_exp_f32 v12, v12
    s_waitcnt lgkmcnt(1)
    v_mfma_f32_32x32x16_bf16 v[16:31], a[156:159], a[252:255], v[16:31]
    ds_read_b128 a[252:255], v249 offset:32768
    v_exp_f32 v13, v13
    v_cvt_pk_bf16_f32 v10, v10, v11
    v_accvgpr_write_b32 a213, v10
    v_mfma_f32_4x4x4_16b_bf16 v[232:235], v[236:237], v[126:127], v[232:235] cbsz:4 abid:2
    v_exp_f32 v14, v14
    v_exp_f32 v15, v15
    v_mfma_f32_4x4x4_16b_bf16 v[232:235], v[236:237], a[208:209], v[232:235] cbsz:4 abid:0
    v_cvt_pk_bf16_f32 v12, v12, v13
    v_accvgpr_write_b32 a214, v12
    v_mfma_f32_4x4x4_16b_bf16 v[232:235], v[236:237], a[210:211], v[232:235] cbsz:4 abid:0
    v_cvt_pk_bf16_f32 v14, v14, v15
    v_accvgpr_write_b32 a215, v14
    v_mfma_f32_4x4x4_16b_bf16 v[232:235], v[236:237], a[212:213], v[232:235] cbsz:4 abid:0
    v_mfma_f32_32x32x16_bf16 v[0:15], a[96:99], a[64:67], 0
    ds_read_b128 a[96:99], v244 offset:49152
    v_max3_f32 v242, v16, v17, v242
    v_max3_f32 v242, v18, v19, v242
    v_max3_f32 v242, v20, v21, v242
    s_waitcnt lgkmcnt(2)
    v_mfma_f32_32x32x16_bf16 v[0:15], a[128:131], a[248:251], v[0:15]
    ds_read_b128 a[248:251], v250 offset:32768
    ds_read_b128 a[128:131], v244 offset:57344
    v_max3_f32 v242, v22, v23, v242
    v_max3_f32 v242, v24, v25, v242
    v_max3_f32 v242, v26, v27, v242
    v_mfma_f32_32x32x16_bf16 v[0:15], a[100:103], a[68:71], v[0:15]
    ds_read_b128 a[100:103], v245 offset:49152
    v_max3_f32 v242, v28, v29, v242
    v_max3_f32 v242, v30, v31, v242
    v_fma_f32 v254, v242, s32, -v239
    v_cmp_lt_f32 vcc, s33, v254
    s_waitcnt lgkmcnt(4)
    v_mfma_f32_32x32x16_bf16 v[0:15], a[132:135], a[252:255], v[0:15]
    ds_read_b128 a[252:255], v251 offset:32768
    ds_read_b128 a[132:135], v245 offset:57344
    v_fma_f32 v16, v16, s32, -v239
    v_fma_f32 v17, v17, s32, -v239
    v_fma_f32 v18, v18, s32, -v239
    v_mfma_f32_32x32x16_bf16 v[0:15], a[104:107], a[72:75], v[0:15]
    ds_read_b128 a[104:107], v246 offset:49152
    v_fma_f32 v19, v19, s32, -v239
    v_fma_f32 v20, v20, s32, -v239
    v_fma_f32 v21, v21, s32, -v239
    s_waitcnt lgkmcnt(5)
    v_mfma_f32_32x32x16_bf16 v[0:15], a[136:139], a[248:251], v[0:15]
    ds_read_b128 a[248:251], v248 offset:16384
    ds_read_b128 a[136:139], v246 offset:57344
    s_cbranch_vccnz L_stub_0_1_6
L_back_0_1_6:
    v_exp_f32 v16, v16
    v_fma_f32 v22, v22, s32, -v239
    v_mfma_f32_32x32x16_bf16 v[0:15], a[108:111], a[76:79], v[0:15]
    ds_read_b128 a[108:111], v247 offset:49152
    v_exp_f32 v17, v17
    v_fma_f32 v23, v23, s32, -v239
    v_exp_f32 v18, v18
    s_waitcnt lgkmcnt(5)
    v_mfma_f32_32x32x16_bf16 v[0:15], a[140:143], a[252:255], v[0:15]
    ds_read_b128 a[252:255], v249 offset:16384
    ds_read_b128 a[140:143], v247 offset:57344
    v_fma_f32 v24, v24, s32, -v239
    v_exp_f32 v19, v19
    v_mfma_f32_32x32x16_bf16 v[0:15], a[112:115], a[80:83], v[0:15]
    ds_read_b128 a[112:115], v244 offset:53248
    v_fma_f32 v25, v25, s32, -v239
    v_cvt_pk_bf16_f32 v128, v16, v17
    v_exp_f32 v20, v20
    s_waitcnt lgkmcnt(5)
    v_mfma_f32_32x32x16_bf16 v[0:15], a[144:147], a[248:251], v[0:15]
    ds_read_b128 a[248:251], v250 offset:16384
    ds_read_b128 a[144:147], v244 offset:61440
    v_fma_f32 v26, v26, s32, -v239
    v_exp_f32 v21, v21
    v_fma_f32 v27, v27, s32, -v239
    v_mfma_f32_32x32x16_bf16 v[0:15], a[116:119], a[84:87], v[0:15]
    ds_read_b128 a[116:119], v245 offset:53248
    v_cvt_pk_bf16_f32 v129, v18, v19
    v_exp_f32 v22, v22
    v_fma_f32 v28, v28, s32, -v239
    s_waitcnt lgkmcnt(5)
    v_mfma_f32_32x32x16_bf16 v[0:15], a[148:151], a[252:255], v[0:15]
    ds_read_b128 a[252:255], v251 offset:16384
    ds_read_b128 a[148:151], v245 offset:61440
    v_exp_f32 v23, v23
    v_fma_f32 v29, v29, s32, -v239
    v_mfma_f32_32x32x16_bf16 v[0:15], a[120:123], a[88:91], v[0:15]
    ds_read_b128 a[120:123], v246 offset:53248
    v_cvt_pk_bf16_f32 v130, v20, v21
    v_exp_f32 v24, v24
    v_fma_f32 v30, v30, s32, -v239
    s_waitcnt lgkmcnt(5)
    v_mfma_f32_32x32x16_bf16 v[0:15], a[152:155], a[248:251], v[0:15]
    v_subrev_u32 v248, 32768, v248
    v_subrev_u32 v249, 32768, v249
    v_subrev_u32 v250, 32768, v250
    v_subrev_u32 v251, 32768, v251
    ds_read_b128 a[248:251], v248
    ds_read_b128 a[152:155], v246 offset:61440
    v_mfma_f32_32x32x16_bf16 v[0:15], a[124:127], a[92:95], v[0:15]
    ds_read_b128 a[124:127], v247 offset:53248
    v_exp_f32 v25, v25
    v_fma_f32 v31, v31, s32, -v239
    v_cvt_pk_bf16_f32 v131, v22, v23
    v_exp_f32 v26, v26
    s_waitcnt lgkmcnt(5)
    v_mfma_f32_32x32x16_bf16 v[0:15], a[156:159], a[252:255], v[0:15]
    ds_read_b128 a[252:255], v249
    ds_read_b128 a[156:159], v247 offset:61440
    v_exp_f32 v27, v27
    v_cvt_pk_bf16_f32 v132, v24, v25
    v_exp_f32 v28, v28
    v_mfma_f32_4x4x4_16b_bf16 v[232:235], v[236:237], a[214:215], v[232:235] cbsz:4 abid:0
    v_exp_f32 v29, v29
    v_cvt_pk_bf16_f32 v133, v26, v27
    v_mfma_f32_4x4x4_16b_bf16 v[232:235], v[236:237], v[128:129], v[232:235] cbsz:4 abid:1
    v_exp_f32 v30, v30
    v_exp_f32 v31, v31
    v_mfma_f32_4x4x4_16b_bf16 v[232:235], v[236:237], v[130:131], v[232:235] cbsz:4 abid:1
    v_cvt_pk_bf16_f32 v134, v28, v29
    v_cvt_pk_bf16_f32 v135, v30, v31
    v_mfma_f32_4x4x4_16b_bf16 v[232:235], v[236:237], v[132:133], v[232:235] cbsz:4 abid:1
    v_mfma_f32_32x32x16_bf16 v[16:31], a[96:99], a[0:3], 0
    s_waitcnt lgkmcnt(0)
    s_waitcnt vmcnt(8)
    s_barrier
    s_add_u32 m0, s30, 49152
    s_add_u32 s35, s24, 98304
    buffer_load_dwordx4 v252, s[12:15], s35 offen nt lds
    v_mfma_f32_32x32x16_bf16 v[16:31], a[128:131], a[248:251], v[16:31]
    ds_read_b128 a[248:251], v250
    s_add_u32 s35, s24, 130048
    buffer_load_dwordx4 v253, s[12:15], s35 offen offset:1024 nt lds
    v_max3_f32 v243, v0, v1, v243
    v_max3_f32 v243, v2, v3, v243
    v_mfma_f32_32x32x16_bf16 v[16:31], a[100:103], a[4:7], v[16:31]
    s_add_u32 s35, s24, 161792
    buffer_load_dwordx4 v252, s[12:15], s35 offen offset:2048 nt lds
    v_max3_f32 v243, v4, v5, v243
    v_max3_f32 v243, v6, v7, v243
    v_mfma_f32_32x32x16_bf16 v[16:31], a[132:135], a[252:255], v[16:31]
    ds_read_b128 a[252:255], v251
    s_add_u32 s35, s24, 193536
    buffer_load_dwordx4 v253, s[12:15], s35 offen offset:3072 nt lds
    v_max3_f32 v243, v8, v9, v243
    v_max3_f32 v243, v10, v11, v243
    v_mfma_f32_32x32x16_bf16 v[16:31], a[104:107], a[8:11], v[16:31]
    v_max3_f32 v243, v12, v13, v243
    v_max3_f32 v243, v14, v15, v243
    v_fma_f32 v254, v243, s32, -v240
    v_cmp_lt_f32 vcc, s33, v254
    s_waitcnt lgkmcnt(1)
    v_mfma_f32_32x32x16_bf16 v[16:31], a[136:139], a[248:251], v[16:31]
    ds_read_b128 a[248:251], v248 offset:16384
    v_fma_f32 v0, v0, s32, -v240
    v_fma_f32 v1, v1, s32, -v240
    v_fma_f32 v2, v2, s32, -v240
    v_fma_f32 v3, v3, s32, -v240
    v_mfma_f32_32x32x16_bf16 v[16:31], a[108:111], a[12:15], v[16:31]
    v_fma_f32 v4, v4, s32, -v240
    v_fma_f32 v5, v5, s32, -v240
    s_cbranch_vccnz L_stub_0_2_6
L_back_0_2_6:
    v_exp_f32 v0, v0
    s_waitcnt lgkmcnt(1)
    v_mfma_f32_32x32x16_bf16 v[16:31], a[140:143], a[252:255], v[16:31]
    ds_read_b128 a[252:255], v249 offset:16384
    v_fma_f32 v6, v6, s32, -v240
    v_exp_f32 v1, v1
    v_fma_f32 v7, v7, s32, -v240
    v_mfma_f32_32x32x16_bf16 v[16:31], a[112:115], a[16:19], v[16:31]
    v_exp_f32 v2, v2
    v_fma_f32 v8, v8, s32, -v240
    v_exp_f32 v3, v3
    s_waitcnt lgkmcnt(1)
    v_mfma_f32_32x32x16_bf16 v[16:31], a[144:147], a[248:251], v[16:31]
    ds_read_b128 a[248:251], v250 offset:16384
    v_fma_f32 v9, v9, s32, -v240
    v_cvt_pk_bf16_f32 v136, v0, v1
    v_exp_f32 v4, v4
    v_mfma_f32_32x32x16_bf16 v[16:31], a[116:119], a[20:23], v[16:31]
    v_fma_f32 v10, v10, s32, -v240
    v_exp_f32 v5, v5
    v_fma_f32 v11, v11, s32, -v240
    s_waitcnt lgkmcnt(1)
    v_mfma_f32_32x32x16_bf16 v[16:31], a[148:151], a[252:255], v[16:31]
    ds_read_b128 a[252:255], v251 offset:16384
    v_cvt_pk_bf16_f32 v137, v2, v3
    v_exp_f32 v6, v6
    v_fma_f32 v12, v12, s32, -v240
    v_mfma_f32_32x32x16_bf16 v[16:31], a[120:123], a[24:27], v[16:31]
    v_exp_f32 v7, v7
    v_fma_f32 v13, v13, s32, -v240
    v_cvt_pk_bf16_f32 v138, v4, v5
    s_waitcnt lgkmcnt(1)
    v_mfma_f32_32x32x16_bf16 v[16:31], a[152:155], a[248:251], v[16:31]
    v_add_u32 v248, 32768, v248
    v_add_u32 v249, 32768, v249
    v_add_u32 v250, 32768, v250
    v_add_u32 v251, 32768, v251
    ds_read_b128 a[248:251], v248
    v_exp_f32 v8, v8
    v_mfma_f32_32x32x16_bf16 v[16:31], a[124:127], a[28:31], v[16:31]
    v_fma_f32 v14, v14, s32, -v240
    v_exp_f32 v9, v9
    v_fma_f32 v15, v15, s32, -v240
    v_cvt_pk_bf16_f32 v139, v6, v7
    s_waitcnt lgkmcnt(1)
    v_mfma_f32_32x32x16_bf16 v[16:31], a[156:159], a[252:255], v[16:31]
    ds_read_b128 a[252:255], v249
    v_exp_f32 v10, v10
    v_exp_f32 v11, v11
    v_cvt_pk_bf16_f32 v140, v8, v9
    v_exp_f32 v12, v12
    v_mfma_f32_4x4x4_16b_bf16 v[232:235], v[236:237], v[134:135], v[232:235] cbsz:4 abid:1
    v_exp_f32 v13, v13
    v_cvt_pk_bf16_f32 v141, v10, v11
    v_mfma_f32_4x4x4_16b_bf16 v[232:235], v[236:237], v[136:137], v[232:235] cbsz:4 abid:2
    v_exp_f32 v14, v14
    v_exp_f32 v15, v15
    v_mfma_f32_4x4x4_16b_bf16 v[232:235], v[236:237], v[138:139], v[232:235] cbsz:4 abid:2
    v_cvt_pk_bf16_f32 v142, v12, v13
    v_cvt_pk_bf16_f32 v143, v14, v15
    v_mfma_f32_4x4x4_16b_bf16 v[232:235], v[236:237], v[140:141], v[232:235] cbsz:4 abid:2
    v_mfma_f32_32x32x16_bf16 v[0:15], a[96:99], a[32:35], 0
    v_max3_f32 v241, v16, v17, v241
    v_max3_f32 v241, v18, v19, v241
    v_max3_f32 v241, v20, v21, v241
    v_max3_f32 v241, v22, v23, v241
    s_waitcnt lgkmcnt(1)
    v_mfma_f32_32x32x16_bf16 v[0:15], a[128:131], a[248:251], v[0:15]
    ds_read_b128 a[248:251], v250
    v_max3_f32 v241, v24, v25, v241
    v_max3_f32 v241, v26, v27, v241
    v_max3_f32 v241, v28, v29, v241
    v_max3_f32 v241, v30, v31, v241
    v_mfma_f32_32x32x16_bf16 v[0:15], a[100:103], a[36:39], v[0:15]
    v_fma_f32 v254, v241, s32, -v238
    v_cmp_lt_f32 vcc, s33, v254
    v_fma_f32 v16, v16, s32, -v238
    v_fma_f32 v17, v17, s32, -v238
    s_waitcnt lgkmcnt(1)
    v_mfma_f32_32x32x16_bf16 v[0:15], a[132:135], a[252:255], v[0:15]
    ds_read_b128 a[252:255], v251
    v_fma_f32 v18, v18, s32, -v238
    v_fma_f32 v19, v19, s32, -v238
    v_fma_f32 v20, v20, s32, -v238
    v_fma_f32 v21, v21, s32, -v238
    v_mfma_f32_32x32x16_bf16 v[0:15], a[104:107], a[40:43], v[0:15]
    s_cbranch_vccnz L_stub_0_0_7
L_back_0_0_7:
    v_exp_f32 v16, v16
    v_fma_f32 v22, v22, s32, -v238
    v_exp_f32 v17, v17
    s_waitcnt lgkmcnt(1)
    v_mfma_f32_32x32x16_bf16 v[0:15], a[136:139], a[248:251], v[0:15]
    ds_read_b128 a[248:251], v248 offset:49152
    v_fma_f32 v23, v23, s32, -v238
    v_exp_f32 v18, v18
    v_fma_f32 v24, v24, s32, -v238
    v_mfma_f32_32x32x16_bf16 v[0:15], a[108:111], a[44:47], v[0:15]
    v_exp_f32 v19, v19
    v_fma_f32 v25, v25, s32, -v238
    v_cvt_pk_bf16_f32 v16, v16, v17
    s_waitcnt lgkmcnt(1)
    v_mfma_f32_32x32x16_bf16 v[0:15], a[140:143], a[252:255], v[0:15]
    ds_read_b128 a[252:255], v249 offset:49152
    v_accvgpr_write_b32 a216, v16
    v_exp_f32 v20, v20
    v_fma_f32 v26, v26, s32, -v238
    v_mfma_f32_32x32x16_bf16 v[0:15], a[112:115], a[48:51], v[0:15]
    v_exp_f32 v21, v21
    v_fma_f32 v27, v27, s32, -v238
    v_cvt_pk_bf16_f32 v18, v18, v19
    s_waitcnt lgkmcnt(1)
    v_mfma_f32_32x32x16_bf16 v[0:15], a[144:147], a[248:251], v[0:15]
    ds_read_b128 a[248:251], v250 offset:49152
    v_accvgpr_write_b32 a217, v18
    v_exp_f32 v22, v22
    v_fma_f32 v28, v28, s32, -v238
    v_mfma_f32_32x32x16_bf16 v[0:15], a[116:119], a[52:55], v[0:15]
    v_exp_f32 v23, v23
    v_fma_f32 v29, v29, s32, -v238
    v_cvt_pk_bf16_f32 v20, v20, v21
    s_waitcnt lgkmcnt(1)
    v_mfma_f32_32x32x16_bf16 v[0:15], a[148:151], a[252:255], v[0:15]
    ds_read_b128 a[252:255], v251 offset:49152
    v_accvgpr_write_b32 a218, v20
    v_exp_f32 v24, v24
    v_fma_f32 v30, v30, s32, -v238
    v_mfma_f32_32x32x16_bf16 v[0:15], a[120:123], a[56:59], v[0:15]
    v_exp_f32 v25, v25
    v_fma_f32 v31, v31, s32, -v238
    v_cvt_pk_bf16_f32 v22, v22, v23
    s_waitcnt lgkmcnt(1)
    v_mfma_f32_32x32x16_bf16 v[0:15], a[152:155], a[248:251], v[0:15]
    ds_read_b128 a[248:251], v248 offset:32768
    v_accvgpr_write_b32 a219, v22
    v_exp_f32 v26, v26
    v_exp_f32 v27, v27
    v_mfma_f32_32x32x16_bf16 v[0:15], a[124:127], a[60:63], v[0:15]
    v_cvt_pk_bf16_f32 v24, v24, v25
    v_accvgpr_write_b32 a220, v24
    v_exp_f32 v28, v28
    s_waitcnt lgkmcnt(1)
    v_mfma_f32_32x32x16_bf16 v[0:15], a[156:159], a[252:255], v[0:15]
    ds_read_b128 a[252:255], v249 offset:32768
    v_exp_f32 v29, v29
    v_cvt_pk_bf16_f32 v26, v26, v27
    v_accvgpr_write_b32 a221, v26
    v_mfma_f32_4x4x4_16b_bf16 v[232:235], v[236:237], v[142:143], v[232:235] cbsz:4 abid:2
    v_exp_f32 v30, v30
    v_exp_f32 v31, v31
    v_mfma_f32_4x4x4_16b_bf16 v[232:235], v[236:237], a[216:217], v[232:235] cbsz:4 abid:0
    v_cvt_pk_bf16_f32 v28, v28, v29
    v_accvgpr_write_b32 a222, v28
    v_mfma_f32_4x4x4_16b_bf16 v[232:235], v[236:237], a[218:219], v[232:235] cbsz:4 abid:0
    v_cvt_pk_bf16_f32 v30, v30, v31
    v_accvgpr_write_b32 a223, v30
    v_mfma_f32_4x4x4_16b_bf16 v[232:235], v[236:237], a[220:221], v[232:235] cbsz:4 abid:0
    v_mfma_f32_32x32x16_bf16 v[16:31], a[96:99], a[64:67], 0
    ds_read_b128 a[96:99], v244
    v_max3_f32 v242, v0, v1, v242
    v_max3_f32 v242, v2, v3, v242
    v_max3_f32 v242, v4, v5, v242
    s_waitcnt lgkmcnt(2)
    v_mfma_f32_32x32x16_bf16 v[16:31], a[128:131], a[248:251], v[16:31]
    ds_read_b128 a[248:251], v250 offset:32768
    ds_read_b128 a[128:131], v244 offset:8192
    v_max3_f32 v242, v6, v7, v242
    v_max3_f32 v242, v8, v9, v242
    v_max3_f32 v242, v10, v11, v242
    v_mfma_f32_32x32x16_bf16 v[16:31], a[100:103], a[68:71], v[16:31]
    ds_read_b128 a[100:103], v245
    v_max3_f32 v242, v12, v13, v242
    v_max3_f32 v242, v14, v15, v242
    v_fma_f32 v254, v242, s32, -v239
    v_cmp_lt_f32 vcc, s33, v254
    s_waitcnt lgkmcnt(4)
    v_mfma_f32_32x32x16_bf16 v[16:31], a[132:135], a[252:255], v[16:31]
    ds_read_b128 a[252:255], v251 offset:32768
    ds_read_b128 a[132:135], v245 offset:8192
    v_fma_f32 v0, v0, s32, -v239
    v_fma_f32 v1, v1, s32, -v239
    v_fma_f32 v2, v2, s32, -v239
    v_mfma_f32_32x32x16_bf16 v[16:31], a[104:107], a[72:75], v[16:31]
    ds_read_b128 a[104:107], v246
    v_fma_f32 v3, v3, s32, -v239
    v_fma_f32 v4, v4, s32, -v239
    v_fma_f32 v5, v5, s32, -v239
    s_waitcnt lgkmcnt(5)
    v_mfma_f32_32x32x16_bf16 v[16:31], a[136:139], a[248:251], v[16:31]
    ds_read_b128 a[248:251], v248 offset:16384
    ds_read_b128 a[136:139], v246 offset:8192
    s_cbranch_vccnz L_stub_0_1_7
L_back_0_1_7:
    v_exp_f32 v0, v0
    v_fma_f32 v6, v6, s32, -v239
    v_mfma_f32_32x32x16_bf16 v[16:31], a[108:111], a[76:79], v[16:31]
    ds_read_b128 a[108:111], v247
    v_exp_f32 v1, v1
    v_fma_f32 v7, v7, s32, -v239
    v_exp_f32 v2, v2
    s_waitcnt lgkmcnt(5)
    v_mfma_f32_32x32x16_bf16 v[16:31], a[140:143], a[252:255], v[16:31]
    ds_read_b128 a[252:255], v249 offset:16384
    ds_read_b128 a[140:143], v247 offset:8192
    v_fma_f32 v8, v8, s32, -v239
    v_exp_f32 v3, v3
    v_mfma_f32_32x32x16_bf16 v[16:31], a[112:115], a[80:83], v[16:31]
    ds_read_b128 a[112:115], v244 offset:4096
    v_fma_f32 v9, v9, s32, -v239
    v_cvt_pk_bf16_f32 v144, v0, v1
    v_exp_f32 v4, v4
    s_waitcnt lgkmcnt(5)
    v_mfma_f32_32x32x16_bf16 v[16:31], a[144:147], a[248:251], v[16:31]
    ds_read_b128 a[248:251], v250 offset:16384
    ds_read_b128 a[144:147], v244 offset:12288
    v_fma_f32 v10, v10, s32, -v239
    v_exp_f32 v5, v5
    v_fma_f32 v11, v11, s32, -v239
    v_mfma_f32_32x32x16_bf16 v[16:31], a[116:119], a[84:87], v[16:31]
    ds_read_b128 a[116:119], v245 offset:4096
    v_cvt_pk_bf16_f32 v145, v2, v3
    v_exp_f32 v6, v6
    v_fma_f32 v12, v12, s32, -v239
    s_waitcnt lgkmcnt(5)
    v_mfma_f32_32x32x16_bf16 v[16:31], a[148:151], a[252:255], v[16:31]
    ds_read_b128 a[252:255], v251 offset:16384
    ds_read_b128 a[148:151], v245 offset:12288
    v_exp_f32 v7, v7
    v_fma_f32 v13, v13, s32, -v239
    v_mfma_f32_32x32x16_bf16 v[16:31], a[120:123], a[88:91], v[16:31]
    ds_read_b128 a[120:123], v246 offset:4096
    v_cvt_pk_bf16_f32 v146, v4, v5
    v_exp_f32 v8, v8
    v_fma_f32 v14, v14, s32, -v239
    s_waitcnt lgkmcnt(5)
    v_mfma_f32_32x32x16_bf16 v[16:31], a[152:155], a[248:251], v[16:31]
    v_subrev_u32 v248, 32768, v248
    v_subrev_u32 v249, 32768, v249
    v_subrev_u32 v250, 32768, v250
    v_subrev_u32 v251, 32768, v251
    ds_read_b128 a[248:251], v248
    ds_read_b128 a[152:155], v246 offset:12288
    v_mfma_f32_32x32x16_bf16 v[16:31], a[124:127], a[92:95], v[16:31]
    ds_read_b128 a[124:127], v247 offset:4096
    v_exp_f32 v9, v9
    v_fma_f32 v15, v15, s32, -v239
    v_cvt_pk_bf16_f32 v147, v6, v7
    v_exp_f32 v10, v10
    s_waitcnt lgkmcnt(5)
    v_mfma_f32_32x32x16_bf16 v[16:31], a[156:159], a[252:255], v[16:31]
    ds_read_b128 a[252:255], v249
    ds_read_b128 a[156:159], v247 offset:12288
    v_exp_f32 v11, v11
    v_cvt_pk_bf16_f32 v148, v8, v9
    v_exp_f32 v12, v12
    v_mfma_f32_4x4x4_16b_bf16 v[232:235], v[236:237], a[222:223], v[232:235] cbsz:4 abid:0
    v_exp_f32 v13, v13
    v_cvt_pk_bf16_f32 v149, v10, v11
    v_mfma_f32_4x4x4_16b_bf16 v[232:235], v[236:237], v[144:145], v[232:235] cbsz:4 abid:1
    v_exp_f32 v14, v14
    v_exp_f32 v15, v15
    v_mfma_f32_4x4x4_16b_bf16 v[232:235], v[236:237], v[146:147], v[232:235] cbsz:4 abid:1
    v_cvt_pk_bf16_f32 v150, v12, v13
    v_cvt_pk_bf16_f32 v151, v14, v15
    v_mfma_f32_4x4x4_16b_bf16 v[232:235], v[236:237], v[148:149], v[232:235] cbsz:4 abid:1
    v_mfma_f32_32x32x16_bf16 v[0:15], a[96:99], a[0:3], 0
    s_waitcnt lgkmcnt(0)
    s_waitcnt vmcnt(8)
    s_barrier
    s_add_u32 m0, s30, 0
    s_add_u32 s35, s26, 4096
    buffer_load_dwordx4 v252, s[16:19], s35 offen nt lds
    v_mfma_f32_32x32x16_bf16 v[0:15], a[128:131], a[248:251], v[0:15]
    ds_read_b128 a[248:251], v250
    s_add_u32 s35, s26, 35840
    buffer_load_dwordx4 v253, s[16:19], s35 offen offset:1024 nt lds
    v_max3_f32 v243, v16, v17, v243
    v_max3_f32 v243, v18, v19, v243
    v_mfma_f32_32x32x16_bf16 v[0:15], a[100:103], a[4:7], v[0:15]
    s_add_u32 s35, s26, 67584
    buffer_load_dwordx4 v252, s[16:19], s35 offen offset:2048 nt lds
    v_max3_f32 v243, v20, v21, v243
    v_max3_f32 v243, v22, v23, v243
    v_mfma_f32_32x32x16_bf16 v[0:15], a[132:135], a[252:255], v[0:15]
    ds_read_b128 a[252:255], v251
    s_add_u32 s35, s26, 99328
    buffer_load_dwordx4 v253, s[16:19], s35 offen offset:3072 nt lds
    v_max3_f32 v243, v24, v25, v243
    v_max3_f32 v243, v26, v27, v243
    v_mfma_f32_32x32x16_bf16 v[0:15], a[104:107], a[8:11], v[0:15]
    v_max3_f32 v243, v28, v29, v243
    v_max3_f32 v243, v30, v31, v243
    v_fma_f32 v254, v243, s32, -v240
    v_cmp_lt_f32 vcc, s33, v254
    s_waitcnt lgkmcnt(1)
    v_mfma_f32_32x32x16_bf16 v[0:15], a[136:139], a[248:251], v[0:15]
    ds_read_b128 a[248:251], v248 offset:16384
    v_fma_f32 v16, v16, s32, -v240
    v_fma_f32 v17, v17, s32, -v240
    v_fma_f32 v18, v18, s32, -v240
    v_fma_f32 v19, v19, s32, -v240
    v_mfma_f32_32x32x16_bf16 v[0:15], a[108:111], a[12:15], v[0:15]
    v_fma_f32 v20, v20, s32, -v240
    v_fma_f32 v21, v21, s32, -v240
    s_cbranch_vccnz L_stub_0_2_7
L_back_0_2_7:
    v_exp_f32 v16, v16
    s_waitcnt lgkmcnt(1)
    v_mfma_f32_32x32x16_bf16 v[0:15], a[140:143], a[252:255], v[0:15]
    ds_read_b128 a[252:255], v249 offset:16384
    v_fma_f32 v22, v22, s32, -v240
    v_exp_f32 v17, v17
    v_fma_f32 v23, v23, s32, -v240
    v_mfma_f32_32x32x16_bf16 v[0:15], a[112:115], a[16:19], v[0:15]
    v_exp_f32 v18, v18
    v_fma_f32 v24, v24, s32, -v240
    v_exp_f32 v19, v19
    s_waitcnt lgkmcnt(1)
    v_mfma_f32_32x32x16_bf16 v[0:15], a[144:147], a[248:251], v[0:15]
    ds_read_b128 a[248:251], v250 offset:16384
    v_fma_f32 v25, v25, s32, -v240
    v_cvt_pk_bf16_f32 v152, v16, v17
    v_exp_f32 v20, v20
    v_mfma_f32_32x32x16_bf16 v[0:15], a[116:119], a[20:23], v[0:15]
    v_fma_f32 v26, v26, s32, -v240
    v_exp_f32 v21, v21
    v_fma_f32 v27, v27, s32, -v240
    s_waitcnt lgkmcnt(1)
    v_mfma_f32_32x32x16_bf16 v[0:15], a[148:151], a[252:255], v[0:15]
    ds_read_b128 a[252:255], v251 offset:16384
    v_cvt_pk_bf16_f32 v153, v18, v19
    v_exp_f32 v22, v22
    v_fma_f32 v28, v28, s32, -v240
    v_mfma_f32_32x32x16_bf16 v[0:15], a[120:123], a[24:27], v[0:15]
    v_exp_f32 v23, v23
    v_fma_f32 v29, v29, s32, -v240
    v_cvt_pk_bf16_f32 v154, v20, v21
    s_waitcnt lgkmcnt(1)
    v_mfma_f32_32x32x16_bf16 v[0:15], a[152:155], a[248:251], v[0:15]
    v_add_u32 v248, 32768, v248
    v_add_u32 v249, 32768, v249
    v_add_u32 v250, 32768, v250
    v_add_u32 v251, 32768, v251
    ds_read_b128 a[248:251], v248
    v_exp_f32 v24, v24
    v_mfma_f32_32x32x16_bf16 v[0:15], a[124:127], a[28:31], v[0:15]
    v_fma_f32 v30, v30, s32, -v240
    v_exp_f32 v25, v25
    v_fma_f32 v31, v31, s32, -v240
    v_cvt_pk_bf16_f32 v155, v22, v23
    s_waitcnt lgkmcnt(1)
    v_mfma_f32_32x32x16_bf16 v[0:15], a[156:159], a[252:255], v[0:15]
    ds_read_b128 a[252:255], v249
    v_exp_f32 v26, v26
    v_exp_f32 v27, v27
    v_cvt_pk_bf16_f32 v156, v24, v25
    v_exp_f32 v28, v28
    v_mfma_f32_4x4x4_16b_bf16 v[232:235], v[236:237], v[150:151], v[232:235] cbsz:4 abid:1
    v_exp_f32 v29, v29
    v_cvt_pk_bf16_f32 v157, v26, v27
    v_mfma_f32_4x4x4_16b_bf16 v[232:235], v[236:237], v[152:153], v[232:235] cbsz:4 abid:2
    v_exp_f32 v30, v30
    v_exp_f32 v31, v31
    v_mfma_f32_4x4x4_16b_bf16 v[232:235], v[236:237], v[154:155], v[232:235] cbsz:4 abid:2
    v_cvt_pk_bf16_f32 v158, v28, v29
    v_cvt_pk_bf16_f32 v159, v30, v31
    v_mfma_f32_4x4x4_16b_bf16 v[232:235], v[236:237], v[156:157], v[232:235] cbsz:4 abid:2
    v_mfma_f32_32x32x16_bf16 v[16:31], a[96:99], a[32:35], 0
    v_max3_f32 v241, v0, v1, v241
    v_max3_f32 v241, v2, v3, v241
    v_max3_f32 v241, v4, v5, v241
    v_max3_f32 v241, v6, v7, v241
    s_waitcnt lgkmcnt(1)
    v_mfma_f32_32x32x16_bf16 v[16:31], a[128:131], a[248:251], v[16:31]
    ds_read_b128 a[248:251], v250
    v_max3_f32 v241, v8, v9, v241
    v_max3_f32 v241, v10, v11, v241
    v_max3_f32 v241, v12, v13, v241
    v_max3_f32 v241, v14, v15, v241
    v_mfma_f32_32x32x16_bf16 v[16:31], a[100:103], a[36:39], v[16:31]
    v_fma_f32 v254, v241, s32, -v238
    v_cmp_lt_f32 vcc, s33, v254
    v_fma_f32 v0, v0, s32, -v238
    v_fma_f32 v1, v1, s32, -v238
    s_waitcnt lgkmcnt(1)
    v_mfma_f32_32x32x16_bf16 v[16:31], a[132:135], a[252:255], v[16:31]
    ds_read_b128 a[252:255], v251
    v_fma_f32 v2, v2, s32, -v238
    v_fma_f32 v3, v3, s32, -v238
    v_fma_f32 v4, v4, s32, -v238
    v_fma_f32 v5, v5, s32, -v238
    v_mfma_f32_32x32x16_bf16 v[16:31], a[104:107], a[40:43], v[16:31]
    s_cbranch_vccnz L_stub_0_0_8
L_back_0_0_8:
    v_exp_f32 v0, v0
    v_fma_f32 v6, v6, s32, -v238
    v_exp_f32 v1, v1
    s_waitcnt lgkmcnt(1)
    v_mfma_f32_32x32x16_bf16 v[16:31], a[136:139], a[248:251], v[16:31]
    ds_read_b128 a[248:251], v248 offset:49152
    v_fma_f32 v7, v7, s32, -v238
    v_exp_f32 v2, v2
    v_fma_f32 v8, v8, s32, -v238
    v_mfma_f32_32x32x16_bf16 v[16:31], a[108:111], a[44:47], v[16:31]
    v_exp_f32 v3, v3
    v_fma_f32 v9, v9, s32, -v238
    v_cvt_pk_bf16_f32 v0, v0, v1
    s_waitcnt lgkmcnt(1)
    v_mfma_f32_32x32x16_bf16 v[16:31], a[140:143], a[252:255], v[16:31]
    ds_read_b128 a[252:255], v249 offset:49152
    v_accvgpr_write_b32 a224, v0
    v_exp_f32 v4, v4
    v_fma_f32 v10, v10, s32, -v238
    v_mfma_f32_32x32x16_bf16 v[16:31], a[112:115], a[48:51], v[16:31]
    v_exp_f32 v5, v5
    v_fma_f32 v11, v11, s32, -v238
    v_cvt_pk_bf16_f32 v2, v2, v3
    s_waitcnt lgkmcnt(1)
    v_mfma_f32_32x32x16_bf16 v[16:31], a[144:147], a[248:251], v[16:31]
    ds_read_b128 a[248:251], v250 offset:49152
    v_accvgpr_write_b32 a225, v2
    v_exp_f32 v6, v6
    v_fma_f32 v12, v12, s32, -v238
    v_mfma_f32_32x32x16_bf16 v[16:31], a[116:119], a[52:55], v[16:31]
    v_exp_f32 v7, v7
    v_fma_f32 v13, v13, s32, -v238
    v_cvt_pk_bf16_f32 v4, v4, v5
    s_waitcnt lgkmcnt(1)
    v_mfma_f32_32x32x16_bf16 v[16:31], a[148:151], a[252:255], v[16:31]
    ds_read_b128 a[252:255], v251 offset:49152
    v_accvgpr_write_b32 a226, v4
    v_exp_f32 v8, v8
    v_fma_f32 v14, v14, s32, -v238
    v_mfma_f32_32x32x16_bf16 v[16:31], a[120:123], a[56:59], v[16:31]
    v_exp_f32 v9, v9
    v_fma_f32 v15, v15, s32, -v238
    v_cvt_pk_bf16_f32 v6, v6, v7
    s_waitcnt lgkmcnt(1)
    v_mfma_f32_32x32x16_bf16 v[16:31], a[152:155], a[248:251], v[16:31]
    ds_read_b128 a[248:251], v248 offset:32768
    v_accvgpr_write_b32 a227, v6
    v_exp_f32 v10, v10
    v_exp_f32 v11, v11
    v_mfma_f32_32x32x16_bf16 v[16:31], a[124:127], a[60:63], v[16:31]
    v_cvt_pk_bf16_f32 v8, v8, v9
    v_accvgpr_write_b32 a228, v8
    v_exp_f32 v12, v12
    s_waitcnt lgkmcnt(1)
    v_mfma_f32_32x32x16_bf16 v[16:31], a[156:159], a[252:255], v[16:31]
    ds_read_b128 a[252:255], v249 offset:32768
    v_exp_f32 v13, v13
    v_cvt_pk_bf16_f32 v10, v10, v11
    v_accvgpr_write_b32 a229, v10
    v_mfma_f32_4x4x4_16b_bf16 v[232:235], v[236:237], v[158:159], v[232:235] cbsz:4 abid:2
    v_exp_f32 v14, v14
    v_exp_f32 v15, v15
    v_mfma_f32_4x4x4_16b_bf16 v[232:235], v[236:237], a[224:225], v[232:235] cbsz:4 abid:0
    v_cvt_pk_bf16_f32 v12, v12, v13
    v_accvgpr_write_b32 a230, v12
    v_mfma_f32_4x4x4_16b_bf16 v[232:235], v[236:237], a[226:227], v[232:235] cbsz:4 abid:0
    v_cvt_pk_bf16_f32 v14, v14, v15
    v_accvgpr_write_b32 a231, v14
    v_mfma_f32_4x4x4_16b_bf16 v[232:235], v[236:237], a[228:229], v[232:235] cbsz:4 abid:0
    v_mfma_f32_32x32x16_bf16 v[0:15], a[96:99], a[64:67], 0
    ds_read_b128 a[96:99], v244 offset:16384
    v_max3_f32 v242, v16, v17, v242
    v_max3_f32 v242, v18, v19, v242
    v_max3_f32 v242, v20, v21, v242
    s_waitcnt lgkmcnt(2)
    v_mfma_f32_32x32x16_bf16 v[0:15], a[128:131], a[248:251], v[0:15]
    ds_read_b128 a[248:251], v250 offset:32768
    ds_read_b128 a[128:131], v244 offset:24576
    v_max3_f32 v242, v22, v23, v242
    v_max3_f32 v242, v24, v25, v242
    v_max3_f32 v242, v26, v27, v242
    v_mfma_f32_32x32x16_bf16 v[0:15], a[100:103], a[68:71], v[0:15]
    ds_read_b128 a[100:103], v245 offset:16384
    v_max3_f32 v242, v28, v29, v242
    v_max3_f32 v242, v30, v31, v242
    v_fma_f32 v254, v242, s32, -v239
    v_cmp_lt_f32 vcc, s33, v254
    s_waitcnt lgkmcnt(4)
    v_mfma_f32_32x32x16_bf16 v[0:15], a[132:135], a[252:255], v[0:15]
    ds_read_b128 a[252:255], v251 offset:32768
    ds_read_b128 a[132:135], v245 offset:24576
    v_fma_f32 v16, v16, s32, -v239
    v_fma_f32 v17, v17, s32, -v239
    v_fma_f32 v18, v18, s32, -v239
    v_mfma_f32_32x32x16_bf16 v[0:15], a[104:107], a[72:75], v[0:15]
    ds_read_b128 a[104:107], v246 offset:16384
    v_fma_f32 v19, v19, s32, -v239
    v_fma_f32 v20, v20, s32, -v239
    v_fma_f32 v21, v21, s32, -v239
    s_waitcnt lgkmcnt(5)
    v_mfma_f32_32x32x16_bf16 v[0:15], a[136:139], a[248:251], v[0:15]
    ds_read_b128 a[248:251], v248 offset:16384
    ds_read_b128 a[136:139], v246 offset:24576
    s_cbranch_vccnz L_stub_0_1_8
L_back_0_1_8:
    v_exp_f32 v16, v16
    v_fma_f32 v22, v22, s32, -v239
    v_mfma_f32_32x32x16_bf16 v[0:15], a[108:111], a[76:79], v[0:15]
    ds_read_b128 a[108:111], v247 offset:16384
    v_exp_f32 v17, v17
    v_fma_f32 v23, v23, s32, -v239
    v_exp_f32 v18, v18
    s_waitcnt lgkmcnt(5)
    v_mfma_f32_32x32x16_bf16 v[0:15], a[140:143], a[252:255], v[0:15]
    ds_read_b128 a[252:255], v249 offset:16384
    ds_read_b128 a[140:143], v247 offset:24576
    v_fma_f32 v24, v24, s32, -v239
    v_exp_f32 v19, v19
    v_mfma_f32_32x32x16_bf16 v[0:15], a[112:115], a[80:83], v[0:15]
    ds_read_b128 a[112:115], v244 offset:20480
    v_fma_f32 v25, v25, s32, -v239
    v_cvt_pk_bf16_f32 v160, v16, v17
    v_exp_f32 v20, v20
    s_waitcnt lgkmcnt(5)
    v_mfma_f32_32x32x16_bf16 v[0:15], a[144:147], a[248:251], v[0:15]
    ds_read_b128 a[248:251], v250 offset:16384
    ds_read_b128 a[144:147], v244 offset:28672
    v_fma_f32 v26, v26, s32, -v239
    v_exp_f32 v21, v21
    v_fma_f32 v27, v27, s32, -v239
    v_mfma_f32_32x32x16_bf16 v[0:15], a[116:119], a[84:87], v[0:15]
    ds_read_b128 a[116:119], v245 offset:20480
    v_cvt_pk_bf16_f32 v161, v18, v19
    v_exp_f32 v22, v22
    v_fma_f32 v28, v28, s32, -v239
    s_waitcnt lgkmcnt(5)
    v_mfma_f32_32x32x16_bf16 v[0:15], a[148:151], a[252:255], v[0:15]
    ds_read_b128 a[252:255], v251 offset:16384
    ds_read_b128 a[148:151], v245 offset:28672
    v_exp_f32 v23, v23
    v_fma_f32 v29, v29, s32, -v239
    v_mfma_f32_32x32x16_bf16 v[0:15], a[120:123], a[88:91], v[0:15]
    ds_read_b128 a[120:123], v246 offset:20480
    v_cvt_pk_bf16_f32 v162, v20, v21
    v_exp_f32 v24, v24
    v_fma_f32 v30, v30, s32, -v239
    s_waitcnt lgkmcnt(5)
    v_mfma_f32_32x32x16_bf16 v[0:15], a[152:155], a[248:251], v[0:15]
    v_subrev_u32 v248, 32768, v248
    v_subrev_u32 v249, 32768, v249
    v_subrev_u32 v250, 32768, v250
    v_subrev_u32 v251, 32768, v251
    ds_read_b128 a[248:251], v248
    ds_read_b128 a[152:155], v246 offset:28672
    v_mfma_f32_32x32x16_bf16 v[0:15], a[124:127], a[92:95], v[0:15]
    ds_read_b128 a[124:127], v247 offset:20480
    v_exp_f32 v25, v25
    v_fma_f32 v31, v31, s32, -v239
    v_cvt_pk_bf16_f32 v163, v22, v23
    v_exp_f32 v26, v26
    s_waitcnt lgkmcnt(5)
    v_mfma_f32_32x32x16_bf16 v[0:15], a[156:159], a[252:255], v[0:15]
    ds_read_b128 a[252:255], v249
    ds_read_b128 a[156:159], v247 offset:28672
    v_exp_f32 v27, v27
    v_cvt_pk_bf16_f32 v164, v24, v25
    v_exp_f32 v28, v28
    v_mfma_f32_4x4x4_16b_bf16 v[232:235], v[236:237], a[230:231], v[232:235] cbsz:4 abid:0
    v_exp_f32 v29, v29
    v_cvt_pk_bf16_f32 v165, v26, v27
    v_mfma_f32_4x4x4_16b_bf16 v[232:235], v[236:237], v[160:161], v[232:235] cbsz:4 abid:1
    v_exp_f32 v30, v30
    v_exp_f32 v31, v31
    v_mfma_f32_4x4x4_16b_bf16 v[232:235], v[236:237], v[162:163], v[232:235] cbsz:4 abid:1
    v_cvt_pk_bf16_f32 v166, v28, v29
    v_cvt_pk_bf16_f32 v167, v30, v31
    v_mfma_f32_4x4x4_16b_bf16 v[232:235], v[236:237], v[164:165], v[232:235] cbsz:4 abid:1
    v_mfma_f32_32x32x16_bf16 v[16:31], a[96:99], a[0:3], 0
    s_waitcnt lgkmcnt(0)
    s_waitcnt vmcnt(8)
    s_barrier
    s_add_u32 m0, s30, 16384
    s_add_u32 s35, s26, 12288
    buffer_load_dwordx4 v252, s[16:19], s35 offen nt lds
    v_mfma_f32_32x32x16_bf16 v[16:31], a[128:131], a[248:251], v[16:31]
    ds_read_b128 a[248:251], v250
    s_add_u32 s35, s26, 44032
    buffer_load_dwordx4 v253, s[16:19], s35 offen offset:1024 nt lds
    v_max3_f32 v243, v0, v1, v243
    v_max3_f32 v243, v2, v3, v243
    v_mfma_f32_32x32x16_bf16 v[16:31], a[100:103], a[4:7], v[16:31]
    s_add_u32 s35, s26, 75776
    buffer_load_dwordx4 v252, s[16:19], s35 offen offset:2048 nt lds
    v_max3_f32 v243, v4, v5, v243
    v_max3_f32 v243, v6, v7, v243
    v_mfma_f32_32x32x16_bf16 v[16:31], a[132:135], a[252:255], v[16:31]
    ds_read_b128 a[252:255], v251
    s_add_u32 s35, s26, 107520
    buffer_load_dwordx4 v253, s[16:19], s35 offen offset:3072 nt lds
    v_max3_f32 v243, v8, v9, v243
    v_max3_f32 v243, v10, v11, v243
    v_mfma_f32_32x32x16_bf16 v[16:31], a[104:107], a[8:11], v[16:31]
    v_max3_f32 v243, v12, v13, v243
    v_max3_f32 v243, v14, v15, v243
    v_fma_f32 v254, v243, s32, -v240
    v_cmp_lt_f32 vcc, s33, v254
    s_waitcnt lgkmcnt(1)
    v_mfma_f32_32x32x16_bf16 v[16:31], a[136:139], a[248:251], v[16:31]
    ds_read_b128 a[248:251], v248 offset:16384
    v_fma_f32 v0, v0, s32, -v240
    v_fma_f32 v1, v1, s32, -v240
    v_fma_f32 v2, v2, s32, -v240
    v_fma_f32 v3, v3, s32, -v240
    v_mfma_f32_32x32x16_bf16 v[16:31], a[108:111], a[12:15], v[16:31]
    v_fma_f32 v4, v4, s32, -v240
    v_fma_f32 v5, v5, s32, -v240
    s_cbranch_vccnz L_stub_0_2_8
L_back_0_2_8:
    v_exp_f32 v0, v0
    s_waitcnt lgkmcnt(1)
    v_mfma_f32_32x32x16_bf16 v[16:31], a[140:143], a[252:255], v[16:31]
    ds_read_b128 a[252:255], v249 offset:16384
    v_fma_f32 v6, v6, s32, -v240
    v_exp_f32 v1, v1
    v_fma_f32 v7, v7, s32, -v240
    v_mfma_f32_32x32x16_bf16 v[16:31], a[112:115], a[16:19], v[16:31]
    v_exp_f32 v2, v2
    v_fma_f32 v8, v8, s32, -v240
    v_exp_f32 v3, v3
    s_waitcnt lgkmcnt(1)
    v_mfma_f32_32x32x16_bf16 v[16:31], a[144:147], a[248:251], v[16:31]
    ds_read_b128 a[248:251], v250 offset:16384
    v_fma_f32 v9, v9, s32, -v240
    v_cvt_pk_bf16_f32 v168, v0, v1
    v_exp_f32 v4, v4
    v_mfma_f32_32x32x16_bf16 v[16:31], a[116:119], a[20:23], v[16:31]
    v_fma_f32 v10, v10, s32, -v240
    v_exp_f32 v5, v5
    v_fma_f32 v11, v11, s32, -v240
    s_waitcnt lgkmcnt(1)
    v_mfma_f32_32x32x16_bf16 v[16:31], a[148:151], a[252:255], v[16:31]
    ds_read_b128 a[252:255], v251 offset:16384
    v_cvt_pk_bf16_f32 v169, v2, v3
    v_exp_f32 v6, v6
    v_fma_f32 v12, v12, s32, -v240
    v_mfma_f32_32x32x16_bf16 v[16:31], a[120:123], a[24:27], v[16:31]
    v_exp_f32 v7, v7
    v_fma_f32 v13, v13, s32, -v240
    v_cvt_pk_bf16_f32 v170, v4, v5
    s_waitcnt lgkmcnt(1)
    v_mfma_f32_32x32x16_bf16 v[16:31], a[152:155], a[248:251], v[16:31]
    v_add_u32 v248, 32768, v248
    v_add_u32 v249, 32768, v249
    v_add_u32 v250, 32768, v250
    v_add_u32 v251, 32768, v251
    ds_read_b128 a[248:251], v248
    v_exp_f32 v8, v8
    v_mfma_f32_32x32x16_bf16 v[16:31], a[124:127], a[28:31], v[16:31]
    v_fma_f32 v14, v14, s32, -v240
    v_exp_f32 v9, v9
    v_fma_f32 v15, v15, s32, -v240
    v_cvt_pk_bf16_f32 v171, v6, v7
    s_waitcnt lgkmcnt(1)
    v_mfma_f32_32x32x16_bf16 v[16:31], a[156:159], a[252:255], v[16:31]
    ds_read_b128 a[252:255], v249
    v_exp_f32 v10, v10
    v_exp_f32 v11, v11
    v_cvt_pk_bf16_f32 v172, v8, v9
    v_exp_f32 v12, v12
    v_mfma_f32_4x4x4_16b_bf16 v[232:235], v[236:237], v[166:167], v[232:235] cbsz:4 abid:1
    v_exp_f32 v13, v13
    v_cvt_pk_bf16_f32 v173, v10, v11
    v_mfma_f32_4x4x4_16b_bf16 v[232:235], v[236:237], v[168:169], v[232:235] cbsz:4 abid:2
    v_exp_f32 v14, v14
    v_exp_f32 v15, v15
    v_mfma_f32_4x4x4_16b_bf16 v[232:235], v[236:237], v[170:171], v[232:235] cbsz:4 abid:2
    v_cvt_pk_bf16_f32 v174, v12, v13
    v_cvt_pk_bf16_f32 v175, v14, v15
    v_mfma_f32_4x4x4_16b_bf16 v[232:235], v[236:237], v[172:173], v[232:235] cbsz:4 abid:2
    v_mfma_f32_32x32x16_bf16 v[0:15], a[96:99], a[32:35], 0
    v_max3_f32 v241, v16, v17, v241
    v_max3_f32 v241, v18, v19, v241
    v_max3_f32 v241, v20, v21, v241
    v_max3_f32 v241, v22, v23, v241
    s_waitcnt lgkmcnt(1)
    v_mfma_f32_32x32x16_bf16 v[0:15], a[128:131], a[248:251], v[0:15]
    ds_read_b128 a[248:251], v250
    v_max3_f32 v241, v24, v25, v241
    v_max3_f32 v241, v26, v27, v241
    v_max3_f32 v241, v28, v29, v241
    v_max3_f32 v241, v30, v31, v241
    v_mfma_f32_32x32x16_bf16 v[0:15], a[100:103], a[36:39], v[0:15]
    v_fma_f32 v254, v241, s32, -v238
    v_cmp_lt_f32 vcc, s33, v254
    v_fma_f32 v16, v16, s32, -v238
    v_fma_f32 v17, v17, s32, -v238
    s_waitcnt lgkmcnt(1)
    v_mfma_f32_32x32x16_bf16 v[0:15], a[132:135], a[252:255], v[0:15]
    ds_read_b128 a[252:255], v251
    v_fma_f32 v18, v18, s32, -v238
    v_fma_f32 v19, v19, s32, -v238
    v_fma_f32 v20, v20, s32, -v238
    v_fma_f32 v21, v21, s32, -v238
    v_mfma_f32_32x32x16_bf16 v[0:15], a[104:107], a[40:43], v[0:15]
    s_cbranch_vccnz L_stub_0_0_9
L_back_0_0_9:
    v_exp_f32 v16, v16
    v_fma_f32 v22, v22, s32, -v238
    v_exp_f32 v17, v17
    s_waitcnt lgkmcnt(1)
    v_mfma_f32_32x32x16_bf16 v[0:15], a[136:139], a[248:251], v[0:15]
    ds_read_b128 a[248:251], v248 offset:49152
    v_fma_f32 v23, v23, s32, -v238
    v_exp_f32 v18, v18
    v_fma_f32 v24, v24, s32, -v238
    v_mfma_f32_32x32x16_bf16 v[0:15], a[108:111], a[44:47], v[0:15]
    v_exp_f32 v19, v19
    v_fma_f32 v25, v25, s32, -v238
    v_cvt_pk_bf16_f32 v16, v16, v17
    s_waitcnt lgkmcnt(1)
    v_mfma_f32_32x32x16_bf16 v[0:15], a[140:143], a[252:255], v[0:15]
    ds_read_b128 a[252:255], v249 offset:49152
    v_accvgpr_write_b32 a232, v16
    v_exp_f32 v20, v20
    v_fma_f32 v26, v26, s32, -v238
    v_mfma_f32_32x32x16_bf16 v[0:15], a[112:115], a[48:51], v[0:15]
    v_exp_f32 v21, v21
    v_fma_f32 v27, v27, s32, -v238
    v_cvt_pk_bf16_f32 v18, v18, v19
    s_waitcnt lgkmcnt(1)
    v_mfma_f32_32x32x16_bf16 v[0:15], a[144:147], a[248:251], v[0:15]
    ds_read_b128 a[248:251], v250 offset:49152
    v_accvgpr_write_b32 a233, v18
    v_exp_f32 v22, v22
    v_fma_f32 v28, v28, s32, -v238
    v_mfma_f32_32x32x16_bf16 v[0:15], a[116:119], a[52:55], v[0:15]
    v_exp_f32 v23, v23
    v_fma_f32 v29, v29, s32, -v238
    v_cvt_pk_bf16_f32 v20, v20, v21
    s_waitcnt lgkmcnt(1)
    v_mfma_f32_32x32x16_bf16 v[0:15], a[148:151], a[252:255], v[0:15]
    ds_read_b128 a[252:255], v251 offset:49152
    v_accvgpr_write_b32 a234, v20
    v_exp_f32 v24, v24
    v_fma_f32 v30, v30, s32, -v238
    v_mfma_f32_32x32x16_bf16 v[0:15], a[120:123], a[56:59], v[0:15]
    v_exp_f32 v25, v25
    v_fma_f32 v31, v31, s32, -v238
    v_cvt_pk_bf16_f32 v22, v22, v23
    s_waitcnt lgkmcnt(1)
    v_mfma_f32_32x32x16_bf16 v[0:15], a[152:155], a[248:251], v[0:15]
    ds_read_b128 a[248:251], v248 offset:32768
    v_accvgpr_write_b32 a235, v22
    v_exp_f32 v26, v26
    v_exp_f32 v27, v27
    v_mfma_f32_32x32x16_bf16 v[0:15], a[124:127], a[60:63], v[0:15]
    v_cvt_pk_bf16_f32 v24, v24, v25
    v_accvgpr_write_b32 a236, v24
    v_exp_f32 v28, v28
    s_waitcnt lgkmcnt(1)
    v_mfma_f32_32x32x16_bf16 v[0:15], a[156:159], a[252:255], v[0:15]
    ds_read_b128 a[252:255], v249 offset:32768
    v_exp_f32 v29, v29
    v_cvt_pk_bf16_f32 v26, v26, v27
    v_accvgpr_write_b32 a237, v26
    v_mfma_f32_4x4x4_16b_bf16 v[232:235], v[236:237], v[174:175], v[232:235] cbsz:4 abid:2
    v_exp_f32 v30, v30
    v_exp_f32 v31, v31
    v_mfma_f32_4x4x4_16b_bf16 v[232:235], v[236:237], a[232:233], v[232:235] cbsz:4 abid:0
    v_cvt_pk_bf16_f32 v28, v28, v29
    v_accvgpr_write_b32 a238, v28
    v_mfma_f32_4x4x4_16b_bf16 v[232:235], v[236:237], a[234:235], v[232:235] cbsz:4 abid:0
    v_cvt_pk_bf16_f32 v30, v30, v31
    v_accvgpr_write_b32 a239, v30
    v_mfma_f32_4x4x4_16b_bf16 v[232:235], v[236:237], a[236:237], v[232:235] cbsz:4 abid:0
    v_mfma_f32_32x32x16_bf16 v[16:31], a[96:99], a[64:67], 0
    ds_read_b128 a[96:99], v244 offset:32768
    v_max3_f32 v242, v0, v1, v242
    v_max3_f32 v242, v2, v3, v242
    v_max3_f32 v242, v4, v5, v242
    s_waitcnt lgkmcnt(2)
    v_mfma_f32_32x32x16_bf16 v[16:31], a[128:131], a[248:251], v[16:31]
    ds_read_b128 a[248:251], v250 offset:32768
    ds_read_b128 a[128:131], v244 offset:40960
    v_max3_f32 v242, v6, v7, v242
    v_max3_f32 v242, v8, v9, v242
    v_max3_f32 v242, v10, v11, v242
    v_mfma_f32_32x32x16_bf16 v[16:31], a[100:103], a[68:71], v[16:31]
    ds_read_b128 a[100:103], v245 offset:32768
    v_max3_f32 v242, v12, v13, v242
    v_max3_f32 v242, v14, v15, v242
    v_fma_f32 v254, v242, s32, -v239
    v_cmp_lt_f32 vcc, s33, v254
    s_waitcnt lgkmcnt(4)
    v_mfma_f32_32x32x16_bf16 v[16:31], a[132:135], a[252:255], v[16:31]
    ds_read_b128 a[252:255], v251 offset:32768
    ds_read_b128 a[132:135], v245 offset:40960
    v_fma_f32 v0, v0, s32, -v239
    v_fma_f32 v1, v1, s32, -v239
    v_fma_f32 v2, v2, s32, -v239
    v_mfma_f32_32x32x16_bf16 v[16:31], a[104:107], a[72:75], v[16:31]
    ds_read_b128 a[104:107], v246 offset:32768
    v_fma_f32 v3, v3, s32, -v239
    v_fma_f32 v4, v4, s32, -v239
    v_fma_f32 v5, v5, s32, -v239
    s_waitcnt lgkmcnt(5)
    v_mfma_f32_32x32x16_bf16 v[16:31], a[136:139], a[248:251], v[16:31]
    ds_read_b128 a[248:251], v248 offset:16384
    ds_read_b128 a[136:139], v246 offset:40960
    s_cbranch_vccnz L_stub_0_1_9
L_back_0_1_9:
    v_exp_f32 v0, v0
    v_fma_f32 v6, v6, s32, -v239
    v_mfma_f32_32x32x16_bf16 v[16:31], a[108:111], a[76:79], v[16:31]
    ds_read_b128 a[108:111], v247 offset:32768
    v_exp_f32 v1, v1
    v_fma_f32 v7, v7, s32, -v239
    v_exp_f32 v2, v2
    s_waitcnt lgkmcnt(5)
    v_mfma_f32_32x32x16_bf16 v[16:31], a[140:143], a[252:255], v[16:31]
    ds_read_b128 a[252:255], v249 offset:16384
    ds_read_b128 a[140:143], v247 offset:40960
    v_fma_f32 v8, v8, s32, -v239
    v_exp_f32 v3, v3
    v_mfma_f32_32x32x16_bf16 v[16:31], a[112:115], a[80:83], v[16:31]
    ds_read_b128 a[112:115], v244 offset:36864
    v_fma_f32 v9, v9, s32, -v239
    v_cvt_pk_bf16_f32 v176, v0, v1
    v_exp_f32 v4, v4
    s_waitcnt lgkmcnt(5)
    v_mfma_f32_32x32x16_bf16 v[16:31], a[144:147], a[248:251], v[16:31]
    ds_read_b128 a[248:251], v250 offset:16384
    ds_read_b128 a[144:147], v244 offset:45056
    v_fma_f32 v10, v10, s32, -v239
    v_exp_f32 v5, v5
    v_fma_f32 v11, v11, s32, -v239
    v_mfma_f32_32x32x16_bf16 v[16:31], a[116:119], a[84:87], v[16:31]
    ds_read_b128 a[116:119], v245 offset:36864
    v_cvt_pk_bf16_f32 v177, v2, v3
    v_exp_f32 v6, v6
    v_fma_f32 v12, v12, s32, -v239
    s_waitcnt lgkmcnt(5)
    v_mfma_f32_32x32x16_bf16 v[16:31], a[148:151], a[252:255], v[16:31]
    ds_read_b128 a[252:255], v251 offset:16384
    ds_read_b128 a[148:151], v245 offset:45056
    v_exp_f32 v7, v7
    v_fma_f32 v13, v13, s32, -v239
    v_mfma_f32_32x32x16_bf16 v[16:31], a[120:123], a[88:91], v[16:31]
    ds_read_b128 a[120:123], v246 offset:36864
    v_cvt_pk_bf16_f32 v178, v4, v5
    v_exp_f32 v8, v8
    v_fma_f32 v14, v14, s32, -v239
    s_waitcnt lgkmcnt(5)
    v_mfma_f32_32x32x16_bf16 v[16:31], a[152:155], a[248:251], v[16:31]
    v_subrev_u32 v248, 32768, v248
    v_subrev_u32 v249, 32768, v249
    v_subrev_u32 v250, 32768, v250
    v_subrev_u32 v251, 32768, v251
    ds_read_b128 a[248:251], v248
    ds_read_b128 a[152:155], v246 offset:45056
    v_mfma_f32_32x32x16_bf16 v[16:31], a[124:127], a[92:95], v[16:31]
    ds_read_b128 a[124:127], v247 offset:36864
    v_exp_f32 v9, v9
    v_fma_f32 v15, v15, s32, -v239
    v_cvt_pk_bf16_f32 v179, v6, v7
    v_exp_f32 v10, v10
    s_waitcnt lgkmcnt(5)
    v_mfma_f32_32x32x16_bf16 v[16:31], a[156:159], a[252:255], v[16:31]
    ds_read_b128 a[252:255], v249
    ds_read_b128 a[156:159], v247 offset:45056
    v_exp_f32 v11, v11
    v_cvt_pk_bf16_f32 v180, v8, v9
    v_exp_f32 v12, v12
    v_mfma_f32_4x4x4_16b_bf16 v[232:235], v[236:237], a[238:239], v[232:235] cbsz:4 abid:0
    v_exp_f32 v13, v13
    v_cvt_pk_bf16_f32 v181, v10, v11
    v_mfma_f32_4x4x4_16b_bf16 v[232:235], v[236:237], v[176:177], v[232:235] cbsz:4 abid:1
    v_exp_f32 v14, v14
    v_exp_f32 v15, v15
    v_mfma_f32_4x4x4_16b_bf16 v[232:235], v[236:237], v[178:179], v[232:235] cbsz:4 abid:1
    v_cvt_pk_bf16_f32 v182, v12, v13
    v_cvt_pk_bf16_f32 v183, v14, v15
    v_mfma_f32_4x4x4_16b_bf16 v[232:235], v[236:237], v[180:181], v[232:235] cbsz:4 abid:1
    v_mfma_f32_32x32x16_bf16 v[0:15], a[96:99], a[0:3], 0
    s_waitcnt lgkmcnt(0)
    s_waitcnt vmcnt(8)
    s_barrier
    s_add_u32 m0, s30, 32768
    s_add_u32 s35, s26, 135168
    buffer_load_dwordx4 v252, s[16:19], s35 offen nt lds
    v_mfma_f32_32x32x16_bf16 v[0:15], a[128:131], a[248:251], v[0:15]
    ds_read_b128 a[248:251], v250
    s_add_u32 s35, s26, 166912
    buffer_load_dwordx4 v253, s[16:19], s35 offen offset:1024 nt lds
    v_max3_f32 v243, v16, v17, v243
    v_max3_f32 v243, v18, v19, v243
    v_mfma_f32_32x32x16_bf16 v[0:15], a[100:103], a[4:7], v[0:15]
    s_add_u32 s35, s26, 18432
    buffer_load_dwordx4 v252, s[16:19], s35 offen offset:2048 nt lds
    v_max3_f32 v243, v20, v21, v243
    v_max3_f32 v243, v22, v23, v243
    v_mfma_f32_32x32x16_bf16 v[0:15], a[132:135], a[252:255], v[0:15]
    ds_read_b128 a[252:255], v251
    s_add_u32 s35, s26, 50176
    buffer_load_dwordx4 v253, s[16:19], s35 offen offset:3072 nt lds
    v_max3_f32 v243, v24, v25, v243
    v_max3_f32 v243, v26, v27, v243
    v_mfma_f32_32x32x16_bf16 v[0:15], a[104:107], a[8:11], v[0:15]
    v_max3_f32 v243, v28, v29, v243
    v_max3_f32 v243, v30, v31, v243
    v_fma_f32 v254, v243, s32, -v240
    v_cmp_lt_f32 vcc, s33, v254
    s_waitcnt lgkmcnt(1)
    v_mfma_f32_32x32x16_bf16 v[0:15], a[136:139], a[248:251], v[0:15]
    ds_read_b128 a[248:251], v248 offset:16384
    v_fma_f32 v16, v16, s32, -v240
    v_fma_f32 v17, v17, s32, -v240
    v_fma_f32 v18, v18, s32, -v240
    v_fma_f32 v19, v19, s32, -v240
    v_mfma_f32_32x32x16_bf16 v[0:15], a[108:111], a[12:15], v[0:15]
    v_fma_f32 v20, v20, s32, -v240
    v_fma_f32 v21, v21, s32, -v240
    s_cbranch_vccnz L_stub_0_2_9
L_back_0_2_9:
    v_exp_f32 v16, v16
    s_waitcnt lgkmcnt(1)
    v_mfma_f32_32x32x16_bf16 v[0:15], a[140:143], a[252:255], v[0:15]
    ds_read_b128 a[252:255], v249 offset:16384
    v_fma_f32 v22, v22, s32, -v240
    v_exp_f32 v17, v17
    v_fma_f32 v23, v23, s32, -v240
    v_mfma_f32_32x32x16_bf16 v[0:15], a[112:115], a[16:19], v[0:15]
    v_exp_f32 v18, v18
    v_fma_f32 v24, v24, s32, -v240
    v_exp_f32 v19, v19
    s_waitcnt lgkmcnt(1)
    v_mfma_f32_32x32x16_bf16 v[0:15], a[144:147], a[248:251], v[0:15]
    ds_read_b128 a[248:251], v250 offset:16384
    v_fma_f32 v25, v25, s32, -v240
    v_cvt_pk_bf16_f32 v184, v16, v17
    v_exp_f32 v20, v20
    v_mfma_f32_32x32x16_bf16 v[0:15], a[116:119], a[20:23], v[0:15]
    v_fma_f32 v26, v26, s32, -v240
    v_exp_f32 v21, v21
    v_fma_f32 v27, v27, s32, -v240
    s_waitcnt lgkmcnt(1)
    v_mfma_f32_32x32x16_bf16 v[0:15], a[148:151], a[252:255], v[0:15]
    ds_read_b128 a[252:255], v251 offset:16384
    v_cvt_pk_bf16_f32 v185, v18, v19
    v_exp_f32 v22, v22
    v_fma_f32 v28, v28, s32, -v240
    v_mfma_f32_32x32x16_bf16 v[0:15], a[120:123], a[24:27], v[0:15]
    v_exp_f32 v23, v23
    v_fma_f32 v29, v29, s32, -v240
    v_cvt_pk_bf16_f32 v186, v20, v21
    s_waitcnt lgkmcnt(1)
    v_mfma_f32_32x32x16_bf16 v[0:15], a[152:155], a[248:251], v[0:15]
    v_add_u32 v248, 32768, v248
    v_add_u32 v249, 32768, v249
    v_add_u32 v250, 32768, v250
    v_add_u32 v251, 32768, v251
    ds_read_b128 a[248:251], v248
    v_exp_f32 v24, v24
    v_mfma_f32_32x32x16_bf16 v[0:15], a[124:127], a[28:31], v[0:15]
    v_fma_f32 v30, v30, s32, -v240
    v_exp_f32 v25, v25
    v_fma_f32 v31, v31, s32, -v240
    v_cvt_pk_bf16_f32 v187, v22, v23
    s_waitcnt lgkmcnt(1)
    v_mfma_f32_32x32x16_bf16 v[0:15], a[156:159], a[252:255], v[0:15]
    ds_read_b128 a[252:255], v249
    v_exp_f32 v26, v26
    v_exp_f32 v27, v27
    v_cvt_pk_bf16_f32 v188, v24, v25
    v_exp_f32 v28, v28
    v_mfma_f32_4x4x4_16b_bf16 v[232:235], v[236:237], v[182:183], v[232:235] cbsz:4 abid:1
    v_exp_f32 v29, v29
    v_cvt_pk_bf16_f32 v189, v26, v27
    v_mfma_f32_4x4x4_16b_bf16 v[232:235], v[236:237], v[184:185], v[232:235] cbsz:4 abid:2
    v_exp_f32 v30, v30
    v_exp_f32 v31, v31
    v_mfma_f32_4x4x4_16b_bf16 v[232:235], v[236:237], v[186:187], v[232:235] cbsz:4 abid:2
    v_cvt_pk_bf16_f32 v190, v28, v29
    v_cvt_pk_bf16_f32 v191, v30, v31
    v_mfma_f32_4x4x4_16b_bf16 v[232:235], v[236:237], v[188:189], v[232:235] cbsz:4 abid:2
    v_mfma_f32_32x32x16_bf16 v[16:31], a[96:99], a[32:35], 0
    v_max3_f32 v241, v0, v1, v241
    v_max3_f32 v241, v2, v3, v241
    v_max3_f32 v241, v4, v5, v241
    v_max3_f32 v241, v6, v7, v241
    s_waitcnt lgkmcnt(1)
    v_mfma_f32_32x32x16_bf16 v[16:31], a[128:131], a[248:251], v[16:31]
    ds_read_b128 a[248:251], v250
    v_max3_f32 v241, v8, v9, v241
    v_max3_f32 v241, v10, v11, v241
    v_max3_f32 v241, v12, v13, v241
    v_max3_f32 v241, v14, v15, v241
    v_mfma_f32_32x32x16_bf16 v[16:31], a[100:103], a[36:39], v[16:31]
    v_fma_f32 v254, v241, s32, -v238
    v_cmp_lt_f32 vcc, s33, v254
    v_fma_f32 v0, v0, s32, -v238
    v_fma_f32 v1, v1, s32, -v238
    s_waitcnt lgkmcnt(1)
    v_mfma_f32_32x32x16_bf16 v[16:31], a[132:135], a[252:255], v[16:31]
    ds_read_b128 a[252:255], v251
    v_fma_f32 v2, v2, s32, -v238
    v_fma_f32 v3, v3, s32, -v238
    v_fma_f32 v4, v4, s32, -v238
    v_fma_f32 v5, v5, s32, -v238
    v_mfma_f32_32x32x16_bf16 v[16:31], a[104:107], a[40:43], v[16:31]
    s_cbranch_vccnz L_stub_0_0_10
L_back_0_0_10:
    v_exp_f32 v0, v0
    v_fma_f32 v6, v6, s32, -v238
    v_exp_f32 v1, v1
    s_waitcnt lgkmcnt(1)
    v_mfma_f32_32x32x16_bf16 v[16:31], a[136:139], a[248:251], v[16:31]
    ds_read_b128 a[248:251], v248 offset:49152
    v_fma_f32 v7, v7, s32, -v238
    v_exp_f32 v2, v2
    v_fma_f32 v8, v8, s32, -v238
    v_mfma_f32_32x32x16_bf16 v[16:31], a[108:111], a[44:47], v[16:31]
    v_exp_f32 v3, v3
    v_fma_f32 v9, v9, s32, -v238
    v_cvt_pk_bf16_f32 v0, v0, v1
    s_waitcnt lgkmcnt(1)
    v_mfma_f32_32x32x16_bf16 v[16:31], a[140:143], a[252:255], v[16:31]
    ds_read_b128 a[252:255], v249 offset:49152
    v_accvgpr_write_b32 a240, v0
    v_exp_f32 v4, v4
    v_fma_f32 v10, v10, s32, -v238
    v_mfma_f32_32x32x16_bf16 v[16:31], a[112:115], a[48:51], v[16:31]
    v_exp_f32 v5, v5
    v_fma_f32 v11, v11, s32, -v238
    v_cvt_pk_bf16_f32 v2, v2, v3
    s_waitcnt lgkmcnt(1)
    v_mfma_f32_32x32x16_bf16 v[16:31], a[144:147], a[248:251], v[16:31]
    ds_read_b128 a[248:251], v250 offset:49152
    v_accvgpr_write_b32 a241, v2
    v_exp_f32 v6, v6
    v_fma_f32 v12, v12, s32, -v238
    v_mfma_f32_32x32x16_bf16 v[16:31], a[116:119], a[52:55], v[16:31]
    v_exp_f32 v7, v7
    v_fma_f32 v13, v13, s32, -v238
    v_cvt_pk_bf16_f32 v4, v4, v5
    s_waitcnt lgkmcnt(1)
    v_mfma_f32_32x32x16_bf16 v[16:31], a[148:151], a[252:255], v[16:31]
    ds_read_b128 a[252:255], v251 offset:49152
    v_accvgpr_write_b32 a242, v4
    v_exp_f32 v8, v8
    v_fma_f32 v14, v14, s32, -v238
    v_mfma_f32_32x32x16_bf16 v[16:31], a[120:123], a[56:59], v[16:31]
    v_exp_f32 v9, v9
    v_fma_f32 v15, v15, s32, -v238
    v_cvt_pk_bf16_f32 v6, v6, v7
    s_waitcnt lgkmcnt(1)
    v_mfma_f32_32x32x16_bf16 v[16:31], a[152:155], a[248:251], v[16:31]
    ds_read_b128 a[248:251], v248 offset:32768
    v_accvgpr_write_b32 a243, v6
    v_exp_f32 v10, v10
    v_exp_f32 v11, v11
    v_mfma_f32_32x32x16_bf16 v[16:31], a[124:127], a[60:63], v[16:31]
    v_cvt_pk_bf16_f32 v8, v8, v9
    v_accvgpr_write_b32 a244, v8
    v_exp_f32 v12, v12
    s_waitcnt lgkmcnt(1)
    v_mfma_f32_32x32x16_bf16 v[16:31], a[156:159], a[252:255], v[16:31]
    ds_read_b128 a[252:255], v249 offset:32768
    v_exp_f32 v13, v13
    v_cvt_pk_bf16_f32 v10, v10, v11
    v_accvgpr_write_b32 a245, v10
    v_mfma_f32_4x4x4_16b_bf16 v[232:235], v[236:237], v[190:191], v[232:235] cbsz:4 abid:2
    v_exp_f32 v14, v14
    v_exp_f32 v15, v15
    v_mfma_f32_4x4x4_16b_bf16 v[232:235], v[236:237], a[240:241], v[232:235] cbsz:4 abid:0
    v_cvt_pk_bf16_f32 v12, v12, v13
    v_accvgpr_write_b32 a246, v12
    v_mfma_f32_4x4x4_16b_bf16 v[232:235], v[236:237], a[242:243], v[232:235] cbsz:4 abid:0
    v_cvt_pk_bf16_f32 v14, v14, v15
    v_accvgpr_write_b32 a247, v14
    v_mfma_f32_4x4x4_16b_bf16 v[232:235], v[236:237], a[244:245], v[232:235] cbsz:4 abid:0
    v_mfma_f32_32x32x16_bf16 v[0:15], a[96:99], a[64:67], 0
    ds_read_b128 a[96:99], v244 offset:49152
    v_max3_f32 v242, v16, v17, v242
    v_max3_f32 v242, v18, v19, v242
    v_max3_f32 v242, v20, v21, v242
    s_waitcnt lgkmcnt(2)
    v_mfma_f32_32x32x16_bf16 v[0:15], a[128:131], a[248:251], v[0:15]
    ds_read_b128 a[248:251], v250 offset:32768
    ds_read_b128 a[128:131], v244 offset:57344
    v_max3_f32 v242, v22, v23, v242
    v_max3_f32 v242, v24, v25, v242
    v_max3_f32 v242, v26, v27, v242
    v_mfma_f32_32x32x16_bf16 v[0:15], a[100:103], a[68:71], v[0:15]
    ds_read_b128 a[100:103], v245 offset:49152
    v_max3_f32 v242, v28, v29, v242
    v_max3_f32 v242, v30, v31, v242
    v_fma_f32 v254, v242, s32, -v239
    v_cmp_lt_f32 vcc, s33, v254
    s_waitcnt lgkmcnt(4)
    v_mfma_f32_32x32x16_bf16 v[0:15], a[132:135], a[252:255], v[0:15]
    ds_read_b128 a[252:255], v251 offset:32768
    ds_read_b128 a[132:135], v245 offset:57344
    v_fma_f32 v16, v16, s32, -v239
    v_fma_f32 v17, v17, s32, -v239
    v_fma_f32 v18, v18, s32, -v239
    v_mfma_f32_32x32x16_bf16 v[0:15], a[104:107], a[72:75], v[0:15]
    ds_read_b128 a[104:107], v246 offset:49152
    v_fma_f32 v19, v19, s32, -v239
    v_fma_f32 v20, v20, s32, -v239
    v_fma_f32 v21, v21, s32, -v239
    s_waitcnt lgkmcnt(5)
    v_mfma_f32_32x32x16_bf16 v[0:15], a[136:139], a[248:251], v[0:15]
    ds_read_b128 a[248:251], v248 offset:16384
    ds_read_b128 a[136:139], v246 offset:57344
    s_cbranch_vccnz L_stub_0_1_10
L_back_0_1_10:
    v_exp_f32 v16, v16
    v_fma_f32 v22, v22, s32, -v239
    v_mfma_f32_32x32x16_bf16 v[0:15], a[108:111], a[76:79], v[0:15]
    ds_read_b128 a[108:111], v247 offset:49152
    v_exp_f32 v17, v17
    v_fma_f32 v23, v23, s32, -v239
    v_exp_f32 v18, v18
    s_waitcnt lgkmcnt(5)
    v_mfma_f32_32x32x16_bf16 v[0:15], a[140:143], a[252:255], v[0:15]
    ds_read_b128 a[252:255], v249 offset:16384
    ds_read_b128 a[140:143], v247 offset:57344
    v_fma_f32 v24, v24, s32, -v239
    v_exp_f32 v19, v19
    v_mfma_f32_32x32x16_bf16 v[0:15], a[112:115], a[80:83], v[0:15]
    ds_read_b128 a[112:115], v244 offset:53248
    v_fma_f32 v25, v25, s32, -v239
    v_cvt_pk_bf16_f32 v192, v16, v17
    v_exp_f32 v20, v20
    s_waitcnt lgkmcnt(5)
    v_mfma_f32_32x32x16_bf16 v[0:15], a[144:147], a[248:251], v[0:15]
    ds_read_b128 a[248:251], v250 offset:16384
    ds_read_b128 a[144:147], v244 offset:61440
    v_fma_f32 v26, v26, s32, -v239
    v_exp_f32 v21, v21
    v_fma_f32 v27, v27, s32, -v239
    v_mfma_f32_32x32x16_bf16 v[0:15], a[116:119], a[84:87], v[0:15]
    ds_read_b128 a[116:119], v245 offset:53248
    v_cvt_pk_bf16_f32 v193, v18, v19
    v_exp_f32 v22, v22
    v_fma_f32 v28, v28, s32, -v239
    s_waitcnt lgkmcnt(5)
    v_mfma_f32_32x32x16_bf16 v[0:15], a[148:151], a[252:255], v[0:15]
    ds_read_b128 a[252:255], v251 offset:16384
    ds_read_b128 a[148:151], v245 offset:61440
    v_exp_f32 v23, v23
    v_fma_f32 v29, v29, s32, -v239
    v_mfma_f32_32x32x16_bf16 v[0:15], a[120:123], a[88:91], v[0:15]
    ds_read_b128 a[120:123], v246 offset:53248
    v_cvt_pk_bf16_f32 v194, v20, v21
    v_exp_f32 v24, v24
    v_fma_f32 v30, v30, s32, -v239
    s_waitcnt lgkmcnt(5)
    v_mfma_f32_32x32x16_bf16 v[0:15], a[152:155], a[248:251], v[0:15]
    v_subrev_u32 v248, 32768, v248
    v_subrev_u32 v249, 32768, v249
    v_subrev_u32 v250, 32768, v250
    v_subrev_u32 v251, 32768, v251
    ds_read_b128 a[248:251], v248
    ds_read_b128 a[152:155], v246 offset:61440
    v_mfma_f32_32x32x16_bf16 v[0:15], a[124:127], a[92:95], v[0:15]
    ds_read_b128 a[124:127], v247 offset:53248
    v_exp_f32 v25, v25
    v_fma_f32 v31, v31, s32, -v239
    v_cvt_pk_bf16_f32 v195, v22, v23
    v_exp_f32 v26, v26
    s_waitcnt lgkmcnt(5)
    v_mfma_f32_32x32x16_bf16 v[0:15], a[156:159], a[252:255], v[0:15]
    ds_read_b128 a[252:255], v249
    ds_read_b128 a[156:159], v247 offset:61440
    v_exp_f32 v27, v27
    v_cvt_pk_bf16_f32 v196, v24, v25
    v_exp_f32 v28, v28
    v_mfma_f32_4x4x4_16b_bf16 v[232:235], v[236:237], a[246:247], v[232:235] cbsz:4 abid:0
    v_exp_f32 v29, v29
    v_cvt_pk_bf16_f32 v197, v26, v27
    v_mfma_f32_4x4x4_16b_bf16 v[232:235], v[236:237], v[192:193], v[232:235] cbsz:4 abid:1
    v_exp_f32 v30, v30
    v_exp_f32 v31, v31
    v_mfma_f32_4x4x4_16b_bf16 v[232:235], v[236:237], v[194:195], v[232:235] cbsz:4 abid:1
    v_cvt_pk_bf16_f32 v198, v28, v29
    v_cvt_pk_bf16_f32 v199, v30, v31
    v_mfma_f32_4x4x4_16b_bf16 v[232:235], v[236:237], v[196:197], v[232:235] cbsz:4 abid:1
    v_mfma_f32_32x32x16_bf16 v[16:31], a[96:99], a[0:3], 0
    s_waitcnt lgkmcnt(0)
    s_waitcnt vmcnt(8)
    s_barrier
    s_add_u32 m0, s30, 49152
    s_add_u32 s35, s26, 143360
    buffer_load_dwordx4 v252, s[16:19], s35 offen nt lds
    v_mfma_f32_32x32x16_bf16 v[16:31], a[128:131], a[248:251], v[16:31]
    ds_read_b128 a[248:251], v250
    s_add_u32 s35, s26, 175104
    buffer_load_dwordx4 v253, s[16:19], s35 offen offset:1024 nt lds
    v_max3_f32 v243, v0, v1, v243
    v_max3_f32 v243, v2, v3, v243
    v_mfma_f32_32x32x16_bf16 v[16:31], a[100:103], a[4:7], v[16:31]
    s_add_u32 s35, s26, 26624
    buffer_load_dwordx4 v252, s[16:19], s35 offen offset:2048 nt lds
    v_max3_f32 v243, v4, v5, v243
    v_max3_f32 v243, v6, v7, v243
    v_mfma_f32_32x32x16_bf16 v[16:31], a[132:135], a[252:255], v[16:31]
    ds_read_b128 a[252:255], v251
    s_add_u32 s35, s26, 58368
    buffer_load_dwordx4 v253, s[16:19], s35 offen offset:3072 nt lds
    v_max3_f32 v243, v8, v9, v243
    v_max3_f32 v243, v10, v11, v243
    v_mfma_f32_32x32x16_bf16 v[16:31], a[104:107], a[8:11], v[16:31]
    v_max3_f32 v243, v12, v13, v243
    v_max3_f32 v243, v14, v15, v243
    v_fma_f32 v254, v243, s32, -v240
    v_cmp_lt_f32 vcc, s33, v254
    s_waitcnt lgkmcnt(1)
    v_mfma_f32_32x32x16_bf16 v[16:31], a[136:139], a[248:251], v[16:31]
    ds_read_b128 a[248:251], v248 offset:16384
    v_fma_f32 v0, v0, s32, -v240
    v_fma_f32 v1, v1, s32, -v240
    v_fma_f32 v2, v2, s32, -v240
    v_fma_f32 v3, v3, s32, -v240
    v_mfma_f32_32x32x16_bf16 v[16:31], a[108:111], a[12:15], v[16:31]
    v_fma_f32 v4, v4, s32, -v240
    v_fma_f32 v5, v5, s32, -v240
    s_cbranch_vccnz L_stub_0_2_10
L_back_0_2_10:
    v_exp_f32 v0, v0
    s_waitcnt lgkmcnt(1)
    v_mfma_f32_32x32x16_bf16 v[16:31], a[140:143], a[252:255], v[16:31]
    ds_read_b128 a[252:255], v249 offset:16384
    v_fma_f32 v6, v6, s32, -v240
    v_exp_f32 v1, v1
    v_fma_f32 v7, v7, s32, -v240
    v_mfma_f32_32x32x16_bf16 v[16:31], a[112:115], a[16:19], v[16:31]
    v_exp_f32 v2, v2
    v_fma_f32 v8, v8, s32, -v240
    v_exp_f32 v3, v3
    s_waitcnt lgkmcnt(1)
    v_mfma_f32_32x32x16_bf16 v[16:31], a[144:147], a[248:251], v[16:31]
    ds_read_b128 a[248:251], v250 offset:16384
    v_fma_f32 v9, v9, s32, -v240
    v_cvt_pk_bf16_f32 v200, v0, v1
    v_exp_f32 v4, v4
    v_mfma_f32_32x32x16_bf16 v[16:31], a[116:119], a[20:23], v[16:31]
    v_fma_f32 v10, v10, s32, -v240
    v_exp_f32 v5, v5
    v_fma_f32 v11, v11, s32, -v240
    s_waitcnt lgkmcnt(1)
    v_mfma_f32_32x32x16_bf16 v[16:31], a[148:151], a[252:255], v[16:31]
    ds_read_b128 a[252:255], v251 offset:16384
    v_cvt_pk_bf16_f32 v201, v2, v3
    v_exp_f32 v6, v6
    v_fma_f32 v12, v12, s32, -v240
    v_mfma_f32_32x32x16_bf16 v[16:31], a[120:123], a[24:27], v[16:31]
    v_exp_f32 v7, v7
    v_fma_f32 v13, v13, s32, -v240
    v_cvt_pk_bf16_f32 v202, v4, v5
    s_waitcnt lgkmcnt(1)
    v_mfma_f32_32x32x16_bf16 v[16:31], a[152:155], a[248:251], v[16:31]
    v_add_u32 v248, 32768, v248
    v_add_u32 v249, 32768, v249
    v_add_u32 v250, 32768, v250
    v_add_u32 v251, 32768, v251
    ds_read_b128 a[248:251], v248
    v_exp_f32 v8, v8
    v_mfma_f32_32x32x16_bf16 v[16:31], a[124:127], a[28:31], v[16:31]
    v_fma_f32 v14, v14, s32, -v240
    v_exp_f32 v9, v9
    v_fma_f32 v15, v15, s32, -v240
    v_cvt_pk_bf16_f32 v203, v6, v7
    s_waitcnt lgkmcnt(1)
    v_mfma_f32_32x32x16_bf16 v[16:31], a[156:159], a[252:255], v[16:31]
    ds_read_b128 a[252:255], v249
    v_exp_f32 v10, v10
    v_exp_f32 v11, v11
    v_cvt_pk_bf16_f32 v204, v8, v9
    v_exp_f32 v12, v12
    v_mfma_f32_4x4x4_16b_bf16 v[232:235], v[236:237], v[198:199], v[232:235] cbsz:4 abid:1
    v_exp_f32 v13, v13
    v_cvt_pk_bf16_f32 v205, v10, v11
    v_mfma_f32_4x4x4_16b_bf16 v[232:235], v[236:237], v[200:201], v[232:235] cbsz:4 abid:2
    v_exp_f32 v14, v14
    v_exp_f32 v15, v15
    v_mfma_f32_4x4x4_16b_bf16 v[232:235], v[236:237], v[202:203], v[232:235] cbsz:4 abid:2
    v_cvt_pk_bf16_f32 v206, v12, v13
    v_cvt_pk_bf16_f32 v207, v14, v15
    v_mfma_f32_4x4x4_16b_bf16 v[232:235], v[236:237], v[204:205], v[232:235] cbsz:4 abid:2
    v_mfma_f32_32x32x16_bf16 v[0:15], a[96:99], a[32:35], 0
    v_max3_f32 v241, v16, v17, v241
    v_max3_f32 v241, v18, v19, v241
    v_max3_f32 v241, v20, v21, v241
    v_max3_f32 v241, v22, v23, v241
    s_waitcnt lgkmcnt(1)
    v_mfma_f32_32x32x16_bf16 v[0:15], a[128:131], a[248:251], v[0:15]
    ds_read_b128 a[248:251], v250
    v_max3_f32 v241, v24, v25, v241
    v_max3_f32 v241, v26, v27, v241
    v_max3_f32 v241, v28, v29, v241
    v_max3_f32 v241, v30, v31, v241
    v_mfma_f32_32x32x16_bf16 v[0:15], a[100:103], a[36:39], v[0:15]
    v_fma_f32 v254, v241, s32, -v238
    v_cmp_lt_f32 vcc, s33, v254
    v_fma_f32 v16, v16, s32, -v238
    v_fma_f32 v17, v17, s32, -v238
    s_waitcnt lgkmcnt(1)
    v_mfma_f32_32x32x16_bf16 v[0:15], a[132:135], a[252:255], v[0:15]
    ds_read_b128 a[252:255], v251
    v_fma_f32 v18, v18, s32, -v238
    v_fma_f32 v19, v19, s32, -v238
    v_fma_f32 v20, v20, s32, -v238
    v_fma_f32 v21, v21, s32, -v238
    v_mfma_f32_32x32x16_bf16 v[0:15], a[104:107], a[40:43], v[0:15]
    s_cbranch_vccnz L_stub_0_0_11
L_back_0_0_11:
    v_exp_f32 v16, v16
    v_fma_f32 v22, v22, s32, -v238
    v_exp_f32 v17, v17
    s_waitcnt lgkmcnt(1)
    v_mfma_f32_32x32x16_bf16 v[0:15], a[136:139], a[248:251], v[0:15]
    ds_read_b128 a[248:251], v248 offset:49152
    v_fma_f32 v23, v23, s32, -v238
    v_exp_f32 v18, v18
    v_fma_f32 v24, v24, s32, -v238
    v_mfma_f32_32x32x16_bf16 v[0:15], a[108:111], a[44:47], v[0:15]
    v_exp_f32 v19, v19
    v_fma_f32 v25, v25, s32, -v238
    v_cvt_pk_bf16_f32 v208, v16, v17
    s_waitcnt lgkmcnt(1)
    v_mfma_f32_32x32x16_bf16 v[0:15], a[140:143], a[252:255], v[0:15]
    ds_read_b128 a[252:255], v249 offset:49152
    v_exp_f32 v20, v20
    v_fma_f32 v26, v26, s32, -v238
    v_exp_f32 v21, v21
    v_mfma_f32_32x32x16_bf16 v[0:15], a[112:115], a[48:51], v[0:15]
    v_fma_f32 v27, v27, s32, -v238
    v_cvt_pk_bf16_f32 v209, v18, v19
    v_exp_f32 v22, v22
    s_waitcnt lgkmcnt(1)
    v_mfma_f32_32x32x16_bf16 v[0:15], a[144:147], a[248:251], v[0:15]
    ds_read_b128 a[248:251], v250 offset:49152
    v_fma_f32 v28, v28, s32, -v238
    v_exp_f32 v23, v23
    v_fma_f32 v29, v29, s32, -v238
    v_mfma_f32_32x32x16_bf16 v[0:15], a[116:119], a[52:55], v[0:15]
    v_cvt_pk_bf16_f32 v210, v20, v21
    v_exp_f32 v24, v24
    v_fma_f32 v30, v30, s32, -v238
    s_waitcnt lgkmcnt(1)
    v_mfma_f32_32x32x16_bf16 v[0:15], a[148:151], a[252:255], v[0:15]
    ds_read_b128 a[252:255], v251 offset:49152
    v_exp_f32 v25, v25
    v_fma_f32 v31, v31, s32, -v238
    v_cvt_pk_bf16_f32 v211, v22, v23
    v_mfma_f32_32x32x16_bf16 v[0:15], a[120:123], a[56:59], v[0:15]
    v_exp_f32 v26, v26
    v_exp_f32 v27, v27
    v_cvt_pk_bf16_f32 v212, v24, v25
    s_waitcnt lgkmcnt(1)
    v_mfma_f32_32x32x16_bf16 v[0:15], a[152:155], a[248:251], v[0:15]
    ds_read_b128 a[248:251], v248 offset:32768
    v_exp_f32 v28, v28
    v_mfma_f32_32x32x16_bf16 v[0:15], a[124:127], a[60:63], v[0:15]
    s_waitcnt lgkmcnt(1)
    v_mfma_f32_32x32x16_bf16 v[0:15], a[156:159], a[252:255], v[0:15]
    ds_read_b128 a[252:255], v249 offset:32768
    v_mfma_f32_4x4x4_16b_bf16 v[232:235], v[236:237], v[206:207], v[232:235] cbsz:4 abid:2
    v_exp_f32 v29, v29
    v_cvt_pk_bf16_f32 v213, v26, v27
    v_mfma_f32_4x4x4_16b_bf16 v[232:235], v[236:237], v[208:209], v[232:235] cbsz:4 abid:0
    v_exp_f32 v30, v30
    v_exp_f32 v31, v31
    v_mfma_f32_4x4x4_16b_bf16 v[232:235], v[236:237], v[210:211], v[232:235] cbsz:4 abid:0
    v_cvt_pk_bf16_f32 v214, v28, v29
    v_cvt_pk_bf16_f32 v215, v30, v31
    v_mfma_f32_4x4x4_16b_bf16 v[232:235], v[236:237], v[212:213], v[232:235] cbsz:4 abid:0
    v_mfma_f32_32x32x16_bf16 v[16:31], a[96:99], a[64:67], 0
    v_max3_f32 v242, v0, v1, v242
    v_max3_f32 v242, v2, v3, v242
    v_max3_f32 v242, v4, v5, v242
    v_max3_f32 v242, v6, v7, v242
    s_waitcnt lgkmcnt(1)
    v_mfma_f32_32x32x16_bf16 v[16:31], a[128:131], a[248:251], v[16:31]
    ds_read_b128 a[248:251], v250 offset:32768
    v_max3_f32 v242, v8, v9, v242
    v_max3_f32 v242, v10, v11, v242
    v_max3_f32 v242, v12, v13, v242
    v_max3_f32 v242, v14, v15, v242
    v_mfma_f32_32x32x16_bf16 v[16:31], a[100:103], a[68:71], v[16:31]
    v_fma_f32 v254, v242, s32, -v239
    v_cmp_lt_f32 vcc, s33, v254
    v_fma_f32 v0, v0, s32, -v239
    v_fma_f32 v1, v1, s32, -v239
    s_waitcnt lgkmcnt(1)
    v_mfma_f32_32x32x16_bf16 v[16:31], a[132:135], a[252:255], v[16:31]
    ds_read_b128 a[252:255], v251 offset:32768
    v_fma_f32 v2, v2, s32, -v239
    v_fma_f32 v3, v3, s32, -v239
    v_fma_f32 v4, v4, s32, -v239
    v_fma_f32 v5, v5, s32, -v239
    v_mfma_f32_32x32x16_bf16 v[16:31], a[104:107], a[72:75], v[16:31]
    s_cbranch_vccnz L_stub_0_1_11
L_back_0_1_11:
    v_exp_f32 v0, v0
    v_fma_f32 v6, v6, s32, -v239
    v_exp_f32 v1, v1
    s_waitcnt lgkmcnt(1)
    v_mfma_f32_32x32x16_bf16 v[16:31], a[136:139], a[248:251], v[16:31]
    ds_read_b128 a[248:251], v248 offset:16384
    v_fma_f32 v7, v7, s32, -v239
    v_exp_f32 v2, v2
    v_fma_f32 v8, v8, s32, -v239
    v_mfma_f32_32x32x16_bf16 v[16:31], a[108:111], a[76:79], v[16:31]
    v_exp_f32 v3, v3
    v_fma_f32 v9, v9, s32, -v239
    v_cvt_pk_bf16_f32 v216, v0, v1
    s_waitcnt lgkmcnt(1)
    v_mfma_f32_32x32x16_bf16 v[16:31], a[140:143], a[252:255], v[16:31]
    ds_read_b128 a[252:255], v249 offset:16384
    v_exp_f32 v4, v4
    v_fma_f32 v10, v10, s32, -v239
    v_exp_f32 v5, v5
    v_mfma_f32_32x32x16_bf16 v[16:31], a[112:115], a[80:83], v[16:31]
    v_fma_f32 v11, v11, s32, -v239
    v_cvt_pk_bf16_f32 v217, v2, v3
    v_exp_f32 v6, v6
    s_waitcnt lgkmcnt(1)
    v_mfma_f32_32x32x16_bf16 v[16:31], a[144:147], a[248:251], v[16:31]
    ds_read_b128 a[248:251], v250 offset:16384
    v_fma_f32 v12, v12, s32, -v239
    v_exp_f32 v7, v7
    v_fma_f32 v13, v13, s32, -v239
    v_mfma_f32_32x32x16_bf16 v[16:31], a[116:119], a[84:87], v[16:31]
    v_cvt_pk_bf16_f32 v218, v4, v5
    v_exp_f32 v8, v8
    v_fma_f32 v14, v14, s32, -v239
    s_waitcnt lgkmcnt(1)
    v_mfma_f32_32x32x16_bf16 v[16:31], a[148:151], a[252:255], v[16:31]
    ds_read_b128 a[252:255], v251 offset:16384
    v_exp_f32 v9, v9
    v_fma_f32 v15, v15, s32, -v239
    v_cvt_pk_bf16_f32 v219, v6, v7
    v_mfma_f32_32x32x16_bf16 v[16:31], a[120:123], a[88:91], v[16:31]
    v_exp_f32 v10, v10
    v_exp_f32 v11, v11
    v_cvt_pk_bf16_f32 v220, v8, v9
    s_waitcnt lgkmcnt(1)
    v_mfma_f32_32x32x16_bf16 v[16:31], a[152:155], a[248:251], v[16:31]
    v_exp_f32 v12, v12
    v_mfma_f32_32x32x16_bf16 v[16:31], a[124:127], a[92:95], v[16:31]
    s_waitcnt lgkmcnt(0)
    v_mfma_f32_32x32x16_bf16 v[16:31], a[156:159], a[252:255], v[16:31]
    v_mfma_f32_4x4x4_16b_bf16 v[232:235], v[236:237], v[214:215], v[232:235] cbsz:4 abid:0
    v_exp_f32 v13, v13
    v_cvt_pk_bf16_f32 v221, v10, v11
    v_mfma_f32_4x4x4_16b_bf16 v[232:235], v[236:237], v[216:217], v[232:235] cbsz:4 abid:1
    v_exp_f32 v14, v14
    v_exp_f32 v15, v15
    v_mfma_f32_4x4x4_16b_bf16 v[232:235], v[236:237], v[218:219], v[232:235] cbsz:4 abid:1
    v_cvt_pk_bf16_f32 v222, v12, v13
    v_cvt_pk_bf16_f32 v223, v14, v15
    v_mfma_f32_4x4x4_16b_bf16 v[232:235], v[236:237], v[220:221], v[232:235] cbsz:4 abid:1
    s_nop 1
    v_max3_f32 v243, v16, v17, v243
    v_max3_f32 v243, v18, v19, v243
    v_max3_f32 v243, v20, v21, v243
    v_max3_f32 v243, v22, v23, v243
    v_max3_f32 v243, v24, v25, v243
    v_max3_f32 v243, v26, v27, v243
    v_max3_f32 v243, v28, v29, v243
    v_max3_f32 v243, v30, v31, v243
    v_fma_f32 v254, v243, s32, -v240
    v_cmp_lt_f32 vcc, s33, v254
    v_fma_f32 v16, v16, s32, -v240
    v_fma_f32 v17, v17, s32, -v240
    v_fma_f32 v18, v18, s32, -v240
    v_fma_f32 v19, v19, s32, -v240
    v_fma_f32 v20, v20, s32, -v240
    v_fma_f32 v21, v21, s32, -v240
    s_cbranch_vccnz L_stub_0_2_11
L_back_0_2_11:
    v_exp_f32 v16, v16
    v_fma_f32 v22, v22, s32, -v240
    v_exp_f32 v17, v17
    v_fma_f32 v23, v23, s32, -v240
    v_exp_f32 v18, v18
    v_fma_f32 v24, v24, s32, -v240
    v_exp_f32 v19, v19
    v_fma_f32 v25, v25, s32, -v240
    v_cvt_pk_bf16_f32 v224, v16, v17
    v_exp_f32 v20, v20
    v_fma_f32 v26, v26, s32, -v240
    v_exp_f32 v21, v21
    v_fma_f32 v27, v27, s32, -v240
    v_cvt_pk_bf16_f32 v225, v18, v19
    v_exp_f32 v22, v22
    v_fma_f32 v28, v28, s32, -v240
    v_exp_f32 v23, v23
    v_fma_f32 v29, v29, s32, -v240
    v_cvt_pk_bf16_f32 v226, v20, v21
    v_exp_f32 v24, v24
    v_fma_f32 v30, v30, s32, -v240
    v_exp_f32 v25, v25
    v_fma_f32 v31, v31, s32, -v240
    v_cvt_pk_bf16_f32 v227, v22, v23
    v_exp_f32 v26, v26
    v_exp_f32 v27, v27
    v_cvt_pk_bf16_f32 v228, v24, v25
    v_exp_f32 v28, v28
    v_mfma_f32_4x4x4_16b_bf16 v[232:235], v[236:237], v[222:223], v[232:235] cbsz:4 abid:1
    v_exp_f32 v29, v29
    v_cvt_pk_bf16_f32 v229, v26, v27
    v_mfma_f32_4x4x4_16b_bf16 v[232:235], v[236:237], v[224:225], v[232:235] cbsz:4 abid:2
    v_exp_f32 v30, v30
    v_exp_f32 v31, v31
    v_mfma_f32_4x4x4_16b_bf16 v[232:235], v[236:237], v[226:227], v[232:235] cbsz:4 abid:2
    v_cvt_pk_bf16_f32 v230, v28, v29
    v_cvt_pk_bf16_f32 v231, v30, v31
    v_mfma_f32_4x4x4_16b_bf16 v[232:235], v[236:237], v[228:229], v[232:235] cbsz:4 abid:2
    s_nop 1
    v_mfma_f32_4x4x4_16b_bf16 v[232:235], v[236:237], v[230:231], v[232:235] cbsz:4 abid:2
    v_mbcnt_lo_u32_b32 v248, -1, 0
    v_mbcnt_hi_u32_b32 v248, -1, v248
    v_bfe_u32 v244, v248, 1, 1
    v_bfe_u32 v249, v248, 4, 1
    v_lshl_add_u32 v244, v249, 1, v244
    v_lshrrev_b32 v249, 5, v248
    v_xor_b32 v244, v244, v249
    v_lshlrev_b32 v244, 4, v244
    v_lshl_add_u32 v244, v249, 9, v244
    v_bfe_u32 v249, v248, 3, 1
    v_lshl_add_u32 v244, v249, 6, v244
    v_bfe_u32 v249, v248, 2, 2
    v_lshl_add_u32 v244, v249, 7, v244
    v_and_b32 v249, 1, v248
    v_lshl_add_u32 v244, v249, 3, v244
    v_xor_b32 v245, 32, v244
    v_xor_b32 v246, 64, v244
    v_xor_b32 v247, 0x60, v244
    ds_read_b64_tr_b16 a[248:249], v244
    ds_read_b64_tr_b16 a[250:251], v245 offset:1024
    ds_read_b64_tr_b16 a[252:253], v244 offset:2048
    ds_read_b64_tr_b16 a[254:255], v245 offset:3072
    v_fma_f32 v248, v241, s32, -v238
    v_ceil_f32 v248, v248
    v_add_f32 v248, v248, v238
    v_max_f32 v248, v248, v238
    v_mov_b32 v249, v248
    s_nop 1
    v_permlane32_swap_b32 v248, v249
    v_max_f32 v248, v248, v249
    v_sub_f32 v248, v248, v238
    v_cvt_pk_u8_f32 v248, v248, 0, 0
    v_mul_u32_u24 v241, s34, v248
    v_sub_u32 v248, 0, v248
    v_ldexp_f32 v248, v232, v248
    v_mov_b32 v249, v248
    s_nop 1
    v_permlane32_swap_b32 v248, v249
    v_add_f32 v248, v248, v249
    v_rcp_f32 v238, v248
    v_fma_f32 v248, v242, s32, -v239
    v_ceil_f32 v248, v248
    v_add_f32 v248, v248, v239
    v_max_f32 v248, v248, v239
    v_mov_b32 v249, v248
    s_nop 1
    v_permlane32_swap_b32 v248, v249
    v_max_f32 v248, v248, v249
    v_sub_f32 v248, v248, v239
    v_cvt_pk_u8_f32 v248, v248, 0, 0
    v_mul_u32_u24 v242, s34, v248
    v_sub_u32 v248, 0, v248
    v_ldexp_f32 v248, v233, v248
    v_mov_b32 v249, v248
    s_nop 1
    v_permlane32_swap_b32 v248, v249
    v_add_f32 v248, v248, v249
    v_rcp_f32 v239, v248
    v_fma_f32 v248, v243, s32, -v240
    v_ceil_f32 v248, v248
    v_add_f32 v248, v248, v240
    v_max_f32 v248, v248, v240
    v_mov_b32 v249, v248
    s_nop 1
    v_permlane32_swap_b32 v248, v249
    v_max_f32 v248, v248, v249
    v_sub_f32 v248, v248, v240
    v_cvt_pk_u8_f32 v248, v248, 0, 0
    v_mul_u32_u24 v243, s34, v248
    v_sub_u32 v248, 0, v248
    v_ldexp_f32 v248, v234, v248
    v_mov_b32 v249, v248
    s_nop 1
    v_permlane32_swap_b32 v248, v249
    v_add_f32 v248, v248, v249
    v_rcp_f32 v240, v248
    v_accvgpr_read_b32 v254, a160
    v_pk_sub_u16 v254, v254, v241 clamp
    v_accvgpr_write_b32 a160, v254
    v_accvgpr_read_b32 v254, a161
    v_pk_sub_u16 v254, v254, v241 clamp
    v_accvgpr_write_b32 a161, v254
    v_accvgpr_read_b32 v254, a162
    v_pk_sub_u16 v254, v254, v241 clamp
    v_accvgpr_write_b32 a162, v254
    v_accvgpr_read_b32 v254, a163
    v_pk_sub_u16 v254, v254, v241 clamp
    v_accvgpr_write_b32 a163, v254
    v_accvgpr_read_b32 v254, a164
    v_pk_sub_u16 v254, v254, v241 clamp
    v_accvgpr_write_b32 a164, v254
    v_accvgpr_read_b32 v254, a165
    v_pk_sub_u16 v254, v254, v241 clamp
    v_accvgpr_write_b32 a165, v254
    v_accvgpr_read_b32 v254, a166
    v_pk_sub_u16 v254, v254, v241 clamp
    v_accvgpr_write_b32 a166, v254
    v_accvgpr_read_b32 v254, a167
    v_pk_sub_u16 v254, v254, v241 clamp
    v_accvgpr_write_b32 a167, v254
    v_pk_sub_u16 v32, v32, v242 clamp
    v_pk_sub_u16 v33, v33, v242 clamp
    v_pk_sub_u16 v34, v34, v242 clamp
    v_pk_sub_u16 v35, v35, v242 clamp
    v_pk_sub_u16 v36, v36, v242 clamp
    v_pk_sub_u16 v37, v37, v242 clamp
    v_pk_sub_u16 v38, v38, v242 clamp
    v_pk_sub_u16 v39, v39, v242 clamp
    v_pk_sub_u16 v40, v40, v243 clamp
    v_pk_sub_u16 v41, v41, v243 clamp
    v_pk_sub_u16 v42, v42, v243 clamp
    v_pk_sub_u16 v43, v43, v243 clamp
    v_pk_sub_u16 v44, v44, v243 clamp
    v_pk_sub_u16 v45, v45, v243 clamp
    v_pk_sub_u16 v46, v46, v243 clamp
    v_pk_sub_u16 v47, v47, v243 clamp
    s_waitcnt lgkmcnt(2)
    v_mfma_f32_32x32x16_bf16 a[0:15], a[248:251], a[160:163], 0
    ds_read_b64_tr_b16 v[232:233], v246
    ds_read_b64_tr_b16 v[234:235], v247 offset:1024
    s_add_u32 m0, s31, 0
    s_add_u32 s35, s48, 4352
    buffer_load_dwordx4 v252, s[16:19], s35 offen nt lds
    v_mfma_f32_32x32x16_bf16 a[64:79], a[248:251], v[32:35], 0
    ds_read_b64_tr_b16 v[248:249], v246 offset:2048
    ds_read_b64_tr_b16 v[250:251], v247 offset:3072
    s_add_u32 m0, s31, 81920
    s_add_u32 s35, s48, 4480
    buffer_load_dwordx4 v252, s[16:19], s35 offen nt lds
    v_mfma_f32_32x32x16_bf16 a[128:143], a[248:251], v[40:43], 0
    ds_read_b64_tr_b16 a[248:249], v244 offset:8192
    ds_read_b64_tr_b16 a[250:251], v245 offset:9216
    s_add_u32 m0, s31, 0
    s_add_u32 s35, s48, 36096
    buffer_load_dwordx4 v253, s[16:19], s35 offen offset:1024 nt lds
    s_waitcnt lgkmcnt(6)
    v_mfma_f32_32x32x16_bf16 a[0:15], a[252:255], a[164:167], a[0:15]
    s_add_u32 m0, s31, 81920
    s_add_u32 s35, s48, 36224
    buffer_load_dwordx4 v253, s[16:19], s35 offen offset:1024 nt lds
    v_accvgpr_read_b32 v254, a168
    v_pk_sub_u16 v254, v254, v241 clamp
    v_accvgpr_write_b32 a168, v254
    v_mfma_f32_32x32x16_bf16 a[64:79], a[252:255], v[36:39], a[64:79]
    v_accvgpr_read_b32 v254, a169
    v_pk_sub_u16 v254, v254, v241 clamp
    v_accvgpr_write_b32 a169, v254
    v_accvgpr_read_b32 v254, a170
    v_pk_sub_u16 v254, v254, v241 clamp
    v_accvgpr_write_b32 a170, v254
    v_mfma_f32_32x32x16_bf16 a[128:143], a[252:255], v[44:47], a[128:143]
    ds_read_b64_tr_b16 a[252:253], v244 offset:10240
    ds_read_b64_tr_b16 a[254:255], v245 offset:11264
    v_accvgpr_read_b32 v254, a171
    v_pk_sub_u16 v254, v254, v241 clamp
    v_accvgpr_write_b32 a171, v254
    s_waitcnt lgkmcnt(6)
    v_mfma_f32_32x32x16_bf16 a[16:31], v[232:235], a[160:163], 0
    v_accvgpr_read_b32 v254, a172
    v_pk_sub_u16 v254, v254, v241 clamp
    v_accvgpr_write_b32 a172, v254
    v_accvgpr_read_b32 v254, a173
    v_pk_sub_u16 v254, v254, v241 clamp
    v_accvgpr_write_b32 a173, v254
    v_mfma_f32_32x32x16_bf16 a[80:95], v[232:235], v[32:35], 0
    v_accvgpr_read_b32 v254, a174
    v_pk_sub_u16 v254, v254, v241 clamp
    v_accvgpr_write_b32 a174, v254
    v_accvgpr_read_b32 v254, a175
    v_pk_sub_u16 v254, v254, v241 clamp
    v_accvgpr_write_b32 a175, v254
    v_mfma_f32_32x32x16_bf16 a[144:159], v[232:235], v[40:43], 0
    ds_read_b64_tr_b16 v[232:233], v246 offset:8192
    ds_read_b64_tr_b16 v[234:235], v247 offset:9216
    v_pk_sub_u16 v48, v48, v242 clamp
    v_pk_sub_u16 v49, v49, v242 clamp
    v_pk_sub_u16 v50, v50, v242 clamp
    s_waitcnt lgkmcnt(6)
    v_mfma_f32_32x32x16_bf16 a[16:31], v[248:251], a[164:167], a[16:31]
    v_pk_sub_u16 v51, v51, v242 clamp
    v_pk_sub_u16 v52, v52, v242 clamp
    v_pk_sub_u16 v53, v53, v242 clamp
    v_pk_sub_u16 v54, v54, v242 clamp
    v_pk_sub_u16 v55, v55, v242 clamp
    v_mfma_f32_32x32x16_bf16 a[80:95], v[248:251], v[36:39], a[80:95]
    v_pk_sub_u16 v56, v56, v243 clamp
    v_pk_sub_u16 v57, v57, v243 clamp
    v_pk_sub_u16 v58, v58, v243 clamp
    v_pk_sub_u16 v59, v59, v243 clamp
    v_pk_sub_u16 v60, v60, v243 clamp
    v_mfma_f32_32x32x16_bf16 a[144:159], v[248:251], v[44:47], a[144:159]
    ds_read_b64_tr_b16 v[248:249], v246 offset:10240
    ds_read_b64_tr_b16 v[250:251], v247 offset:11264
    v_pk_sub_u16 v61, v61, v243 clamp
    v_pk_sub_u16 v62, v62, v243 clamp
    v_pk_sub_u16 v63, v63, v243 clamp
    s_waitcnt lgkmcnt(6)
    v_mfma_f32_32x32x16_bf16 a[32:47], a[248:251], a[160:163], 0
    v_mfma_f32_32x32x16_bf16 a[96:111], a[248:251], v[32:35], 0
    v_mfma_f32_32x32x16_bf16 v[0:15], a[248:251], v[40:43], 0
    ds_read_b64_tr_b16 a[248:249], v244 offset:4096
    ds_read_b64_tr_b16 a[250:251], v245 offset:5120
    s_waitcnt lgkmcnt(6)
    v_mfma_f32_32x32x16_bf16 a[32:47], a[252:255], a[164:167], a[32:47]
    v_mfma_f32_32x32x16_bf16 a[96:111], a[252:255], v[36:39], a[96:111]
    v_mfma_f32_32x32x16_bf16 v[0:15], a[252:255], v[44:47], v[0:15]
    ds_read_b64_tr_b16 a[252:253], v244 offset:6144
    ds_read_b64_tr_b16 a[254:255], v245 offset:7168
    s_waitcnt lgkmcnt(6)
    v_mfma_f32_32x32x16_bf16 a[48:63], v[232:235], a[160:163], 0
    v_mfma_f32_32x32x16_bf16 a[112:127], v[232:235], v[32:35], 0
    v_mfma_f32_32x32x16_bf16 v[16:31], v[232:235], v[40:43], 0
    s_waitcnt vmcnt(12)
    s_barrier
    ds_read_b64_tr_b16 v[232:233], v246 offset:4096
    ds_read_b64_tr_b16 v[234:235], v247 offset:5120
    s_waitcnt lgkmcnt(6)
    v_mfma_f32_32x32x16_bf16 a[48:63], v[248:251], a[164:167], a[48:63]
    v_mfma_f32_32x32x16_bf16 a[112:127], v[248:251], v[36:39], a[112:127]
    v_mfma_f32_32x32x16_bf16 v[16:31], v[248:251], v[44:47], v[16:31]
    ds_read_b64_tr_b16 v[248:249], v246 offset:6144
    ds_read_b64_tr_b16 v[250:251], v247 offset:7168
    s_waitcnt lgkmcnt(6)
    v_mfma_f32_32x32x16_bf16 a[0:15], a[248:251], a[168:171], a[0:15]
    v_accvgpr_read_b32 v254, a176
    v_pk_sub_u16 v254, v254, v241 clamp
    v_accvgpr_write_b32 a176, v254
    v_accvgpr_read_b32 v254, a177
    v_pk_sub_u16 v254, v254, v241 clamp
    v_accvgpr_write_b32 a177, v254
    v_mfma_f32_32x32x16_bf16 a[64:79], a[248:251], v[48:51], a[64:79]
    v_accvgpr_read_b32 v254, a178
    v_pk_sub_u16 v254, v254, v241 clamp
    v_accvgpr_write_b32 a178, v254
    v_accvgpr_read_b32 v254, a179
    v_pk_sub_u16 v254, v254, v241 clamp
    v_accvgpr_write_b32 a179, v254
    v_mfma_f32_32x32x16_bf16 a[128:143], a[248:251], v[56:59], a[128:143]
    ds_read_b64_tr_b16 a[248:249], v244 offset:12288
    ds_read_b64_tr_b16 a[250:251], v245 offset:13312
    v_accvgpr_read_b32 v254, a180
    v_pk_sub_u16 v254, v254, v241 clamp
    v_accvgpr_write_b32 a180, v254
    s_waitcnt lgkmcnt(6)
    v_mfma_f32_32x32x16_bf16 a[0:15], a[252:255], a[172:175], a[0:15]
    v_accvgpr_read_b32 v254, a181
    v_pk_sub_u16 v254, v254, v241 clamp
    v_accvgpr_write_b32 a181, v254
    v_accvgpr_read_b32 v254, a182
    v_pk_sub_u16 v254, v254, v241 clamp
    v_accvgpr_write_b32 a182, v254
    v_mfma_f32_32x32x16_bf16 a[64:79], a[252:255], v[52:55], a[64:79]
    v_accvgpr_read_b32 v254, a183
    v_pk_sub_u16 v254, v254, v241 clamp
    v_accvgpr_write_b32 a183, v254
    v_pk_sub_u16 v64, v64, v242 clamp
    v_pk_sub_u16 v65, v65, v242 clamp
    v_mfma_f32_32x32x16_bf16 a[128:143], a[252:255], v[60:63], a[128:143]
    ds_read_b64_tr_b16 a[252:253], v244 offset:14336
    ds_read_b64_tr_b16 a[254:255], v245 offset:15360
    v_pk_sub_u16 v66, v66, v242 clamp
    v_pk_sub_u16 v67, v67, v242 clamp
    v_pk_sub_u16 v68, v68, v242 clamp
    s_waitcnt lgkmcnt(6)
    v_mfma_f32_32x32x16_bf16 a[16:31], v[232:235], a[168:171], a[16:31]
    v_pk_sub_u16 v69, v69, v242 clamp
    v_pk_sub_u16 v70, v70, v242 clamp
    v_pk_sub_u16 v71, v71, v242 clamp
    v_pk_sub_u16 v72, v72, v243 clamp
    v_pk_sub_u16 v73, v73, v243 clamp
    v_mfma_f32_32x32x16_bf16 a[80:95], v[232:235], v[48:51], a[80:95]
    v_pk_sub_u16 v74, v74, v243 clamp
    v_pk_sub_u16 v75, v75, v243 clamp
    v_pk_sub_u16 v76, v76, v243 clamp
    v_pk_sub_u16 v77, v77, v243 clamp
    v_pk_sub_u16 v78, v78, v243 clamp
    v_mfma_f32_32x32x16_bf16 a[144:159], v[232:235], v[56:59], a[144:159]
    ds_read_b64_tr_b16 v[232:233], v246 offset:12288
    ds_read_b64_tr_b16 v[234:235], v247 offset:13312
    v_pk_sub_u16 v79, v79, v243 clamp
    s_waitcnt lgkmcnt(6)
    v_mfma_f32_32x32x16_bf16 a[16:31], v[248:251], a[172:175], a[16:31]
    v_mfma_f32_32x32x16_bf16 a[80:95], v[248:251], v[52:55], a[80:95]
    v_mfma_f32_32x32x16_bf16 a[144:159], v[248:251], v[60:63], a[144:159]
    ds_read_b64_tr_b16 v[248:249], v246 offset:14336
    ds_read_b64_tr_b16 v[250:251], v247 offset:15360
    s_waitcnt lgkmcnt(6)
    v_mfma_f32_32x32x16_bf16 a[32:47], a[248:251], a[168:171], a[32:47]
    v_mfma_f32_32x32x16_bf16 a[96:111], a[248:251], v[48:51], a[96:111]
    v_mfma_f32_32x32x16_bf16 v[0:15], a[248:251], v[56:59], v[0:15]
    ds_read_b64_tr_b16 a[248:249], v244 offset:16384
    ds_read_b64_tr_b16 a[250:251], v245 offset:17408
    s_waitcnt lgkmcnt(6)
    v_mfma_f32_32x32x16_bf16 a[32:47], a[252:255], a[172:175], a[32:47]
    v_mfma_f32_32x32x16_bf16 a[96:111], a[252:255], v[52:55], a[96:111]
    s_add_u32 m0, s31, 0
    s_add_u32 s35, s48, 67840
    buffer_load_dwordx4 v252, s[16:19], s35 offen offset:2048 nt lds
    v_mfma_f32_32x32x16_bf16 v[0:15], a[252:255], v[60:63], v[0:15]
    ds_read_b64_tr_b16 a[252:253], v244 offset:18432
    ds_read_b64_tr_b16 a[254:255], v245 offset:19456
    s_add_u32 m0, s31, 81920
    s_add_u32 s35, s48, 67968
    buffer_load_dwordx4 v252, s[16:19], s35 offen offset:2048 nt lds
    s_waitcnt lgkmcnt(6)
    v_mfma_f32_32x32x16_bf16 a[48:63], v[232:235], a[168:171], a[48:63]
    s_add_u32 m0, s31, 0
    s_add_u32 s35, s48, 99584
    buffer_load_dwordx4 v253, s[16:19], s35 offen offset:3072 nt lds
    v_mfma_f32_32x32x16_bf16 a[112:127], v[232:235], v[48:51], a[112:127]
    s_add_u32 m0, s31, 81920
    s_add_u32 s35, s48, 99712
    buffer_load_dwordx4 v253, s[16:19], s35 offen offset:3072 nt lds
    v_mfma_f32_32x32x16_bf16 v[16:31], v[232:235], v[56:59], v[16:31]
    ds_read_b64_tr_b16 v[232:233], v246 offset:16384
    ds_read_b64_tr_b16 v[234:235], v247 offset:17408
    s_waitcnt lgkmcnt(6)
    v_mfma_f32_32x32x16_bf16 a[48:63], v[248:251], a[172:175], a[48:63]
    v_mfma_f32_32x32x16_bf16 a[112:127], v[248:251], v[52:55], a[112:127]
    v_mfma_f32_32x32x16_bf16 v[16:31], v[248:251], v[60:63], v[16:31]
    ds_read_b64_tr_b16 v[248:249], v246 offset:18432
    ds_read_b64_tr_b16 v[250:251], v247 offset:19456
    s_waitcnt lgkmcnt(6)
    v_mfma_f32_32x32x16_bf16 a[0:15], a[248:251], a[176:179], a[0:15]
    v_accvgpr_read_b32 v254, a184
    v_pk_sub_u16 v254, v254, v241 clamp
    v_accvgpr_write_b32 a184, v254
    v_accvgpr_read_b32 v254, a185
    v_pk_sub_u16 v254, v254, v241 clamp
    v_accvgpr_write_b32 a185, v254
    v_mfma_f32_32x32x16_bf16 a[64:79], a[248:251], v[64:67], a[64:79]
    v_accvgpr_read_b32 v254, a186
    v_pk_sub_u16 v254, v254, v241 clamp
    v_accvgpr_write_b32 a186, v254
    v_accvgpr_read_b32 v254, a187
    v_pk_sub_u16 v254, v254, v241 clamp
    v_accvgpr_write_b32 a187, v254
    v_mfma_f32_32x32x16_bf16 a[128:143], a[248:251], v[72:75], a[128:143]
    ds_read_b64_tr_b16 a[248:249], v244 offset:24576
    ds_read_b64_tr_b16 a[250:251], v245 offset:25600
    v_accvgpr_read_b32 v254, a188
    v_pk_sub_u16 v254, v254, v241 clamp
    v_accvgpr_write_b32 a188, v254
    s_waitcnt lgkmcnt(6)
    v_mfma_f32_32x32x16_bf16 a[0:15], a[252:255], a[180:183], a[0:15]
    v_accvgpr_read_b32 v254, a189
    v_pk_sub_u16 v254, v254, v241 clamp
    v_accvgpr_write_b32 a189, v254
    v_accvgpr_read_b32 v254, a190
    v_pk_sub_u16 v254, v254, v241 clamp
    v_accvgpr_write_b32 a190, v254
    v_mfma_f32_32x32x16_bf16 a[64:79], a[252:255], v[68:71], a[64:79]
    v_accvgpr_read_b32 v254, a191
    v_pk_sub_u16 v254, v254, v241 clamp
    v_accvgpr_write_b32 a191, v254
    v_pk_sub_u16 v80, v80, v242 clamp
    v_pk_sub_u16 v81, v81, v242 clamp
    v_mfma_f32_32x32x16_bf16 a[128:143], a[252:255], v[76:79], a[128:143]
    ds_read_b64_tr_b16 a[252:253], v244 offset:26624
    ds_read_b64_tr_b16 a[254:255], v245 offset:27648
    v_pk_sub_u16 v82, v82, v242 clamp
    v_pk_sub_u16 v83, v83, v242 clamp
    v_pk_sub_u16 v84, v84, v242 clamp
    s_waitcnt lgkmcnt(6)
    v_mfma_f32_32x32x16_bf16 a[16:31], v[232:235], a[176:179], a[16:31]
    v_pk_sub_u16 v85, v85, v242 clamp
    v_pk_sub_u16 v86, v86, v242 clamp
    v_pk_sub_u16 v87, v87, v242 clamp
    v_pk_sub_u16 v88, v88, v243 clamp
    v_pk_sub_u16 v89, v89, v243 clamp
    v_mfma_f32_32x32x16_bf16 a[80:95], v[232:235], v[64:67], a[80:95]
    v_pk_sub_u16 v90, v90, v243 clamp
    v_pk_sub_u16 v91, v91, v243 clamp
    v_pk_sub_u16 v92, v92, v243 clamp
    v_pk_sub_u16 v93, v93, v243 clamp
    v_pk_sub_u16 v94, v94, v243 clamp
    v_mfma_f32_32x32x16_bf16 a[144:159], v[232:235], v[72:75], a[144:159]
    ds_read_b64_tr_b16 v[232:233], v246 offset:24576
    ds_read_b64_tr_b16 v[234:235], v247 offset:25600
    v_pk_sub_u16 v95, v95, v243 clamp
    s_waitcnt lgkmcnt(6)
    v_mfma_f32_32x32x16_bf16 a[16:31], v[248:251], a[180:183], a[16:31]
    v_mfma_f32_32x32x16_bf16 a[80:95], v[248:251], v[68:71], a[80:95]
    v_mfma_f32_32x32x16_bf16 a[144:159], v[248:251], v[76:79], a[144:159]
    ds_read_b64_tr_b16 v[248:249], v246 offset:26624
    ds_read_b64_tr_b16 v[250:251], v247 offset:27648
    s_waitcnt lgkmcnt(6)
    v_mfma_f32_32x32x16_bf16 a[32:47], a[248:251], a[176:179], a[32:47]
    v_mfma_f32_32x32x16_bf16 a[96:111], a[248:251], v[64:67], a[96:111]
    v_mfma_f32_32x32x16_bf16 v[0:15], a[248:251], v[72:75], v[0:15]
    ds_read_b64_tr_b16 a[248:249], v244 offset:20480
    ds_read_b64_tr_b16 a[250:251], v245 offset:21504
    s_waitcnt lgkmcnt(6)
    v_mfma_f32_32x32x16_bf16 a[32:47], a[252:255], a[180:183], a[32:47]
    v_mfma_f32_32x32x16_bf16 a[96:111], a[252:255], v[68:71], a[96:111]
    v_mfma_f32_32x32x16_bf16 v[0:15], a[252:255], v[76:79], v[0:15]
    ds_read_b64_tr_b16 a[252:253], v244 offset:22528
    ds_read_b64_tr_b16 a[254:255], v245 offset:23552
    s_waitcnt lgkmcnt(6)
    v_mfma_f32_32x32x16_bf16 a[48:63], v[232:235], a[176:179], a[48:63]
    v_mfma_f32_32x32x16_bf16 a[112:127], v[232:235], v[64:67], a[112:127]
    v_mfma_f32_32x32x16_bf16 v[16:31], v[232:235], v[72:75], v[16:31]
    s_waitcnt vmcnt(12)
    s_barrier
    ds_read_b64_tr_b16 v[232:233], v246 offset:20480
    ds_read_b64_tr_b16 v[234:235], v247 offset:21504
    s_add_u32 m0, s30, 0
    s_add_u32 s35, s26, 86016
    buffer_load_dwordx4 v252, s[16:19], s35 offen nt lds
    s_waitcnt lgkmcnt(6)
    v_mfma_f32_32x32x16_bf16 a[48:63], v[248:251], a[180:183], a[48:63]
    s_add_u32 s35, s26, 117760
    buffer_load_dwordx4 v253, s[16:19], s35 offen offset:1024 nt lds
    v_mfma_f32_32x32x16_bf16 a[112:127], v[248:251], v[68:71], a[112:127]
    s_add_u32 s35, s26, 149504
    buffer_load_dwordx4 v252, s[16:19], s35 offen offset:2048 nt lds
    v_mfma_f32_32x32x16_bf16 v[16:31], v[248:251], v[76:79], v[16:31]
    ds_read_b64_tr_b16 v[248:249], v246 offset:22528
    ds_read_b64_tr_b16 v[250:251], v247 offset:23552
    s_add_u32 s35, s26, 181248
    buffer_load_dwordx4 v253, s[16:19], s35 offen offset:3072 nt lds
    s_waitcnt lgkmcnt(6)
    v_mfma_f32_32x32x16_bf16 a[0:15], a[248:251], a[184:187], a[0:15]
    v_accvgpr_read_b32 v254, a192
    v_pk_sub_u16 v254, v254, v241 clamp
    v_accvgpr_write_b32 a192, v254
    v_accvgpr_read_b32 v254, a193
    v_pk_sub_u16 v254, v254, v241 clamp
    v_accvgpr_write_b32 a193, v254
    v_mfma_f32_32x32x16_bf16 a[64:79], a[248:251], v[80:83], a[64:79]
    v_accvgpr_read_b32 v254, a194
    v_pk_sub_u16 v254, v254, v241 clamp
    v_accvgpr_write_b32 a194, v254
    v_accvgpr_read_b32 v254, a195
    v_pk_sub_u16 v254, v254, v241 clamp
    v_accvgpr_write_b32 a195, v254
    v_mfma_f32_32x32x16_bf16 a[128:143], a[248:251], v[88:91], a[128:143]
    ds_read_b64_tr_b16 a[248:249], v244 offset:28672
    ds_read_b64_tr_b16 a[250:251], v245 offset:29696
    v_accvgpr_read_b32 v254, a196
    v_pk_sub_u16 v254, v254, v241 clamp
    v_accvgpr_write_b32 a196, v254
    s_waitcnt lgkmcnt(6)
    v_mfma_f32_32x32x16_bf16 a[0:15], a[252:255], a[188:191], a[0:15]
    v_accvgpr_read_b32 v254, a197
    v_pk_sub_u16 v254, v254, v241 clamp
    v_accvgpr_write_b32 a197, v254
    v_accvgpr_read_b32 v254, a198
    v_pk_sub_u16 v254, v254, v241 clamp
    v_accvgpr_write_b32 a198, v254
    v_mfma_f32_32x32x16_bf16 a[64:79], a[252:255], v[84:87], a[64:79]
    v_accvgpr_read_b32 v254, a199
    v_pk_sub_u16 v254, v254, v241 clamp
    v_accvgpr_write_b32 a199, v254
    v_pk_sub_u16 v96, v96, v242 clamp
    v_pk_sub_u16 v97, v97, v242 clamp
    v_mfma_f32_32x32x16_bf16 a[128:143], a[252:255], v[92:95], a[128:143]
    ds_read_b64_tr_b16 a[252:253], v244 offset:30720
    ds_read_b64_tr_b16 a[254:255], v245 offset:31744
    v_pk_sub_u16 v98, v98, v242 clamp
    v_pk_sub_u16 v99, v99, v242 clamp
    v_pk_sub_u16 v100, v100, v242 clamp
    s_waitcnt lgkmcnt(6)
    v_mfma_f32_32x32x16_bf16 a[16:31], v[232:235], a[184:187], a[16:31]
    v_pk_sub_u16 v101, v101, v242 clamp
    v_pk_sub_u16 v102, v102, v242 clamp
    v_pk_sub_u16 v103, v103, v242 clamp
    v_pk_sub_u16 v104, v104, v243 clamp
    v_pk_sub_u16 v105, v105, v243 clamp
    v_mfma_f32_32x32x16_bf16 a[80:95], v[232:235], v[80:83], a[80:95]
    v_pk_sub_u16 v106, v106, v243 clamp
    v_pk_sub_u16 v107, v107, v243 clamp
    v_pk_sub_u16 v108, v108, v243 clamp
    v_pk_sub_u16 v109, v109, v243 clamp
    v_pk_sub_u16 v110, v110, v243 clamp
    v_mfma_f32_32x32x16_bf16 a[144:159], v[232:235], v[88:91], a[144:159]
    ds_read_b64_tr_b16 v[232:233], v246 offset:28672
    ds_read_b64_tr_b16 v[234:235], v247 offset:29696
    v_pk_sub_u16 v111, v111, v243 clamp
    s_waitcnt lgkmcnt(6)
    v_mfma_f32_32x32x16_bf16 a[16:31], v[248:251], a[188:191], a[16:31]
    s_add_u32 m0, s31, 16384
    s_add_u32 s35, s48, 135424
    buffer_load_dwordx4 v252, s[16:19], s35 offen nt lds
    v_mfma_f32_32x32x16_bf16 a[80:95], v[248:251], v[84:87], a[80:95]
    s_add_u32 m0, s31, 49152
    s_add_u32 s35, s48, 135552
    buffer_load_dwordx4 v252, s[16:19], s35 offen nt lds
    v_mfma_f32_32x32x16_bf16 a[144:159], v[248:251], v[92:95], a[144:159]
    ds_read_b64_tr_b16 v[248:249], v246 offset:30720
    ds_read_b64_tr_b16 v[250:251], v247 offset:31744
    s_add_u32 m0, s31, 16384
    s_add_u32 s35, s48, 167168
    buffer_load_dwordx4 v253, s[16:19], s35 offen offset:1024 nt lds
    s_waitcnt lgkmcnt(6)
    v_mfma_f32_32x32x16_bf16 a[32:47], a[248:251], a[184:187], a[32:47]
    s_add_u32 m0, s31, 49152
    s_add_u32 s35, s48, 167296
    buffer_load_dwordx4 v253, s[16:19], s35 offen offset:1024 nt lds
    v_mfma_f32_32x32x16_bf16 a[96:111], a[248:251], v[80:83], a[96:111]
    v_mfma_f32_32x32x16_bf16 v[0:15], a[248:251], v[88:91], v[0:15]
    ds_read_b64_tr_b16 a[248:249], v244 offset:32768
    ds_read_b64_tr_b16 a[250:251], v245 offset:33792
    s_waitcnt lgkmcnt(6)
    v_mfma_f32_32x32x16_bf16 a[32:47], a[252:255], a[188:191], a[32:47]
    v_mfma_f32_32x32x16_bf16 a[96:111], a[252:255], v[84:87], a[96:111]
    v_mfma_f32_32x32x16_bf16 v[0:15], a[252:255], v[92:95], v[0:15]
    ds_read_b64_tr_b16 a[252:253], v244 offset:34816
    ds_read_b64_tr_b16 a[254:255], v245 offset:35840
    s_waitcnt lgkmcnt(6)
    v_mfma_f32_32x32x16_bf16 a[48:63], v[232:235], a[184:187], a[48:63]
    v_mfma_f32_32x32x16_bf16 a[112:127], v[232:235], v[80:83], a[112:127]
    v_mfma_f32_32x32x16_bf16 v[16:31], v[232:235], v[88:91], v[16:31]
    ds_read_b64_tr_b16 v[232:233], v246 offset:32768
    ds_read_b64_tr_b16 v[234:235], v247 offset:33792
    s_waitcnt lgkmcnt(6)
    v_mfma_f32_32x32x16_bf16 a[48:63], v[248:251], a[188:191], a[48:63]
    v_mfma_f32_32x32x16_bf16 a[112:127], v[248:251], v[84:87], a[112:127]
    v_mfma_f32_32x32x16_bf16 v[16:31], v[248:251], v[92:95], v[16:31]
    ds_read_b64_tr_b16 v[248:249], v246 offset:34816
    ds_read_b64_tr_b16 v[250:251], v247 offset:35840
    s_waitcnt lgkmcnt(6)
    v_mfma_f32_32x32x16_bf16 a[0:15], a[248:251], a[192:195], a[0:15]
    v_accvgpr_read_b32 v254, a200
    v_pk_sub_u16 v254, v254, v241 clamp
    v_accvgpr_write_b32 a200, v254
    v_accvgpr_read_b32 v254, a201
    v_pk_sub_u16 v254, v254, v241 clamp
    v_accvgpr_write_b32 a201, v254
    v_mfma_f32_32x32x16_bf16 a[64:79], a[248:251], v[96:99], a[64:79]
    v_accvgpr_read_b32 v254, a202
    v_pk_sub_u16 v254, v254, v241 clamp
    v_accvgpr_write_b32 a202, v254
    v_accvgpr_read_b32 v254, a203
    v_pk_sub_u16 v254, v254, v241 clamp
    v_accvgpr_write_b32 a203, v254
    v_mfma_f32_32x32x16_bf16 a[128:143], a[248:251], v[104:107], a[128:143]
    ds_read_b64_tr_b16 a[248:249], v244 offset:40960
    ds_read_b64_tr_b16 a[250:251], v245 offset:41984
    v_accvgpr_read_b32 v254, a204
    v_pk_sub_u16 v254, v254, v241 clamp
    v_accvgpr_write_b32 a204, v254
    s_waitcnt lgkmcnt(6)
    v_mfma_f32_32x32x16_bf16 a[0:15], a[252:255], a[196:199], a[0:15]
    v_accvgpr_read_b32 v254, a205
    v_pk_sub_u16 v254, v254, v241 clamp
    v_accvgpr_write_b32 a205, v254
    v_accvgpr_read_b32 v254, a206
    v_pk_sub_u16 v254, v254, v241 clamp
    v_accvgpr_write_b32 a206, v254
    v_mfma_f32_32x32x16_bf16 a[64:79], a[252:255], v[100:103], a[64:79]
    v_accvgpr_read_b32 v254, a207
    v_pk_sub_u16 v254, v254, v241 clamp
    v_accvgpr_write_b32 a207, v254
    v_pk_sub_u16 v112, v112, v242 clamp
    v_pk_sub_u16 v113, v113, v242 clamp
    v_mfma_f32_32x32x16_bf16 a[128:143], a[252:255], v[108:111], a[128:143]
    ds_read_b64_tr_b16 a[252:253], v244 offset:43008
    ds_read_b64_tr_b16 a[254:255], v245 offset:44032
    v_pk_sub_u16 v114, v114, v242 clamp
    v_pk_sub_u16 v115, v115, v242 clamp
    v_pk_sub_u16 v116, v116, v242 clamp
    s_waitcnt lgkmcnt(6)
    v_mfma_f32_32x32x16_bf16 a[16:31], v[232:235], a[192:195], a[16:31]
    v_pk_sub_u16 v117, v117, v242 clamp
    v_pk_sub_u16 v118, v118, v242 clamp
    v_pk_sub_u16 v119, v119, v242 clamp
    v_pk_sub_u16 v120, v120, v243 clamp
    v_pk_sub_u16 v121, v121, v243 clamp
    v_mfma_f32_32x32x16_bf16 a[80:95], v[232:235], v[96:99], a[80:95]
    v_pk_sub_u16 v122, v122, v243 clamp
    v_pk_sub_u16 v123, v123, v243 clamp
    v_pk_sub_u16 v124, v124, v243 clamp
    v_pk_sub_u16 v125, v125, v243 clamp
    v_pk_sub_u16 v126, v126, v243 clamp
    v_mfma_f32_32x32x16_bf16 a[144:159], v[232:235], v[104:107], a[144:159]
    ds_read_b64_tr_b16 v[232:233], v246 offset:40960
    ds_read_b64_tr_b16 v[234:235], v247 offset:41984
    v_pk_sub_u16 v127, v127, v243 clamp
    s_waitcnt lgkmcnt(6)
    v_mfma_f32_32x32x16_bf16 a[16:31], v[248:251], a[196:199], a[16:31]
    v_mfma_f32_32x32x16_bf16 a[80:95], v[248:251], v[100:103], a[80:95]
    v_mfma_f32_32x32x16_bf16 a[144:159], v[248:251], v[108:111], a[144:159]
    ds_read_b64_tr_b16 v[248:249], v246 offset:43008
    ds_read_b64_tr_b16 v[250:251], v247 offset:44032
    s_waitcnt lgkmcnt(6)
    v_mfma_f32_32x32x16_bf16 a[32:47], a[248:251], a[192:195], a[32:47]
    v_mfma_f32_32x32x16_bf16 a[96:111], a[248:251], v[96:99], a[96:111]
    v_mfma_f32_32x32x16_bf16 v[0:15], a[248:251], v[104:107], v[0:15]
    ds_read_b64_tr_b16 a[248:249], v244 offset:36864
    ds_read_b64_tr_b16 a[250:251], v245 offset:37888
    s_waitcnt lgkmcnt(6)
    v_mfma_f32_32x32x16_bf16 a[32:47], a[252:255], a[196:199], a[32:47]
    v_mfma_f32_32x32x16_bf16 a[96:111], a[252:255], v[100:103], a[96:111]
    v_mfma_f32_32x32x16_bf16 v[0:15], a[252:255], v[108:111], v[0:15]
    ds_read_b64_tr_b16 a[252:253], v244 offset:38912
    ds_read_b64_tr_b16 a[254:255], v245 offset:39936
    s_waitcnt lgkmcnt(6)
    v_mfma_f32_32x32x16_bf16 a[48:63], v[232:235], a[192:195], a[48:63]
    v_mfma_f32_32x32x16_bf16 a[112:127], v[232:235], v[96:99], a[112:127]
    v_mfma_f32_32x32x16_bf16 v[16:31], v[232:235], v[104:107], v[16:31]
    s_waitcnt vmcnt(16)
    s_barrier
    ds_read_b64_tr_b16 v[232:233], v246 offset:36864
    ds_read_b64_tr_b16 v[234:235], v247 offset:37888
    s_add_u32 m0, s30, 16384
    s_add_u32 s35, s26, 94208
    buffer_load_dwordx4 v252, s[16:19], s35 offen nt lds
    s_waitcnt lgkmcnt(6)
    v_mfma_f32_32x32x16_bf16 a[48:63], v[248:251], a[196:199], a[48:63]
    s_add_u32 s35, s26, 125952
    buffer_load_dwordx4 v253, s[16:19], s35 offen offset:1024 nt lds
    v_mfma_f32_32x32x16_bf16 a[112:127], v[248:251], v[100:103], a[112:127]
    s_add_u32 s35, s26, 157696
    buffer_load_dwordx4 v252, s[16:19], s35 offen offset:2048 nt lds
    v_mfma_f32_32x32x16_bf16 v[16:31], v[248:251], v[108:111], v[16:31]
    ds_read_b64_tr_b16 v[248:249], v246 offset:38912
    ds_read_b64_tr_b16 v[250:251], v247 offset:39936
    s_add_u32 s35, s26, 189440
    buffer_load_dwordx4 v253, s[16:19], s35 offen offset:3072 nt lds
    s_waitcnt lgkmcnt(6)
    v_mfma_f32_32x32x16_bf16 a[0:15], a[248:251], a[200:203], a[0:15]
    v_accvgpr_read_b32 v254, a208
    v_pk_sub_u16 v254, v254, v241 clamp
    v_accvgpr_write_b32 a208, v254
    v_accvgpr_read_b32 v254, a209
    v_pk_sub_u16 v254, v254, v241 clamp
    v_accvgpr_write_b32 a209, v254
    v_mfma_f32_32x32x16_bf16 a[64:79], a[248:251], v[112:115], a[64:79]
    v_accvgpr_read_b32 v254, a210
    v_pk_sub_u16 v254, v254, v241 clamp
    v_accvgpr_write_b32 a210, v254
    v_accvgpr_read_b32 v254, a211
    v_pk_sub_u16 v254, v254, v241 clamp
    v_accvgpr_write_b32 a211, v254
    v_mfma_f32_32x32x16_bf16 a[128:143], a[248:251], v[120:123], a[128:143]
    ds_read_b64_tr_b16 a[248:249], v244 offset:45056
    ds_read_b64_tr_b16 a[250:251], v245 offset:46080
    v_accvgpr_read_b32 v254, a212
    v_pk_sub_u16 v254, v254, v241 clamp
    v_accvgpr_write_b32 a212, v254
    s_waitcnt lgkmcnt(6)
    v_mfma_f32_32x32x16_bf16 a[0:15], a[252:255], a[204:207], a[0:15]
    v_accvgpr_read_b32 v254, a213
    v_pk_sub_u16 v254, v254, v241 clamp
    v_accvgpr_write_b32 a213, v254
    v_accvgpr_read_b32 v254, a214
    v_pk_sub_u16 v254, v254, v241 clamp
    v_accvgpr_write_b32 a214, v254
    v_mfma_f32_32x32x16_bf16 a[64:79], a[252:255], v[116:119], a[64:79]
    v_accvgpr_read_b32 v254, a215
    v_pk_sub_u16 v254, v254, v241 clamp
    v_accvgpr_write_b32 a215, v254
    v_pk_sub_u16 v128, v128, v242 clamp
    v_pk_sub_u16 v129, v129, v242 clamp
    v_mfma_f32_32x32x16_bf16 a[128:143], a[252:255], v[124:127], a[128:143]
    ds_read_b64_tr_b16 a[252:253], v244 offset:47104
    ds_read_b64_tr_b16 a[254:255], v245 offset:48128
    v_pk_sub_u16 v130, v130, v242 clamp
    v_pk_sub_u16 v131, v131, v242 clamp
    v_pk_sub_u16 v132, v132, v242 clamp
    s_waitcnt lgkmcnt(6)
    v_mfma_f32_32x32x16_bf16 a[16:31], v[232:235], a[200:203], a[16:31]
    v_pk_sub_u16 v133, v133, v242 clamp
    v_pk_sub_u16 v134, v134, v242 clamp
    v_pk_sub_u16 v135, v135, v242 clamp
    v_pk_sub_u16 v136, v136, v243 clamp
    v_pk_sub_u16 v137, v137, v243 clamp
    v_mfma_f32_32x32x16_bf16 a[80:95], v[232:235], v[112:115], a[80:95]
    v_pk_sub_u16 v138, v138, v243 clamp
    v_pk_sub_u16 v139, v139, v243 clamp
    v_pk_sub_u16 v140, v140, v243 clamp
    v_pk_sub_u16 v141, v141, v243 clamp
    v_pk_sub_u16 v142, v142, v243 clamp
    v_mfma_f32_32x32x16_bf16 a[144:159], v[232:235], v[120:123], a[144:159]
    ds_read_b64_tr_b16 v[232:233], v246 offset:45056
    ds_read_b64_tr_b16 v[234:235], v247 offset:46080
    v_pk_sub_u16 v143, v143, v243 clamp
    s_waitcnt lgkmcnt(6)
    v_mfma_f32_32x32x16_bf16 a[16:31], v[248:251], a[204:207], a[16:31]
    s_add_u32 m0, s31, 16384
    s_add_u32 s35, s48, 18688
    buffer_load_dwordx4 v252, s[16:19], s35 offen offset:2048 nt lds
    v_mfma_f32_32x32x16_bf16 a[80:95], v[248:251], v[116:119], a[80:95]
    s_add_u32 m0, s31, 49152
    s_add_u32 s35, s48, 18816
    buffer_load_dwordx4 v252, s[16:19], s35 offen offset:2048 nt lds
    v_mfma_f32_32x32x16_bf16 a[144:159], v[248:251], v[124:127], a[144:159]
    ds_read_b64_tr_b16 v[248:249], v246 offset:47104
    ds_read_b64_tr_b16 v[250:251], v247 offset:48128
    s_add_u32 m0, s31, 16384
    s_add_u32 s35, s48, 50432
    buffer_load_dwordx4 v253, s[16:19], s35 offen offset:3072 nt lds
    s_waitcnt lgkmcnt(6)
    v_mfma_f32_32x32x16_bf16 a[32:47], a[248:251], a[200:203], a[32:47]
    s_add_u32 m0, s31, 49152
    s_add_u32 s35, s48, 50560
    buffer_load_dwordx4 v253, s[16:19], s35 offen offset:3072 nt lds
    v_mfma_f32_32x32x16_bf16 a[96:111], a[248:251], v[112:115], a[96:111]
    v_mfma_f32_32x32x16_bf16 v[0:15], a[248:251], v[120:123], v[0:15]
    ds_read_b64_tr_b16 a[248:249], v244 offset:49152
    ds_read_b64_tr_b16 a[250:251], v245 offset:50176
    s_waitcnt lgkmcnt(6)
    v_mfma_f32_32x32x16_bf16 a[32:47], a[252:255], a[204:207], a[32:47]
    v_mfma_f32_32x32x16_bf16 a[96:111], a[252:255], v[116:119], a[96:111]
    v_mfma_f32_32x32x16_bf16 v[0:15], a[252:255], v[124:127], v[0:15]
    ds_read_b64_tr_b16 a[252:253], v244 offset:51200
    ds_read_b64_tr_b16 a[254:255], v245 offset:52224
    s_waitcnt lgkmcnt(6)
    v_mfma_f32_32x32x16_bf16 a[48:63], v[232:235], a[200:203], a[48:63]
    v_mfma_f32_32x32x16_bf16 a[112:127], v[232:235], v[112:115], a[112:127]
    v_mfma_f32_32x32x16_bf16 v[16:31], v[232:235], v[120:123], v[16:31]
    ds_read_b64_tr_b16 v[232:233], v246 offset:49152
    ds_read_b64_tr_b16 v[234:235], v247 offset:50176
    s_waitcnt lgkmcnt(6)
    v_mfma_f32_32x32x16_bf16 a[48:63], v[248:251], a[204:207], a[48:63]
    v_mfma_f32_32x32x16_bf16 a[112:127], v[248:251], v[116:119], a[112:127]
    v_mfma_f32_32x32x16_bf16 v[16:31], v[248:251], v[124:127], v[16:31]
    ds_read_b64_tr_b16 v[248:249], v246 offset:51200
    ds_read_b64_tr_b16 v[250:251], v247 offset:52224
    s_waitcnt lgkmcnt(6)
    v_mfma_f32_32x32x16_bf16 a[0:15], a[248:251], a[208:211], a[0:15]
    v_accvgpr_read_b32 v254, a216
    v_pk_sub_u16 v254, v254, v241 clamp
    v_accvgpr_write_b32 a216, v254
    v_accvgpr_read_b32 v254, a217
    v_pk_sub_u16 v254, v254, v241 clamp
    v_accvgpr_write_b32 a217, v254
    v_mfma_f32_32x32x16_bf16 a[64:79], a[248:251], v[128:131], a[64:79]
    v_accvgpr_read_b32 v254, a218
    v_pk_sub_u16 v254, v254, v241 clamp
    v_accvgpr_write_b32 a218, v254
    v_accvgpr_read_b32 v254, a219
    v_pk_sub_u16 v254, v254, v241 clamp
    v_accvgpr_write_b32 a219, v254
    v_mfma_f32_32x32x16_bf16 a[128:143], a[248:251], v[136:139], a[128:143]
    ds_read_b64_tr_b16 a[248:249], v244 offset:57344
    ds_read_b64_tr_b16 a[250:251], v245 offset:58368
    v_accvgpr_read_b32 v254, a220
    v_pk_sub_u16 v254, v254, v241 clamp
    v_accvgpr_write_b32 a220, v254
    s_waitcnt lgkmcnt(6)
    v_mfma_f32_32x32x16_bf16 a[0:15], a[252:255], a[212:215], a[0:15]
    v_accvgpr_read_b32 v254, a221
    v_pk_sub_u16 v254, v254, v241 clamp
    v_accvgpr_write_b32 a221, v254
    v_accvgpr_read_b32 v254, a222
    v_pk_sub_u16 v254, v254, v241 clamp
    v_accvgpr_write_b32 a222, v254
    v_mfma_f32_32x32x16_bf16 a[64:79], a[252:255], v[132:135], a[64:79]
    v_accvgpr_read_b32 v254, a223
    v_pk_sub_u16 v254, v254, v241 clamp
    v_accvgpr_write_b32 a223, v254
    v_pk_sub_u16 v144, v144, v242 clamp
    v_pk_sub_u16 v145, v145, v242 clamp
    v_mfma_f32_32x32x16_bf16 a[128:143], a[252:255], v[140:143], a[128:143]
    ds_read_b64_tr_b16 a[252:253], v244 offset:59392
    ds_read_b64_tr_b16 a[254:255], v245 offset:60416
    v_pk_sub_u16 v146, v146, v242 clamp
    v_pk_sub_u16 v147, v147, v242 clamp
    v_pk_sub_u16 v148, v148, v242 clamp
    s_waitcnt lgkmcnt(6)
    v_mfma_f32_32x32x16_bf16 a[16:31], v[232:235], a[208:211], a[16:31]
    v_pk_sub_u16 v149, v149, v242 clamp
    v_pk_sub_u16 v150, v150, v242 clamp
    v_pk_sub_u16 v151, v151, v242 clamp
    v_pk_sub_u16 v152, v152, v243 clamp
    v_pk_sub_u16 v153, v153, v243 clamp
    v_mfma_f32_32x32x16_bf16 a[80:95], v[232:235], v[128:131], a[80:95]
    v_pk_sub_u16 v154, v154, v243 clamp
    v_pk_sub_u16 v155, v155, v243 clamp
    v_pk_sub_u16 v156, v156, v243 clamp
    v_pk_sub_u16 v157, v157, v243 clamp
    v_pk_sub_u16 v158, v158, v243 clamp
    v_mfma_f32_32x32x16_bf16 a[144:159], v[232:235], v[136:139], a[144:159]
    ds_read_b64_tr_b16 v[232:233], v246 offset:57344
    ds_read_b64_tr_b16 v[234:235], v247 offset:58368
    v_pk_sub_u16 v159, v159, v243 clamp
    s_waitcnt lgkmcnt(6)
    v_mfma_f32_32x32x16_bf16 a[16:31], v[248:251], a[212:215], a[16:31]
    v_mfma_f32_32x32x16_bf16 a[80:95], v[248:251], v[132:135], a[80:95]
    v_mfma_f32_32x32x16_bf16 a[144:159], v[248:251], v[140:143], a[144:159]
    ds_read_b64_tr_b16 v[248:249], v246 offset:59392
    ds_read_b64_tr_b16 v[250:251], v247 offset:60416
    s_waitcnt lgkmcnt(6)
    v_mfma_f32_32x32x16_bf16 a[32:47], a[248:251], a[208:211], a[32:47]
    v_mfma_f32_32x32x16_bf16 a[96:111], a[248:251], v[128:131], a[96:111]
    v_mfma_f32_32x32x16_bf16 v[0:15], a[248:251], v[136:139], v[0:15]
    ds_read_b64_tr_b16 a[248:249], v244 offset:53248
    ds_read_b64_tr_b16 a[250:251], v245 offset:54272
    s_waitcnt lgkmcnt(6)
    v_mfma_f32_32x32x16_bf16 a[32:47], a[252:255], a[212:215], a[32:47]
    v_mfma_f32_32x32x16_bf16 a[96:111], a[252:255], v[132:135], a[96:111]
    v_mfma_f32_32x32x16_bf16 v[0:15], a[252:255], v[140:143], v[0:15]
    ds_read_b64_tr_b16 a[252:253], v244 offset:55296
    ds_read_b64_tr_b16 a[254:255], v245 offset:56320
    s_waitcnt lgkmcnt(6)
    v_mfma_f32_32x32x16_bf16 a[48:63], v[232:235], a[208:211], a[48:63]
    v_mfma_f32_32x32x16_bf16 a[112:127], v[232:235], v[128:131], a[112:127]
    v_mfma_f32_32x32x16_bf16 v[16:31], v[232:235], v[136:139], v[16:31]
    s_waitcnt vmcnt(12)
    s_barrier
    ds_read_b64_tr_b16 v[232:233], v246 offset:53248
    ds_read_b64_tr_b16 v[234:235], v247 offset:54272
    s_waitcnt lgkmcnt(6)
    v_mfma_f32_32x32x16_bf16 a[48:63], v[248:251], a[212:215], a[48:63]
    v_mfma_f32_32x32x16_bf16 a[112:127], v[248:251], v[132:135], a[112:127]
    v_mfma_f32_32x32x16_bf16 v[16:31], v[248:251], v[140:143], v[16:31]
    ds_read_b64_tr_b16 v[248:249], v246 offset:55296
    ds_read_b64_tr_b16 v[250:251], v247 offset:56320
    s_waitcnt lgkmcnt(6)
    v_mfma_f32_32x32x16_bf16 a[0:15], a[248:251], a[216:219], a[0:15]
    v_accvgpr_read_b32 v254, a224
    v_pk_sub_u16 v254, v254, v241 clamp
    v_accvgpr_write_b32 a224, v254
    v_accvgpr_read_b32 v254, a225
    v_pk_sub_u16 v254, v254, v241 clamp
    v_accvgpr_write_b32 a225, v254
    v_mfma_f32_32x32x16_bf16 a[64:79], a[248:251], v[144:147], a[64:79]
    s_add_u32 m0, s31, 32768
    s_add_u32 s35, s48, 86272
    buffer_load_dwordx4 v252, s[16:19], s35 offen nt lds
    v_accvgpr_read_b32 v254, a226
    v_pk_sub_u16 v254, v254, v241 clamp
    v_accvgpr_write_b32 a226, v254
    v_mfma_f32_32x32x16_bf16 a[128:143], a[248:251], v[152:155], a[128:143]
    ds_read_b64_tr_b16 a[248:249], v244 offset:61440
    ds_read_b64_tr_b16 a[250:251], v245 offset:62464
    s_add_u32 m0, s31, 65536
    s_add_u32 s35, s48, 86400
    buffer_load_dwordx4 v252, s[16:19], s35 offen nt lds
    s_waitcnt lgkmcnt(6)
    v_mfma_f32_32x32x16_bf16 a[0:15], a[252:255], a[220:223], a[0:15]
    s_add_u32 m0, s31, 32768
    s_add_u32 s35, s48, 118016
    buffer_load_dwordx4 v253, s[16:19], s35 offen offset:1024 nt lds
    v_accvgpr_read_b32 v254, a227
    v_pk_sub_u16 v254, v254, v241 clamp
    v_accvgpr_write_b32 a227, v254
    v_mfma_f32_32x32x16_bf16 a[64:79], a[252:255], v[148:151], a[64:79]
    s_add_u32 m0, s31, 65536
    s_add_u32 s35, s48, 118144
    buffer_load_dwordx4 v253, s[16:19], s35 offen offset:1024 nt lds
    v_accvgpr_read_b32 v254, a228
    v_pk_sub_u16 v254, v254, v241 clamp
    v_accvgpr_write_b32 a228, v254
    v_mfma_f32_32x32x16_bf16 a[128:143], a[252:255], v[156:159], a[128:143]
    ds_read_b64_tr_b16 a[252:253], v244 offset:63488
    ds_read_b64_tr_b16 a[254:255], v245 offset:64512
    v_accvgpr_read_b32 v254, a229
    v_pk_sub_u16 v254, v254, v241 clamp
    v_accvgpr_write_b32 a229, v254
    s_waitcnt lgkmcnt(6)
    v_mfma_f32_32x32x16_bf16 a[16:31], v[232:235], a[216:219], a[16:31]
    v_accvgpr_read_b32 v254, a230
    v_pk_sub_u16 v254, v254, v241 clamp
    v_accvgpr_write_b32 a230, v254
    v_accvgpr_read_b32 v254, a231
    v_pk_sub_u16 v254, v254, v241 clamp
    v_accvgpr_write_b32 a231, v254
    v_mfma_f32_32x32x16_bf16 a[80:95], v[232:235], v[144:147], a[80:95]
    v_pk_sub_u16 v160, v160, v242 clamp
    v_pk_sub_u16 v161, v161, v242 clamp
    v_pk_sub_u16 v162, v162, v242 clamp
    v_pk_sub_u16 v163, v163, v242 clamp
    v_pk_sub_u16 v164, v164, v242 clamp
    v_mfma_f32_32x32x16_bf16 a[144:159], v[232:235], v[152:155], a[144:159]
    ds_read_b64_tr_b16 v[232:233], v246 offset:61440
    ds_read_b64_tr_b16 v[234:235], v247 offset:62464
    v_pk_sub_u16 v165, v165, v242 clamp
    v_pk_sub_u16 v166, v166, v242 clamp
    v_pk_sub_u16 v167, v167, v242 clamp
    s_waitcnt lgkmcnt(6)
    v_mfma_f32_32x32x16_bf16 a[16:31], v[248:251], a[220:223], a[16:31]
    v_pk_sub_u16 v168, v168, v243 clamp
    v_pk_sub_u16 v169, v169, v243 clamp
    v_pk_sub_u16 v170, v170, v243 clamp
    v_pk_sub_u16 v171, v171, v243 clamp
    v_pk_sub_u16 v172, v172, v243 clamp
    v_mfma_f32_32x32x16_bf16 a[80:95], v[248:251], v[148:151], a[80:95]
    v_pk_sub_u16 v173, v173, v243 clamp
    v_pk_sub_u16 v174, v174, v243 clamp
    v_pk_sub_u16 v175, v175, v243 clamp
    v_mfma_f32_32x32x16_bf16 a[144:159], v[248:251], v[156:159], a[144:159]
    ds_read_b64_tr_b16 v[248:249], v246 offset:63488
    ds_read_b64_tr_b16 v[250:251], v247 offset:64512
    s_waitcnt lgkmcnt(6)
    v_mfma_f32_32x32x16_bf16 a[32:47], a[248:251], a[216:219], a[32:47]
    v_mfma_f32_32x32x16_bf16 a[96:111], a[248:251], v[144:147], a[96:111]
    v_mfma_f32_32x32x16_bf16 v[0:15], a[248:251], v[152:155], v[0:15]
    ds_read_b64_tr_b16 a[248:249], v244
    ds_read_b64_tr_b16 a[250:251], v245 offset:1024
    s_waitcnt lgkmcnt(6)
    v_mfma_f32_32x32x16_bf16 a[32:47], a[252:255], a[220:223], a[32:47]
    v_mfma_f32_32x32x16_bf16 a[96:111], a[252:255], v[148:151], a[96:111]
    v_mfma_f32_32x32x16_bf16 v[0:15], a[252:255], v[156:159], v[0:15]
    ds_read_b64_tr_b16 a[252:253], v244 offset:2048
    ds_read_b64_tr_b16 a[254:255], v245 offset:3072
    s_waitcnt lgkmcnt(6)
    v_mfma_f32_32x32x16_bf16 a[48:63], v[232:235], a[216:219], a[48:63]
    v_mfma_f32_32x32x16_bf16 a[112:127], v[232:235], v[144:147], a[112:127]
    v_mfma_f32_32x32x16_bf16 v[16:31], v[232:235], v[152:155], v[16:31]
    ds_read_b64_tr_b16 v[232:233], v246
    ds_read_b64_tr_b16 v[234:235], v247 offset:1024
    s_waitcnt lgkmcnt(6)
    v_mfma_f32_32x32x16_bf16 a[48:63], v[248:251], a[220:223], a[48:63]
    v_mfma_f32_32x32x16_bf16 a[112:127], v[248:251], v[148:151], a[112:127]
    v_mfma_f32_32x32x16_bf16 v[16:31], v[248:251], v[156:159], v[16:31]
    ds_read_b64_tr_b16 v[248:249], v246 offset:2048
    ds_read_b64_tr_b16 v[250:251], v247 offset:3072
    s_waitcnt lgkmcnt(6)
    v_mfma_f32_32x32x16_bf16 a[0:15], a[248:251], a[224:227], a[0:15]
    v_accvgpr_read_b32 v254, a232
    v_pk_sub_u16 v254, v254, v241 clamp
    v_accvgpr_write_b32 a232, v254
    v_accvgpr_read_b32 v254, a233
    v_pk_sub_u16 v254, v254, v241 clamp
    v_accvgpr_write_b32 a233, v254
    v_mfma_f32_32x32x16_bf16 a[64:79], a[248:251], v[160:163], a[64:79]
    v_accvgpr_read_b32 v254, a234
    v_pk_sub_u16 v254, v254, v241 clamp
    v_accvgpr_write_b32 a234, v254
    v_accvgpr_read_b32 v254, a235
    v_pk_sub_u16 v254, v254, v241 clamp
    v_accvgpr_write_b32 a235, v254
    v_mfma_f32_32x32x16_bf16 a[128:143], a[248:251], v[168:171], a[128:143]
    ds_read_b64_tr_b16 a[248:249], v244 offset:8192
    ds_read_b64_tr_b16 a[250:251], v245 offset:9216
    v_accvgpr_read_b32 v254, a236
    v_pk_sub_u16 v254, v254, v241 clamp
    v_accvgpr_write_b32 a236, v254
    s_waitcnt lgkmcnt(6)
    v_mfma_f32_32x32x16_bf16 a[0:15], a[252:255], a[228:231], a[0:15]
    v_accvgpr_read_b32 v254, a237
    v_pk_sub_u16 v254, v254, v241 clamp
    v_accvgpr_write_b32 a237, v254
    v_accvgpr_read_b32 v254, a238
    v_pk_sub_u16 v254, v254, v241 clamp
    v_accvgpr_write_b32 a238, v254
    v_mfma_f32_32x32x16_bf16 a[64:79], a[252:255], v[164:167], a[64:79]
    v_accvgpr_read_b32 v254, a239
    v_pk_sub_u16 v254, v254, v241 clamp
    v_accvgpr_write_b32 a239, v254
    v_pk_sub_u16 v176, v176, v242 clamp
    v_pk_sub_u16 v177, v177, v242 clamp
    v_mfma_f32_32x32x16_bf16 a[128:143], a[252:255], v[172:175], a[128:143]
    ds_read_b64_tr_b16 a[252:253], v244 offset:10240
    ds_read_b64_tr_b16 a[254:255], v245 offset:11264
    v_pk_sub_u16 v178, v178, v242 clamp
    v_pk_sub_u16 v179, v179, v242 clamp
    v_pk_sub_u16 v180, v180, v242 clamp
    s_waitcnt lgkmcnt(6)
    v_mfma_f32_32x32x16_bf16 a[16:31], v[232:235], a[224:227], a[16:31]
    v_pk_sub_u16 v181, v181, v242 clamp
    v_pk_sub_u16 v182, v182, v242 clamp
    v_pk_sub_u16 v183, v183, v242 clamp
    v_pk_sub_u16 v184, v184, v243 clamp
    v_pk_sub_u16 v185, v185, v243 clamp
    v_mfma_f32_32x32x16_bf16 a[80:95], v[232:235], v[160:163], a[80:95]
    v_pk_sub_u16 v186, v186, v243 clamp
    v_pk_sub_u16 v187, v187, v243 clamp
    v_pk_sub_u16 v188, v188, v243 clamp
    v_pk_sub_u16 v189, v189, v243 clamp
    v_pk_sub_u16 v190, v190, v243 clamp
    v_mfma_f32_32x32x16_bf16 a[144:159], v[232:235], v[168:171], a[144:159]
    ds_read_b64_tr_b16 v[232:233], v246 offset:8192
    ds_read_b64_tr_b16 v[234:235], v247 offset:9216
    v_pk_sub_u16 v191, v191, v243 clamp
    s_waitcnt lgkmcnt(6)
    v_mfma_f32_32x32x16_bf16 a[16:31], v[248:251], a[228:231], a[16:31]
    v_mfma_f32_32x32x16_bf16 a[80:95], v[248:251], v[164:167], a[80:95]
    v_mfma_f32_32x32x16_bf16 a[144:159], v[248:251], v[172:175], a[144:159]
    ds_read_b64_tr_b16 v[248:249], v246 offset:10240
    ds_read_b64_tr_b16 v[250:251], v247 offset:11264
    s_waitcnt lgkmcnt(6)
    v_mfma_f32_32x32x16_bf16 a[32:47], a[248:251], a[224:227], a[32:47]
    v_mfma_f32_32x32x16_bf16 a[96:111], a[248:251], v[160:163], a[96:111]
    v_mfma_f32_32x32x16_bf16 v[0:15], a[248:251], v[168:171], v[0:15]
    ds_read_b64_tr_b16 a[248:249], v244 offset:4096
    ds_read_b64_tr_b16 a[250:251], v245 offset:5120
    s_waitcnt lgkmcnt(6)
    v_mfma_f32_32x32x16_bf16 a[32:47], a[252:255], a[228:231], a[32:47]
    v_mfma_f32_32x32x16_bf16 a[96:111], a[252:255], v[164:167], a[96:111]
    v_mfma_f32_32x32x16_bf16 v[0:15], a[252:255], v[172:175], v[0:15]
    ds_read_b64_tr_b16 a[252:253], v244 offset:6144
    ds_read_b64_tr_b16 a[254:255], v245 offset:7168
    s_add_u32 m0, s31, 32768
    s_add_u32 s35, s48, 149760
    buffer_load_dwordx4 v252, s[16:19], s35 offen offset:2048 nt lds
    s_waitcnt lgkmcnt(6)
    v_mfma_f32_32x32x16_bf16 a[48:63], v[232:235], a[224:227], a[48:63]
    s_add_u32 m0, s31, 65536
    s_add_u32 s35, s48, 149888
    buffer_load_dwordx4 v252, s[16:19], s35 offen offset:2048 nt lds
    v_mfma_f32_32x32x16_bf16 a[112:127], v[232:235], v[160:163], a[112:127]
    s_add_u32 m0, s31, 32768
    s_add_u32 s35, s48, 181504
    buffer_load_dwordx4 v253, s[16:19], s35 offen offset:3072 nt lds
    v_mfma_f32_32x32x16_bf16 v[16:31], v[232:235], v[168:171], v[16:31]
    s_waitcnt vmcnt(11)
    s_barrier
    ds_read_b64_tr_b16 v[232:233], v246 offset:4096
    ds_read_b64_tr_b16 v[234:235], v247 offset:5120
    s_add_u32 m0, s31, 65536
    s_add_u32 s35, s48, 181632
    buffer_load_dwordx4 v253, s[16:19], s35 offen offset:3072 nt lds
    s_waitcnt lgkmcnt(6)
    v_mfma_f32_32x32x16_bf16 a[48:63], v[248:251], a[228:231], a[48:63]
    v_mfma_f32_32x32x16_bf16 a[112:127], v[248:251], v[164:167], a[112:127]
    v_mfma_f32_32x32x16_bf16 v[16:31], v[248:251], v[172:175], v[16:31]
    ds_read_b64_tr_b16 v[248:249], v246 offset:6144
    ds_read_b64_tr_b16 v[250:251], v247 offset:7168
    s_waitcnt lgkmcnt(6)
    v_mfma_f32_32x32x16_bf16 a[0:15], a[248:251], a[232:235], a[0:15]
    v_accvgpr_read_b32 v254, a240
    v_pk_sub_u16 v254, v254, v241 clamp
    v_accvgpr_write_b32 a240, v254
    v_accvgpr_read_b32 v254, a241
    v_pk_sub_u16 v254, v254, v241 clamp
    v_accvgpr_write_b32 a241, v254
    v_mfma_f32_32x32x16_bf16 a[64:79], a[248:251], v[176:179], a[64:79]
    v_accvgpr_read_b32 v254, a242
    v_pk_sub_u16 v254, v254, v241 clamp
    v_accvgpr_write_b32 a242, v254
    v_accvgpr_read_b32 v254, a243
    v_pk_sub_u16 v254, v254, v241 clamp
    v_accvgpr_write_b32 a243, v254
    v_mfma_f32_32x32x16_bf16 a[128:143], a[248:251], v[184:187], a[128:143]
    ds_read_b64_tr_b16 a[248:249], v244 offset:12288
    ds_read_b64_tr_b16 a[250:251], v245 offset:13312
    v_accvgpr_read_b32 v254, a244
    v_pk_sub_u16 v254, v254, v241 clamp
    v_accvgpr_write_b32 a244, v254
    s_waitcnt lgkmcnt(6)
    v_mfma_f32_32x32x16_bf16 a[0:15], a[252:255], a[236:239], a[0:15]
    v_accvgpr_read_b32 v254, a245
    v_pk_sub_u16 v254, v254, v241 clamp
    v_accvgpr_write_b32 a245, v254
    v_accvgpr_read_b32 v254, a246
    v_pk_sub_u16 v254, v254, v241 clamp
    v_accvgpr_write_b32 a246, v254
    v_mfma_f32_32x32x16_bf16 a[64:79], a[252:255], v[180:183], a[64:79]
    v_accvgpr_read_b32 v254, a247
    v_pk_sub_u16 v254, v254, v241 clamp
    v_accvgpr_write_b32 a247, v254
    v_pk_sub_u16 v192, v192, v242 clamp
    v_pk_sub_u16 v193, v193, v242 clamp
    v_mfma_f32_32x32x16_bf16 a[128:143], a[252:255], v[188:191], a[128:143]
    ds_read_b64_tr_b16 a[252:253], v244 offset:14336
    ds_read_b64_tr_b16 a[254:255], v245 offset:15360
    v_pk_sub_u16 v194, v194, v242 clamp
    v_pk_sub_u16 v195, v195, v242 clamp
    v_pk_sub_u16 v196, v196, v242 clamp
    s_waitcnt lgkmcnt(6)
    v_mfma_f32_32x32x16_bf16 a[16:31], v[232:235], a[232:235], a[16:31]
    v_pk_sub_u16 v197, v197, v242 clamp
    v_pk_sub_u16 v198, v198, v242 clamp
    v_pk_sub_u16 v199, v199, v242 clamp
    v_pk_sub_u16 v200, v200, v243 clamp
    v_pk_sub_u16 v201, v201, v243 clamp
    v_mfma_f32_32x32x16_bf16 a[80:95], v[232:235], v[176:179], a[80:95]
    v_pk_sub_u16 v202, v202, v243 clamp
    v_pk_sub_u16 v203, v203, v243 clamp
    v_pk_sub_u16 v204, v204, v243 clamp
    v_pk_sub_u16 v205, v205, v243 clamp
    v_pk_sub_u16 v206, v206, v243 clamp
    v_mfma_f32_32x32x16_bf16 a[144:159], v[232:235], v[184:187], a[144:159]
    ds_read_b64_tr_b16 v[232:233], v246 offset:12288
    ds_read_b64_tr_b16 v[234:235], v247 offset:13312
    v_pk_sub_u16 v207, v207, v243 clamp
    s_waitcnt lgkmcnt(6)
    v_mfma_f32_32x32x16_bf16 a[16:31], v[248:251], a[236:239], a[16:31]
    v_mfma_f32_32x32x16_bf16 a[80:95], v[248:251], v[180:183], a[80:95]
    v_mfma_f32_32x32x16_bf16 a[144:159], v[248:251], v[188:191], a[144:159]
    ds_read_b64_tr_b16 v[248:249], v246 offset:14336
    ds_read_b64_tr_b16 v[250:251], v247 offset:15360
    s_waitcnt lgkmcnt(6)
    v_mfma_f32_32x32x16_bf16 a[32:47], a[248:251], a[232:235], a[32:47]
    v_mfma_f32_32x32x16_bf16 a[96:111], a[248:251], v[176:179], a[96:111]
    v_mfma_f32_32x32x16_bf16 v[0:15], a[248:251], v[184:187], v[0:15]
    ds_read_b64_tr_b16 a[248:249], v244 offset:16384
    ds_read_b64_tr_b16 a[250:251], v245 offset:17408
    s_waitcnt lgkmcnt(6)
    v_mfma_f32_32x32x16_bf16 a[32:47], a[252:255], a[236:239], a[32:47]
    v_mfma_f32_32x32x16_bf16 a[96:111], a[252:255], v[180:183], a[96:111]
    v_mfma_f32_32x32x16_bf16 v[0:15], a[252:255], v[188:191], v[0:15]
    ds_read_b64_tr_b16 a[252:253], v244 offset:18432
    ds_read_b64_tr_b16 a[254:255], v245 offset:19456
    s_waitcnt lgkmcnt(6)
    v_mfma_f32_32x32x16_bf16 a[48:63], v[232:235], a[232:235], a[48:63]
    v_mfma_f32_32x32x16_bf16 a[112:127], v[232:235], v[176:179], a[112:127]
    v_mfma_f32_32x32x16_bf16 v[16:31], v[232:235], v[184:187], v[16:31]
    ds_read_b64_tr_b16 v[232:233], v246 offset:16384
    ds_read_b64_tr_b16 v[234:235], v247 offset:17408
    s_waitcnt lgkmcnt(6)
    v_mfma_f32_32x32x16_bf16 a[48:63], v[248:251], a[236:239], a[48:63]
    v_mfma_f32_32x32x16_bf16 a[112:127], v[248:251], v[180:183], a[112:127]
    v_mfma_f32_32x32x16_bf16 v[16:31], v[248:251], v[188:191], v[16:31]
    ds_read_b64_tr_b16 v[248:249], v246 offset:18432
    ds_read_b64_tr_b16 v[250:251], v247 offset:19456
    s_waitcnt lgkmcnt(6)
    v_mfma_f32_32x32x16_bf16 a[0:15], a[248:251], a[240:243], a[0:15]
    v_pk_sub_u16 v208, v208, v241 clamp
    v_pk_sub_u16 v209, v209, v241 clamp
    v_pk_sub_u16 v210, v210, v241 clamp
    v_pk_sub_u16 v211, v211, v241 clamp
    v_pk_sub_u16 v212, v212, v241 clamp
    v_mfma_f32_32x32x16_bf16 a[64:79], a[248:251], v[192:195], a[64:79]
    v_pk_sub_u16 v213, v213, v241 clamp
    v_pk_sub_u16 v214, v214, v241 clamp
    v_pk_sub_u16 v215, v215, v241 clamp
    v_pk_sub_u16 v216, v216, v242 clamp
    v_pk_sub_u16 v217, v217, v242 clamp
    v_mfma_f32_32x32x16_bf16 a[128:143], a[248:251], v[200:203], a[128:143]
    ds_read_b64_tr_b16 a[248:249], v244 offset:24576
    ds_read_b64_tr_b16 a[250:251], v245 offset:25600
    v_pk_sub_u16 v218, v218, v242 clamp
    v_pk_sub_u16 v219, v219, v242 clamp
    v_pk_sub_u16 v220, v220, v242 clamp
    s_waitcnt lgkmcnt(6)
    v_mfma_f32_32x32x16_bf16 a[0:15], a[252:255], a[244:247], a[0:15]
    v_pk_sub_u16 v221, v221, v242 clamp
    v_pk_sub_u16 v222, v222, v242 clamp
    v_pk_sub_u16 v223, v223, v242 clamp
    v_pk_sub_u16 v224, v224, v243 clamp
    v_pk_sub_u16 v225, v225, v243 clamp
    v_mfma_f32_32x32x16_bf16 a[64:79], a[252:255], v[196:199], a[64:79]
    v_pk_sub_u16 v226, v226, v243 clamp
    v_pk_sub_u16 v227, v227, v243 clamp
    v_pk_sub_u16 v228, v228, v243 clamp
    v_pk_sub_u16 v229, v229, v243 clamp
    v_pk_sub_u16 v230, v230, v243 clamp
    v_mfma_f32_32x32x16_bf16 a[128:143], a[252:255], v[204:207], a[128:143]
    ds_read_b64_tr_b16 a[252:253], v244 offset:26624
    ds_read_b64_tr_b16 a[254:255], v245 offset:27648
    v_pk_sub_u16 v231, v231, v243 clamp
    s_waitcnt lgkmcnt(6)
    v_mfma_f32_32x32x16_bf16 a[16:31], v[232:235], a[240:243], a[16:31]
    v_mfma_f32_32x32x16_bf16 a[80:95], v[232:235], v[192:195], a[80:95]
    v_mfma_f32_32x32x16_bf16 a[144:159], v[232:235], v[200:203], a[144:159]
    ds_read_b64_tr_b16 v[232:233], v246 offset:24576
    ds_read_b64_tr_b16 v[234:235], v247 offset:25600
    s_waitcnt lgkmcnt(6)
    v_mfma_f32_32x32x16_bf16 a[16:31], v[248:251], a[244:247], a[16:31]
    v_mfma_f32_32x32x16_bf16 a[80:95], v[248:251], v[196:199], a[80:95]
    v_mfma_f32_32x32x16_bf16 a[144:159], v[248:251], v[204:207], a[144:159]
    ds_read_b64_tr_b16 v[248:249], v246 offset:26624
    ds_read_b64_tr_b16 v[250:251], v247 offset:27648
    s_waitcnt lgkmcnt(6)
    v_mfma_f32_32x32x16_bf16 a[32:47], a[248:251], a[240:243], a[32:47]
    v_mfma_f32_32x32x16_bf16 a[96:111], a[248:251], v[192:195], a[96:111]
    v_mfma_f32_32x32x16_bf16 v[0:15], a[248:251], v[200:203], v[0:15]
    ds_read_b64_tr_b16 a[248:249], v244 offset:20480
    ds_read_b64_tr_b16 a[250:251], v245 offset:21504
    s_waitcnt lgkmcnt(6)
    v_mfma_f32_32x32x16_bf16 a[32:47], a[252:255], a[244:247], a[32:47]
    v_mfma_f32_32x32x16_bf16 a[96:111], a[252:255], v[196:199], a[96:111]
    v_mfma_f32_32x32x16_bf16 v[0:15], a[252:255], v[204:207], v[0:15]
    ds_read_b64_tr_b16 a[252:253], v244 offset:22528
    ds_read_b64_tr_b16 a[254:255], v245 offset:23552
    s_waitcnt lgkmcnt(6)
    v_mfma_f32_32x32x16_bf16 a[48:63], v[232:235], a[240:243], a[48:63]
    v_mfma_f32_32x32x16_bf16 a[112:127], v[232:235], v[192:195], a[112:127]
    v_mfma_f32_32x32x16_bf16 v[16:31], v[232:235], v[200:203], v[16:31]
    s_waitcnt vmcnt(9)
    s_waitcnt vmcnt(8)
    s_barrier
    ds_read_b64_tr_b16 v[232:233], v246 offset:20480
    ds_read_b64_tr_b16 v[234:235], v247 offset:21504
    s_waitcnt lgkmcnt(6)
    v_mfma_f32_32x32x16_bf16 a[48:63], v[248:251], a[244:247], a[48:63]
    v_mfma_f32_32x32x16_bf16 a[112:127], v[248:251], v[196:199], a[112:127]
    v_mfma_f32_32x32x16_bf16 v[16:31], v[248:251], v[204:207], v[16:31]
    ds_read_b64_tr_b16 v[248:249], v246 offset:22528
    ds_read_b64_tr_b16 v[250:251], v247 offset:23552
    s_waitcnt lgkmcnt(6)
    v_mfma_f32_32x32x16_bf16 a[0:15], a[248:251], v[208:211], a[0:15]
    v_mfma_f32_32x32x16_bf16 a[64:79], a[248:251], v[216:219], a[64:79]
    v_mfma_f32_32x32x16_bf16 a[128:143], a[248:251], v[224:227], a[128:143]
    ds_read_b64_tr_b16 a[248:249], v244 offset:28672
    ds_read_b64_tr_b16 a[250:251], v245 offset:29696
    s_waitcnt lgkmcnt(6)
    v_mfma_f32_32x32x16_bf16 a[0:15], a[252:255], v[212:215], a[0:15]
    v_mfma_f32_32x32x16_bf16 a[64:79], a[252:255], v[220:223], a[64:79]
    v_mfma_f32_32x32x16_bf16 a[128:143], a[252:255], v[228:231], a[128:143]
    ds_read_b64_tr_b16 a[252:253], v244 offset:30720
    ds_read_b64_tr_b16 a[254:255], v245 offset:31744
    s_waitcnt lgkmcnt(6)
    v_mfma_f32_32x32x16_bf16 a[16:31], v[232:235], v[208:211], a[16:31]
    v_mfma_f32_32x32x16_bf16 a[80:95], v[232:235], v[216:219], a[80:95]
    v_mfma_f32_32x32x16_bf16 a[144:159], v[232:235], v[224:227], a[144:159]
    ds_read_b64_tr_b16 v[232:233], v246 offset:28672
    ds_read_b64_tr_b16 v[234:235], v247 offset:29696
    s_waitcnt lgkmcnt(6)
    v_mfma_f32_32x32x16_bf16 a[16:31], v[248:251], v[212:215], a[16:31]
    v_mfma_f32_32x32x16_bf16 a[80:95], v[248:251], v[220:223], a[80:95]
    v_mfma_f32_32x32x16_bf16 a[144:159], v[248:251], v[228:231], a[144:159]
    ds_read_b64_tr_b16 v[248:249], v246 offset:30720
    ds_read_b64_tr_b16 v[250:251], v247 offset:31744
    s_waitcnt lgkmcnt(6)
    v_mfma_f32_32x32x16_bf16 a[32:47], a[248:251], v[208:211], a[32:47]
    v_mfma_f32_32x32x16_bf16 a[96:111], a[248:251], v[216:219], a[96:111]
    v_mfma_f32_32x32x16_bf16 v[0:15], a[248:251], v[224:227], v[0:15]
    s_waitcnt lgkmcnt(4)
    v_mfma_f32_32x32x16_bf16 a[32:47], a[252:255], v[212:215], a[32:47]
    v_mfma_f32_32x32x16_bf16 a[96:111], a[252:255], v[220:223], a[96:111]
    v_mfma_f32_32x32x16_bf16 v[0:15], a[252:255], v[228:231], v[0:15]
    s_waitcnt lgkmcnt(2)
    v_mfma_f32_32x32x16_bf16 a[48:63], v[232:235], v[208:211], a[48:63]
    v_mfma_f32_32x32x16_bf16 a[112:127], v[232:235], v[216:219], a[112:127]
    v_mfma_f32_32x32x16_bf16 v[16:31], v[232:235], v[224:227], v[16:31]
    s_waitcnt lgkmcnt(0)
    v_mfma_f32_32x32x16_bf16 a[48:63], v[248:251], v[212:215], a[48:63]
    v_mfma_f32_32x32x16_bf16 a[112:127], v[248:251], v[220:223], a[112:127]
    v_mfma_f32_32x32x16_bf16 v[16:31], v[248:251], v[228:231], v[16:31]
    v_add_u32 v244, 65536, v244
    v_add_u32 v245, 65536, v245
    v_add_u32 v246, 65536, v246
    v_add_u32 v247, 65536, v247
    ds_read_b64_tr_b16 a[248:249], v244
    ds_read_b64_tr_b16 a[250:251], v245 offset:1024
    ds_read_b64_tr_b16 a[252:253], v244 offset:2048
    ds_read_b64_tr_b16 a[254:255], v245 offset:3072
    v_mbcnt_lo_u32_b32 v248, -1, 0
    v_mbcnt_hi_u32_b32 v248, -1, v248
    v_bfe_u32 v250, v248, 2, 2
    v_bfe_u32 v249, v248, 1, 1
    v_lshl_add_u32 v250, v249, 2, v250
    v_lshlrev_b32 v250, 4, v250
    v_and_b32 v249, 31, v248
    v_lshl_add_u32 v250, v249, 7, v250
    v_lshl_add_u32 v251, v248, 4, s30
    v_lshrrev_b32 v248, 5, v248
    v_lshl_add_u32 v250, v248, 3, v250
    v_add_u32 v250, s30, v250
    v_subrev_u32 v243, s30, v251
    v_lshlrev_b32 v243, 2, v243
    v_accvgpr_read_b32 v232, a0
    v_accvgpr_read_b32 v233, a1
    v_accvgpr_read_b32 v234, a2
    v_accvgpr_read_b32 v235, a3
    v_mul_f32 v232, v238, v232
    v_mul_f32 v233, v238, v233
    v_mul_f32 v234, v238, v234
    v_mul_f32 v235, v238, v235
    v_cvt_pk_bf16_f32 v248, v232, v233
    v_cvt_pk_bf16_f32 v249, v234, v235
    ds_write_b64 v250, v[248:249] offset:32768
    v_accvgpr_read_b32 v232, a4
    v_accvgpr_read_b32 v233, a5
    v_accvgpr_read_b32 v234, a6
    v_accvgpr_read_b32 v235, a7
    v_mul_f32 v232, v238, v232
    v_mul_f32 v233, v238, v233
    v_mul_f32 v234, v238, v234
    v_mul_f32 v235, v238, v235
    v_xor_b32 v242, 16, v250
    v_cvt_pk_bf16_f32 v248, v232, v233
    v_cvt_pk_bf16_f32 v249, v234, v235
    ds_write_b64 v242, v[248:249] offset:32768
    v_accvgpr_read_b32 v232, a8
    v_accvgpr_read_b32 v233, a9
    v_accvgpr_read_b32 v234, a10
    v_accvgpr_read_b32 v235, a11
    v_mul_f32 v232, v238, v232
    v_mul_f32 v233, v238, v233
    v_mul_f32 v234, v238, v234
    v_mul_f32 v235, v238, v235
    v_xor_b32 v242, 32, v250
    v_cvt_pk_bf16_f32 v248, v232, v233
    v_cvt_pk_bf16_f32 v249, v234, v235
    ds_write_b64 v242, v[248:249] offset:32768
    v_accvgpr_read_b32 v232, a12
    v_accvgpr_read_b32 v233, a13
    v_accvgpr_read_b32 v234, a14
    v_accvgpr_read_b32 v235, a15
    v_mul_f32 v232, v238, v232
    v_mul_f32 v233, v238, v233
    v_mul_f32 v234, v238, v234
    v_mul_f32 v235, v238, v235
    v_xor_b32 v242, 48, v250
    v_cvt_pk_bf16_f32 v248, v232, v233
    v_cvt_pk_bf16_f32 v249, v234, v235
    ds_write_b64 v242, v[248:249] offset:32768
    v_accvgpr_read_b32 v232, a64
    v_accvgpr_read_b32 v233, a65
    v_accvgpr_read_b32 v234, a66
    v_accvgpr_read_b32 v235, a67
    v_mul_f32 v232, v239, v232
    v_mul_f32 v233, v239, v233
    v_mul_f32 v234, v239, v234
    v_mul_f32 v235, v239, v235
    v_cvt_pk_bf16_f32 v248, v232, v233
    v_cvt_pk_bf16_f32 v249, v234, v235
    ds_write_b64 v250, v[248:249] offset:49152
    v_accvgpr_read_b32 v232, a68
    v_accvgpr_read_b32 v233, a69
    v_accvgpr_read_b32 v234, a70
    v_accvgpr_read_b32 v235, a71
    v_mul_f32 v232, v239, v232
    v_mul_f32 v233, v239, v233
    v_mul_f32 v234, v239, v234
    v_mul_f32 v235, v239, v235
    v_xor_b32 v242, 16, v250
    v_cvt_pk_bf16_f32 v248, v232, v233
    v_cvt_pk_bf16_f32 v249, v234, v235
    ds_write_b64 v242, v[248:249] offset:49152
    v_accvgpr_read_b32 v232, a72
    v_accvgpr_read_b32 v233, a73
    v_accvgpr_read_b32 v234, a74
    v_accvgpr_read_b32 v235, a75
    v_mul_f32 v232, v239, v232
    v_mul_f32 v233, v239, v233
    v_mul_f32 v234, v239, v234
    v_mul_f32 v235, v239, v235
    v_xor_b32 v242, 32, v250
    v_cvt_pk_bf16_f32 v248, v232, v233
    v_cvt_pk_bf16_f32 v249, v234, v235
    ds_write_b64 v242, v[248:249] offset:49152
    v_accvgpr_read_b32 v232, a76
    v_accvgpr_read_b32 v233, a77
    v_accvgpr_read_b32 v234, a78
    v_accvgpr_read_b32 v235, a79
    v_mul_f32 v232, v239, v232
    v_mul_f32 v233, v239, v233
    v_mul_f32 v234, v239, v234
    v_mul_f32 v235, v239, v235
    v_xor_b32 v242, 48, v250
    v_cvt_pk_bf16_f32 v248, v232, v233
    v_cvt_pk_bf16_f32 v249, v234, v235
    ds_write_b64 v242, v[248:249] offset:49152
    v_accvgpr_read_b32 v232, a128
    v_accvgpr_read_b32 v233, a129
    v_accvgpr_read_b32 v234, a130
    v_accvgpr_read_b32 v235, a131
    v_mul_f32 v232, v240, v232
    v_mul_f32 v233, v240, v233
    v_mul_f32 v234, v240, v234
    v_mul_f32 v235, v240, v235
    v_cvt_pk_bf16_f32 v248, v232, v233
    v_cvt_pk_bf16_f32 v249, v234, v235
    ds_write_b64 v250, v[248:249]
    v_accvgpr_read_b32 v232, a132
    v_accvgpr_read_b32 v233, a133
    v_accvgpr_read_b32 v234, a134
    v_accvgpr_read_b32 v235, a135
    v_mul_f32 v232, v240, v232
    v_mul_f32 v233, v240, v233
    v_mul_f32 v234, v240, v234
    v_mul_f32 v235, v240, v235
    v_xor_b32 v242, 16, v250
    v_cvt_pk_bf16_f32 v248, v232, v233
    v_cvt_pk_bf16_f32 v249, v234, v235
    ds_write_b64 v242, v[248:249]
    v_accvgpr_read_b32 v232, a136
    v_accvgpr_read_b32 v233, a137
    v_accvgpr_read_b32 v234, a138
    v_accvgpr_read_b32 v235, a139
    v_mul_f32 v232, v240, v232
    v_mul_f32 v233, v240, v233
    v_mul_f32 v234, v240, v234
    v_mul_f32 v235, v240, v235
    v_xor_b32 v242, 32, v250
    v_cvt_pk_bf16_f32 v248, v232, v233
    v_cvt_pk_bf16_f32 v249, v234, v235
    ds_write_b64 v242, v[248:249]
    v_accvgpr_read_b32 v232, a140
    v_accvgpr_read_b32 v233, a141
    v_accvgpr_read_b32 v234, a142
    v_accvgpr_read_b32 v235, a143
    v_mul_f32 v232, v240, v232
    v_mul_f32 v233, v240, v233
    v_mul_f32 v234, v240, v234
    v_mul_f32 v235, v240, v235
    v_xor_b32 v242, 48, v250
    v_cvt_pk_bf16_f32 v248, v232, v233
    v_cvt_pk_bf16_f32 v249, v234, v235
    s_waitcnt lgkmcnt(13)
    ds_write_b64 v242, v[248:249]
    v_mfma_f32_32x32x16_bf16 a[0:15], a[248:251], a[160:163], 0
    v_accvgpr_read_b32 v232, a16
    v_accvgpr_read_b32 v233, a17
    v_accvgpr_read_b32 v234, a18
    v_accvgpr_read_b32 v235, a19
    v_mul_f32 v232, v238, v232
    v_mfma_f32_32x32x16_bf16 a[64:79], a[248:251], v[32:35], 0
    v_mul_f32 v233, v238, v233
    v_mul_f32 v234, v238, v234
    v_mul_f32 v235, v238, v235
    v_xor_b32 v242, 64, v250
    v_cvt_pk_bf16_f32 v248, v232, v233
    v_cvt_pk_bf16_f32 v249, v234, v235
    v_mfma_f32_32x32x16_bf16 a[128:143], a[248:251], v[40:43], 0
    ds_read_b64_tr_b16 a[248:249], v244 offset:4096
    s_waitcnt lgkmcnt(13)
    ds_read_b64_tr_b16 a[250:251], v245 offset:5120
    ds_write_b64 v242, v[248:249] offset:32768
    v_accvgpr_read_b32 v232, a20
    v_mfma_f32_32x32x16_bf16 a[0:15], a[252:255], a[164:167], a[0:15]
    v_accvgpr_read_b32 v233, a21
    v_accvgpr_read_b32 v234, a22
    v_accvgpr_read_b32 v235, a23
    v_mul_f32 v232, v238, v232
    v_mul_f32 v233, v238, v233
    v_mfma_f32_32x32x16_bf16 a[64:79], a[252:255], v[36:39], a[64:79]
    v_mul_f32 v234, v238, v234
    v_mul_f32 v235, v238, v235
    v_xor_b32 v242, 80, v250
    v_cvt_pk_bf16_f32 v248, v232, v233
    v_cvt_pk_bf16_f32 v249, v234, v235
    v_mfma_f32_32x32x16_bf16 a[128:143], a[252:255], v[44:47], a[128:143]
    s_waitcnt lgkmcnt(13)
    ds_read_b64_tr_b16 a[252:253], v244 offset:6144
    ds_read_b64_tr_b16 a[254:255], v245 offset:7168
    s_waitcnt lgkmcnt(13)
    ds_write_b64 v242, v[248:249] offset:32768
    s_waitcnt lgkmcnt(4)
    v_mfma_f32_32x32x16_bf16 a[0:15], a[248:251], a[168:171], a[0:15]
    s_waitcnt vmcnt(1)
    s_waitcnt vmcnt(0)
    s_barrier
    v_accvgpr_read_b32 v232, a24
    v_accvgpr_read_b32 v233, a25
    v_mfma_f32_32x32x16_bf16 a[64:79], a[248:251], v[48:51], a[64:79]
    v_accvgpr_read_b32 v234, a26
    v_accvgpr_read_b32 v235, a27
    v_mul_f32 v232, v238, v232
    v_mul_f32 v233, v238, v233
    v_mul_f32 v234, v238, v234
    v_mfma_f32_32x32x16_bf16 a[128:143], a[248:251], v[56:59], a[128:143]
    ds_read_b64_tr_b16 a[248:249], v244 offset:8192
    ds_read_b64_tr_b16 a[250:251], v245 offset:9216
    v_mul_f32 v235, v238, v235
    v_xor_b32 v242, 96, v250
    v_cvt_pk_bf16_f32 v248, v232, v233
    s_waitcnt lgkmcnt(3)
    v_mfma_f32_32x32x16_bf16 a[0:15], a[252:255], a[172:175], a[0:15]
    v_cvt_pk_bf16_f32 v249, v234, v235
    ds_write_b64 v242, v[248:249] offset:32768
    v_accvgpr_read_b32 v232, a28
    v_accvgpr_read_b32 v233, a29
    v_accvgpr_read_b32 v234, a30
    v_mfma_f32_32x32x16_bf16 a[64:79], a[252:255], v[52:55], a[64:79]
    v_accvgpr_read_b32 v235, a31
    v_mul_f32 v232, v238, v232
    v_mul_f32 v233, v238, v233
    v_mul_f32 v234, v238, v234
    v_mul_f32 v235, v238, v235
    v_xor_b32 v242, 112, v250
    v_mfma_f32_32x32x16_bf16 a[128:143], a[252:255], v[60:63], a[128:143]
    ds_read_b64_tr_b16 a[252:253], v244 offset:10240
    ds_read_b64_tr_b16 a[254:255], v245 offset:11264
    v_cvt_pk_bf16_f32 v248, v232, v233
    v_cvt_pk_bf16_f32 v249, v234, v235
    ds_write_b64 v242, v[248:249] offset:32768
    s_waitcnt lgkmcnt(4)
    v_mfma_f32_32x32x16_bf16 a[0:15], a[248:251], a[176:179], a[0:15]
    v_accvgpr_read_b32 v232, a80
    v_accvgpr_read_b32 v233, a81
    v_accvgpr_read_b32 v234, a82
    v_accvgpr_read_b32 v235, a83
    v_mul_f32 v232, v239, v232
    v_mfma_f32_32x32x16_bf16 a[64:79], a[248:251], v[64:67], a[64:79]
    v_mul_f32 v233, v239, v233
    v_mul_f32 v234, v239, v234
    v_mul_f32 v235, v239, v235
    v_xor_b32 v242, 64, v250
    v_cvt_pk_bf16_f32 v248, v232, v233
    v_cvt_pk_bf16_f32 v249, v234, v235
    v_mfma_f32_32x32x16_bf16 a[128:143], a[248:251], v[72:75], a[128:143]
    ds_read_b64_tr_b16 a[248:249], v244 offset:12288
    ds_read_b64_tr_b16 a[250:251], v245 offset:13312
    ds_write_b64 v242, v[248:249] offset:49152
    v_accvgpr_read_b32 v232, a84
    v_accvgpr_read_b32 v233, a85
    s_waitcnt lgkmcnt(4)
    v_mfma_f32_32x32x16_bf16 a[0:15], a[252:255], a[180:183], a[0:15]
    v_accvgpr_read_b32 v234, a86
    v_accvgpr_read_b32 v235, a87
    v_mul_f32 v232, v239, v232
    v_mul_f32 v233, v239, v233
    v_mul_f32 v234, v239, v234
    v_mfma_f32_32x32x16_bf16 a[64:79], a[252:255], v[68:71], a[64:79]
    v_mul_f32 v235, v239, v235
    v_xor_b32 v242, 80, v250
    v_cvt_pk_bf16_f32 v248, v232, v233
    v_cvt_pk_bf16_f32 v249, v234, v235
    ds_write_b64 v242, v[248:249] offset:49152
    v_mfma_f32_32x32x16_bf16 a[128:143], a[252:255], v[76:79], a[128:143]
    ds_read_b64_tr_b16 a[252:253], v244 offset:14336
    ds_read_b64_tr_b16 a[254:255], v245 offset:15360
    v_accvgpr_read_b32 v232, a88
    v_accvgpr_read_b32 v233, a89
    v_accvgpr_read_b32 v234, a90
    s_waitcnt lgkmcnt(4)
    v_mfma_f32_32x32x16_bf16 a[0:15], a[248:251], a[184:187], a[0:15]
    v_accvgpr_read_b32 v235, a91
    v_mul_f32 v232, v239, v232
    v_mul_f32 v233, v239, v233
    v_mul_f32 v234, v239, v234
    v_mul_f32 v235, v239, v235
    v_xor_b32 v242, 96, v250
    v_mfma_f32_32x32x16_bf16 a[64:79], a[248:251], v[80:83], a[64:79]
    v_cvt_pk_bf16_f32 v248, v232, v233
    v_cvt_pk_bf16_f32 v249, v234, v235
    ds_write_b64 v242, v[248:249] offset:49152
    v_accvgpr_read_b32 v232, a92
    v_accvgpr_read_b32 v233, a93
    v_mfma_f32_32x32x16_bf16 a[128:143], a[248:251], v[88:91], a[128:143]
    ds_read_b64_tr_b16 a[248:249], v244 offset:16384
    ds_read_b64_tr_b16 a[250:251], v245 offset:17408
    v_accvgpr_read_b32 v234, a94
    v_accvgpr_read_b32 v235, a95
    v_mul_f32 v232, v239, v232
    s_waitcnt lgkmcnt(3)
    v_mfma_f32_32x32x16_bf16 a[0:15], a[252:255], a[188:191], a[0:15]
    v_mul_f32 v233, v239, v233
    v_mul_f32 v234, v239, v234
    v_mul_f32 v235, v239, v235
    v_xor_b32 v242, 112, v250
    v_cvt_pk_bf16_f32 v248, v232, v233
    v_cvt_pk_bf16_f32 v249, v234, v235
    v_mfma_f32_32x32x16_bf16 a[64:79], a[252:255], v[84:87], a[64:79]
    ds_write_b64 v242, v[248:249] offset:49152
    v_accvgpr_read_b32 v232, a144
    v_accvgpr_read_b32 v233, a145
    v_accvgpr_read_b32 v234, a146
    v_accvgpr_read_b32 v235, a147
    v_mfma_f32_32x32x16_bf16 a[128:143], a[252:255], v[92:95], a[128:143]
    ds_read_b64_tr_b16 a[252:253], v244 offset:18432
    ds_read_b64_tr_b16 a[254:255], v245 offset:19456
    v_mul_f32 v232, v240, v232
    v_mul_f32 v233, v240, v233
    v_mul_f32 v234, v240, v234
    s_waitcnt lgkmcnt(3)
    v_mfma_f32_32x32x16_bf16 a[0:15], a[248:251], a[192:195], a[0:15]
    v_mul_f32 v235, v240, v235
    v_xor_b32 v242, 64, v250
    v_cvt_pk_bf16_f32 v248, v232, v233
    v_cvt_pk_bf16_f32 v249, v234, v235
    ds_write_b64 v242, v[248:249]
    v_mfma_f32_32x32x16_bf16 a[64:79], a[248:251], v[96:99], a[64:79]
    v_accvgpr_read_b32 v232, a148
    v_accvgpr_read_b32 v233, a149
    v_accvgpr_read_b32 v234, a150
    v_accvgpr_read_b32 v235, a151
    v_mul_f32 v232, v240, v232
    v_mfma_f32_32x32x16_bf16 a[128:143], a[248:251], v[104:107], a[128:143]
    ds_read_b64_tr_b16 a[248:249], v244 offset:20480
    ds_read_b64_tr_b16 a[250:251], v245 offset:21504
    v_mul_f32 v233, v240, v233
    v_mul_f32 v234, v240, v234
    v_mul_f32 v235, v240, v235
    s_waitcnt lgkmcnt(3)
    v_mfma_f32_32x32x16_bf16 a[0:15], a[252:255], a[196:199], a[0:15]
    v_xor_b32 v242, 80, v250
    v_cvt_pk_bf16_f32 v248, v232, v233
    v_cvt_pk_bf16_f32 v249, v234, v235
    ds_write_b64 v242, v[248:249]
    v_accvgpr_read_b32 v232, a152
    v_mfma_f32_32x32x16_bf16 a[64:79], a[252:255], v[100:103], a[64:79]
    v_accvgpr_read_b32 v233, a153
    v_accvgpr_read_b32 v234, a154
    v_accvgpr_read_b32 v235, a155
    v_mul_f32 v232, v240, v232
    v_mul_f32 v233, v240, v233
    v_mfma_f32_32x32x16_bf16 a[128:143], a[252:255], v[108:111], a[128:143]
    ds_read_b64_tr_b16 a[252:253], v244 offset:22528
    ds_read_b64_tr_b16 a[254:255], v245 offset:23552
    v_mul_f32 v234, v240, v234
    v_mul_f32 v235, v240, v235
    v_xor_b32 v242, 96, v250
    s_waitcnt lgkmcnt(3)
    v_mfma_f32_32x32x16_bf16 a[0:15], a[248:251], a[200:203], a[0:15]
    v_cvt_pk_bf16_f32 v248, v232, v233
    v_cvt_pk_bf16_f32 v249, v234, v235
    ds_write_b64 v242, v[248:249]
    v_accvgpr_read_b32 v232, a156
    v_accvgpr_read_b32 v233, a157
    v_mfma_f32_32x32x16_bf16 a[64:79], a[248:251], v[112:115], a[64:79]
    v_accvgpr_read_b32 v234, a158
    v_accvgpr_read_b32 v235, a159
    v_mul_f32 v232, v240, v232
    v_mul_f32 v233, v240, v233
    v_mul_f32 v234, v240, v234
    v_mfma_f32_32x32x16_bf16 a[128:143], a[248:251], v[120:123], a[128:143]
    ds_read_b64_tr_b16 a[248:249], v244 offset:24576
    ds_read_b64_tr_b16 a[250:251], v245 offset:25600
    v_mul_f32 v235, v240, v235
    v_xor_b32 v242, 112, v250
    v_cvt_pk_bf16_f32 v248, v232, v233
    s_waitcnt lgkmcnt(3)
    v_mfma_f32_32x32x16_bf16 a[0:15], a[252:255], a[204:207], a[0:15]
    v_cvt_pk_bf16_f32 v249, v234, v235
    ds_write_b64 v242, v[248:249]
    v_accvgpr_read_b32 v232, a32
    v_accvgpr_read_b32 v233, a33
    v_accvgpr_read_b32 v234, a34
    v_mfma_f32_32x32x16_bf16 a[64:79], a[252:255], v[116:119], a[64:79]
    v_accvgpr_read_b32 v235, a35
    v_mul_f32 v232, v238, v232
    v_mul_f32 v233, v238, v233
    v_mul_f32 v234, v238, v234
    v_mul_f32 v235, v238, v235
    v_cvt_pk_bf16_f32 v248, v232, v233
    v_mfma_f32_32x32x16_bf16 a[128:143], a[252:255], v[124:127], a[128:143]
    ds_read_b64_tr_b16 a[252:253], v244 offset:26624
    ds_read_b64_tr_b16 a[254:255], v245 offset:27648
    v_cvt_pk_bf16_f32 v249, v234, v235
    ds_write_b64 v250, v[248:249] offset:16384
    v_accvgpr_read_b32 v232, a36
    s_waitcnt lgkmcnt(4)
    v_mfma_f32_32x32x16_bf16 a[0:15], a[248:251], a[208:211], a[0:15]
    v_accvgpr_read_b32 v233, a37
    v_accvgpr_read_b32 v234, a38
    v_accvgpr_read_b32 v235, a39
    v_mul_f32 v232, v238, v232
    v_mul_f32 v233, v238, v233
    v_mfma_f32_32x32x16_bf16 a[64:79], a[248:251], v[128:131], a[64:79]
    v_mul_f32 v234, v238, v234
    v_mul_f32 v235, v238, v235
    v_xor_b32 v242, 16, v250
    v_cvt_pk_bf16_f32 v248, v232, v233
    v_cvt_pk_bf16_f32 v249, v234, v235
    v_mfma_f32_32x32x16_bf16 a[128:143], a[248:251], v[136:139], a[128:143]
    ds_read_b64_tr_b16 a[248:249], v244 offset:28672
    ds_read_b64_tr_b16 a[250:251], v245 offset:29696
    ds_write_b64 v242, v[248:249] offset:16384
    v_accvgpr_read_b32 v232, a40
    v_accvgpr_read_b32 v233, a41
    s_waitcnt lgkmcnt(4)
    v_mfma_f32_32x32x16_bf16 a[0:15], a[252:255], a[212:215], a[0:15]
    v_accvgpr_read_b32 v234, a42
    v_accvgpr_read_b32 v235, a43
    v_mul_f32 v232, v238, v232
    v_mul_f32 v233, v238, v233
    v_mul_f32 v234, v238, v234
    v_mfma_f32_32x32x16_bf16 a[64:79], a[252:255], v[132:135], a[64:79]
    v_mul_f32 v235, v238, v235
    v_xor_b32 v242, 32, v250
    v_cvt_pk_bf16_f32 v248, v232, v233
    v_cvt_pk_bf16_f32 v249, v234, v235
    ds_write_b64 v242, v[248:249] offset:16384
    v_mfma_f32_32x32x16_bf16 a[128:143], a[252:255], v[140:143], a[128:143]
    ds_read_b64_tr_b16 a[252:253], v244 offset:30720
    ds_read_b64_tr_b16 a[254:255], v245 offset:31744
    v_accvgpr_read_b32 v232, a44
    v_accvgpr_read_b32 v233, a45
    v_accvgpr_read_b32 v234, a46
    s_waitcnt lgkmcnt(4)
    v_mfma_f32_32x32x16_bf16 a[0:15], a[248:251], a[216:219], a[0:15]
    v_accvgpr_read_b32 v235, a47
    v_mul_f32 v232, v238, v232
    v_mul_f32 v233, v238, v233
    v_mul_f32 v234, v238, v234
    v_mul_f32 v235, v238, v235
    v_xor_b32 v242, 48, v250
    v_mfma_f32_32x32x16_bf16 a[64:79], a[248:251], v[144:147], a[64:79]
    v_cvt_pk_bf16_f32 v248, v232, v233
    v_cvt_pk_bf16_f32 v249, v234, v235
    ds_write_b64 v242, v[248:249] offset:16384
    v_accvgpr_read_b32 v232, a48
    v_accvgpr_read_b32 v233, a49
    v_mfma_f32_32x32x16_bf16 a[128:143], a[248:251], v[152:155], a[128:143]
    ds_read_b64_tr_b16 a[248:249], v244 offset:32768
    ds_read_b64_tr_b16 a[250:251], v245 offset:33792
    v_accvgpr_read_b32 v234, a50
    v_accvgpr_read_b32 v235, a51
    v_mul_f32 v232, v238, v232
    s_waitcnt lgkmcnt(3)
    v_mfma_f32_32x32x16_bf16 a[0:15], a[252:255], a[220:223], a[0:15]
    v_mul_f32 v233, v238, v233
    v_mul_f32 v234, v238, v234
    v_mul_f32 v235, v238, v235
    v_xor_b32 v242, 64, v250
    v_cvt_pk_bf16_f32 v248, v232, v233
    v_cvt_pk_bf16_f32 v249, v234, v235
    v_mfma_f32_32x32x16_bf16 a[64:79], a[252:255], v[148:151], a[64:79]
    ds_write_b64 v242, v[248:249] offset:16384
    v_accvgpr_read_b32 v232, a52
    v_accvgpr_read_b32 v233, a53
    v_accvgpr_read_b32 v234, a54
    v_accvgpr_read_b32 v235, a55
    v_mfma_f32_32x32x16_bf16 a[128:143], a[252:255], v[156:159], a[128:143]
    ds_read_b64_tr_b16 a[252:253], v244 offset:34816
    ds_read_b64_tr_b16 a[254:255], v245 offset:35840
    v_mul_f32 v232, v238, v232
    v_mul_f32 v233, v238, v233
    v_mul_f32 v234, v238, v234
    s_waitcnt lgkmcnt(3)
    v_mfma_f32_32x32x16_bf16 a[0:15], a[248:251], a[224:227], a[0:15]
    v_mul_f32 v235, v238, v235
    v_xor_b32 v242, 80, v250
    v_cvt_pk_bf16_f32 v248, v232, v233
    v_cvt_pk_bf16_f32 v249, v234, v235
    ds_write_b64 v242, v[248:249] offset:16384
    v_mfma_f32_32x32x16_bf16 a[64:79], a[248:251], v[160:163], a[64:79]
    v_accvgpr_read_b32 v232, a56
    v_accvgpr_read_b32 v233, a57
    v_accvgpr_read_b32 v234, a58
    v_accvgpr_read_b32 v235, a59
    v_mul_f32 v232, v238, v232
    v_mfma_f32_32x32x16_bf16 a[128:143], a[248:251], v[168:171], a[128:143]
    ds_read_b64_tr_b16 a[248:249], v244 offset:36864
    ds_read_b64_tr_b16 a[250:251], v245 offset:37888
    v_mul_f32 v233, v238, v233
    v_mul_f32 v234, v238, v234
    v_mul_f32 v235, v238, v235
    s_waitcnt lgkmcnt(3)
    v_mfma_f32_32x32x16_bf16 a[0:15], a[252:255], a[228:231], a[0:15]
    v_xor_b32 v242, 96, v250
    v_cvt_pk_bf16_f32 v248, v232, v233
    v_cvt_pk_bf16_f32 v249, v234, v235
    ds_write_b64 v242, v[248:249] offset:16384
    v_accvgpr_read_b32 v232, a60
    v_mfma_f32_32x32x16_bf16 a[64:79], a[252:255], v[164:167], a[64:79]
    v_accvgpr_read_b32 v233, a61
    v_accvgpr_read_b32 v234, a62
    v_accvgpr_read_b32 v235, a63
    v_mul_f32 v232, v238, v232
    v_mul_f32 v233, v238, v233
    v_mfma_f32_32x32x16_bf16 a[128:143], a[252:255], v[172:175], a[128:143]
    ds_read_b64_tr_b16 a[252:253], v244 offset:38912
    ds_read_b64_tr_b16 a[254:255], v245 offset:39936
    v_mul_f32 v234, v238, v234
    v_mul_f32 v235, v238, v235
    v_xor_b32 v242, 112, v250
    s_waitcnt lgkmcnt(3)
    v_mfma_f32_32x32x16_bf16 a[0:15], a[248:251], a[232:235], a[0:15]
    v_cvt_pk_bf16_f32 v248, v232, v233
    v_cvt_pk_bf16_f32 v249, v234, v235
    ds_write_b64 v242, v[248:249] offset:16384
    ds_read_b128 a[32:35], v251 offset:32768
    ds_read_b128 a[36:39], v251 offset:16384
    v_mfma_f32_32x32x16_bf16 a[64:79], a[248:251], v[176:179], a[64:79]
    ds_read_b128 a[40:43], v251 offset:33792
    s_add_u32 s35, s28, 4096
    s_waitcnt lgkmcnt(2)
    buffer_store_dwordx4 a[32:35], v252, s[20:23], s35 offen sc1
    v_mfma_f32_32x32x16_bf16 a[128:143], a[248:251], v[184:187], a[128:143]
    ds_read_b64_tr_b16 a[248:249], v244 offset:40960
    ds_read_b64_tr_b16 a[250:251], v245 offset:41984
    ds_read_b128 a[44:47], v251 offset:17408
    s_add_u32 s35, s28, 4096
    s_waitcnt lgkmcnt(4)
    buffer_store_dwordx4 a[36:39], v252, s[20:23], s35 offen offset:128 sc1
    v_mfma_f32_32x32x16_bf16 a[0:15], a[252:255], a[236:239], a[0:15]
    ds_read_b128 a[32:35], v251 offset:34816
    s_add_u32 s35, s28, 8192
    s_waitcnt lgkmcnt(4)
    buffer_store_dwordx4 a[40:43], v253, s[20:23], s35 offen sc1
    v_mfma_f32_32x32x16_bf16 a[64:79], a[252:255], v[180:183], a[64:79]
    ds_read_b128 a[36:39], v251 offset:18432
    s_add_u32 s35, s28, 8192
    s_waitcnt lgkmcnt(2)
    buffer_store_dwordx4 a[44:47], v253, s[20:23], s35 offen offset:128 sc1
    v_mfma_f32_32x32x16_bf16 a[128:143], a[252:255], v[188:191], a[128:143]
    ds_read_b64_tr_b16 a[252:253], v244 offset:43008
    ds_read_b64_tr_b16 a[254:255], v245 offset:44032
    ds_read_b128 a[40:43], v251 offset:35840
    s_add_u32 s35, s28, 12288
    s_waitcnt lgkmcnt(4)
    buffer_store_dwordx4 a[32:35], v252, s[20:23], s35 offen sc1
    v_mfma_f32_32x32x16_bf16 a[0:15], a[248:251], a[240:243], a[0:15]
    ds_read_b128 a[44:47], v251 offset:19456
    s_add_u32 s35, s28, 12288
    s_waitcnt lgkmcnt(4)
    buffer_store_dwordx4 a[36:39], v252, s[20:23], s35 offen offset:128 sc1
    v_mfma_f32_32x32x16_bf16 a[64:79], a[248:251], v[192:195], a[64:79]
    s_add_u32 s35, s28, 16384
    s_waitcnt lgkmcnt(1)
    buffer_store_dwordx4 a[40:43], v253, s[20:23], s35 offen sc1
    s_add_u32 s35, s28, 16384
    s_waitcnt lgkmcnt(0)
    buffer_store_dwordx4 a[44:47], v253, s[20:23], s35 offen offset:128 sc1
    v_mfma_f32_32x32x16_bf16 a[128:143], a[248:251], v[200:203], a[128:143]
    ds_read_b64_tr_b16 a[248:249], v244 offset:45056
    ds_read_b64_tr_b16 a[250:251], v245 offset:46080
    v_accvgpr_read_b32 v232, a96
    v_accvgpr_read_b32 v233, a97
    v_accvgpr_read_b32 v234, a98
    v_mfma_f32_32x32x16_bf16 a[0:15], a[252:255], a[244:247], a[0:15]
    v_accvgpr_read_b32 v235, a99
    v_mul_f32 v232, v239, v232
    v_mul_f32 v233, v239, v233
    v_mul_f32 v234, v239, v234
    v_mul_f32 v235, v239, v235
    v_cvt_pk_bf16_f32 v248, v232, v233
    v_mfma_f32_32x32x16_bf16 a[64:79], a[252:255], v[196:199], a[64:79]
    v_cvt_pk_bf16_f32 v249, v234, v235
    ds_write_b64 v250, v[248:249] offset:16384
    v_accvgpr_read_b32 v232, a100
    v_accvgpr_read_b32 v233, a101
    v_accvgpr_read_b32 v234, a102
    v_mfma_f32_32x32x16_bf16 a[128:143], a[252:255], v[204:207], a[128:143]
    ds_read_b64_tr_b16 a[252:253], v244 offset:47104
    ds_read_b64_tr_b16 a[254:255], v245 offset:48128
    v_accvgpr_read_b32 v235, a103
    v_mul_f32 v232, v239, v232
    v_mul_f32 v233, v239, v233
    s_waitcnt lgkmcnt(3)
    v_mfma_f32_32x32x16_bf16 a[0:15], a[248:251], v[208:211], a[0:15]
    v_mul_f32 v234, v239, v234
    v_mul_f32 v235, v239, v235
    v_xor_b32 v242, 16, v250
    v_cvt_pk_bf16_f32 v248, v232, v233
    v_cvt_pk_bf16_f32 v249, v234, v235
    v_mfma_f32_32x32x16_bf16 a[64:79], a[248:251], v[216:219], a[64:79]
    ds_write_b64 v242, v[248:249] offset:16384
    v_accvgpr_read_b32 v232, a104
    v_accvgpr_read_b32 v233, a105
    v_accvgpr_read_b32 v234, a106
    v_accvgpr_read_b32 v235, a107
    v_mfma_f32_32x32x16_bf16 a[128:143], a[248:251], v[224:227], a[128:143]
    ds_read_b64_tr_b16 a[248:249], v246
    ds_read_b64_tr_b16 a[250:251], v247 offset:1024
    v_mul_f32 v232, v239, v232
    v_mul_f32 v233, v239, v233
    v_mul_f32 v234, v239, v234
    s_waitcnt lgkmcnt(3)
    v_mfma_f32_32x32x16_bf16 a[0:15], a[252:255], v[212:215], a[0:15]
    v_mul_f32 v235, v239, v235
    v_xor_b32 v242, 32, v250
    v_cvt_pk_bf16_f32 v248, v232, v233
    v_cvt_pk_bf16_f32 v249, v234, v235
    ds_write_b64 v242, v[248:249] offset:16384
    v_mfma_f32_32x32x16_bf16 a[64:79], a[252:255], v[220:223], a[64:79]
    v_accvgpr_read_b32 v232, a108
    v_accvgpr_read_b32 v233, a109
    v_accvgpr_read_b32 v234, a110
    v_accvgpr_read_b32 v235, a111
    v_mul_f32 v232, v239, v232
    v_mfma_f32_32x32x16_bf16 a[128:143], a[252:255], v[228:231], a[128:143]
    ds_read_b64_tr_b16 a[252:253], v246 offset:2048
    ds_read_b64_tr_b16 a[254:255], v247 offset:3072
    v_mul_f32 v233, v239, v233
    v_mul_f32 v234, v239, v234
    v_mul_f32 v235, v239, v235
    s_waitcnt lgkmcnt(3)
    v_mfma_f32_32x32x16_bf16 a[16:31], a[248:251], a[160:163], 0
    v_xor_b32 v242, 48, v250
    v_cvt_pk_bf16_f32 v248, v232, v233
    v_cvt_pk_bf16_f32 v249, v234, v235
    ds_write_b64 v242, v[248:249] offset:16384
    v_accvgpr_read_b32 v232, a112
    v_mfma_f32_32x32x16_bf16 a[80:95], a[248:251], v[32:35], 0
    v_accvgpr_read_b32 v233, a113
    v_accvgpr_read_b32 v234, a114
    v_accvgpr_read_b32 v235, a115
    v_mul_f32 v232, v239, v232
    v_mul_f32 v233, v239, v233
    v_mfma_f32_32x32x16_bf16 a[144:159], a[248:251], v[40:43], 0
    ds_read_b64_tr_b16 a[248:249], v246 offset:4096
    ds_read_b64_tr_b16 a[250:251], v247 offset:5120
    v_mul_f32 v234, v239, v234
    v_mul_f32 v235, v239, v235
    v_xor_b32 v242, 64, v250
    s_waitcnt lgkmcnt(3)
    v_mfma_f32_32x32x16_bf16 a[16:31], a[252:255], a[164:167], a[16:31]
    v_cvt_pk_bf16_f32 v248, v232, v233
    v_cvt_pk_bf16_f32 v249, v234, v235
    ds_write_b64 v242, v[248:249] offset:16384
    v_accvgpr_read_b32 v232, a116
    v_accvgpr_read_b32 v233, a117
    v_mfma_f32_32x32x16_bf16 a[80:95], a[252:255], v[36:39], a[80:95]
    v_accvgpr_read_b32 v234, a118
    v_accvgpr_read_b32 v235, a119
    v_mul_f32 v232, v239, v232
    v_mul_f32 v233, v239, v233
    v_mul_f32 v234, v239, v234
    v_mfma_f32_32x32x16_bf16 a[144:159], a[252:255], v[44:47], a[144:159]
    ds_read_b64_tr_b16 a[252:253], v246 offset:6144
    ds_read_b64_tr_b16 a[254:255], v247 offset:7168
    v_mul_f32 v235, v239, v235
    v_xor_b32 v242, 80, v250
    v_cvt_pk_bf16_f32 v248, v232, v233
    s_waitcnt lgkmcnt(3)
    v_mfma_f32_32x32x16_bf16 a[16:31], a[248:251], a[168:171], a[16:31]
    v_cvt_pk_bf16_f32 v249, v234, v235
    ds_write_b64 v242, v[248:249] offset:16384
    v_accvgpr_read_b32 v232, a120
    v_accvgpr_read_b32 v233, a121
    v_accvgpr_read_b32 v234, a122
    v_mfma_f32_32x32x16_bf16 a[80:95], a[248:251], v[48:51], a[80:95]
    v_accvgpr_read_b32 v235, a123
    v_mul_f32 v232, v239, v232
    v_mul_f32 v233, v239, v233
    v_mul_f32 v234, v239, v234
    v_mul_f32 v235, v239, v235
    v_xor_b32 v242, 96, v250
    v_mfma_f32_32x32x16_bf16 a[144:159], a[248:251], v[56:59], a[144:159]
    ds_read_b64_tr_b16 a[248:249], v246 offset:8192
    ds_read_b64_tr_b16 a[250:251], v247 offset:9216
    v_cvt_pk_bf16_f32 v248, v232, v233
    v_cvt_pk_bf16_f32 v249, v234, v235
    ds_write_b64 v242, v[248:249] offset:16384
    s_waitcnt lgkmcnt(4)
    v_mfma_f32_32x32x16_bf16 a[16:31], a[252:255], a[172:175], a[16:31]
    v_accvgpr_read_b32 v232, a124
    v_accvgpr_read_b32 v233, a125
    v_accvgpr_read_b32 v234, a126
    v_accvgpr_read_b32 v235, a127
    v_mul_f32 v232, v239, v232
    v_mfma_f32_32x32x16_bf16 a[80:95], a[252:255], v[52:55], a[80:95]
    v_mul_f32 v233, v239, v233
    v_mul_f32 v234, v239, v234
    v_mul_f32 v235, v239, v235
    v_xor_b32 v242, 112, v250
    v_cvt_pk_bf16_f32 v248, v232, v233
    v_cvt_pk_bf16_f32 v249, v234, v235
    v_mfma_f32_32x32x16_bf16 a[144:159], a[252:255], v[60:63], a[144:159]
    ds_read_b64_tr_b16 a[252:253], v246 offset:10240
    ds_read_b64_tr_b16 a[254:255], v247 offset:11264
    ds_write_b64 v242, v[248:249] offset:16384
    v_mul_f32 v0, v240, v0
    v_mul_f32 v1, v240, v1
    s_waitcnt lgkmcnt(4)
    v_mfma_f32_32x32x16_bf16 a[16:31], a[248:251], a[176:179], a[16:31]
    v_mul_f32 v2, v240, v2
    v_mul_f32 v3, v240, v3
    v_cvt_pk_bf16_f32 v248, v0, v1
    v_cvt_pk_bf16_f32 v249, v2, v3
    ds_write_b64 v250, v[248:249] offset:32768
    v_mfma_f32_32x32x16_bf16 a[80:95], a[248:251], v[64:67], a[80:95]
    v_mul_f32 v4, v240, v4
    v_mul_f32 v5, v240, v5
    v_mul_f32 v6, v240, v6
    v_mul_f32 v7, v240, v7
    v_xor_b32 v242, 16, v250
    v_cvt_pk_bf16_f32 v248, v4, v5
    v_mfma_f32_32x32x16_bf16 a[144:159], a[248:251], v[72:75], a[144:159]
    ds_read_b64_tr_b16 a[248:249], v246 offset:12288
    ds_read_b64_tr_b16 a[250:251], v247 offset:13312
    v_cvt_pk_bf16_f32 v249, v6, v7
    ds_write_b64 v242, v[248:249] offset:32768
    v_mul_f32 v8, v240, v8
    s_waitcnt lgkmcnt(5)
    v_mfma_f32_32x32x16_bf16 a[16:31], a[252:255], a[180:183], a[16:31]
    v_mul_f32 v9, v240, v9
    v_mul_f32 v10, v240, v10
    v_mul_f32 v11, v240, v11
    v_xor_b32 v242, 32, v250
    v_cvt_pk_bf16_f32 v248, v8, v9
    v_cvt_pk_bf16_f32 v249, v10, v11
    v_mfma_f32_32x32x16_bf16 a[80:95], a[252:255], v[68:71], a[80:95]
    ds_write_b64 v242, v[248:249] offset:32768
    v_mul_f32 v12, v240, v12
    v_mul_f32 v13, v240, v13
    v_mul_f32 v14, v240, v14
    v_mul_f32 v15, v240, v15
    v_xor_b32 v242, 48, v250
    v_mfma_f32_32x32x16_bf16 a[144:159], a[252:255], v[76:79], a[144:159]
    ds_read_b64_tr_b16 a[252:253], v246 offset:14336
    ds_read_b64_tr_b16 a[254:255], v247 offset:15360
    v_cvt_pk_bf16_f32 v248, v12, v13
    v_cvt_pk_bf16_f32 v249, v14, v15
    ds_write_b64 v242, v[248:249] offset:32768
    s_waitcnt lgkmcnt(5)
    v_mfma_f32_32x32x16_bf16 a[16:31], a[248:251], a[184:187], a[16:31]
    v_mul_f32 v16, v240, v16
    v_mul_f32 v17, v240, v17
    v_mul_f32 v18, v240, v18
    v_mul_f32 v19, v240, v19
    v_xor_b32 v242, 64, v250
    v_cvt_pk_bf16_f32 v248, v16, v17
    v_mfma_f32_32x32x16_bf16 a[80:95], a[248:251], v[80:83], a[80:95]
    v_cvt_pk_bf16_f32 v249, v18, v19
    ds_write_b64 v242, v[248:249] offset:32768
    v_mul_f32 v20, v240, v20
    v_mul_f32 v21, v240, v21
    v_mul_f32 v22, v240, v22
    v_mfma_f32_32x32x16_bf16 a[144:159], a[248:251], v[88:91], a[144:159]
    ds_read_b64_tr_b16 a[248:249], v246 offset:16384
    ds_read_b64_tr_b16 a[250:251], v247 offset:17408
    v_mul_f32 v23, v240, v23
    v_xor_b32 v242, 80, v250
    v_cvt_pk_bf16_f32 v248, v20, v21
    s_waitcnt lgkmcnt(4)
    v_mfma_f32_32x32x16_bf16 a[16:31], a[252:255], a[188:191], a[16:31]
    v_cvt_pk_bf16_f32 v249, v22, v23
    ds_write_b64 v242, v[248:249] offset:32768
    v_mul_f32 v24, v240, v24
    v_mul_f32 v25, v240, v25
    v_mul_f32 v26, v240, v26
    v_mfma_f32_32x32x16_bf16 a[80:95], a[252:255], v[84:87], a[80:95]
    v_mul_f32 v27, v240, v27
    v_xor_b32 v242, 96, v250
    v_cvt_pk_bf16_f32 v248, v24, v25
    v_cvt_pk_bf16_f32 v249, v26, v27
    ds_write_b64 v242, v[248:249] offset:32768
    v_mfma_f32_32x32x16_bf16 a[144:159], a[252:255], v[92:95], a[144:159]
    ds_read_b64_tr_b16 a[252:253], v246 offset:18432
    ds_read_b64_tr_b16 a[254:255], v247 offset:19456
    v_mul_f32 v28, v240, v28
    v_mul_f32 v29, v240, v29
    v_mul_f32 v30, v240, v30
    s_waitcnt lgkmcnt(4)
    v_mfma_f32_32x32x16_bf16 a[16:31], a[248:251], a[192:195], a[16:31]
    v_mul_f32 v31, v240, v31
    v_xor_b32 v242, 112, v250
    v_cvt_pk_bf16_f32 v248, v28, v29
    v_cvt_pk_bf16_f32 v249, v30, v31
    ds_write_b64 v242, v[248:249] offset:32768
    v_mfma_f32_32x32x16_bf16 a[80:95], a[248:251], v[96:99], a[80:95]
    v_mfma_f32_32x32x16_bf16 a[144:159], a[248:251], v[104:107], a[144:159]
    ds_read_b64_tr_b16 a[248:249], v246 offset:20480
    ds_read_b64_tr_b16 a[250:251], v247 offset:21504
    s_waitcnt lgkmcnt(3)
    v_mfma_f32_32x32x16_bf16 a[16:31], a[252:255], a[196:199], a[16:31]
    v_mfma_f32_32x32x16_bf16 a[80:95], a[252:255], v[100:103], a[80:95]
    v_mfma_f32_32x32x16_bf16 a[144:159], a[252:255], v[108:111], a[144:159]
    ds_read_b64_tr_b16 a[252:253], v246 offset:22528
    ds_read_b64_tr_b16 a[254:255], v247 offset:23552
    s_waitcnt lgkmcnt(2)
    v_mfma_f32_32x32x16_bf16 a[16:31], a[248:251], a[200:203], a[16:31]
    v_mfma_f32_32x32x16_bf16 a[80:95], a[248:251], v[112:115], a[80:95]
    v_mfma_f32_32x32x16_bf16 a[144:159], a[248:251], v[120:123], a[144:159]
    ds_read_b64_tr_b16 a[248:249], v246 offset:24576
    ds_read_b64_tr_b16 a[250:251], v247 offset:25600
    s_waitcnt lgkmcnt(2)
    v_mfma_f32_32x32x16_bf16 a[16:31], a[252:255], a[204:207], a[16:31]
    v_mfma_f32_32x32x16_bf16 a[80:95], a[252:255], v[116:119], a[80:95]
    v_mfma_f32_32x32x16_bf16 a[144:159], a[252:255], v[124:127], a[144:159]
    ds_read_b64_tr_b16 a[252:253], v246 offset:26624
    ds_read_b64_tr_b16 a[254:255], v247 offset:27648
    s_waitcnt lgkmcnt(2)
    v_mfma_f32_32x32x16_bf16 a[16:31], a[248:251], a[208:211], a[16:31]
    v_mfma_f32_32x32x16_bf16 a[80:95], a[248:251], v[128:131], a[80:95]
    v_mfma_f32_32x32x16_bf16 a[144:159], a[248:251], v[136:139], a[144:159]
    ds_read_b64_tr_b16 a[248:249], v246 offset:28672
    ds_read_b64_tr_b16 a[250:251], v247 offset:29696
    s_waitcnt lgkmcnt(2)
    v_mfma_f32_32x32x16_bf16 a[16:31], a[252:255], a[212:215], a[16:31]
    v_mfma_f32_32x32x16_bf16 a[80:95], a[252:255], v[132:135], a[80:95]
    v_mfma_f32_32x32x16_bf16 a[144:159], a[252:255], v[140:143], a[144:159]
    ds_read_b64_tr_b16 a[252:253], v246 offset:30720
    ds_read_b64_tr_b16 a[254:255], v247 offset:31744
    s_waitcnt lgkmcnt(2)
    v_mfma_f32_32x32x16_bf16 a[16:31], a[248:251], a[216:219], a[16:31]
    v_mfma_f32_32x32x16_bf16 a[80:95], a[248:251], v[144:147], a[80:95]
    v_mfma_f32_32x32x16_bf16 a[144:159], a[248:251], v[152:155], a[144:159]
    ds_read_b64_tr_b16 a[248:249], v246 offset:32768
    ds_read_b64_tr_b16 a[250:251], v247 offset:33792
    s_waitcnt lgkmcnt(2)
    v_mfma_f32_32x32x16_bf16 a[16:31], a[252:255], a[220:223], a[16:31]
    v_mfma_f32_32x32x16_bf16 a[80:95], a[252:255], v[148:151], a[80:95]
    v_mfma_f32_32x32x16_bf16 a[144:159], a[252:255], v[156:159], a[144:159]
    ds_read_b64_tr_b16 a[252:253], v246 offset:34816
    ds_read_b64_tr_b16 a[254:255], v247 offset:35840
    s_waitcnt lgkmcnt(2)
    v_mfma_f32_32x32x16_bf16 a[16:31], a[248:251], a[224:227], a[16:31]
    v_mfma_f32_32x32x16_bf16 a[80:95], a[248:251], v[160:163], a[80:95]
    v_mfma_f32_32x32x16_bf16 a[144:159], a[248:251], v[168:171], a[144:159]
    ds_read_b64_tr_b16 a[248:249], v246 offset:36864
    ds_read_b64_tr_b16 a[250:251], v247 offset:37888
    s_waitcnt lgkmcnt(2)
    v_mfma_f32_32x32x16_bf16 a[16:31], a[252:255], a[228:231], a[16:31]
    v_mfma_f32_32x32x16_bf16 a[80:95], a[252:255], v[164:167], a[80:95]
    v_mfma_f32_32x32x16_bf16 a[144:159], a[252:255], v[172:175], a[144:159]
    ds_read_b64_tr_b16 a[252:253], v246 offset:38912
    ds_read_b64_tr_b16 a[254:255], v247 offset:39936
    s_waitcnt lgkmcnt(2)
    v_mfma_f32_32x32x16_bf16 a[16:31], a[248:251], a[232:235], a[16:31]
    v_mfma_f32_32x32x16_bf16 a[80:95], a[248:251], v[176:179], a[80:95]
    v_mfma_f32_32x32x16_bf16 a[144:159], a[248:251], v[184:187], a[144:159]
    ds_read_b64_tr_b16 a[248:249], v246 offset:40960
    ds_read_b64_tr_b16 a[250:251], v247 offset:41984
    s_waitcnt lgkmcnt(2)
    v_mfma_f32_32x32x16_bf16 a[16:31], a[252:255], a[236:239], a[16:31]
    v_mfma_f32_32x32x16_bf16 a[80:95], a[252:255], v[180:183], a[80:95]
    v_mfma_f32_32x32x16_bf16 a[144:159], a[252:255], v[188:191], a[144:159]
    ds_read_b64_tr_b16 a[252:253], v246 offset:43008
    ds_read_b64_tr_b16 a[254:255], v247 offset:44032
    s_waitcnt lgkmcnt(2)
    v_mfma_f32_32x32x16_bf16 a[16:31], a[248:251], a[240:243], a[16:31]
    v_mfma_f32_32x32x16_bf16 a[80:95], a[248:251], v[192:195], a[80:95]
    v_mfma_f32_32x32x16_bf16 a[144:159], a[248:251], v[200:203], a[144:159]
    ds_read_b64_tr_b16 a[248:249], v246 offset:45056
    ds_read_b64_tr_b16 a[250:251], v247 offset:46080
    s_waitcnt lgkmcnt(2)
    v_mfma_f32_32x32x16_bf16 a[16:31], a[252:255], a[244:247], a[16:31]
    v_mfma_f32_32x32x16_bf16 a[80:95], a[252:255], v[196:199], a[80:95]
    v_mfma_f32_32x32x16_bf16 a[144:159], a[252:255], v[204:207], a[144:159]
    ds_read_b64_tr_b16 a[252:253], v246 offset:47104
    ds_read_b64_tr_b16 a[254:255], v247 offset:48128
    s_waitcnt lgkmcnt(2)
    v_mfma_f32_32x32x16_bf16 a[16:31], a[248:251], v[208:211], a[16:31]
    v_mfma_f32_32x32x16_bf16 a[80:95], a[248:251], v[216:219], a[80:95]
    v_mfma_f32_32x32x16_bf16 a[144:159], a[248:251], v[224:227], a[144:159]
    v_add_u32 v244, 49152, v244
    v_add_u32 v245, 49152, v245
    v_add_u32 v246, 49152, v246
    v_add_u32 v247, 49152, v247
    ds_read_b64_tr_b16 a[248:249], v244 offset:32768
    ds_read_b64_tr_b16 a[250:251], v245 offset:33792
    s_waitcnt lgkmcnt(2)
    v_mfma_f32_32x32x16_bf16 a[16:31], a[252:255], v[212:215], a[16:31]
    v_mfma_f32_32x32x16_bf16 a[80:95], a[252:255], v[220:223], a[80:95]
    v_mfma_f32_32x32x16_bf16 a[144:159], a[252:255], v[228:231], a[144:159]
    ds_read_b64_tr_b16 a[252:253], v244 offset:34816
    ds_read_b64_tr_b16 a[254:255], v245 offset:35840
    v_add_u32 v255, 98304, v250
    v_add_u32 v241, 98304, v251
    s_waitcnt lgkmcnt(2)
    v_mfma_f32_32x32x16_bf16 a[32:47], a[248:251], a[160:163], 0
    v_mfma_f32_32x32x16_bf16 a[96:111], a[248:251], v[32:35], 0
    v_mfma_f32_32x32x16_bf16 v[0:15], a[248:251], v[40:43], 0
    ds_read_b64_tr_b16 a[248:249], v246 offset:32768
    ds_read_b64_tr_b16 a[250:251], v247 offset:33792
    s_waitcnt lgkmcnt(2)
    v_mfma_f32_32x32x16_bf16 a[32:47], a[252:255], a[164:167], a[32:47]
    v_mfma_f32_32x32x16_bf16 a[96:111], a[252:255], v[36:39], a[96:111]
    v_mfma_f32_32x32x16_bf16 v[0:15], a[252:255], v[44:47], v[0:15]
    ds_read_b64_tr_b16 a[252:253], v246 offset:34816
    ds_read_b64_tr_b16 a[254:255], v247 offset:35840
    s_waitcnt lgkmcnt(2)
    v_mfma_f32_32x32x16_bf16 a[48:63], a[248:251], a[160:163], 0
    s_barrier
    v_mfma_f32_32x32x16_bf16 a[112:127], a[248:251], v[32:35], 0
    s_add_u32 m0, s31, 0
    s_add_u32 s35, s29, 69888
    buffer_load_dwordx4 v252, s[8:11], s35 offen nt lds
    v_accvgpr_read_b32 v232, a0
    v_accvgpr_read_b32 v233, a1
    v_mfma_f32_32x32x16_bf16 v[16:31], a[248:251], v[40:43], 0
    ds_read_b64_tr_b16 a[248:249], v244 offset:36864
    ds_read_b64_tr_b16 a[250:251], v245 offset:37888
    s_add_u32 m0, s31, 16384
    s_add_u32 s35, s29, 70016
    buffer_load_dwordx4 v252, s[8:11], s35 offen nt lds
    s_waitcnt lgkmcnt(2)
    v_mfma_f32_32x32x16_bf16 a[48:63], a[252:255], a[164:167], a[48:63]
    s_add_u32 m0, s31, 0
    s_add_u32 s35, s29, 72960
    buffer_load_dwordx4 v253, s[8:11], s35 offen offset:1024 nt lds
    v_accvgpr_read_b32 v234, a2
    v_accvgpr_read_b32 v235, a3
    v_mfma_f32_32x32x16_bf16 a[112:127], a[252:255], v[36:39], a[112:127]
    s_add_u32 m0, s31, 16384
    s_add_u32 s35, s29, 73088
    buffer_load_dwordx4 v253, s[8:11], s35 offen offset:1024 nt lds
    v_mul_f32 v232, v238, v232
    v_mul_f32 v233, v238, v233
    v_mul_f32 v234, v238, v234
    v_mfma_f32_32x32x16_bf16 v[16:31], a[252:255], v[44:47], v[16:31]
    ds_read_b64_tr_b16 a[252:253], v244 offset:38912
    ds_read_b64_tr_b16 a[254:255], v245 offset:39936
    v_mul_f32 v235, v238, v235
    v_cvt_pk_bf16_f32 v248, v232, v233
    v_cvt_pk_bf16_f32 v249, v234, v235
    s_waitcnt lgkmcnt(2)
    v_mfma_f32_32x32x16_bf16 a[32:47], a[248:251], a[168:171], a[32:47]
    ds_write_b64 v255, v[248:249]
    v_accvgpr_read_b32 v232, a4
    v_accvgpr_read_b32 v233, a5
    v_accvgpr_read_b32 v234, a6
    v_accvgpr_read_b32 v235, a7
    v_mfma_f32_32x32x16_bf16 a[96:111], a[248:251], v[48:51], a[96:111]
    v_mul_f32 v232, v238, v232
    v_mul_f32 v233, v238, v233
    v_mul_f32 v234, v238, v234
    v_mul_f32 v235, v238, v235
    v_xor_b32 v242, 16, v255
    v_cvt_pk_bf16_f32 v248, v232, v233
    v_mfma_f32_32x32x16_bf16 v[0:15], a[248:251], v[56:59], v[0:15]
    ds_read_b64_tr_b16 a[248:249], v246 offset:36864
    ds_read_b64_tr_b16 a[250:251], v247 offset:37888
    v_cvt_pk_bf16_f32 v249, v234, v235
    ds_write_b64 v242, v[248:249]
    v_accvgpr_read_b32 v232, a8
    s_waitcnt lgkmcnt(4)
    v_mfma_f32_32x32x16_bf16 a[32:47], a[252:255], a[172:175], a[32:47]
    s_add_u32 m0, s31, 0
    s_add_u32 s35, s29, 76032
    buffer_load_dwordx4 v252, s[8:11], s35 offen offset:2048 nt lds
    v_accvgpr_read_b32 v233, a9
    v_accvgpr_read_b32 v234, a10
    v_mfma_f32_32x32x16_bf16 a[96:111], a[252:255], v[52:55], a[96:111]
    s_add_u32 m0, s31, 16384
    s_add_u32 s35, s29, 76160
    buffer_load_dwordx4 v252, s[8:11], s35 offen offset:2048 nt lds
    v_accvgpr_read_b32 v235, a11
    v_mul_f32 v232, v238, v232
    v_mfma_f32_32x32x16_bf16 v[0:15], a[252:255], v[60:63], v[0:15]
    ds_read_b64_tr_b16 a[252:253], v246 offset:38912
    ds_read_b64_tr_b16 a[254:255], v247 offset:39936
    s_add_u32 m0, s31, 0
    s_add_u32 s35, s29, 79104
    buffer_load_dwordx4 v253, s[8:11], s35 offen offset:3072 nt lds
    s_waitcnt lgkmcnt(3)
    v_mfma_f32_32x32x16_bf16 a[48:63], a[248:251], a[168:171], a[48:63]
    s_add_u32 m0, s31, 16384
    s_add_u32 s35, s29, 79232
    buffer_load_dwordx4 v253, s[8:11], s35 offen offset:3072 nt lds
    v_mul_f32 v233, v238, v233
    v_mul_f32 v234, v238, v234
    v_mul_f32 v235, v238, v235
    v_mfma_f32_32x32x16_bf16 a[112:127], a[248:251], v[48:51], a[112:127]
    v_xor_b32 v242, 32, v255
    v_cvt_pk_bf16_f32 v248, v232, v233
    v_cvt_pk_bf16_f32 v249, v234, v235
    ds_write_b64 v242, v[248:249]
    v_accvgpr_read_b32 v232, a12
    v_mfma_f32_32x32x16_bf16 v[16:31], a[248:251], v[56:59], v[16:31]
    ds_read_b64_tr_b16 a[248:249], v244 offset:40960
    ds_read_b64_tr_b16 a[250:251], v245 offset:41984
    v_accvgpr_read_b32 v233, a13
    v_accvgpr_read_b32 v234, a14
    v_accvgpr_read_b32 v235, a15
    s_waitcnt lgkmcnt(3)
    v_mfma_f32_32x32x16_bf16 a[48:63], a[252:255], a[172:175], a[48:63]
    v_mul_f32 v232, v238, v232
    v_mul_f32 v233, v238, v233
    v_mul_f32 v234, v238, v234
    v_mul_f32 v235, v238, v235
    v_xor_b32 v242, 48, v255
    v_cvt_pk_bf16_f32 v248, v232, v233
    v_mfma_f32_32x32x16_bf16 a[112:127], a[252:255], v[52:55], a[112:127]
    v_cvt_pk_bf16_f32 v249, v234, v235
    ds_write_b64 v242, v[248:249]
    v_accvgpr_read_b32 v232, a16
    v_accvgpr_read_b32 v233, a17
    v_accvgpr_read_b32 v234, a18
    v_mfma_f32_32x32x16_bf16 v[16:31], a[252:255], v[60:63], v[16:31]
    ds_read_b64_tr_b16 a[252:253], v244 offset:43008
    ds_read_b64_tr_b16 a[254:255], v245 offset:44032
    v_accvgpr_read_b32 v235, a19
    v_mul_f32 v232, v238, v232
    v_mul_f32 v233, v238, v233
    s_waitcnt lgkmcnt(3)
    v_mfma_f32_32x32x16_bf16 a[32:47], a[248:251], a[176:179], a[32:47]
    s_add_u32 s35, s29, 69632
    buffer_load_dwordx4 a[160:163], v252, s[8:11], s35 offen nt
    v_mul_f32 v234, v238, v234
    v_mul_f32 v235, v238, v235
    v_xor_b32 v242, 64, v255
    v_cvt_pk_bf16_f32 v248, v232, v233
    v_mfma_f32_32x32x16_bf16 a[96:111], a[248:251], v[64:67], a[96:111]
    s_add_u32 s35, s29, 69632
    buffer_load_dwordx4 v[40:43], v252, s[8:11], s35 offen offset:128 nt
    v_cvt_pk_bf16_f32 v249, v234, v235
    ds_write_b64 v242, v[248:249]
    v_accvgpr_read_b32 v232, a20
    v_mfma_f32_32x32x16_bf16 v[0:15], a[248:251], v[72:75], v[0:15]
    ds_read_b64_tr_b16 a[248:249], v246 offset:40960
    ds_read_b64_tr_b16 a[250:251], v247 offset:41984
    s_add_u32 s35, s29, 73728
    buffer_load_dwordx4 a[164:167], v253, s[8:11], s35 offen nt
    v_accvgpr_read_b32 v233, a21
    s_waitcnt lgkmcnt(3)
    v_mfma_f32_32x32x16_bf16 a[32:47], a[252:255], a[180:183], a[32:47]
    s_add_u32 s35, s29, 73728
    buffer_load_dwordx4 v[44:47], v253, s[8:11], s35 offen offset:128 nt
    v_accvgpr_read_b32 v234, a22
    v_accvgpr_read_b32 v235, a23
    v_mul_f32 v232, v238, v232
    v_mfma_f32_32x32x16_bf16 a[96:111], a[252:255], v[68:71], a[96:111]
    v_mul_f32 v233, v238, v233
    v_mul_f32 v234, v238, v234
    v_mul_f32 v235, v238, v235
    v_xor_b32 v242, 80, v255
    v_cvt_pk_bf16_f32 v248, v232, v233
    v_cvt_pk_bf16_f32 v249, v234, v235
    v_mfma_f32_32x32x16_bf16 v[0:15], a[252:255], v[76:79], v[0:15]
    ds_read_b64_tr_b16 a[252:253], v246 offset:43008
    ds_read_b64_tr_b16 a[254:255], v247 offset:44032
    ds_write_b64 v242, v[248:249]
    v_accvgpr_read_b32 v232, a24
    v_accvgpr_read_b32 v233, a25
    s_waitcnt lgkmcnt(3)
    v_mfma_f32_32x32x16_bf16 a[48:63], a[248:251], a[176:179], a[48:63]
    v_accvgpr_read_b32 v234, a26
    v_accvgpr_read_b32 v235, a27
    v_mul_f32 v232, v238, v232
    v_mul_f32 v233, v238, v233
    v_mul_f32 v234, v238, v234
    v_mfma_f32_32x32x16_bf16 a[112:127], a[248:251], v[64:67], a[112:127]
    v_mul_f32 v235, v238, v235
    v_xor_b32 v242, 96, v255
    v_cvt_pk_bf16_f32 v248, v232, v233
    v_cvt_pk_bf16_f32 v249, v234, v235
    ds_write_b64 v242, v[248:249]
    v_mfma_f32_32x32x16_bf16 v[16:31], a[248:251], v[72:75], v[16:31]
    ds_read_b64_tr_b16 a[248:249], v244 offset:45056
    ds_read_b64_tr_b16 a[250:251], v245 offset:46080
    s_add_u32 s35, s29, 77824
    buffer_load_dwordx4 v[32:35], v252, s[8:11], s35 offen nt
    v_accvgpr_read_b32 v232, a28
    s_waitcnt lgkmcnt(4)
    v_mfma_f32_32x32x16_bf16 a[48:63], a[252:255], a[180:183], a[48:63]
    s_add_u32 s35, s29, 77824
    buffer_load_dwordx4 a[168:171], v252, s[8:11], s35 offen offset:128 nt
    v_accvgpr_read_b32 v233, a29
    v_accvgpr_read_b32 v234, a30
    v_accvgpr_read_b32 v235, a31
    v_mfma_f32_32x32x16_bf16 a[112:127], a[252:255], v[68:71], a[112:127]
    s_add_u32 s35, s29, 81920
    buffer_load_dwordx4 v[36:39], v253, s[8:11], s35 offen nt
    v_mul_f32 v232, v238, v232
    v_mul_f32 v233, v238, v233
    v_mul_f32 v234, v238, v234
    v_mul_f32 v235, v238, v235
    v_mfma_f32_32x32x16_bf16 v[16:31], a[252:255], v[76:79], v[16:31]
    ds_read_b64_tr_b16 a[252:253], v244 offset:47104
    ds_read_b64_tr_b16 a[254:255], v245 offset:48128
    s_add_u32 s35, s29, 81920
    buffer_load_dwordx4 a[172:175], v253, s[8:11], s35 offen offset:128 nt
    v_xor_b32 v242, 112, v255
    s_waitcnt lgkmcnt(2)
    v_mfma_f32_32x32x16_bf16 a[32:47], a[248:251], a[184:187], a[32:47]
    v_cvt_pk_bf16_f32 v248, v232, v233
    v_cvt_pk_bf16_f32 v249, v234, v235
    ds_write_b64 v242, v[248:249]
    v_mfma_f32_32x32x16_bf16 a[96:111], a[248:251], v[80:83], a[96:111]
    v_mfma_f32_32x32x16_bf16 v[0:15], a[248:251], v[88:91], v[0:15]
    ds_read_b64_tr_b16 a[248:249], v246 offset:45056
    ds_read_b64_tr_b16 a[250:251], v247 offset:46080
    s_waitcnt lgkmcnt(3)
    v_mfma_f32_32x32x16_bf16 a[32:47], a[252:255], a[188:191], a[32:47]
    v_mfma_f32_32x32x16_bf16 a[96:111], a[252:255], v[84:87], a[96:111]
    s_add_u32 s35, s29, 86016
    buffer_load_dwordx4 v[48:51], v252, s[8:11], s35 offen nt
    v_mfma_f32_32x32x16_bf16 v[0:15], a[252:255], v[92:95], v[0:15]
    ds_read_b64_tr_b16 a[252:253], v246 offset:47104
    ds_read_b64_tr_b16 a[254:255], v247 offset:48128
    s_add_u32 s35, s29, 86016
    buffer_load_dwordx4 a[176:179], v252, s[8:11], s35 offen offset:128 nt
    s_waitcnt lgkmcnt(2)
    v_mfma_f32_32x32x16_bf16 a[48:63], a[248:251], a[184:187], a[48:63]
    s_add_u32 s35, s29, 90112
    buffer_load_dwordx4 v[52:55], v253, s[8:11], s35 offen nt
    v_mfma_f32_32x32x16_bf16 a[112:127], a[248:251], v[80:83], a[112:127]
    s_add_u32 s35, s29, 90112
    buffer_load_dwordx4 a[180:183], v253, s[8:11], s35 offen offset:128 nt
    v_mfma_f32_32x32x16_bf16 v[16:31], a[248:251], v[88:91], v[16:31]
    ds_read_b64_tr_b16 a[248:249], v244 offset:28672
    ds_read_b64_tr_b16 a[250:251], v245 offset:29696
    s_waitcnt lgkmcnt(2)
    v_mfma_f32_32x32x16_bf16 a[48:63], a[252:255], a[188:191], a[48:63]
    v_mfma_f32_32x32x16_bf16 a[112:127], a[252:255], v[84:87], a[112:127]
    v_mfma_f32_32x32x16_bf16 v[16:31], a[252:255], v[92:95], v[16:31]
    ds_read_b64_tr_b16 a[252:253], v244 offset:30720
    ds_read_b64_tr_b16 a[254:255], v245 offset:31744
    s_waitcnt lgkmcnt(2)
    v_mfma_f32_32x32x16_bf16 a[32:47], a[248:251], v[208:211], a[32:47]
    s_add_u32 s35, s29, 94208
    buffer_load_dwordx4 v[56:59], v252, s[8:11], s35 offen nt
    v_mfma_f32_32x32x16_bf16 a[96:111], a[248:251], v[216:219], a[96:111]
    s_add_u32 s35, s29, 94208
    buffer_load_dwordx4 v[64:67], v252, s[8:11], s35 offen offset:128 nt
    v_mfma_f32_32x32x16_bf16 v[0:15], a[248:251], v[224:227], v[0:15]
    ds_read_b64_tr_b16 a[248:249], v246 offset:28672
    ds_read_b64_tr_b16 a[250:251], v247 offset:29696
    s_add_u32 s35, s29, 98304
    buffer_load_dwordx4 v[60:63], v253, s[8:11], s35 offen nt
    s_waitcnt lgkmcnt(2)
    v_mfma_f32_32x32x16_bf16 a[32:47], a[252:255], v[212:215], a[32:47]
    s_add_u32 s35, s29, 98304
    buffer_load_dwordx4 v[68:71], v253, s[8:11], s35 offen offset:128 nt
    v_mfma_f32_32x32x16_bf16 a[96:111], a[252:255], v[220:223], a[96:111]
    v_mfma_f32_32x32x16_bf16 v[0:15], a[252:255], v[228:231], v[0:15]
    ds_read_b64_tr_b16 a[252:253], v246 offset:30720
    ds_read_b64_tr_b16 a[254:255], v247 offset:31744
    s_waitcnt lgkmcnt(2)
    v_mfma_f32_32x32x16_bf16 a[48:63], a[248:251], v[208:211], a[48:63]
    s_barrier
    v_mfma_f32_32x32x16_bf16 a[112:127], a[248:251], v[216:219], a[112:127]
    v_mfma_f32_32x32x16_bf16 v[16:31], a[248:251], v[224:227], v[16:31]
    ds_read_b64_tr_b16 a[248:249], v244 offset:24576
    ds_read_b64_tr_b16 a[250:251], v245 offset:25600
    s_add_u32 s35, s75, 4096
    buffer_load_dwordx4 v[72:75], v252, s[8:11], s35 offen nt
    s_waitcnt lgkmcnt(2)
    v_mfma_f32_32x32x16_bf16 a[48:63], a[252:255], v[212:215], a[48:63]
    s_add_u32 s35, s75, 4096
    buffer_load_dwordx4 v[80:83], v252, s[8:11], s35 offen offset:128 nt
    v_mfma_f32_32x32x16_bf16 a[112:127], a[252:255], v[220:223], a[112:127]
    s_add_u32 s35, s75, 12288
    buffer_load_dwordx4 v[76:79], v253, s[8:11], s35 offen nt
    v_mfma_f32_32x32x16_bf16 v[16:31], a[252:255], v[228:231], v[16:31]
    ds_read_b64_tr_b16 a[252:253], v244 offset:26624
    ds_read_b64_tr_b16 a[254:255], v245 offset:27648
    s_add_u32 s35, s75, 12288
    buffer_load_dwordx4 v[84:87], v253, s[8:11], s35 offen offset:128 nt
    s_waitcnt lgkmcnt(2)
    v_mfma_f32_32x32x16_bf16 a[32:47], a[248:251], a[240:243], a[32:47]
    ds_read_b128 v[208:211], v241
    ds_read_b128 v[212:215], v241 offset:1024
    ds_read_b128 v[216:219], v241 offset:2048
    ds_read_b128 v[220:223], v241 offset:3072
    v_accvgpr_read_b32 v232, a64
    v_mfma_f32_32x32x16_bf16 a[96:111], a[248:251], v[192:195], a[96:111]
    v_accvgpr_read_b32 v233, a65
    v_accvgpr_read_b32 v234, a66
    v_accvgpr_read_b32 v235, a67
    v_mul_f32 v232, v239, v232
    v_mul_f32 v233, v239, v233
    v_mfma_f32_32x32x16_bf16 v[0:15], a[248:251], v[200:203], v[0:15]
    ds_read_b64_tr_b16 a[248:249], v246 offset:24576
    ds_read_b64_tr_b16 a[250:251], v247 offset:25600
    v_mul_f32 v234, v239, v234
    v_mul_f32 v235, v239, v235
    v_cvt_pk_bf16_f32 v248, v232, v233
    s_waitcnt lgkmcnt(6)
    v_mfma_f32_32x32x16_bf16 a[32:47], a[252:255], a[244:247], a[32:47]
    v_cvt_pk_bf16_f32 v249, v234, v235
    ds_write_b64 v255, v[248:249]
    v_accvgpr_read_b32 v232, a68
    v_accvgpr_read_b32 v233, a69
    v_accvgpr_read_b32 v234, a70
    v_mfma_f32_32x32x16_bf16 a[96:111], a[252:255], v[196:199], a[96:111]
    s_add_u32 s35, s75, 20480
    buffer_load_dwordx4 a[184:187], v252, s[8:11], s35 offen nt
    v_accvgpr_read_b32 v235, a71
    v_mul_f32 v232, v239, v232
    v_mul_f32 v233, v239, v233
    v_mfma_f32_32x32x16_bf16 v[0:15], a[252:255], v[204:207], v[0:15]
    ds_read_b64_tr_b16 a[252:253], v246 offset:26624
    ds_read_b64_tr_b16 a[254:255], v247 offset:27648
    s_add_u32 s35, s75, 20480
    buffer_load_dwordx4 v[88:91], v252, s[8:11], s35 offen offset:128 nt
    v_mul_f32 v234, v239, v234
    s_waitcnt lgkmcnt(3)
    v_mfma_f32_32x32x16_bf16 a[48:63], a[248:251], a[240:243], a[48:63]
    s_add_u32 s35, s75, 28672
    buffer_load_dwordx4 a[188:191], v253, s[8:11], s35 offen nt
    v_mul_f32 v235, v239, v235
    v_xor_b32 v242, 16, v255
    v_cvt_pk_bf16_f32 v248, v232, v233
    v_mfma_f32_32x32x16_bf16 a[112:127], a[248:251], v[192:195], a[112:127]
    s_add_u32 s35, s75, 28672
    buffer_load_dwordx4 v[92:95], v253, s[8:11], s35 offen offset:128 nt
    v_cvt_pk_bf16_f32 v249, v234, v235
    ds_write_b64 v242, v[248:249]
    v_accvgpr_read_b32 v232, a72
    v_mfma_f32_32x32x16_bf16 v[16:31], a[248:251], v[200:203], v[16:31]
    ds_read_b64_tr_b16 a[248:249], v244 offset:20480
    ds_read_b64_tr_b16 a[250:251], v245 offset:21504
    v_accvgpr_read_b32 v233, a73
    v_accvgpr_read_b32 v234, a74
    v_accvgpr_read_b32 v235, a75
    s_waitcnt lgkmcnt(3)
    v_mfma_f32_32x32x16_bf16 a[48:63], a[252:255], a[244:247], a[48:63]
    v_mul_f32 v232, v239, v232
    v_mul_f32 v233, v239, v233
    v_mul_f32 v234, v239, v234
    v_mul_f32 v235, v239, v235
    v_xor_b32 v242, 32, v255
    v_cvt_pk_bf16_f32 v248, v232, v233
    v_mfma_f32_32x32x16_bf16 a[112:127], a[252:255], v[196:199], a[112:127]
    v_cvt_pk_bf16_f32 v249, v234, v235
    ds_write_b64 v242, v[248:249]
    v_accvgpr_read_b32 v232, a76
    v_accvgpr_read_b32 v233, a77
    v_accvgpr_read_b32 v234, a78
    v_mfma_f32_32x32x16_bf16 v[16:31], a[252:255], v[204:207], v[16:31]
    ds_read_b64_tr_b16 a[252:253], v244 offset:22528
    ds_read_b64_tr_b16 a[254:255], v245 offset:23552
    v_accvgpr_read_b32 v235, a79
    v_mul_f32 v232, v239, v232
    v_mul_f32 v233, v239, v233
    s_waitcnt lgkmcnt(3)
    v_mfma_f32_32x32x16_bf16 a[32:47], a[248:251], a[232:235], a[32:47]
    s_add_u32 m0, s31, 81920
    s_add_u32 s35, s29, 86400
    buffer_load_dwordx4 v252, s[8:11], s35 offen nt lds
    v_mul_f32 v234, v239, v234
    v_mul_f32 v235, v239, v235
    v_xor_b32 v242, 48, v255
    v_mfma_f32_32x32x16_bf16 a[96:111], a[248:251], v[176:179], a[96:111]
    s_add_u32 s35, s29, 89472
    buffer_load_dwordx4 v253, s[8:11], s35 offen offset:1024 nt lds
    v_cvt_pk_bf16_f32 v248, v232, v233
    v_cvt_pk_bf16_f32 v249, v234, v235
    ds_write_b64 v242, v[248:249]
    v_mfma_f32_32x32x16_bf16 v[0:15], a[248:251], v[184:187], v[0:15]
    ds_read_b64_tr_b16 a[248:249], v246 offset:20480
    ds_read_b64_tr_b16 a[250:251], v247 offset:21504
    s_add_u32 s35, s29, 92544
    buffer_load_dwordx4 v252, s[8:11], s35 offen offset:2048 nt lds
    v_accvgpr_read_b32 v232, a80
    s_waitcnt lgkmcnt(3)
    v_mfma_f32_32x32x16_bf16 a[32:47], a[252:255], a[236:239], a[32:47]
    s_add_u32 s35, s29, 95616
    buffer_load_dwordx4 v253, s[8:11], s35 offen offset:3072 nt lds
    v_accvgpr_read_b32 v233, a81
    v_accvgpr_read_b32 v234, a82
    v_accvgpr_read_b32 v235, a83
    v_mfma_f32_32x32x16_bf16 a[96:111], a[252:255], v[180:183], a[96:111]
    v_mul_f32 v232, v239, v232
    v_mul_f32 v233, v239, v233
    v_mul_f32 v234, v239, v234
    v_mul_f32 v235, v239, v235
    v_xor_b32 v242, 64, v255
    v_cvt_pk_bf16_f32 v248, v232, v233
    v_mfma_f32_32x32x16_bf16 v[0:15], a[252:255], v[188:191], v[0:15]
    ds_read_b64_tr_b16 a[252:253], v246 offset:22528
    ds_read_b64_tr_b16 a[254:255], v247 offset:23552
    v_cvt_pk_bf16_f32 v249, v234, v235
    ds_write_b64 v242, v[248:249]
    v_accvgpr_read_b32 v232, a84
    s_waitcnt lgkmcnt(3)
    v_mfma_f32_32x32x16_bf16 a[48:63], a[248:251], a[232:235], a[48:63]
    v_accvgpr_read_b32 v233, a85
    v_accvgpr_read_b32 v234, a86
    v_accvgpr_read_b32 v235, a87
    v_mul_f32 v232, v239, v232
    v_mul_f32 v233, v239, v233
    v_mfma_f32_32x32x16_bf16 a[112:127], a[248:251], v[176:179], a[112:127]
    v_mul_f32 v234, v239, v234
    v_mul_f32 v235, v239, v235
    v_xor_b32 v242, 80, v255
    v_cvt_pk_bf16_f32 v248, v232, v233
    v_cvt_pk_bf16_f32 v249, v234, v235
    v_mfma_f32_32x32x16_bf16 v[16:31], a[248:251], v[184:187], v[16:31]
    ds_read_b64_tr_b16 a[248:249], v244 offset:16384
    ds_read_b64_tr_b16 a[250:251], v245 offset:17408
    ds_write_b64 v242, v[248:249]
    v_accvgpr_read_b32 v232, a88
    v_accvgpr_read_b32 v233, a89
    s_waitcnt lgkmcnt(4)
    v_mfma_f32_32x32x16_bf16 a[48:63], a[252:255], a[236:239], a[48:63]
    v_accvgpr_read_b32 v234, a90
    v_accvgpr_read_b32 v235, a91
    v_mul_f32 v232, v239, v232
    v_mul_f32 v233, v239, v233
    v_mul_f32 v234, v239, v234
    v_mfma_f32_32x32x16_bf16 a[112:127], a[252:255], v[180:183], a[112:127]
    v_mul_f32 v235, v239, v235
    v_xor_b32 v242, 96, v255
    v_cvt_pk_bf16_f32 v248, v232, v233
    v_cvt_pk_bf16_f32 v249, v234, v235
    ds_write_b64 v242, v[248:249]
    v_mfma_f32_32x32x16_bf16 v[16:31], a[252:255], v[188:191], v[16:31]
    ds_read_b64_tr_b16 a[252:253], v244 offset:18432
    ds_read_b64_tr_b16 a[254:255], v245 offset:19456
    v_accvgpr_read_b32 v232, a92
    v_accvgpr_read_b32 v233, a93
    v_accvgpr_read_b32 v234, a94
    s_waitcnt lgkmcnt(4)
    v_mfma_f32_32x32x16_bf16 a[32:47], a[248:251], a[224:227], a[32:47]
    ds_read_b128 a[232:235], v251 offset:32768
    ds_read_b128 a[236:239], v251 offset:33792
    ds_read_b128 v[176:179], v251 offset:34816
    ds_read_b128 v[180:183], v251 offset:35840
    v_accvgpr_read_b32 v235, a95
    v_mfma_f32_32x32x16_bf16 a[96:111], a[248:251], v[160:163], a[96:111]
    s_waitcnt lgkmcnt(0)
    s_add_u32 m0, s30, 32768
    s_add_u32 s35, s25, 69632
    buffer_load_dwordx4 v252, s[12:15], s35 offen nt lds
    v_mul_f32 v232, v239, v232
    v_mul_f32 v233, v239, v233
    v_mfma_f32_32x32x16_bf16 v[0:15], a[248:251], v[168:171], v[0:15]
    ds_read_b64_tr_b16 a[248:249], v246 offset:16384
    ds_read_b64_tr_b16 a[250:251], v247 offset:17408
    s_add_u32 s35, s25, 101376
    buffer_load_dwordx4 v253, s[12:15], s35 offen offset:1024 nt lds
    v_mul_f32 v234, v239, v234
    v_mfma_f32_32x32x16_bf16 a[32:47], a[252:255], a[228:231], a[32:47]
    s_add_u32 s35, s25, 133120
    buffer_load_dwordx4 v252, s[12:15], s35 offen offset:2048 nt lds
    v_mul_f32 v235, v239, v235
    v_xor_b32 v242, 112, v255
    v_cvt_pk_bf16_f32 v248, v232, v233
    v_mfma_f32_32x32x16_bf16 a[96:111], a[252:255], v[164:167], a[96:111]
    v_cvt_pk_bf16_f32 v249, v234, v235
    ds_write_b64 v242, v[248:249]
    ds_read_b128 v[224:227], v241
    ds_read_b128 v[228:231], v241 offset:1024
    ds_read_b128 a[240:243], v241 offset:2048
    v_mfma_f32_32x32x16_bf16 v[0:15], a[252:255], v[172:175], v[0:15]
    ds_read_b64_tr_b16 a[252:253], v246 offset:18432
    ds_read_b64_tr_b16 a[254:255], v247 offset:19456
    ds_read_b128 a[244:247], v241 offset:3072
    v_accvgpr_read_b32 v232, a128
    v_accvgpr_read_b32 v233, a129
    s_waitcnt lgkmcnt(7)
    v_mfma_f32_32x32x16_bf16 a[48:63], a[248:251], a[224:227], a[48:63]
    v_accvgpr_read_b32 v234, a130
    v_accvgpr_read_b32 v235, a131
    v_mul_f32 v232, v240, v232
    v_mul_f32 v233, v240, v233
    v_mul_f32 v234, v240, v234
    v_mfma_f32_32x32x16_bf16 a[112:127], a[248:251], v[160:163], a[112:127]
    v_mul_f32 v235, v240, v235
    v_cvt_pk_bf16_f32 v248, v232, v233
    v_cvt_pk_bf16_f32 v249, v234, v235
    ds_write_b64 v255, v[248:249]
    v_accvgpr_read_b32 v232, a132
    v_mfma_f32_32x32x16_bf16 v[16:31], a[248:251], v[168:171], v[16:31]
    ds_read_b64_tr_b16 a[248:249], v244 offset:12288
    ds_read_b64_tr_b16 a[250:251], v245 offset:13312
    s_add_u32 s35, s25, 164864
    buffer_load_dwordx4 v253, s[12:15], s35 offen offset:3072 nt lds
    v_accvgpr_read_b32 v233, a133
    s_waitcnt lgkmcnt(4)
    v_mfma_f32_32x32x16_bf16 a[48:63], a[252:255], a[228:231], a[48:63]
    v_accvgpr_read_b32 v234, a134
    v_accvgpr_read_b32 v235, a135
    v_mul_f32 v232, v240, v232
    v_mul_f32 v233, v240, v233
    v_mul_f32 v234, v240, v234
    v_mfma_f32_32x32x16_bf16 a[112:127], a[252:255], v[164:167], a[112:127]
    v_mul_f32 v235, v240, v235
    v_xor_b32 v242, 16, v255
    v_cvt_pk_bf16_f32 v248, v232, v233
    v_cvt_pk_bf16_f32 v249, v234, v235
    ds_write_b64 v242, v[248:249]
    v_mfma_f32_32x32x16_bf16 v[16:31], a[252:255], v[172:175], v[16:31]
    ds_read_b64_tr_b16 a[252:253], v244 offset:14336
    ds_read_b64_tr_b16 a[254:255], v245 offset:15360
    v_accvgpr_read_b32 v232, a136
    v_accvgpr_read_b32 v233, a137
    v_accvgpr_read_b32 v234, a138
    s_waitcnt lgkmcnt(3)
    v_mfma_f32_32x32x16_bf16 a[32:47], a[248:251], a[216:219], a[32:47]
    ds_read_b128 v[184:187], v251 offset:49152
    ds_read_b128 v[188:191], v251 offset:50176
    ds_read_b128 a[224:227], v251 offset:51200
    ds_read_b128 a[228:231], v251 offset:52224
    v_accvgpr_read_b32 v235, a139
    v_mfma_f32_32x32x16_bf16 a[96:111], a[248:251], v[144:147], a[96:111]
    s_waitcnt lgkmcnt(0)
    s_add_u32 m0, s30, 49152
    s_add_u32 s35, s25, 73728
    buffer_load_dwordx4 v252, s[12:15], s35 offen nt lds
    v_mul_f32 v232, v240, v232
    v_mul_f32 v233, v240, v233
    v_mfma_f32_32x32x16_bf16 v[0:15], a[248:251], v[152:155], v[0:15]
    ds_read_b64_tr_b16 a[248:249], v246 offset:12288
    ds_read_b64_tr_b16 a[250:251], v247 offset:13312
    s_add_u32 s35, s25, 105472
    buffer_load_dwordx4 v253, s[12:15], s35 offen offset:1024 nt lds
    v_mul_f32 v234, v240, v234
    v_mfma_f32_32x32x16_bf16 a[32:47], a[252:255], a[220:223], a[32:47]
    v_mul_f32 v235, v240, v235
    v_xor_b32 v242, 32, v255
    v_cvt_pk_bf16_f32 v248, v232, v233
    v_cvt_pk_bf16_f32 v249, v234, v235
    ds_write_b64 v242, v[248:249]
    v_mfma_f32_32x32x16_bf16 a[96:111], a[252:255], v[148:151], a[96:111]
    v_accvgpr_read_b32 v232, a140
    v_accvgpr_read_b32 v233, a141
    v_accvgpr_read_b32 v234, a142
    v_accvgpr_read_b32 v235, a143
    v_mul_f32 v232, v240, v232
    v_mfma_f32_32x32x16_bf16 v[0:15], a[252:255], v[156:159], v[0:15]
    ds_read_b64_tr_b16 a[252:253], v246 offset:14336
    ds_read_b64_tr_b16 a[254:255], v247 offset:15360
    v_mul_f32 v233, v240, v233
    v_mul_f32 v234, v240, v234
    v_mul_f32 v235, v240, v235
    s_waitcnt lgkmcnt(3)
    v_mfma_f32_32x32x16_bf16 a[48:63], a[248:251], a[216:219], a[48:63]
    s_barrier
    v_xor_b32 v242, 48, v255
    v_cvt_pk_bf16_f32 v248, v232, v233
    v_cvt_pk_bf16_f32 v249, v234, v235
    ds_write_b64 v242, v[248:249]
    v_mfma_f32_32x32x16_bf16 a[112:127], a[248:251], v[144:147], a[112:127]
    s_add_u32 s35, s25, 137216
    buffer_load_dwordx4 v252, s[12:15], s35 offen offset:2048 nt lds
    v_accvgpr_read_b32 v232, a144
    v_accvgpr_read_b32 v233, a145
    v_accvgpr_read_b32 v234, a146
    v_mfma_f32_32x32x16_bf16 v[16:31], a[248:251], v[152:155], v[16:31]
    ds_read_b64_tr_b16 a[248:249], v244 offset:8192
    ds_read_b64_tr_b16 a[250:251], v245 offset:9216
    s_add_u32 s35, s25, 168960
    buffer_load_dwordx4 v253, s[12:15], s35 offen offset:3072 nt lds
    v_accvgpr_read_b32 v235, a147
    s_waitcnt lgkmcnt(3)
    v_mfma_f32_32x32x16_bf16 a[48:63], a[252:255], a[220:223], a[48:63]
    ds_read_b128 v[160:163], v251
    ds_read_b128 v[164:167], v251 offset:1024
    ds_read_b128 v[168:171], v251 offset:2048
    ds_read_b128 v[172:175], v251 offset:3072
    v_mul_f32 v232, v240, v232
    v_mfma_f32_32x32x16_bf16 a[112:127], a[252:255], v[148:151], a[112:127]
    s_waitcnt lgkmcnt(0)
    s_add_u32 m0, s30, 0
    s_add_u32 s35, s25, 77824
    buffer_load_dwordx4 v252, s[12:15], s35 offen nt lds
    v_mul_f32 v233, v240, v233
    v_mul_f32 v234, v240, v234
    v_mfma_f32_32x32x16_bf16 v[16:31], a[252:255], v[156:159], v[16:31]
    ds_read_b64_tr_b16 a[252:253], v244 offset:10240
    ds_read_b64_tr_b16 a[254:255], v245 offset:11264
    v_mul_f32 v235, v240, v235
    v_xor_b32 v242, 64, v255
    v_cvt_pk_bf16_f32 v248, v232, v233
    v_mfma_f32_32x32x16_bf16 a[32:47], a[248:251], a[208:211], a[32:47]
    v_cvt_pk_bf16_f32 v249, v234, v235
    ds_write_b64 v242, v[248:249]
    v_accvgpr_read_b32 v232, a148
    v_accvgpr_read_b32 v233, a149
    v_accvgpr_read_b32 v234, a150
    v_mfma_f32_32x32x16_bf16 a[96:111], a[248:251], v[128:131], a[96:111]
    v_accvgpr_read_b32 v235, a151
    v_mul_f32 v232, v240, v232
    v_mul_f32 v233, v240, v233
    v_mul_f32 v234, v240, v234
    v_mul_f32 v235, v240, v235
    v_xor_b32 v242, 80, v255
    v_mfma_f32_32x32x16_bf16 v[0:15], a[248:251], v[136:139], v[0:15]
    ds_read_b64_tr_b16 a[248:249], v246 offset:8192
    ds_read_b64_tr_b16 a[250:251], v247 offset:9216
    v_cvt_pk_bf16_f32 v248, v232, v233
    v_cvt_pk_bf16_f32 v249, v234, v235
    ds_write_b64 v242, v[248:249]
    s_waitcnt lgkmcnt(4)
    v_mfma_f32_32x32x16_bf16 a[32:47], a[252:255], a[212:215], a[32:47]
    s_add_u32 s35, s25, 109568
    buffer_load_dwordx4 v253, s[12:15], s35 offen offset:1024 nt lds
    v_accvgpr_read_b32 v232, a152
    v_accvgpr_read_b32 v233, a153
    v_accvgpr_read_b32 v234, a154
    v_mfma_f32_32x32x16_bf16 a[96:111], a[252:255], v[132:135], a[96:111]
    s_add_u32 s35, s25, 141312
    buffer_load_dwordx4 v252, s[12:15], s35 offen offset:2048 nt lds
    v_accvgpr_read_b32 v235, a155
    v_mul_f32 v232, v240, v232
    v_mul_f32 v233, v240, v233
    v_mfma_f32_32x32x16_bf16 v[0:15], a[252:255], v[140:143], v[0:15]
    ds_read_b64_tr_b16 a[252:253], v246 offset:10240
    ds_read_b64_tr_b16 a[254:255], v247 offset:11264
    s_add_u32 s35, s25, 173056
    buffer_load_dwordx4 v253, s[12:15], s35 offen offset:3072 nt lds
    v_mul_f32 v234, v240, v234
    s_waitcnt lgkmcnt(3)
    v_mfma_f32_32x32x16_bf16 a[48:63], a[248:251], a[208:211], a[48:63]
    ds_read_b128 a[216:219], v251 offset:16384
    ds_read_b128 a[220:223], v251 offset:17408
    ds_read_b128 v[144:147], v251 offset:18432
    ds_read_b128 v[148:151], v251 offset:19456
    v_mul_f32 v235, v240, v235
    v_mfma_f32_32x32x16_bf16 a[112:127], a[248:251], v[128:131], a[112:127]
    v_xor_b32 v242, 96, v255
    v_cvt_pk_bf16_f32 v248, v232, v233
    v_cvt_pk_bf16_f32 v249, v234, v235
    ds_write_b64 v242, v[248:249]
    v_accvgpr_read_b32 v232, a156
    v_mfma_f32_32x32x16_bf16 v[16:31], a[248:251], v[136:139], v[16:31]
    ds_read_b64_tr_b16 a[248:249], v244 offset:4096
    ds_read_b64_tr_b16 a[250:251], v245 offset:5120
    v_accvgpr_read_b32 v233, a157
    v_accvgpr_read_b32 v234, a158
    v_accvgpr_read_b32 v235, a159
    s_waitcnt lgkmcnt(7)
    v_mfma_f32_32x32x16_bf16 a[48:63], a[252:255], a[212:215], a[48:63]
    v_mul_f32 v232, v240, v232
    v_mul_f32 v233, v240, v233
    v_mul_f32 v234, v240, v234
    v_mul_f32 v235, v240, v235
    v_xor_b32 v242, 112, v255
    v_cvt_pk_bf16_f32 v248, v232, v233
    v_mfma_f32_32x32x16_bf16 a[112:127], a[252:255], v[132:135], a[112:127]
    v_cvt_pk_bf16_f32 v249, v234, v235
    ds_write_b64 v242, v[248:249]
    ds_read_b128 v[192:195], v241
    ds_read_b128 v[196:199], v241 offset:1024
    ds_read_b128 v[200:203], v241 offset:2048
    v_mfma_f32_32x32x16_bf16 v[16:31], a[252:255], v[140:143], v[16:31]
    ds_read_b64_tr_b16 a[252:253], v244 offset:6144
    ds_read_b64_tr_b16 a[254:255], v245 offset:7168
    s_waitcnt lgkmcnt(9)
    s_add_u32 m0, s30, 16384
    s_add_u32 s35, s25, 81920
    buffer_load_dwordx4 v252, s[12:15], s35 offen nt lds
    s_waitcnt lgkmcnt(6)
    v_mfma_f32_32x32x16_bf16 a[32:47], a[248:251], a[200:203], a[32:47]
    s_add_u32 s35, s25, 113664
    buffer_load_dwordx4 v253, s[12:15], s35 offen offset:1024 nt lds
    ds_read_b128 v[204:207], v241 offset:3072
    s_waitcnt lgkmcnt(0)
    s_add_u32 m0, s31, 32768
    s_add_u32 s35, s29, 86272
    buffer_load_dwordx4 v252, s[8:11], s35 offen nt lds
    v_mfma_f32_32x32x16_bf16 a[96:111], a[248:251], v[112:115], a[96:111]
    s_add_u32 m0, s30, 16384
    s_add_u32 s35, s25, 145408
    buffer_load_dwordx4 v252, s[12:15], s35 offen offset:2048 nt lds
    s_add_u32 m0, s31, 32768
    s_add_u32 s35, s29, 89344
    buffer_load_dwordx4 v253, s[8:11], s35 offen offset:1024 nt lds
    v_mfma_f32_32x32x16_bf16 v[0:15], a[248:251], v[120:123], v[0:15]
    ds_read_b64_tr_b16 a[248:249], v246 offset:4096
    ds_read_b64_tr_b16 a[250:251], v247 offset:5120
    s_add_u32 m0, s30, 16384
    s_add_u32 s35, s25, 177152
    buffer_load_dwordx4 v253, s[12:15], s35 offen offset:3072 nt lds
    v_mfma_f32_32x32x16_bf16 a[32:47], a[252:255], a[204:207], a[32:47]
    s_add_u32 m0, s31, 32768
    s_add_u32 s35, s29, 92416
    s_waitcnt vmcnt(60)
    buffer_load_dwordx4 v252, s[8:11], s35 offen offset:2048 nt lds
    s_add_u32 s35, s29, 95488
    buffer_load_dwordx4 v253, s[8:11], s35 offen offset:3072 nt lds
    v_mfma_f32_32x32x16_bf16 a[96:111], a[252:255], v[116:119], a[96:111]
    s_add_u32 m0, s31, 65536
    s_add_u32 s35, s75, 4352
    s_waitcnt vmcnt(60)
    buffer_load_dwordx4 v252, s[8:11], s35 offen nt lds
    s_add_u32 s35, s75, 11520
    buffer_load_dwordx4 v253, s[8:11], s35 offen offset:1024 nt lds
    v_mfma_f32_32x32x16_bf16 v[0:15], a[252:255], v[124:127], v[0:15]
    ds_read_b64_tr_b16 a[252:253], v246 offset:6144
    ds_read_b64_tr_b16 a[254:255], v247 offset:7168
    s_add_u32 s35, s75, 18688
    s_waitcnt vmcnt(60)
    buffer_load_dwordx4 v252, s[8:11], s35 offen offset:2048 nt lds
    s_waitcnt lgkmcnt(2)
    v_mfma_f32_32x32x16_bf16 a[48:63], a[248:251], a[200:203], a[48:63]
    s_add_u32 s35, s75, 25856
    buffer_load_dwordx4 v253, s[8:11], s35 offen offset:3072 nt lds
    v_mfma_f32_32x32x16_bf16 a[112:127], a[248:251], v[112:115], a[112:127]
    v_mfma_f32_32x32x16_bf16 v[16:31], a[248:251], v[120:123], v[16:31]
    ds_read_b64_tr_b16 a[248:249], v244
    ds_read_b64_tr_b16 a[250:251], v245 offset:1024
    s_waitcnt lgkmcnt(2)
    v_mfma_f32_32x32x16_bf16 a[48:63], a[252:255], a[204:207], a[48:63]
    v_mfma_f32_32x32x16_bf16 a[112:127], a[252:255], v[116:119], a[112:127]
    v_mfma_f32_32x32x16_bf16 v[16:31], a[252:255], v[124:127], v[16:31]
    ds_read_b64_tr_b16 a[252:253], v244 offset:2048
    ds_read_b64_tr_b16 a[254:255], v245 offset:3072
    s_waitcnt lgkmcnt(2)
    v_mfma_f32_32x32x16_bf16 a[32:47], a[248:251], a[192:195], a[32:47]
    v_mfma_f32_32x32x16_bf16 a[96:111], a[248:251], v[96:99], a[96:111]
    v_mfma_f32_32x32x16_bf16 v[0:15], a[248:251], v[104:107], v[0:15]
    ds_read_b64_tr_b16 a[248:249], v246
    ds_read_b64_tr_b16 a[250:251], v247 offset:1024
    s_waitcnt lgkmcnt(2)
    v_mfma_f32_32x32x16_bf16 a[32:47], a[252:255], a[196:199], a[32:47]
    v_mfma_f32_32x32x16_bf16 a[96:111], a[252:255], v[100:103], a[96:111]
    v_mfma_f32_32x32x16_bf16 v[0:15], a[252:255], v[108:111], v[0:15]
    ds_read_b64_tr_b16 a[252:253], v246 offset:2048
    ds_read_b64_tr_b16 a[254:255], v247 offset:3072
    s_waitcnt lgkmcnt(2)
    v_mfma_f32_32x32x16_bf16 a[48:63], a[248:251], a[192:195], a[48:63]
    v_mfma_f32_32x32x16_bf16 a[112:127], a[248:251], v[96:99], a[112:127]
    v_mfma_f32_32x32x16_bf16 v[16:31], a[248:251], v[104:107], v[16:31]
    s_waitcnt lgkmcnt(0)
    v_mfma_f32_32x32x16_bf16 a[48:63], a[252:255], a[196:199], a[48:63]
    v_mfma_f32_32x32x16_bf16 a[112:127], a[252:255], v[100:103], a[112:127]
    v_mfma_f32_32x32x16_bf16 v[16:31], a[252:255], v[108:111], v[16:31]
    s_waitcnt vmcnt(20)
    s_barrier
    v_mul_f32 v0, v240, v0
    v_mul_f32 v1, v240, v1
    v_mul_f32 v2, v240, v2
    v_mul_f32 v3, v240, v3
    v_cvt_pk_bf16_f32 v248, v0, v1
    v_cvt_pk_bf16_f32 v249, v2, v3
    ds_write_b64 v255, v[248:249] offset:16384
    v_mul_f32 v4, v240, v4
    v_mul_f32 v5, v240, v5
    v_mul_f32 v6, v240, v6
    v_mul_f32 v7, v240, v7
    v_xor_b32 v242, 16, v255
    v_cvt_pk_bf16_f32 v248, v4, v5
    v_cvt_pk_bf16_f32 v249, v6, v7
    ds_write_b64 v242, v[248:249] offset:16384
    v_mul_f32 v8, v240, v8
    v_mul_f32 v9, v240, v9
    v_mul_f32 v10, v240, v10
    v_mul_f32 v11, v240, v11
    v_xor_b32 v242, 32, v255
    v_cvt_pk_bf16_f32 v248, v8, v9
    v_cvt_pk_bf16_f32 v249, v10, v11
    ds_write_b64 v242, v[248:249] offset:16384
    v_mul_f32 v12, v240, v12
    v_mul_f32 v13, v240, v13
    v_mul_f32 v14, v240, v14
    v_mul_f32 v15, v240, v15
    v_xor_b32 v242, 48, v255
    v_cvt_pk_bf16_f32 v248, v12, v13
    v_cvt_pk_bf16_f32 v249, v14, v15
    ds_write_b64 v242, v[248:249] offset:16384
    v_mul_f32 v16, v240, v16
    v_mul_f32 v17, v240, v17
    v_mul_f32 v18, v240, v18
    v_mul_f32 v19, v240, v19
    v_xor_b32 v242, 64, v255
    v_cvt_pk_bf16_f32 v248, v16, v17
    v_cvt_pk_bf16_f32 v249, v18, v19
    ds_write_b64 v242, v[248:249] offset:16384
    v_mul_f32 v20, v240, v20
    v_mul_f32 v21, v240, v21
    v_mul_f32 v22, v240, v22
    v_mul_f32 v23, v240, v23
    v_xor_b32 v242, 80, v255
    v_cvt_pk_bf16_f32 v248, v20, v21
    v_cvt_pk_bf16_f32 v249, v22, v23
    ds_write_b64 v242, v[248:249] offset:16384
    v_mul_f32 v24, v240, v24
    v_mul_f32 v25, v240, v25
    v_mul_f32 v26, v240, v26
    v_mul_f32 v27, v240, v27
    v_xor_b32 v242, 96, v255
    v_cvt_pk_bf16_f32 v248, v24, v25
    v_cvt_pk_bf16_f32 v249, v26, v27
    ds_write_b64 v242, v[248:249] offset:16384
    v_mul_f32 v28, v240, v28
    v_mul_f32 v29, v240, v29
    v_mul_f32 v30, v240, v30
    v_mul_f32 v31, v240, v31
    v_xor_b32 v242, 112, v255
    v_cvt_pk_bf16_f32 v248, v28, v29
    v_cvt_pk_bf16_f32 v249, v30, v31
    ds_write_b64 v242, v[248:249] offset:16384
    ds_read_b128 a[200:203], v241 offset:16384
    ds_read_b128 a[204:207], v241 offset:17408
    ds_read_b128 v[112:115], v241 offset:18432
    ds_read_b128 v[116:119], v241 offset:19456
    v_accvgpr_read_b32 v232, a96
    v_accvgpr_read_b32 v233, a97
    v_accvgpr_read_b32 v234, a98
    v_accvgpr_read_b32 v235, a99
    v_mul_f32 v232, v239, v232
    v_mul_f32 v233, v239, v233
    v_mul_f32 v234, v239, v234
    v_mul_f32 v235, v239, v235
    v_cvt_pk_bf16_f32 v248, v232, v233
    v_cvt_pk_bf16_f32 v249, v234, v235
    ds_write_b64 v255, v[248:249] offset:16384
    v_accvgpr_read_b32 v232, a100
    v_accvgpr_read_b32 v233, a101
    v_accvgpr_read_b32 v234, a102
    v_accvgpr_read_b32 v235, a103
    v_mul_f32 v232, v239, v232
    v_mul_f32 v233, v239, v233
    v_mul_f32 v234, v239, v234
    v_mul_f32 v235, v239, v235
    v_xor_b32 v242, 16, v255
    v_cvt_pk_bf16_f32 v248, v232, v233
    v_cvt_pk_bf16_f32 v249, v234, v235
    ds_write_b64 v242, v[248:249] offset:16384
    v_accvgpr_read_b32 v232, a104
    v_accvgpr_read_b32 v233, a105
    v_accvgpr_read_b32 v234, a106
    v_accvgpr_read_b32 v235, a107
    v_mul_f32 v232, v239, v232
    v_mul_f32 v233, v239, v233
    v_mul_f32 v234, v239, v234
    v_mul_f32 v235, v239, v235
    v_xor_b32 v242, 32, v255
    v_cvt_pk_bf16_f32 v248, v232, v233
    v_cvt_pk_bf16_f32 v249, v234, v235
    ds_write_b64 v242, v[248:249] offset:16384
    v_accvgpr_read_b32 v232, a108
    v_accvgpr_read_b32 v233, a109
    v_accvgpr_read_b32 v234, a110
    v_accvgpr_read_b32 v235, a111
    v_mul_f32 v232, v239, v232
    v_mul_f32 v233, v239, v233
    v_mul_f32 v234, v239, v234
    v_mul_f32 v235, v239, v235
    v_xor_b32 v242, 48, v255
    v_cvt_pk_bf16_f32 v248, v232, v233
    v_cvt_pk_bf16_f32 v249, v234, v235
    s_waitcnt lgkmcnt(13)
    ds_write_b64 v242, v[248:249] offset:16384
    v_accvgpr_read_b32 v232, a112
    v_accvgpr_read_b32 v233, a113
    v_accvgpr_read_b32 v234, a114
    v_accvgpr_read_b32 v235, a115
    v_mul_f32 v232, v239, v232
    v_mul_f32 v233, v239, v233
    v_mul_f32 v234, v239, v234
    v_mul_f32 v235, v239, v235
    v_xor_b32 v242, 64, v255
    v_cvt_pk_bf16_f32 v248, v232, v233
    v_cvt_pk_bf16_f32 v249, v234, v235
    ds_write_b64 v242, v[248:249] offset:16384
    v_accvgpr_read_b32 v232, a116
    v_accvgpr_read_b32 v233, a117
    v_accvgpr_read_b32 v234, a118
    v_accvgpr_read_b32 v235, a119
    v_mul_f32 v232, v239, v232
    v_mul_f32 v233, v239, v233
    v_mul_f32 v234, v239, v234
    v_mul_f32 v235, v239, v235
    v_xor_b32 v242, 80, v255
    v_cvt_pk_bf16_f32 v248, v232, v233
    v_cvt_pk_bf16_f32 v249, v234, v235
    s_waitcnt lgkmcnt(13)
    ds_write_b64 v242, v[248:249] offset:16384
    v_accvgpr_read_b32 v232, a120
    v_accvgpr_read_b32 v233, a121
    v_accvgpr_read_b32 v234, a122
    v_accvgpr_read_b32 v235, a123
    v_mul_f32 v232, v239, v232
    v_mul_f32 v233, v239, v233
    v_mul_f32 v234, v239, v234
    v_mul_f32 v235, v239, v235
    v_xor_b32 v242, 96, v255
    v_cvt_pk_bf16_f32 v248, v232, v233
    v_cvt_pk_bf16_f32 v249, v234, v235
    ds_write_b64 v242, v[248:249] offset:16384
    v_accvgpr_read_b32 v232, a124
    v_accvgpr_read_b32 v233, a125
    v_accvgpr_read_b32 v234, a126
    v_accvgpr_read_b32 v235, a127
    v_mul_f32 v232, v239, v232
    v_mul_f32 v233, v239, v233
    v_mul_f32 v234, v239, v234
    v_mul_f32 v235, v239, v235
    v_xor_b32 v242, 112, v255
    v_cvt_pk_bf16_f32 v248, v232, v233
    v_cvt_pk_bf16_f32 v249, v234, v235
    s_waitcnt lgkmcnt(13)
    ds_write_b64 v242, v[248:249] offset:16384
    ds_read_b128 v[128:131], v241 offset:16384
    s_waitcnt lgkmcnt(13)
    ds_read_b128 v[132:135], v241 offset:17408
    ds_read_b128 v[136:139], v241 offset:18432
    s_waitcnt lgkmcnt(13)
    ds_read_b128 v[140:143], v241 offset:19456
    v_accvgpr_read_b32 v232, a32
    v_accvgpr_read_b32 v233, a33
    v_accvgpr_read_b32 v234, a34
    v_accvgpr_read_b32 v235, a35
    v_mul_f32 v232, v238, v232
    v_mul_f32 v233, v238, v233
    v_mul_f32 v234, v238, v234
    v_mul_f32 v235, v238, v235
    v_cvt_pk_bf16_f32 v248, v232, v233
    v_cvt_pk_bf16_f32 v249, v234, v235
    ds_write_b64 v255, v[248:249] offset:16384
    v_accvgpr_read_b32 v232, a36
    v_accvgpr_read_b32 v233, a37
    v_accvgpr_read_b32 v234, a38
    v_accvgpr_read_b32 v235, a39
    v_mul_f32 v232, v238, v232
    v_mul_f32 v233, v238, v233
    v_mul_f32 v234, v238, v234
    v_mul_f32 v235, v238, v235
    v_xor_b32 v242, 16, v255
    v_cvt_pk_bf16_f32 v248, v232, v233
    v_cvt_pk_bf16_f32 v249, v234, v235
    s_waitcnt lgkmcnt(13)
    ds_write_b64 v242, v[248:249] offset:16384
    v_accvgpr_read_b32 v232, a40
    v_accvgpr_read_b32 v233, a41
    v_accvgpr_read_b32 v234, a42
    v_accvgpr_read_b32 v235, a43
    v_mul_f32 v232, v238, v232
    v_mul_f32 v233, v238, v233
    v_mul_f32 v234, v238, v234
    v_mul_f32 v235, v238, v235
    v_xor_b32 v242, 32, v255
    v_cvt_pk_bf16_f32 v248, v232, v233
    v_cvt_pk_bf16_f32 v249, v234, v235
    ds_write_b64 v242, v[248:249] offset:16384
    v_accvgpr_read_b32 v232, a44
    v_accvgpr_read_b32 v233, a45
    v_accvgpr_read_b32 v234, a46
    v_accvgpr_read_b32 v235, a47
    v_mul_f32 v232, v238, v232
    v_mul_f32 v233, v238, v233
    v_mul_f32 v234, v238, v234
    v_mul_f32 v235, v238, v235
    v_xor_b32 v242, 48, v255
    v_cvt_pk_bf16_f32 v248, v232, v233
    v_cvt_pk_bf16_f32 v249, v234, v235
    s_waitcnt lgkmcnt(13)
    ds_write_b64 v242, v[248:249] offset:16384
    v_accvgpr_read_b32 v232, a48
    v_accvgpr_read_b32 v233, a49
    v_accvgpr_read_b32 v234, a50
    v_accvgpr_read_b32 v235, a51
    v_mul_f32 v232, v238, v232
    v_mul_f32 v233, v238, v233
    v_mul_f32 v234, v238, v234
    v_mul_f32 v235, v238, v235
    v_xor_b32 v242, 64, v255
    v_cvt_pk_bf16_f32 v248, v232, v233
    v_cvt_pk_bf16_f32 v249, v234, v235
    ds_write_b64 v242, v[248:249] offset:16384
    v_accvgpr_read_b32 v232, a52
    v_accvgpr_read_b32 v233, a53
    v_accvgpr_read_b32 v234, a54
    v_accvgpr_read_b32 v235, a55
    v_mul_f32 v232, v238, v232
    v_mul_f32 v233, v238, v233
    v_mul_f32 v234, v238, v234
    v_mul_f32 v235, v238, v235
    v_xor_b32 v242, 80, v255
    v_cvt_pk_bf16_f32 v248, v232, v233
    v_cvt_pk_bf16_f32 v249, v234, v235
    s_waitcnt lgkmcnt(13)
    ds_write_b64 v242, v[248:249] offset:16384
    v_accvgpr_read_b32 v232, a56
    v_accvgpr_read_b32 v233, a57
    v_accvgpr_read_b32 v234, a58
    v_accvgpr_read_b32 v235, a59
    v_mul_f32 v232, v238, v232
    v_mul_f32 v233, v238, v233
    v_mul_f32 v234, v238, v234
    v_mul_f32 v235, v238, v235
    v_xor_b32 v242, 96, v255
    v_cvt_pk_bf16_f32 v248, v232, v233
    v_cvt_pk_bf16_f32 v249, v234, v235
    ds_write_b64 v242, v[248:249] offset:16384
    v_accvgpr_read_b32 v232, a60
    v_accvgpr_read_b32 v233, a61
    v_accvgpr_read_b32 v234, a62
    v_accvgpr_read_b32 v235, a63
    v_mul_f32 v232, v238, v232
    v_mul_f32 v233, v238, v233
    v_mul_f32 v234, v238, v234
    v_mul_f32 v235, v238, v235
    v_xor_b32 v242, 112, v255
    v_cvt_pk_bf16_f32 v248, v232, v233
    v_cvt_pk_bf16_f32 v249, v234, v235
    s_waitcnt lgkmcnt(13)
    ds_write_b64 v242, v[248:249] offset:16384
    ds_read_b128 v[152:155], v241 offset:16384
    s_waitcnt lgkmcnt(13)
    ds_read_b128 v[156:159], v241 offset:17408
    ds_read_b128 a[208:211], v241 offset:18432
    s_waitcnt lgkmcnt(13)
    ds_read_b128 a[212:215], v241 offset:19456
    v_mbcnt_lo_u32_b32 v248, -1, 0
    v_mbcnt_hi_u32_b32 v248, -1, v248
    v_bfe_u32 v244, v248, 2, 2
    v_bfe_u32 v249, v248, 1, 1
    v_lshl_add_u32 v244, v249, 2, v244
    v_lshlrev_b32 v244, 4, v244
    v_and_b32 v249, 31, v248
    v_lshl_add_u32 v244, v249, 7, v244
    v_lshrrev_b32 v248, 5, v248
    v_lshlrev_b32 v248, 4, v248
    v_xor_b32 v244, v244, v248
    v_xor_b32 v245, 32, v244
    v_xor_b32 v246, 64, v244
    v_xor_b32 v247, 96, v244
    v_add_u32 v248, s31, v244
    v_add_u32 v249, s31, v245
    v_add_u32 v250, s31, v246
    v_add_u32 v251, s31, v247
    ds_write_b128 v241, a[160:163] offset:16384
    s_waitcnt lgkmcnt(13)
    ds_write_b128 v241, a[164:167] offset:17408
    ds_write_b128 v241, v[32:35] offset:18432
    s_waitcnt lgkmcnt(13)
    ds_write_b128 v241, v[36:39] offset:19456
    ds_read_b128 a[0:3], v248 offset:49152
    s_waitcnt lgkmcnt(13)
    ds_read_b128 a[4:7], v249 offset:49152
    ds_read_b128 a[8:11], v250 offset:49152
    s_waitcnt lgkmcnt(13)
    ds_read_b128 a[12:15], v251 offset:49152
    ds_write_b128 v241, v[40:43] offset:16384
    s_waitcnt lgkmcnt(13)
    ds_write_b128 v241, v[44:47] offset:17408
    ds_write_b128 v241, a[168:171] offset:18432
    s_waitcnt lgkmcnt(13)
    ds_write_b128 v241, a[172:175] offset:19456
    ds_read_b128 a[16:19], v248 offset:49152
    s_waitcnt lgkmcnt(13)
    ds_read_b128 a[20:23], v249 offset:49152
    ds_read_b128 a[24:27], v250 offset:49152
    s_waitcnt lgkmcnt(13)
    ds_read_b128 a[28:31], v251 offset:49152
    ds_write_b128 v241, v[48:51] offset:16384
    s_waitcnt lgkmcnt(13)
    ds_write_b128 v241, v[52:55] offset:17408
    ds_write_b128 v241, v[56:59] offset:18432
    s_waitcnt lgkmcnt(13)
    ds_write_b128 v241, v[60:63] offset:19456
    ds_read_b128 a[32:35], v248 offset:49152
    s_waitcnt lgkmcnt(13)
    ds_read_b128 a[36:39], v249 offset:49152
    ds_read_b128 a[40:43], v250 offset:49152
    s_waitcnt lgkmcnt(13)
    ds_read_b128 a[44:47], v251 offset:49152
    ds_write_b128 v241, a[176:179] offset:16384
    s_waitcnt lgkmcnt(13)
    ds_write_b128 v241, a[180:183] offset:17408
    ds_write_b128 v241, v[64:67] offset:18432
    s_waitcnt lgkmcnt(13)
    ds_write_b128 v241, v[68:71] offset:19456
    ds_read_b128 a[48:51], v248 offset:49152
    s_waitcnt lgkmcnt(13)
    ds_read_b128 a[52:55], v249 offset:49152
    ds_read_b128 a[56:59], v250 offset:49152
    s_waitcnt lgkmcnt(13)
    ds_read_b128 a[60:63], v251 offset:49152
    ds_write_b128 v241, v[72:75] offset:16384
    s_waitcnt lgkmcnt(13)
    ds_write_b128 v241, v[76:79] offset:17408
    ds_write_b128 v241, a[184:187] offset:18432
    s_waitcnt lgkmcnt(13)
    ds_write_b128 v241, a[188:191] offset:19456
    ds_read_b128 a[64:67], v248 offset:49152
    s_waitcnt lgkmcnt(13)
    ds_read_b128 a[68:71], v249 offset:49152
    ds_read_b128 a[72:75], v250 offset:49152
    s_waitcnt lgkmcnt(13)
    ds_read_b128 a[76:79], v251 offset:49152
    ds_write_b128 v241, v[80:83] offset:16384
    s_waitcnt lgkmcnt(13)
    ds_write_b128 v241, v[84:87] offset:17408
    ds_write_b128 v241, v[88:91] offset:18432
    s_waitcnt lgkmcnt(13)
    ds_write_b128 v241, v[92:95] offset:19456
    ds_read_b128 a[80:83], v248 offset:49152
    s_waitcnt lgkmcnt(13)
    ds_read_b128 a[84:87], v249 offset:49152
    ds_read_b128 a[88:91], v250 offset:49152
    s_waitcnt lgkmcnt(13)
    ds_read_b128 a[92:95], v251 offset:49152
    s_waitcnt lgkmcnt(0)
    s_add_u32 m0, s31, 49152
    s_add_u32 s35, s75, 4480
    buffer_load_dwordx4 v252, s[8:11], s35 offen nt lds
    s_add_u32 s35, s75, 11648
    buffer_load_dwordx4 v253, s[8:11], s35 offen offset:1024 nt lds
    s_add_u32 s35, s75, 18816
    buffer_load_dwordx4 v252, s[8:11], s35 offen offset:2048 nt lds
    s_add_u32 s35, s75, 25984
    buffer_load_dwordx4 v253, s[8:11], s35 offen offset:3072 nt lds
    ds_read_b128 a[96:99], v244 offset:32768
    ds_read_b128 a[128:131], v244 offset:40960
    ds_read_b128 a[100:103], v245 offset:32768
    ds_read_b128 a[132:135], v245 offset:40960
    ds_read_b128 a[104:107], v246 offset:32768
    ds_read_b128 a[136:139], v246 offset:40960
    ds_read_b128 a[108:111], v247 offset:32768
    ds_read_b128 a[140:143], v247 offset:40960
    ds_read_b128 a[112:115], v244 offset:36864
    ds_read_b128 a[144:147], v244 offset:45056
    ds_read_b128 a[116:119], v245 offset:36864
    ds_read_b128 a[148:151], v245 offset:45056
    ds_read_b128 a[120:123], v246 offset:36864
    ds_read_b128 a[152:155], v246 offset:45056
    ds_read_b128 a[124:127], v247 offset:36864
    s_waitcnt lgkmcnt(13)
    ds_read_b128 a[156:159], v247 offset:45056
    ds_read_b128 a[248:251], v248
    s_waitcnt lgkmcnt(13)
    ds_read_b128 a[252:255], v249
    v_mfma_f32_32x32x16_bf16 v[0:15], a[96:99], a[0:3], 0
    s_waitcnt lgkmcnt(2)
    s_waitcnt vmcnt(20)
    s_barrier
    s_add_u32 m0, s30, 32768
    s_add_u32 s35, s25, 4096
    buffer_load_dwordx4 v252, s[12:15], s35 offen nt lds
    s_waitcnt lgkmcnt(1)
    v_mfma_f32_32x32x16_bf16 v[0:15], a[128:131], a[248:251], v[0:15]
    ds_read_b128 a[248:251], v250
    s_add_u32 s35, s25, 35840
    buffer_load_dwordx4 v253, s[12:15], s35 offen offset:1024 nt lds
    v_mfma_f32_32x32x16_bf16 v[0:15], a[100:103], a[4:7], v[0:15]
    s_add_u32 s35, s25, 83968
    buffer_load_dwordx4 v252, s[12:15], s35 offen offset:2048 nt lds
    s_waitcnt lgkmcnt(1)
    v_mfma_f32_32x32x16_bf16 v[0:15], a[132:135], a[252:255], v[0:15]
    ds_read_b128 a[252:255], v251
    s_add_u32 s35, s25, 115712
    buffer_load_dwordx4 v253, s[12:15], s35 offen offset:3072 nt lds
    v_mfma_f32_32x32x16_bf16 v[0:15], a[104:107], a[8:11], v[0:15]
    s_waitcnt lgkmcnt(1)
    v_mfma_f32_32x32x16_bf16 v[0:15], a[136:139], a[248:251], v[0:15]
    ds_read_b128 a[248:251], v248 offset:16384
    v_mfma_f32_32x32x16_bf16 v[0:15], a[108:111], a[12:15], v[0:15]
    s_waitcnt lgkmcnt(1)
    v_mfma_f32_32x32x16_bf16 v[0:15], a[140:143], a[252:255], v[0:15]
    ds_read_b128 a[252:255], v249 offset:16384
    v_mfma_f32_32x32x16_bf16 v[0:15], a[112:115], a[16:19], v[0:15]
    s_waitcnt lgkmcnt(1)
    v_mfma_f32_32x32x16_bf16 v[0:15], a[144:147], a[248:251], v[0:15]
    ds_read_b128 a[248:251], v250 offset:16384
    v_mfma_f32_32x32x16_bf16 v[0:15], a[116:119], a[20:23], v[0:15]
    s_add_u32 s35, s74, 135168
    buffer_store_dwordx4 v[160:163], v252, s[20:23], s35 offen sc1
    s_waitcnt lgkmcnt(1)
    v_mfma_f32_32x32x16_bf16 v[0:15], a[148:151], a[252:255], v[0:15]
    ds_read_b128 a[252:255], v251 offset:16384
    s_add_u32 s35, s74, 135168
    buffer_store_dwordx4 a[232:235], v252, s[20:23], s35 offen offset:128 sc1
    v_mfma_f32_32x32x16_bf16 v[0:15], a[120:123], a[24:27], v[0:15]
    s_add_u32 s35, s74, 135168
    buffer_store_dwordx4 v[192:195], v252, s[20:23], s35 offen offset:256 sc1
    s_waitcnt lgkmcnt(1)
    v_mfma_f32_32x32x16_bf16 v[0:15], a[152:155], a[248:251], v[0:15]
    v_add_u32 v248, 32768, v248
    v_add_u32 v249, 32768, v249
    v_add_u32 v250, 32768, v250
    v_add_u32 v251, 32768, v251
    s_waitcnt vmcnt(15)
    ds_read_b128 a[248:251], v248
    s_add_u32 s35, s74, 135168
    buffer_store_dwordx4 a[200:203], v252, s[20:23], s35 offen offset:384 sc1
    v_mfma_f32_32x32x16_bf16 v[0:15], a[124:127], a[28:31], v[0:15]
    s_waitcnt lgkmcnt(1)
    v_mfma_f32_32x32x16_bf16 v[0:15], a[156:159], a[252:255], v[0:15]
    ds_read_b128 a[252:255], v249
    v_mfma_f32_32x32x16_bf16 v[16:31], a[96:99], a[32:35], 0
    s_nop 9
    v_max_f32 v241, v0, v1
    s_waitcnt lgkmcnt(1)
    v_mfma_f32_32x32x16_bf16 v[16:31], a[128:131], a[248:251], v[16:31]
    ds_read_b128 a[248:251], v250
    v_max3_f32 v241, v2, v3, v241
    v_max3_f32 v241, v4, v5, v241
    v_max3_f32 v241, v6, v7, v241
    v_max3_f32 v241, v8, v9, v241
    v_mfma_f32_32x32x16_bf16 v[16:31], a[100:103], a[36:39], v[16:31]
    v_max3_f32 v241, v10, v11, v241
    v_max3_f32 v241, v12, v13, v241
    v_max3_f32 v241, v14, v15, v241
    v_mul_f32 v238, s32, v241
    s_waitcnt lgkmcnt(1)
    v_mfma_f32_32x32x16_bf16 v[16:31], a[132:135], a[252:255], v[16:31]
    ds_read_b128 a[252:255], v251
    v_ceil_f32 v238, v238
    v_fma_f32 v0, v0, s32, -v238
    v_fma_f32 v1, v1, s32, -v238
    v_fma_f32 v2, v2, s32, -v238
    v_mfma_f32_32x32x16_bf16 v[16:31], a[104:107], a[40:43], v[16:31]
    v_fma_f32 v3, v3, s32, -v238
    v_fma_f32 v4, v4, s32, -v238
    v_fma_f32 v5, v5, s32, -v238
    v_exp_f32 v0, v0
    s_waitcnt lgkmcnt(1)
    v_mfma_f32_32x32x16_bf16 v[16:31], a[136:139], a[248:251], v[16:31]
    ds_read_b128 a[248:251], v248 offset:49152
    v_fma_f32 v6, v6, s32, -v238
    v_exp_f32 v1, v1
    v_fma_f32 v7, v7, s32, -v238
    v_mfma_f32_32x32x16_bf16 v[16:31], a[108:111], a[44:47], v[16:31]
    v_exp_f32 v2, v2
    v_fma_f32 v8, v8, s32, -v238
    v_exp_f32 v3, v3
    s_waitcnt lgkmcnt(1)
    v_mfma_f32_32x32x16_bf16 v[16:31], a[140:143], a[252:255], v[16:31]
    ds_read_b128 a[252:255], v249 offset:49152
    v_fma_f32 v9, v9, s32, -v238
    v_cvt_pk_bf16_f32 v0, v0, v1
    v_accvgpr_write_b32 a160, v0
    v_mfma_f32_32x32x16_bf16 v[16:31], a[112:115], a[48:51], v[16:31]
    v_exp_f32 v4, v4
    v_fma_f32 v10, v10, s32, -v238
    v_exp_f32 v5, v5
    s_waitcnt lgkmcnt(1)
    v_mfma_f32_32x32x16_bf16 v[16:31], a[144:147], a[248:251], v[16:31]
    ds_read_b128 a[248:251], v250 offset:49152
    v_fma_f32 v11, v11, s32, -v238
    v_cvt_pk_bf16_f32 v2, v2, v3
    v_accvgpr_write_b32 a161, v2
    v_mfma_f32_32x32x16_bf16 v[16:31], a[116:119], a[52:55], v[16:31]
    v_exp_f32 v6, v6
    v_fma_f32 v12, v12, s32, -v238
    v_exp_f32 v7, v7
    s_waitcnt lgkmcnt(1)
    v_mfma_f32_32x32x16_bf16 v[16:31], a[148:151], a[252:255], v[16:31]
    ds_read_b128 a[252:255], v251 offset:49152
    v_fma_f32 v13, v13, s32, -v238
    v_cvt_pk_bf16_f32 v4, v4, v5
    v_accvgpr_write_b32 a162, v4
    v_mfma_f32_32x32x16_bf16 v[16:31], a[120:123], a[56:59], v[16:31]
    v_exp_f32 v8, v8
    v_fma_f32 v14, v14, s32, -v238
    v_exp_f32 v9, v9
    s_waitcnt lgkmcnt(1)
    v_mfma_f32_32x32x16_bf16 v[16:31], a[152:155], a[248:251], v[16:31]
    s_waitcnt vmcnt(12)
    ds_read_b128 a[248:251], v248 offset:32768
    v_fma_f32 v15, v15, s32, -v238
    v_cvt_pk_bf16_f32 v6, v6, v7
    v_accvgpr_write_b32 a163, v6
    v_mfma_f32_32x32x16_bf16 v[16:31], a[124:127], a[60:63], v[16:31]
    v_exp_f32 v10, v10
    v_exp_f32 v11, v11
    v_cvt_pk_bf16_f32 v8, v8, v9
    v_accvgpr_write_b32 a164, v8
    s_waitcnt lgkmcnt(1)
    v_mfma_f32_32x32x16_bf16 v[16:31], a[156:159], a[252:255], v[16:31]
    ds_read_b128 a[252:255], v249 offset:32768
    v_exp_f32 v12, v12
    v_exp_f32 v13, v13
    v_cvt_pk_bf16_f32 v10, v10, v11
    v_accvgpr_write_b32 a165, v10
    v_exp_f32 v14, v14
    v_exp_f32 v15, v15
    v_mfma_f32_4x4x4_16b_bf16 v[232:235], v[236:237], a[160:161], 0 cbsz:4 abid:0
    v_cvt_pk_bf16_f32 v12, v12, v13
    v_accvgpr_write_b32 a166, v12
    v_mfma_f32_4x4x4_16b_bf16 v[232:235], v[236:237], a[162:163], v[232:235] cbsz:4 abid:0
    v_cvt_pk_bf16_f32 v14, v14, v15
    v_accvgpr_write_b32 a167, v14
    v_mfma_f32_4x4x4_16b_bf16 v[232:235], v[236:237], a[164:165], v[232:235] cbsz:4 abid:0
    v_mfma_f32_32x32x16_bf16 v[0:15], a[96:99], a[64:67], 0
    ds_read_b128 a[96:99], v244 offset:49152
    v_max_f32 v242, v16, v17
    v_max3_f32 v242, v18, v19, v242
    v_max3_f32 v242, v20, v21, v242
    s_waitcnt lgkmcnt(2)
    v_mfma_f32_32x32x16_bf16 v[0:15], a[128:131], a[248:251], v[0:15]
    ds_read_b128 a[248:251], v250 offset:32768
    ds_read_b128 a[128:131], v244 offset:57344
    v_max3_f32 v242, v22, v23, v242
    v_max3_f32 v242, v24, v25, v242
    v_max3_f32 v242, v26, v27, v242
    v_mfma_f32_32x32x16_bf16 v[0:15], a[100:103], a[68:71], v[0:15]
    ds_read_b128 a[100:103], v245 offset:49152
    v_max3_f32 v242, v28, v29, v242
    v_max3_f32 v242, v30, v31, v242
    v_mul_f32 v239, s32, v242
    s_waitcnt lgkmcnt(4)
    v_mfma_f32_32x32x16_bf16 v[0:15], a[132:135], a[252:255], v[0:15]
    ds_read_b128 a[252:255], v251 offset:32768
    ds_read_b128 a[132:135], v245 offset:57344
    v_ceil_f32 v239, v239
    v_fma_f32 v16, v16, s32, -v239
    v_fma_f32 v17, v17, s32, -v239
    v_mfma_f32_32x32x16_bf16 v[0:15], a[104:107], a[72:75], v[0:15]
    ds_read_b128 a[104:107], v246 offset:49152
    v_fma_f32 v18, v18, s32, -v239
    v_fma_f32 v19, v19, s32, -v239
    v_fma_f32 v20, v20, s32, -v239
    s_waitcnt lgkmcnt(5)
    v_mfma_f32_32x32x16_bf16 v[0:15], a[136:139], a[248:251], v[0:15]
    s_waitcnt vmcnt(8)
    ds_read_b128 a[248:251], v248 offset:16384
    ds_read_b128 a[136:139], v246 offset:57344
    v_fma_f32 v21, v21, s32, -v239
    v_exp_f32 v16, v16
    v_mfma_f32_32x32x16_bf16 v[0:15], a[108:111], a[76:79], v[0:15]
    ds_read_b128 a[108:111], v247 offset:49152
    s_add_u32 s35, s74, 143360
    buffer_store_dwordx4 v[164:167], v253, s[20:23], s35 offen sc1
    v_fma_f32 v22, v22, s32, -v239
    s_waitcnt lgkmcnt(5)
    v_mfma_f32_32x32x16_bf16 v[0:15], a[140:143], a[252:255], v[0:15]
    ds_read_b128 a[252:255], v249 offset:16384
    ds_read_b128 a[140:143], v247 offset:57344
    s_add_u32 s35, s74, 143360
    buffer_store_dwordx4 a[236:239], v253, s[20:23], s35 offen offset:128 sc1
    v_exp_f32 v17, v17
    v_mfma_f32_32x32x16_bf16 v[0:15], a[112:115], a[80:83], v[0:15]
    ds_read_b128 a[112:115], v244 offset:53248
    s_add_u32 s35, s74, 143360
    buffer_store_dwordx4 v[196:199], v253, s[20:23], s35 offen offset:256 sc1
    v_fma_f32 v23, v23, s32, -v239
    v_exp_f32 v18, v18
    s_waitcnt lgkmcnt(5)
    v_mfma_f32_32x32x16_bf16 v[0:15], a[144:147], a[248:251], v[0:15]
    ds_read_b128 a[248:251], v250 offset:16384
    ds_read_b128 a[144:147], v244 offset:61440
    s_add_u32 s35, s74, 143360
    buffer_store_dwordx4 a[204:207], v253, s[20:23], s35 offen offset:384 sc1
    v_fma_f32 v24, v24, s32, -v239
    v_exp_f32 v19, v19
    v_mfma_f32_32x32x16_bf16 v[0:15], a[116:119], a[84:87], v[0:15]
    ds_read_b128 a[116:119], v245 offset:53248
    v_fma_f32 v25, v25, s32, -v239
    v_cvt_pk_bf16_f32 v32, v16, v17
    v_exp_f32 v20, v20
    v_fma_f32 v26, v26, s32, -v239
    s_waitcnt lgkmcnt(5)
    v_mfma_f32_32x32x16_bf16 v[0:15], a[148:151], a[252:255], v[0:15]
    ds_read_b128 a[252:255], v251 offset:16384
    ds_read_b128 a[148:151], v245 offset:61440
    v_exp_f32 v21, v21
    v_fma_f32 v27, v27, s32, -v239
    v_cvt_pk_bf16_f32 v33, v18, v19
    v_mfma_f32_32x32x16_bf16 v[0:15], a[120:123], a[88:91], v[0:15]
    ds_read_b128 a[120:123], v246 offset:53248
    v_exp_f32 v22, v22
    v_fma_f32 v28, v28, s32, -v239
    v_exp_f32 v23, v23
    s_waitcnt lgkmcnt(5)
    v_mfma_f32_32x32x16_bf16 v[0:15], a[152:155], a[248:251], v[0:15]
    v_subrev_u32 v248, 32768, v248
    v_subrev_u32 v249, 32768, v249
    v_subrev_u32 v250, 32768, v250
    v_subrev_u32 v251, 32768, v251
    ds_read_b128 a[248:251], v248
    ds_read_b128 a[152:155], v246 offset:61440
    v_fma_f32 v29, v29, s32, -v239
    v_cvt_pk_bf16_f32 v34, v20, v21
    v_mfma_f32_32x32x16_bf16 v[0:15], a[124:127], a[92:95], v[0:15]
    ds_read_b128 a[124:127], v247 offset:53248
    v_exp_f32 v24, v24
    v_fma_f32 v30, v30, s32, -v239
    v_exp_f32 v25, v25
    v_fma_f32 v31, v31, s32, -v239
    v_cvt_pk_bf16_f32 v35, v22, v23
    s_waitcnt lgkmcnt(5)
    v_mfma_f32_32x32x16_bf16 v[0:15], a[156:159], a[252:255], v[0:15]
    ds_read_b128 a[252:255], v249
    ds_read_b128 a[156:159], v247 offset:61440
    v_exp_f32 v26, v26
    v_exp_f32 v27, v27
    v_cvt_pk_bf16_f32 v36, v24, v25
    v_exp_f32 v28, v28
    v_mfma_f32_4x4x4_16b_bf16 v[232:235], v[236:237], a[166:167], v[232:235] cbsz:4 abid:0
    v_exp_f32 v29, v29
    v_cvt_pk_bf16_f32 v37, v26, v27
    v_mfma_f32_4x4x4_16b_bf16 v[232:235], v[236:237], v[32:33], v[232:235] cbsz:4 abid:1
    v_exp_f32 v30, v30
    v_exp_f32 v31, v31
    v_mfma_f32_4x4x4_16b_bf16 v[232:235], v[236:237], v[34:35], v[232:235] cbsz:4 abid:1
    v_cvt_pk_bf16_f32 v38, v28, v29
    v_cvt_pk_bf16_f32 v39, v30, v31
    v_mfma_f32_4x4x4_16b_bf16 v[232:235], v[236:237], v[36:37], v[232:235] cbsz:4 abid:1
    v_mfma_f32_32x32x16_bf16 v[16:31], a[96:99], a[0:3], 0
    s_waitcnt lgkmcnt(0)
    s_barrier
    s_add_u32 m0, s30, 49152
    s_add_u32 s35, s25, 8192
    buffer_load_dwordx4 v252, s[12:15], s35 offen nt lds
    v_mfma_f32_32x32x16_bf16 v[16:31], a[128:131], a[248:251], v[16:31]
    ds_read_b128 a[248:251], v250
    s_add_u32 s35, s25, 39936
    buffer_load_dwordx4 v253, s[12:15], s35 offen offset:1024 nt lds
    v_max_f32 v243, v0, v1
    v_max3_f32 v243, v2, v3, v243
    v_mfma_f32_32x32x16_bf16 v[16:31], a[100:103], a[4:7], v[16:31]
    s_add_u32 s35, s25, 88064
    buffer_load_dwordx4 v252, s[12:15], s35 offen offset:2048 nt lds
    v_max3_f32 v243, v4, v5, v243
    v_max3_f32 v243, v6, v7, v243
    v_mfma_f32_32x32x16_bf16 v[16:31], a[132:135], a[252:255], v[16:31]
    ds_read_b128 a[252:255], v251
    s_add_u32 s35, s25, 119808
    buffer_load_dwordx4 v253, s[12:15], s35 offen offset:3072 nt lds
    v_max3_f32 v243, v8, v9, v243
    v_max3_f32 v243, v10, v11, v243
    v_mfma_f32_32x32x16_bf16 v[16:31], a[104:107], a[8:11], v[16:31]
    v_max3_f32 v243, v12, v13, v243
    v_max3_f32 v243, v14, v15, v243
    v_mul_f32 v240, s32, v243
    v_ceil_f32 v240, v240
    s_waitcnt lgkmcnt(1)
    v_mfma_f32_32x32x16_bf16 v[16:31], a[136:139], a[248:251], v[16:31]
    ds_read_b128 a[248:251], v248 offset:16384
    v_fma_f32 v0, v0, s32, -v240
    v_fma_f32 v1, v1, s32, -v240
    v_fma_f32 v2, v2, s32, -v240
    v_fma_f32 v3, v3, s32, -v240
    v_mfma_f32_32x32x16_bf16 v[16:31], a[108:111], a[12:15], v[16:31]
    v_fma_f32 v4, v4, s32, -v240
    v_fma_f32 v5, v5, s32, -v240
    v_exp_f32 v0, v0
    s_waitcnt lgkmcnt(1)
    v_mfma_f32_32x32x16_bf16 v[16:31], a[140:143], a[252:255], v[16:31]
    ds_read_b128 a[252:255], v249 offset:16384
    v_fma_f32 v6, v6, s32, -v240
    v_exp_f32 v1, v1
    v_fma_f32 v7, v7, s32, -v240
    v_mfma_f32_32x32x16_bf16 v[16:31], a[112:115], a[16:19], v[16:31]
    v_exp_f32 v2, v2
    v_fma_f32 v8, v8, s32, -v240
    v_exp_f32 v3, v3
    s_waitcnt lgkmcnt(1)
    v_mfma_f32_32x32x16_bf16 v[16:31], a[144:147], a[248:251], v[16:31]
    ds_read_b128 a[248:251], v250 offset:16384
    v_fma_f32 v9, v9, s32, -v240
    v_cvt_pk_bf16_f32 v40, v0, v1
    v_exp_f32 v4, v4
    v_mfma_f32_32x32x16_bf16 v[16:31], a[116:119], a[20:23], v[16:31]
    s_add_u32 s35, s74, 151552
    buffer_store_dwordx4 v[168:171], v252, s[20:23], s35 offen sc1
    v_fma_f32 v10, v10, s32, -v240
    v_exp_f32 v5, v5
    s_waitcnt lgkmcnt(1)
    v_mfma_f32_32x32x16_bf16 v[16:31], a[148:151], a[252:255], v[16:31]
    ds_read_b128 a[252:255], v251 offset:16384
    s_add_u32 s35, s74, 151552
    buffer_store_dwordx4 v[176:179], v252, s[20:23], s35 offen offset:128 sc1
    v_fma_f32 v11, v11, s32, -v240
    v_cvt_pk_bf16_f32 v41, v2, v3
    v_mfma_f32_32x32x16_bf16 v[16:31], a[120:123], a[24:27], v[16:31]
    s_add_u32 s35, s74, 151552
    buffer_store_dwordx4 v[200:203], v252, s[20:23], s35 offen offset:256 sc1
    v_exp_f32 v6, v6
    v_fma_f32 v12, v12, s32, -v240
    s_waitcnt lgkmcnt(1)
    v_mfma_f32_32x32x16_bf16 v[16:31], a[152:155], a[248:251], v[16:31]
    v_add_u32 v248, 32768, v248
    v_add_u32 v249, 32768, v249
    v_add_u32 v250, 32768, v250
    v_add_u32 v251, 32768, v251
    ds_read_b128 a[248:251], v248
    s_add_u32 s35, s74, 151552
    buffer_store_dwordx4 v[112:115], v252, s[20:23], s35 offen offset:384 sc1
    v_exp_f32 v7, v7
    v_mfma_f32_32x32x16_bf16 v[16:31], a[124:127], a[28:31], v[16:31]
    v_fma_f32 v13, v13, s32, -v240
    v_cvt_pk_bf16_f32 v42, v4, v5
    v_exp_f32 v8, v8
    v_fma_f32 v14, v14, s32, -v240
    v_exp_f32 v9, v9
    v_fma_f32 v15, v15, s32, -v240
    s_waitcnt lgkmcnt(1)
    v_mfma_f32_32x32x16_bf16 v[16:31], a[156:159], a[252:255], v[16:31]
    ds_read_b128 a[252:255], v249
    v_cvt_pk_bf16_f32 v43, v6, v7
    v_exp_f32 v10, v10
    v_exp_f32 v11, v11
    v_cvt_pk_bf16_f32 v44, v8, v9
    v_exp_f32 v12, v12
    v_mfma_f32_4x4x4_16b_bf16 v[232:235], v[236:237], v[38:39], v[232:235] cbsz:4 abid:1
    v_exp_f32 v13, v13
    v_cvt_pk_bf16_f32 v45, v10, v11
    v_mfma_f32_4x4x4_16b_bf16 v[232:235], v[236:237], v[40:41], v[232:235] cbsz:4 abid:2
    v_exp_f32 v14, v14
    v_exp_f32 v15, v15
    v_mfma_f32_4x4x4_16b_bf16 v[232:235], v[236:237], v[42:43], v[232:235] cbsz:4 abid:2
    v_cvt_pk_bf16_f32 v46, v12, v13
    v_cvt_pk_bf16_f32 v47, v14, v15
    v_mfma_f32_4x4x4_16b_bf16 v[232:235], v[236:237], v[44:45], v[232:235] cbsz:4 abid:2
    v_mfma_f32_32x32x16_bf16 v[0:15], a[96:99], a[32:35], 0
    v_max3_f32 v241, v16, v17, v241
    v_max3_f32 v241, v18, v19, v241
    v_max3_f32 v241, v20, v21, v241
    v_max3_f32 v241, v22, v23, v241
    s_waitcnt lgkmcnt(1)
    v_mfma_f32_32x32x16_bf16 v[0:15], a[128:131], a[248:251], v[0:15]
    ds_read_b128 a[248:251], v250
    v_max3_f32 v241, v24, v25, v241
    v_max3_f32 v241, v26, v27, v241
    v_max3_f32 v241, v28, v29, v241
    v_max3_f32 v241, v30, v31, v241
    v_mfma_f32_32x32x16_bf16 v[0:15], a[100:103], a[36:39], v[0:15]
    v_fma_f32 v254, v241, s32, -v238
    v_cmp_lt_f32 vcc, s33, v254
    v_fma_f32 v16, v16, s32, -v238
    v_fma_f32 v17, v17, s32, -v238
    s_waitcnt lgkmcnt(1)
    v_mfma_f32_32x32x16_bf16 v[0:15], a[132:135], a[252:255], v[0:15]
    ds_read_b128 a[252:255], v251
    v_fma_f32 v18, v18, s32, -v238
    v_fma_f32 v19, v19, s32, -v238
    v_fma_f32 v20, v20, s32, -v238
    v_fma_f32 v21, v21, s32, -v238
    v_mfma_f32_32x32x16_bf16 v[0:15], a[104:107], a[40:43], v[0:15]
    s_cbranch_vccnz L_stub_1_0_1
L_back_1_0_1:
    v_exp_f32 v16, v16
    v_fma_f32 v22, v22, s32, -v238
    v_exp_f32 v17, v17
    s_waitcnt lgkmcnt(1)
    v_mfma_f32_32x32x16_bf16 v[0:15], a[136:139], a[248:251], v[0:15]
    ds_read_b128 a[248:251], v248 offset:49152
    v_fma_f32 v23, v23, s32, -v238
    v_exp_f32 v18, v18
    v_fma_f32 v24, v24, s32, -v238
    v_mfma_f32_32x32x16_bf16 v[0:15], a[108:111], a[44:47], v[0:15]
    v_exp_f32 v19, v19
    v_fma_f32 v25, v25, s32, -v238
    v_cvt_pk_bf16_f32 v16, v16, v17
    s_waitcnt lgkmcnt(1)
    v_mfma_f32_32x32x16_bf16 v[0:15], a[140:143], a[252:255], v[0:15]
    ds_read_b128 a[252:255], v249 offset:49152
    v_accvgpr_write_b32 a168, v16
    v_exp_f32 v20, v20
    v_fma_f32 v26, v26, s32, -v238
    v_mfma_f32_32x32x16_bf16 v[0:15], a[112:115], a[48:51], v[0:15]
    v_exp_f32 v21, v21
    v_fma_f32 v27, v27, s32, -v238
    v_cvt_pk_bf16_f32 v18, v18, v19
    s_waitcnt lgkmcnt(1)
    v_mfma_f32_32x32x16_bf16 v[0:15], a[144:147], a[248:251], v[0:15]
    ds_read_b128 a[248:251], v250 offset:49152
    v_accvgpr_write_b32 a169, v18
    v_exp_f32 v22, v22
    v_fma_f32 v28, v28, s32, -v238
    v_mfma_f32_32x32x16_bf16 v[0:15], a[116:119], a[52:55], v[0:15]
    v_exp_f32 v23, v23
    v_fma_f32 v29, v29, s32, -v238
    v_cvt_pk_bf16_f32 v20, v20, v21
    s_waitcnt lgkmcnt(1)
    v_mfma_f32_32x32x16_bf16 v[0:15], a[148:151], a[252:255], v[0:15]
    ds_read_b128 a[252:255], v251 offset:49152
    v_accvgpr_write_b32 a170, v20
    v_exp_f32 v24, v24
    v_fma_f32 v30, v30, s32, -v238
    v_mfma_f32_32x32x16_bf16 v[0:15], a[120:123], a[56:59], v[0:15]
    v_exp_f32 v25, v25
    v_fma_f32 v31, v31, s32, -v238
    v_cvt_pk_bf16_f32 v22, v22, v23
    s_waitcnt lgkmcnt(1)
    v_mfma_f32_32x32x16_bf16 v[0:15], a[152:155], a[248:251], v[0:15]
    ds_read_b128 a[248:251], v248 offset:32768
    v_accvgpr_write_b32 a171, v22
    v_exp_f32 v26, v26
    v_exp_f32 v27, v27
    v_mfma_f32_32x32x16_bf16 v[0:15], a[124:127], a[60:63], v[0:15]
    v_cvt_pk_bf16_f32 v24, v24, v25
    v_accvgpr_write_b32 a172, v24
    v_exp_f32 v28, v28
    s_waitcnt lgkmcnt(1)
    v_mfma_f32_32x32x16_bf16 v[0:15], a[156:159], a[252:255], v[0:15]
    ds_read_b128 a[252:255], v249 offset:32768
    v_exp_f32 v29, v29
    v_cvt_pk_bf16_f32 v26, v26, v27
    v_accvgpr_write_b32 a173, v26
    v_mfma_f32_4x4x4_16b_bf16 v[232:235], v[236:237], v[46:47], v[232:235] cbsz:4 abid:2
    v_exp_f32 v30, v30
    v_exp_f32 v31, v31
    v_mfma_f32_4x4x4_16b_bf16 v[232:235], v[236:237], a[168:169], v[232:235] cbsz:4 abid:0
    v_cvt_pk_bf16_f32 v28, v28, v29
    v_accvgpr_write_b32 a174, v28
    v_mfma_f32_4x4x4_16b_bf16 v[232:235], v[236:237], a[170:171], v[232:235] cbsz:4 abid:0
    v_cvt_pk_bf16_f32 v30, v30, v31
    v_accvgpr_write_b32 a175, v30
    v_mfma_f32_4x4x4_16b_bf16 v[232:235], v[236:237], a[172:173], v[232:235] cbsz:4 abid:0
    v_mfma_f32_32x32x16_bf16 v[16:31], a[96:99], a[64:67], 0
    ds_read_b128 a[96:99], v244
    v_max3_f32 v242, v0, v1, v242
    v_max3_f32 v242, v2, v3, v242
    v_max3_f32 v242, v4, v5, v242
    s_waitcnt lgkmcnt(2)
    v_mfma_f32_32x32x16_bf16 v[16:31], a[128:131], a[248:251], v[16:31]
    ds_read_b128 a[248:251], v250 offset:32768
    ds_read_b128 a[128:131], v244 offset:8192
    v_max3_f32 v242, v6, v7, v242
    v_max3_f32 v242, v8, v9, v242
    v_max3_f32 v242, v10, v11, v242
    v_mfma_f32_32x32x16_bf16 v[16:31], a[100:103], a[68:71], v[16:31]
    ds_read_b128 a[100:103], v245
    v_max3_f32 v242, v12, v13, v242
    v_max3_f32 v242, v14, v15, v242
    v_fma_f32 v254, v242, s32, -v239
    v_cmp_lt_f32 vcc, s33, v254
    s_waitcnt lgkmcnt(4)
    v_mfma_f32_32x32x16_bf16 v[16:31], a[132:135], a[252:255], v[16:31]
    ds_read_b128 a[252:255], v251 offset:32768
    ds_read_b128 a[132:135], v245 offset:8192
    v_fma_f32 v0, v0, s32, -v239
    v_fma_f32 v1, v1, s32, -v239
    v_fma_f32 v2, v2, s32, -v239
    v_mfma_f32_32x32x16_bf16 v[16:31], a[104:107], a[72:75], v[16:31]
    ds_read_b128 a[104:107], v246
    v_fma_f32 v3, v3, s32, -v239
    v_fma_f32 v4, v4, s32, -v239
    v_fma_f32 v5, v5, s32, -v239
    s_waitcnt lgkmcnt(5)
    v_mfma_f32_32x32x16_bf16 v[16:31], a[136:139], a[248:251], v[16:31]
    ds_read_b128 a[248:251], v248 offset:16384
    ds_read_b128 a[136:139], v246 offset:8192
    s_cbranch_vccnz L_stub_1_1_1
L_back_1_1_1:
    v_exp_f32 v0, v0
    v_fma_f32 v6, v6, s32, -v239
    v_mfma_f32_32x32x16_bf16 v[16:31], a[108:111], a[76:79], v[16:31]
    ds_read_b128 a[108:111], v247
    s_add_u32 s35, s74, 159744
    buffer_store_dwordx4 v[172:175], v253, s[20:23], s35 offen sc1
    v_exp_f32 v1, v1
    s_waitcnt lgkmcnt(5)
    v_mfma_f32_32x32x16_bf16 v[16:31], a[140:143], a[252:255], v[16:31]
    ds_read_b128 a[252:255], v249 offset:16384
    ds_read_b128 a[140:143], v247 offset:8192
    s_add_u32 s35, s74, 159744
    buffer_store_dwordx4 v[180:183], v253, s[20:23], s35 offen offset:128 sc1
    v_fma_f32 v7, v7, s32, -v239
    v_mfma_f32_32x32x16_bf16 v[16:31], a[112:115], a[80:83], v[16:31]
    ds_read_b128 a[112:115], v244 offset:4096
    s_add_u32 s35, s74, 159744
    buffer_store_dwordx4 v[204:207], v253, s[20:23], s35 offen offset:256 sc1
    v_exp_f32 v2, v2
    v_fma_f32 v8, v8, s32, -v239
    s_waitcnt lgkmcnt(5)
    v_mfma_f32_32x32x16_bf16 v[16:31], a[144:147], a[248:251], v[16:31]
    ds_read_b128 a[248:251], v250 offset:16384
    ds_read_b128 a[144:147], v244 offset:12288
    s_add_u32 s35, s74, 159744
    buffer_store_dwordx4 v[116:119], v253, s[20:23], s35 offen offset:384 sc1
    v_exp_f32 v3, v3
    v_fma_f32 v9, v9, s32, -v239
    v_mfma_f32_32x32x16_bf16 v[16:31], a[116:119], a[84:87], v[16:31]
    ds_read_b128 a[116:119], v245 offset:4096
    v_cvt_pk_bf16_f32 v48, v0, v1
    v_exp_f32 v4, v4
    v_fma_f32 v10, v10, s32, -v239
    s_waitcnt lgkmcnt(5)
    v_mfma_f32_32x32x16_bf16 v[16:31], a[148:151], a[252:255], v[16:31]
    ds_read_b128 a[252:255], v251 offset:16384
    ds_read_b128 a[148:151], v245 offset:12288
    v_exp_f32 v5, v5
    v_fma_f32 v11, v11, s32, -v239
    v_cvt_pk_bf16_f32 v49, v2, v3
    v_mfma_f32_32x32x16_bf16 v[16:31], a[120:123], a[88:91], v[16:31]
    ds_read_b128 a[120:123], v246 offset:4096
    v_exp_f32 v6, v6
    v_fma_f32 v12, v12, s32, -v239
    v_exp_f32 v7, v7
    s_waitcnt lgkmcnt(5)
    v_mfma_f32_32x32x16_bf16 v[16:31], a[152:155], a[248:251], v[16:31]
    v_subrev_u32 v248, 32768, v248
    v_subrev_u32 v249, 32768, v249
    v_subrev_u32 v250, 32768, v250
    v_subrev_u32 v251, 32768, v251
    ds_read_b128 a[248:251], v248
    ds_read_b128 a[152:155], v246 offset:12288
    v_fma_f32 v13, v13, s32, -v239
    v_cvt_pk_bf16_f32 v50, v4, v5
    v_mfma_f32_32x32x16_bf16 v[16:31], a[124:127], a[92:95], v[16:31]
    ds_read_b128 a[124:127], v247 offset:4096
    v_exp_f32 v8, v8
    v_fma_f32 v14, v14, s32, -v239
    v_exp_f32 v9, v9
    v_fma_f32 v15, v15, s32, -v239
    v_cvt_pk_bf16_f32 v51, v6, v7
    s_waitcnt lgkmcnt(5)
    v_mfma_f32_32x32x16_bf16 v[16:31], a[156:159], a[252:255], v[16:31]
    ds_read_b128 a[252:255], v249
    ds_read_b128 a[156:159], v247 offset:12288
    v_exp_f32 v10, v10
    v_exp_f32 v11, v11
    v_cvt_pk_bf16_f32 v52, v8, v9
    v_exp_f32 v12, v12
    v_mfma_f32_4x4x4_16b_bf16 v[232:235], v[236:237], a[174:175], v[232:235] cbsz:4 abid:0
    v_exp_f32 v13, v13
    v_cvt_pk_bf16_f32 v53, v10, v11
    v_mfma_f32_4x4x4_16b_bf16 v[232:235], v[236:237], v[48:49], v[232:235] cbsz:4 abid:1
    v_exp_f32 v14, v14
    v_exp_f32 v15, v15
    v_mfma_f32_4x4x4_16b_bf16 v[232:235], v[236:237], v[50:51], v[232:235] cbsz:4 abid:1
    v_cvt_pk_bf16_f32 v54, v12, v13
    v_cvt_pk_bf16_f32 v55, v14, v15
    v_mfma_f32_4x4x4_16b_bf16 v[232:235], v[236:237], v[52:53], v[232:235] cbsz:4 abid:1
    v_mfma_f32_32x32x16_bf16 v[0:15], a[96:99], a[0:3], 0
    s_waitcnt lgkmcnt(0)
    s_barrier
    s_add_u32 m0, s30, 0
    s_add_u32 s35, s25, 12288
    buffer_load_dwordx4 v252, s[12:15], s35 offen nt lds
    v_mfma_f32_32x32x16_bf16 v[0:15], a[128:131], a[248:251], v[0:15]
    ds_read_b128 a[248:251], v250
    s_add_u32 s35, s25, 44032
    buffer_load_dwordx4 v253, s[12:15], s35 offen offset:1024 nt lds
    v_max3_f32 v243, v16, v17, v243
    v_max3_f32 v243, v18, v19, v243
    v_mfma_f32_32x32x16_bf16 v[0:15], a[100:103], a[4:7], v[0:15]
    s_add_u32 s35, s25, 92160
    buffer_load_dwordx4 v252, s[12:15], s35 offen offset:2048 nt lds
    v_max3_f32 v243, v20, v21, v243
    v_max3_f32 v243, v22, v23, v243
    v_mfma_f32_32x32x16_bf16 v[0:15], a[132:135], a[252:255], v[0:15]
    ds_read_b128 a[252:255], v251
    s_add_u32 s35, s25, 123904
    buffer_load_dwordx4 v253, s[12:15], s35 offen offset:3072 nt lds
    v_max3_f32 v243, v24, v25, v243
    v_max3_f32 v243, v26, v27, v243
    v_mfma_f32_32x32x16_bf16 v[0:15], a[104:107], a[8:11], v[0:15]
    v_max3_f32 v243, v28, v29, v243
    v_max3_f32 v243, v30, v31, v243
    v_fma_f32 v254, v243, s32, -v240
    v_cmp_lt_f32 vcc, s33, v254
    s_waitcnt lgkmcnt(1)
    v_mfma_f32_32x32x16_bf16 v[0:15], a[136:139], a[248:251], v[0:15]
    ds_read_b128 a[248:251], v248 offset:16384
    v_fma_f32 v16, v16, s32, -v240
    v_fma_f32 v17, v17, s32, -v240
    v_fma_f32 v18, v18, s32, -v240
    v_fma_f32 v19, v19, s32, -v240
    v_mfma_f32_32x32x16_bf16 v[0:15], a[108:111], a[12:15], v[0:15]
    v_fma_f32 v20, v20, s32, -v240
    v_fma_f32 v21, v21, s32, -v240
    s_cbranch_vccnz L_stub_1_2_1
L_back_1_2_1:
    v_exp_f32 v16, v16
    s_waitcnt lgkmcnt(1)
    v_mfma_f32_32x32x16_bf16 v[0:15], a[140:143], a[252:255], v[0:15]
    ds_read_b128 a[252:255], v249 offset:16384
    v_fma_f32 v22, v22, s32, -v240
    v_exp_f32 v17, v17
    v_fma_f32 v23, v23, s32, -v240
    v_mfma_f32_32x32x16_bf16 v[0:15], a[112:115], a[16:19], v[0:15]
    v_exp_f32 v18, v18
    v_fma_f32 v24, v24, s32, -v240
    v_exp_f32 v19, v19
    s_waitcnt lgkmcnt(1)
    v_mfma_f32_32x32x16_bf16 v[0:15], a[144:147], a[248:251], v[0:15]
    ds_read_b128 a[248:251], v250 offset:16384
    v_fma_f32 v25, v25, s32, -v240
    v_cvt_pk_bf16_f32 v56, v16, v17
    v_exp_f32 v20, v20
    v_mfma_f32_32x32x16_bf16 v[0:15], a[116:119], a[20:23], v[0:15]
    s_add_u32 s35, s28, 20480
    buffer_store_dwordx4 v[184:187], v252, s[20:23], s35 offen sc1
    v_fma_f32 v26, v26, s32, -v240
    v_exp_f32 v21, v21
    s_waitcnt lgkmcnt(1)
    v_mfma_f32_32x32x16_bf16 v[0:15], a[148:151], a[252:255], v[0:15]
    ds_read_b128 a[252:255], v251 offset:16384
    s_add_u32 s35, s28, 20480
    buffer_store_dwordx4 a[216:219], v252, s[20:23], s35 offen offset:128 sc1
    v_fma_f32 v27, v27, s32, -v240
    v_cvt_pk_bf16_f32 v57, v18, v19
    v_mfma_f32_32x32x16_bf16 v[0:15], a[120:123], a[24:27], v[0:15]
    s_add_u32 s35, s28, 20480
    buffer_store_dwordx4 v[224:227], v252, s[20:23], s35 offen offset:256 sc1
    v_exp_f32 v22, v22
    v_fma_f32 v28, v28, s32, -v240
    s_waitcnt lgkmcnt(1)
    v_mfma_f32_32x32x16_bf16 v[0:15], a[152:155], a[248:251], v[0:15]
    v_add_u32 v248, 32768, v248
    v_add_u32 v249, 32768, v249
    v_add_u32 v250, 32768, v250
    v_add_u32 v251, 32768, v251
    ds_read_b128 a[248:251], v248
    s_add_u32 s35, s28, 20480
    buffer_store_dwordx4 v[128:131], v252, s[20:23], s35 offen offset:384 sc1
    v_exp_f32 v23, v23
    v_mfma_f32_32x32x16_bf16 v[0:15], a[124:127], a[28:31], v[0:15]
    v_fma_f32 v29, v29, s32, -v240
    v_cvt_pk_bf16_f32 v58, v20, v21
    v_exp_f32 v24, v24
    v_fma_f32 v30, v30, s32, -v240
    v_exp_f32 v25, v25
    v_fma_f32 v31, v31, s32, -v240
    s_waitcnt lgkmcnt(1)
    v_mfma_f32_32x32x16_bf16 v[0:15], a[156:159], a[252:255], v[0:15]
    ds_read_b128 a[252:255], v249
    v_cvt_pk_bf16_f32 v59, v22, v23
    v_exp_f32 v26, v26
    v_exp_f32 v27, v27
    v_cvt_pk_bf16_f32 v60, v24, v25
    v_exp_f32 v28, v28
    v_mfma_f32_4x4x4_16b_bf16 v[232:235], v[236:237], v[54:55], v[232:235] cbsz:4 abid:1
    v_exp_f32 v29, v29
    v_cvt_pk_bf16_f32 v61, v26, v27
    v_mfma_f32_4x4x4_16b_bf16 v[232:235], v[236:237], v[56:57], v[232:235] cbsz:4 abid:2
    v_exp_f32 v30, v30
    v_exp_f32 v31, v31
    v_mfma_f32_4x4x4_16b_bf16 v[232:235], v[236:237], v[58:59], v[232:235] cbsz:4 abid:2
    v_cvt_pk_bf16_f32 v62, v28, v29
    v_cvt_pk_bf16_f32 v63, v30, v31
    v_mfma_f32_4x4x4_16b_bf16 v[232:235], v[236:237], v[60:61], v[232:235] cbsz:4 abid:2
    v_mfma_f32_32x32x16_bf16 v[16:31], a[96:99], a[32:35], 0
    v_max3_f32 v241, v0, v1, v241
    v_max3_f32 v241, v2, v3, v241
    v_max3_f32 v241, v4, v5, v241
    v_max3_f32 v241, v6, v7, v241
    s_waitcnt lgkmcnt(1)
    v_mfma_f32_32x32x16_bf16 v[16:31], a[128:131], a[248:251], v[16:31]
    ds_read_b128 a[248:251], v250
    v_max3_f32 v241, v8, v9, v241
    v_max3_f32 v241, v10, v11, v241
    v_max3_f32 v241, v12, v13, v241
    v_max3_f32 v241, v14, v15, v241
    v_mfma_f32_32x32x16_bf16 v[16:31], a[100:103], a[36:39], v[16:31]
    v_fma_f32 v254, v241, s32, -v238
    v_cmp_lt_f32 vcc, s33, v254
    v_fma_f32 v0, v0, s32, -v238
    v_fma_f32 v1, v1, s32, -v238
    s_waitcnt lgkmcnt(1)
    v_mfma_f32_32x32x16_bf16 v[16:31], a[132:135], a[252:255], v[16:31]
    ds_read_b128 a[252:255], v251
    v_fma_f32 v2, v2, s32, -v238
    v_fma_f32 v3, v3, s32, -v238
    v_fma_f32 v4, v4, s32, -v238
    v_fma_f32 v5, v5, s32, -v238
    v_mfma_f32_32x32x16_bf16 v[16:31], a[104:107], a[40:43], v[16:31]
    s_cbranch_vccnz L_stub_1_0_2
L_back_1_0_2:
    v_exp_f32 v0, v0
    v_fma_f32 v6, v6, s32, -v238
    v_exp_f32 v1, v1
    s_waitcnt lgkmcnt(1)
    v_mfma_f32_32x32x16_bf16 v[16:31], a[136:139], a[248:251], v[16:31]
    ds_read_b128 a[248:251], v248 offset:49152
    v_fma_f32 v7, v7, s32, -v238
    v_exp_f32 v2, v2
    v_fma_f32 v8, v8, s32, -v238
    v_mfma_f32_32x32x16_bf16 v[16:31], a[108:111], a[44:47], v[16:31]
    v_exp_f32 v3, v3
    v_fma_f32 v9, v9, s32, -v238
    v_cvt_pk_bf16_f32 v0, v0, v1
    s_waitcnt lgkmcnt(1)
    v_mfma_f32_32x32x16_bf16 v[16:31], a[140:143], a[252:255], v[16:31]
    ds_read_b128 a[252:255], v249 offset:49152
    v_accvgpr_write_b32 a176, v0
    v_exp_f32 v4, v4
    v_fma_f32 v10, v10, s32, -v238
    v_mfma_f32_32x32x16_bf16 v[16:31], a[112:115], a[48:51], v[16:31]
    v_exp_f32 v5, v5
    v_fma_f32 v11, v11, s32, -v238
    v_cvt_pk_bf16_f32 v2, v2, v3
    s_waitcnt lgkmcnt(1)
    v_mfma_f32_32x32x16_bf16 v[16:31], a[144:147], a[248:251], v[16:31]
    ds_read_b128 a[248:251], v250 offset:49152
    v_accvgpr_write_b32 a177, v2
    v_exp_f32 v6, v6
    v_fma_f32 v12, v12, s32, -v238
    v_mfma_f32_32x32x16_bf16 v[16:31], a[116:119], a[52:55], v[16:31]
    v_exp_f32 v7, v7
    v_fma_f32 v13, v13, s32, -v238
    v_cvt_pk_bf16_f32 v4, v4, v5
    s_waitcnt lgkmcnt(1)
    v_mfma_f32_32x32x16_bf16 v[16:31], a[148:151], a[252:255], v[16:31]
    ds_read_b128 a[252:255], v251 offset:49152
    v_accvgpr_write_b32 a178, v4
    v_exp_f32 v8, v8
    v_fma_f32 v14, v14, s32, -v238
    v_mfma_f32_32x32x16_bf16 v[16:31], a[120:123], a[56:59], v[16:31]
    v_exp_f32 v9, v9
    v_fma_f32 v15, v15, s32, -v238
    v_cvt_pk_bf16_f32 v6, v6, v7
    s_waitcnt lgkmcnt(1)
    v_mfma_f32_32x32x16_bf16 v[16:31], a[152:155], a[248:251], v[16:31]
    ds_read_b128 a[248:251], v248 offset:32768
    v_accvgpr_write_b32 a179, v6
    v_exp_f32 v10, v10
    v_exp_f32 v11, v11
    v_mfma_f32_32x32x16_bf16 v[16:31], a[124:127], a[60:63], v[16:31]
    v_cvt_pk_bf16_f32 v8, v8, v9
    v_accvgpr_write_b32 a180, v8
    v_exp_f32 v12, v12
    s_waitcnt lgkmcnt(1)
    v_mfma_f32_32x32x16_bf16 v[16:31], a[156:159], a[252:255], v[16:31]
    ds_read_b128 a[252:255], v249 offset:32768
    v_exp_f32 v13, v13
    v_cvt_pk_bf16_f32 v10, v10, v11
    v_accvgpr_write_b32 a181, v10
    v_mfma_f32_4x4x4_16b_bf16 v[232:235], v[236:237], v[62:63], v[232:235] cbsz:4 abid:2
    v_exp_f32 v14, v14
    v_exp_f32 v15, v15
    v_mfma_f32_4x4x4_16b_bf16 v[232:235], v[236:237], a[176:177], v[232:235] cbsz:4 abid:0
    v_cvt_pk_bf16_f32 v12, v12, v13
    v_accvgpr_write_b32 a182, v12
    v_mfma_f32_4x4x4_16b_bf16 v[232:235], v[236:237], a[178:179], v[232:235] cbsz:4 abid:0
    v_cvt_pk_bf16_f32 v14, v14, v15
    v_accvgpr_write_b32 a183, v14
    v_mfma_f32_4x4x4_16b_bf16 v[232:235], v[236:237], a[180:181], v[232:235] cbsz:4 abid:0
    v_mfma_f32_32x32x16_bf16 v[0:15], a[96:99], a[64:67], 0
    ds_read_b128 a[96:99], v244 offset:16384
    v_max3_f32 v242, v16, v17, v242
    v_max3_f32 v242, v18, v19, v242
    v_max3_f32 v242, v20, v21, v242
    s_waitcnt lgkmcnt(2)
    v_mfma_f32_32x32x16_bf16 v[0:15], a[128:131], a[248:251], v[0:15]
    ds_read_b128 a[248:251], v250 offset:32768
    ds_read_b128 a[128:131], v244 offset:24576
    v_max3_f32 v242, v22, v23, v242
    v_max3_f32 v242, v24, v25, v242
    v_max3_f32 v242, v26, v27, v242
    v_mfma_f32_32x32x16_bf16 v[0:15], a[100:103], a[68:71], v[0:15]
    ds_read_b128 a[100:103], v245 offset:16384
    v_max3_f32 v242, v28, v29, v242
    v_max3_f32 v242, v30, v31, v242
    v_fma_f32 v254, v242, s32, -v239
    v_cmp_lt_f32 vcc, s33, v254
    s_waitcnt lgkmcnt(4)
    v_mfma_f32_32x32x16_bf16 v[0:15], a[132:135], a[252:255], v[0:15]
    ds_read_b128 a[252:255], v251 offset:32768
    ds_read_b128 a[132:135], v245 offset:24576
    v_fma_f32 v16, v16, s32, -v239
    v_fma_f32 v17, v17, s32, -v239
    v_fma_f32 v18, v18, s32, -v239
    v_mfma_f32_32x32x16_bf16 v[0:15], a[104:107], a[72:75], v[0:15]
    ds_read_b128 a[104:107], v246 offset:16384
    v_fma_f32 v19, v19, s32, -v239
    v_fma_f32 v20, v20, s32, -v239
    v_fma_f32 v21, v21, s32, -v239
    s_waitcnt lgkmcnt(5)
    v_mfma_f32_32x32x16_bf16 v[0:15], a[136:139], a[248:251], v[0:15]
    ds_read_b128 a[248:251], v248 offset:16384
    ds_read_b128 a[136:139], v246 offset:24576
    s_cbranch_vccnz L_stub_1_1_2
L_back_1_1_2:
    v_exp_f32 v16, v16
    v_fma_f32 v22, v22, s32, -v239
    v_mfma_f32_32x32x16_bf16 v[0:15], a[108:111], a[76:79], v[0:15]
    ds_read_b128 a[108:111], v247 offset:16384
    s_add_u32 s35, s28, 24576
    buffer_store_dwordx4 v[188:191], v253, s[20:23], s35 offen sc1
    v_exp_f32 v17, v17
    s_waitcnt lgkmcnt(5)
    v_mfma_f32_32x32x16_bf16 v[0:15], a[140:143], a[252:255], v[0:15]
    ds_read_b128 a[252:255], v249 offset:16384
    ds_read_b128 a[140:143], v247 offset:24576
    s_add_u32 s35, s28, 24576
    buffer_store_dwordx4 a[220:223], v253, s[20:23], s35 offen offset:128 sc1
    v_fma_f32 v23, v23, s32, -v239
    v_mfma_f32_32x32x16_bf16 v[0:15], a[112:115], a[80:83], v[0:15]
    ds_read_b128 a[112:115], v244 offset:20480
    s_add_u32 s35, s28, 24576
    buffer_store_dwordx4 v[228:231], v253, s[20:23], s35 offen offset:256 sc1
    v_exp_f32 v18, v18
    v_fma_f32 v24, v24, s32, -v239
    s_waitcnt lgkmcnt(5)
    v_mfma_f32_32x32x16_bf16 v[0:15], a[144:147], a[248:251], v[0:15]
    ds_read_b128 a[248:251], v250 offset:16384
    ds_read_b128 a[144:147], v244 offset:28672
    s_add_u32 s35, s28, 24576
    buffer_store_dwordx4 v[132:135], v253, s[20:23], s35 offen offset:384 sc1
    v_exp_f32 v19, v19
    v_fma_f32 v25, v25, s32, -v239
    v_mfma_f32_32x32x16_bf16 v[0:15], a[116:119], a[84:87], v[0:15]
    ds_read_b128 a[116:119], v245 offset:20480
    v_cvt_pk_bf16_f32 v64, v16, v17
    v_exp_f32 v20, v20
    v_fma_f32 v26, v26, s32, -v239
    s_waitcnt lgkmcnt(5)
    v_mfma_f32_32x32x16_bf16 v[0:15], a[148:151], a[252:255], v[0:15]
    ds_read_b128 a[252:255], v251 offset:16384
    ds_read_b128 a[148:151], v245 offset:28672
    v_exp_f32 v21, v21
    v_fma_f32 v27, v27, s32, -v239
    v_cvt_pk_bf16_f32 v65, v18, v19
    v_mfma_f32_32x32x16_bf16 v[0:15], a[120:123], a[88:91], v[0:15]
    ds_read_b128 a[120:123], v246 offset:20480
    v_exp_f32 v22, v22
    v_fma_f32 v28, v28, s32, -v239
    v_exp_f32 v23, v23
    s_waitcnt lgkmcnt(5)
    v_mfma_f32_32x32x16_bf16 v[0:15], a[152:155], a[248:251], v[0:15]
    v_subrev_u32 v248, 32768, v248
    v_subrev_u32 v249, 32768, v249
    v_subrev_u32 v250, 32768, v250
    v_subrev_u32 v251, 32768, v251
    ds_read_b128 a[248:251], v248
    ds_read_b128 a[152:155], v246 offset:28672
    v_fma_f32 v29, v29, s32, -v239
    v_cvt_pk_bf16_f32 v66, v20, v21
    v_mfma_f32_32x32x16_bf16 v[0:15], a[124:127], a[92:95], v[0:15]
    ds_read_b128 a[124:127], v247 offset:20480
    v_exp_f32 v24, v24
    v_fma_f32 v30, v30, s32, -v239
    v_exp_f32 v25, v25
    v_fma_f32 v31, v31, s32, -v239
    v_cvt_pk_bf16_f32 v67, v22, v23
    s_waitcnt lgkmcnt(5)
    v_mfma_f32_32x32x16_bf16 v[0:15], a[156:159], a[252:255], v[0:15]
    ds_read_b128 a[252:255], v249
    ds_read_b128 a[156:159], v247 offset:28672
    v_exp_f32 v26, v26
    v_exp_f32 v27, v27
    v_cvt_pk_bf16_f32 v68, v24, v25
    v_exp_f32 v28, v28
    v_mfma_f32_4x4x4_16b_bf16 v[232:235], v[236:237], a[182:183], v[232:235] cbsz:4 abid:0
    v_exp_f32 v29, v29
    v_cvt_pk_bf16_f32 v69, v26, v27
    v_mfma_f32_4x4x4_16b_bf16 v[232:235], v[236:237], v[64:65], v[232:235] cbsz:4 abid:1
    v_exp_f32 v30, v30
    v_exp_f32 v31, v31
    v_mfma_f32_4x4x4_16b_bf16 v[232:235], v[236:237], v[66:67], v[232:235] cbsz:4 abid:1
    v_cvt_pk_bf16_f32 v70, v28, v29
    v_cvt_pk_bf16_f32 v71, v30, v31
    v_mfma_f32_4x4x4_16b_bf16 v[232:235], v[236:237], v[68:69], v[232:235] cbsz:4 abid:1
    v_mfma_f32_32x32x16_bf16 v[16:31], a[96:99], a[0:3], 0
    s_waitcnt lgkmcnt(0)
    s_waitcnt vmcnt(32)
    s_barrier
    s_add_u32 m0, s30, 16384
    s_add_u32 s35, s25, 16384
    buffer_load_dwordx4 v252, s[12:15], s35 offen nt lds
    v_mfma_f32_32x32x16_bf16 v[16:31], a[128:131], a[248:251], v[16:31]
    ds_read_b128 a[248:251], v250
    s_add_u32 s35, s25, 48128
    buffer_load_dwordx4 v253, s[12:15], s35 offen offset:1024 nt lds
    v_max3_f32 v243, v0, v1, v243
    v_max3_f32 v243, v2, v3, v243
    v_mfma_f32_32x32x16_bf16 v[16:31], a[100:103], a[4:7], v[16:31]
    s_add_u32 s35, s25, 96256
    buffer_load_dwordx4 v252, s[12:15], s35 offen offset:2048 nt lds
    v_max3_f32 v243, v4, v5, v243
    v_max3_f32 v243, v6, v7, v243
    v_mfma_f32_32x32x16_bf16 v[16:31], a[132:135], a[252:255], v[16:31]
    ds_read_b128 a[252:255], v251
    s_add_u32 s35, s25, 128000
    buffer_load_dwordx4 v253, s[12:15], s35 offen offset:3072 nt lds
    v_max3_f32 v243, v8, v9, v243
    v_max3_f32 v243, v10, v11, v243
    v_mfma_f32_32x32x16_bf16 v[16:31], a[104:107], a[8:11], v[16:31]
    v_max3_f32 v243, v12, v13, v243
    v_max3_f32 v243, v14, v15, v243
    v_fma_f32 v254, v243, s32, -v240
    v_cmp_lt_f32 vcc, s33, v254
    s_waitcnt lgkmcnt(1)
    v_mfma_f32_32x32x16_bf16 v[16:31], a[136:139], a[248:251], v[16:31]
    ds_read_b128 a[248:251], v248 offset:16384
    v_fma_f32 v0, v0, s32, -v240
    v_fma_f32 v1, v1, s32, -v240
    v_fma_f32 v2, v2, s32, -v240
    v_fma_f32 v3, v3, s32, -v240
    v_mfma_f32_32x32x16_bf16 v[16:31], a[108:111], a[12:15], v[16:31]
    v_fma_f32 v4, v4, s32, -v240
    v_fma_f32 v5, v5, s32, -v240
    s_cbranch_vccnz L_stub_1_2_2
L_back_1_2_2:
    v_exp_f32 v0, v0
    s_waitcnt lgkmcnt(1)
    v_mfma_f32_32x32x16_bf16 v[16:31], a[140:143], a[252:255], v[16:31]
    ds_read_b128 a[252:255], v249 offset:16384
    v_fma_f32 v6, v6, s32, -v240
    v_exp_f32 v1, v1
    v_fma_f32 v7, v7, s32, -v240
    v_mfma_f32_32x32x16_bf16 v[16:31], a[112:115], a[16:19], v[16:31]
    v_exp_f32 v2, v2
    v_fma_f32 v8, v8, s32, -v240
    v_exp_f32 v3, v3
    s_waitcnt lgkmcnt(1)
    v_mfma_f32_32x32x16_bf16 v[16:31], a[144:147], a[248:251], v[16:31]
    ds_read_b128 a[248:251], v250 offset:16384
    v_fma_f32 v9, v9, s32, -v240
    v_cvt_pk_bf16_f32 v72, v0, v1
    v_exp_f32 v4, v4
    v_mfma_f32_32x32x16_bf16 v[16:31], a[116:119], a[20:23], v[16:31]
    s_add_u32 s35, s28, 28672
    buffer_store_dwordx4 a[224:227], v252, s[20:23], s35 offen sc1
    v_fma_f32 v10, v10, s32, -v240
    v_exp_f32 v5, v5
    s_waitcnt lgkmcnt(1)
    v_mfma_f32_32x32x16_bf16 v[16:31], a[148:151], a[252:255], v[16:31]
    ds_read_b128 a[252:255], v251 offset:16384
    s_add_u32 s35, s28, 28672
    buffer_store_dwordx4 v[144:147], v252, s[20:23], s35 offen offset:128 sc1
    v_fma_f32 v11, v11, s32, -v240
    v_cvt_pk_bf16_f32 v73, v2, v3
    v_mfma_f32_32x32x16_bf16 v[16:31], a[120:123], a[24:27], v[16:31]
    s_add_u32 s35, s28, 28672
    buffer_store_dwordx4 a[240:243], v252, s[20:23], s35 offen offset:256 sc1
    v_exp_f32 v6, v6
    v_fma_f32 v12, v12, s32, -v240
    s_waitcnt lgkmcnt(1)
    v_mfma_f32_32x32x16_bf16 v[16:31], a[152:155], a[248:251], v[16:31]
    v_add_u32 v248, 32768, v248
    v_add_u32 v249, 32768, v249
    v_add_u32 v250, 32768, v250
    v_add_u32 v251, 32768, v251
    ds_read_b128 a[248:251], v248
    s_add_u32 s35, s28, 28672
    buffer_store_dwordx4 v[136:139], v252, s[20:23], s35 offen offset:384 sc1
    v_exp_f32 v7, v7
    v_mfma_f32_32x32x16_bf16 v[16:31], a[124:127], a[28:31], v[16:31]
    v_fma_f32 v13, v13, s32, -v240
    v_cvt_pk_bf16_f32 v74, v4, v5
    v_exp_f32 v8, v8
    v_fma_f32 v14, v14, s32, -v240
    v_exp_f32 v9, v9
    v_fma_f32 v15, v15, s32, -v240
    s_waitcnt lgkmcnt(1)
    v_mfma_f32_32x32x16_bf16 v[16:31], a[156:159], a[252:255], v[16:31]
    ds_read_b128 a[252:255], v249
    v_cvt_pk_bf16_f32 v75, v6, v7
    v_exp_f32 v10, v10
    v_exp_f32 v11, v11
    v_cvt_pk_bf16_f32 v76, v8, v9
    v_exp_f32 v12, v12
    v_mfma_f32_4x4x4_16b_bf16 v[232:235], v[236:237], v[70:71], v[232:235] cbsz:4 abid:1
    v_exp_f32 v13, v13
    v_cvt_pk_bf16_f32 v77, v10, v11
    v_mfma_f32_4x4x4_16b_bf16 v[232:235], v[236:237], v[72:73], v[232:235] cbsz:4 abid:2
    v_exp_f32 v14, v14
    v_exp_f32 v15, v15
    v_mfma_f32_4x4x4_16b_bf16 v[232:235], v[236:237], v[74:75], v[232:235] cbsz:4 abid:2
    v_cvt_pk_bf16_f32 v78, v12, v13
    v_cvt_pk_bf16_f32 v79, v14, v15
    v_mfma_f32_4x4x4_16b_bf16 v[232:235], v[236:237], v[76:77], v[232:235] cbsz:4 abid:2
    v_mfma_f32_32x32x16_bf16 v[0:15], a[96:99], a[32:35], 0
    v_max3_f32 v241, v16, v17, v241
    v_max3_f32 v241, v18, v19, v241
    v_max3_f32 v241, v20, v21, v241
    v_max3_f32 v241, v22, v23, v241
    s_waitcnt lgkmcnt(1)
    v_mfma_f32_32x32x16_bf16 v[0:15], a[128:131], a[248:251], v[0:15]
    ds_read_b128 a[248:251], v250
    v_max3_f32 v241, v24, v25, v241
    v_max3_f32 v241, v26, v27, v241
    v_max3_f32 v241, v28, v29, v241
    v_max3_f32 v241, v30, v31, v241
    v_mfma_f32_32x32x16_bf16 v[0:15], a[100:103], a[36:39], v[0:15]
    v_fma_f32 v254, v241, s32, -v238
    v_cmp_lt_f32 vcc, s33, v254
    v_fma_f32 v16, v16, s32, -v238
    v_fma_f32 v17, v17, s32, -v238
    s_waitcnt lgkmcnt(1)
    v_mfma_f32_32x32x16_bf16 v[0:15], a[132:135], a[252:255], v[0:15]
    ds_read_b128 a[252:255], v251
    v_fma_f32 v18, v18, s32, -v238
    v_fma_f32 v19, v19, s32, -v238
    v_fma_f32 v20, v20, s32, -v238
    v_fma_f32 v21, v21, s32, -v238
    v_mfma_f32_32x32x16_bf16 v[0:15], a[104:107], a[40:43], v[0:15]
    s_cbranch_vccnz L_stub_1_0_3
L_back_1_0_3:
    v_exp_f32 v16, v16
    v_fma_f32 v22, v22, s32, -v238
    v_exp_f32 v17, v17
    s_waitcnt lgkmcnt(1)
    v_mfma_f32_32x32x16_bf16 v[0:15], a[136:139], a[248:251], v[0:15]
    ds_read_b128 a[248:251], v248 offset:49152
    v_fma_f32 v23, v23, s32, -v238
    v_exp_f32 v18, v18
    v_fma_f32 v24, v24, s32, -v238
    v_mfma_f32_32x32x16_bf16 v[0:15], a[108:111], a[44:47], v[0:15]
    v_exp_f32 v19, v19
    v_fma_f32 v25, v25, s32, -v238
    v_cvt_pk_bf16_f32 v16, v16, v17
    s_waitcnt lgkmcnt(1)
    v_mfma_f32_32x32x16_bf16 v[0:15], a[140:143], a[252:255], v[0:15]
    ds_read_b128 a[252:255], v249 offset:49152
    v_accvgpr_write_b32 a184, v16
    v_exp_f32 v20, v20
    v_fma_f32 v26, v26, s32, -v238
    v_mfma_f32_32x32x16_bf16 v[0:15], a[112:115], a[48:51], v[0:15]
    v_exp_f32 v21, v21
    v_fma_f32 v27, v27, s32, -v238
    v_cvt_pk_bf16_f32 v18, v18, v19
    s_waitcnt lgkmcnt(1)
    v_mfma_f32_32x32x16_bf16 v[0:15], a[144:147], a[248:251], v[0:15]
    ds_read_b128 a[248:251], v250 offset:49152
    v_accvgpr_write_b32 a185, v18
    v_exp_f32 v22, v22
    v_fma_f32 v28, v28, s32, -v238
    v_mfma_f32_32x32x16_bf16 v[0:15], a[116:119], a[52:55], v[0:15]
    v_exp_f32 v23, v23
    v_fma_f32 v29, v29, s32, -v238
    v_cvt_pk_bf16_f32 v20, v20, v21
    s_waitcnt lgkmcnt(1)
    v_mfma_f32_32x32x16_bf16 v[0:15], a[148:151], a[252:255], v[0:15]
    ds_read_b128 a[252:255], v251 offset:49152
    v_accvgpr_write_b32 a186, v20
    v_exp_f32 v24, v24
    v_fma_f32 v30, v30, s32, -v238
    v_mfma_f32_32x32x16_bf16 v[0:15], a[120:123], a[56:59], v[0:15]
    v_exp_f32 v25, v25
    v_fma_f32 v31, v31, s32, -v238
    v_cvt_pk_bf16_f32 v22, v22, v23
    s_waitcnt lgkmcnt(1)
    v_mfma_f32_32x32x16_bf16 v[0:15], a[152:155], a[248:251], v[0:15]
    ds_read_b128 a[248:251], v248 offset:32768
    v_accvgpr_write_b32 a187, v22
    v_exp_f32 v26, v26
    v_exp_f32 v27, v27
    v_mfma_f32_32x32x16_bf16 v[0:15], a[124:127], a[60:63], v[0:15]
    v_cvt_pk_bf16_f32 v24, v24, v25
    v_accvgpr_write_b32 a188, v24
    v_exp_f32 v28, v28
    s_waitcnt lgkmcnt(1)
    v_mfma_f32_32x32x16_bf16 v[0:15], a[156:159], a[252:255], v[0:15]
    ds_read_b128 a[252:255], v249 offset:32768
    v_exp_f32 v29, v29
    v_cvt_pk_bf16_f32 v26, v26, v27
    v_accvgpr_write_b32 a189, v26
    v_mfma_f32_4x4x4_16b_bf16 v[232:235], v[236:237], v[78:79], v[232:235] cbsz:4 abid:2
    v_exp_f32 v30, v30
    v_exp_f32 v31, v31
    v_mfma_f32_4x4x4_16b_bf16 v[232:235], v[236:237], a[184:185], v[232:235] cbsz:4 abid:0
    v_cvt_pk_bf16_f32 v28, v28, v29
    v_accvgpr_write_b32 a190, v28
    v_mfma_f32_4x4x4_16b_bf16 v[232:235], v[236:237], a[186:187], v[232:235] cbsz:4 abid:0
    v_cvt_pk_bf16_f32 v30, v30, v31
    v_accvgpr_write_b32 a191, v30
    v_mfma_f32_4x4x4_16b_bf16 v[232:235], v[236:237], a[188:189], v[232:235] cbsz:4 abid:0
    v_mfma_f32_32x32x16_bf16 v[16:31], a[96:99], a[64:67], 0
    ds_read_b128 a[96:99], v244 offset:32768
    v_max3_f32 v242, v0, v1, v242
    v_max3_f32 v242, v2, v3, v242
    v_max3_f32 v242, v4, v5, v242
    s_waitcnt lgkmcnt(2)
    v_mfma_f32_32x32x16_bf16 v[16:31], a[128:131], a[248:251], v[16:31]
    ds_read_b128 a[248:251], v250 offset:32768
    ds_read_b128 a[128:131], v244 offset:40960
    v_max3_f32 v242, v6, v7, v242
    v_max3_f32 v242, v8, v9, v242
    v_max3_f32 v242, v10, v11, v242
    v_mfma_f32_32x32x16_bf16 v[16:31], a[100:103], a[68:71], v[16:31]
    ds_read_b128 a[100:103], v245 offset:32768
    v_max3_f32 v242, v12, v13, v242
    v_max3_f32 v242, v14, v15, v242
    v_fma_f32 v254, v242, s32, -v239
    v_cmp_lt_f32 vcc, s33, v254
    s_waitcnt lgkmcnt(4)
    v_mfma_f32_32x32x16_bf16 v[16:31], a[132:135], a[252:255], v[16:31]
    ds_read_b128 a[252:255], v251 offset:32768
    ds_read_b128 a[132:135], v245 offset:40960
    v_fma_f32 v0, v0, s32, -v239
    v_fma_f32 v1, v1, s32, -v239
    v_fma_f32 v2, v2, s32, -v239
    v_mfma_f32_32x32x16_bf16 v[16:31], a[104:107], a[72:75], v[16:31]
    ds_read_b128 a[104:107], v246 offset:32768
    v_fma_f32 v3, v3, s32, -v239
    v_fma_f32 v4, v4, s32, -v239
    v_fma_f32 v5, v5, s32, -v239
    s_waitcnt lgkmcnt(5)
    v_mfma_f32_32x32x16_bf16 v[16:31], a[136:139], a[248:251], v[16:31]
    ds_read_b128 a[248:251], v248 offset:16384
    ds_read_b128 a[136:139], v246 offset:40960
    s_cbranch_vccnz L_stub_1_1_3
L_back_1_1_3:
    v_exp_f32 v0, v0
    v_fma_f32 v6, v6, s32, -v239
    v_mfma_f32_32x32x16_bf16 v[16:31], a[108:111], a[76:79], v[16:31]
    ds_read_b128 a[108:111], v247 offset:32768
    s_add_u32 s35, s28, 32768
    buffer_store_dwordx4 a[228:231], v253, s[20:23], s35 offen sc1
    v_exp_f32 v1, v1
    s_waitcnt lgkmcnt(5)
    v_mfma_f32_32x32x16_bf16 v[16:31], a[140:143], a[252:255], v[16:31]
    ds_read_b128 a[252:255], v249 offset:16384
    ds_read_b128 a[140:143], v247 offset:40960
    s_add_u32 s35, s28, 32768
    buffer_store_dwordx4 v[148:151], v253, s[20:23], s35 offen offset:128 sc1
    v_fma_f32 v7, v7, s32, -v239
    v_mfma_f32_32x32x16_bf16 v[16:31], a[112:115], a[80:83], v[16:31]
    ds_read_b128 a[112:115], v244 offset:36864
    s_add_u32 s35, s28, 32768
    buffer_store_dwordx4 a[244:247], v253, s[20:23], s35 offen offset:256 sc1
    v_exp_f32 v2, v2
    v_fma_f32 v8, v8, s32, -v239
    s_waitcnt lgkmcnt(5)
    v_mfma_f32_32x32x16_bf16 v[16:31], a[144:147], a[248:251], v[16:31]
    ds_read_b128 a[248:251], v250 offset:16384
    ds_read_b128 a[144:147], v244 offset:45056
    s_add_u32 s35, s28, 32768
    buffer_store_dwordx4 v[140:143], v253, s[20:23], s35 offen offset:384 sc1
    v_exp_f32 v3, v3
    v_fma_f32 v9, v9, s32, -v239
    v_mfma_f32_32x32x16_bf16 v[16:31], a[116:119], a[84:87], v[16:31]
    ds_read_b128 a[116:119], v245 offset:36864
    v_cvt_pk_bf16_f32 v80, v0, v1
    v_exp_f32 v4, v4
    v_fma_f32 v10, v10, s32, -v239
    s_waitcnt lgkmcnt(5)
    v_mfma_f32_32x32x16_bf16 v[16:31], a[148:151], a[252:255], v[16:31]
    ds_read_b128 a[252:255], v251 offset:16384
    ds_read_b128 a[148:151], v245 offset:45056
    v_exp_f32 v5, v5
    v_fma_f32 v11, v11, s32, -v239
    v_cvt_pk_bf16_f32 v81, v2, v3
    v_mfma_f32_32x32x16_bf16 v[16:31], a[120:123], a[88:91], v[16:31]
    ds_read_b128 a[120:123], v246 offset:36864
    v_exp_f32 v6, v6
    v_fma_f32 v12, v12, s32, -v239
    v_exp_f32 v7, v7
    s_waitcnt lgkmcnt(5)
    v_mfma_f32_32x32x16_bf16 v[16:31], a[152:155], a[248:251], v[16:31]
    v_subrev_u32 v248, 32768, v248
    v_subrev_u32 v249, 32768, v249
    v_subrev_u32 v250, 32768, v250
    v_subrev_u32 v251, 32768, v251
    ds_read_b128 a[248:251], v248
    ds_read_b128 a[152:155], v246 offset:45056
    v_fma_f32 v13, v13, s32, -v239
    v_cvt_pk_bf16_f32 v82, v4, v5
    v_mfma_f32_32x32x16_bf16 v[16:31], a[124:127], a[92:95], v[16:31]
    ds_read_b128 a[124:127], v247 offset:36864
    v_exp_f32 v8, v8
    v_fma_f32 v14, v14, s32, -v239
    v_exp_f32 v9, v9
    v_fma_f32 v15, v15, s32, -v239
    v_cvt_pk_bf16_f32 v83, v6, v7
    s_waitcnt lgkmcnt(5)
    v_mfma_f32_32x32x16_bf16 v[16:31], a[156:159], a[252:255], v[16:31]
    ds_read_b128 a[252:255], v249
    ds_read_b128 a[156:159], v247 offset:45056
    v_exp_f32 v10, v10
    v_exp_f32 v11, v11
    v_cvt_pk_bf16_f32 v84, v8, v9
    v_exp_f32 v12, v12
    v_mfma_f32_4x4x4_16b_bf16 v[232:235], v[236:237], a[190:191], v[232:235] cbsz:4 abid:0
    v_exp_f32 v13, v13
    v_cvt_pk_bf16_f32 v85, v10, v11
    v_mfma_f32_4x4x4_16b_bf16 v[232:235], v[236:237], v[80:81], v[232:235] cbsz:4 abid:1
    v_exp_f32 v14, v14
    v_exp_f32 v15, v15
    v_mfma_f32_4x4x4_16b_bf16 v[232:235], v[236:237], v[82:83], v[232:235] cbsz:4 abid:1
    v_cvt_pk_bf16_f32 v86, v12, v13
    v_cvt_pk_bf16_f32 v87, v14, v15
    v_mfma_f32_4x4x4_16b_bf16 v[232:235], v[236:237], v[84:85], v[232:235] cbsz:4 abid:1
    v_mfma_f32_32x32x16_bf16 v[0:15], a[96:99], a[0:3], 0
    s_waitcnt lgkmcnt(0)
    s_waitcnt vmcnt(32)
    s_barrier
    s_add_u32 m0, s30, 32768
    s_add_u32 s35, s25, 151552
    buffer_load_dwordx4 v252, s[12:15], s35 offen nt lds
    v_mfma_f32_32x32x16_bf16 v[0:15], a[128:131], a[248:251], v[0:15]
    ds_read_b128 a[248:251], v250
    s_add_u32 s35, s25, 183296
    buffer_load_dwordx4 v253, s[12:15], s35 offen offset:1024 nt lds
    v_max3_f32 v243, v16, v17, v243
    v_max3_f32 v243, v18, v19, v243
    v_mfma_f32_32x32x16_bf16 v[0:15], a[100:103], a[4:7], v[0:15]
    s_add_u32 s35, s25, 18432
    buffer_load_dwordx4 v252, s[12:15], s35 offen offset:2048 nt lds
    v_max3_f32 v243, v20, v21, v243
    v_max3_f32 v243, v22, v23, v243
    v_mfma_f32_32x32x16_bf16 v[0:15], a[132:135], a[252:255], v[0:15]
    ds_read_b128 a[252:255], v251
    s_add_u32 s35, s25, 50176
    buffer_load_dwordx4 v253, s[12:15], s35 offen offset:3072 nt lds
    v_max3_f32 v243, v24, v25, v243
    v_max3_f32 v243, v26, v27, v243
    v_mfma_f32_32x32x16_bf16 v[0:15], a[104:107], a[8:11], v[0:15]
    v_max3_f32 v243, v28, v29, v243
    v_max3_f32 v243, v30, v31, v243
    v_fma_f32 v254, v243, s32, -v240
    v_cmp_lt_f32 vcc, s33, v254
    s_waitcnt lgkmcnt(1)
    v_mfma_f32_32x32x16_bf16 v[0:15], a[136:139], a[248:251], v[0:15]
    ds_read_b128 a[248:251], v248 offset:16384
    v_fma_f32 v16, v16, s32, -v240
    v_fma_f32 v17, v17, s32, -v240
    v_fma_f32 v18, v18, s32, -v240
    v_fma_f32 v19, v19, s32, -v240
    v_mfma_f32_32x32x16_bf16 v[0:15], a[108:111], a[12:15], v[0:15]
    v_fma_f32 v20, v20, s32, -v240
    v_fma_f32 v21, v21, s32, -v240
    s_cbranch_vccnz L_stub_1_2_3
L_back_1_2_3:
    v_exp_f32 v16, v16
    s_waitcnt lgkmcnt(1)
    v_mfma_f32_32x32x16_bf16 v[0:15], a[140:143], a[252:255], v[0:15]
    ds_read_b128 a[252:255], v249 offset:16384
    v_fma_f32 v22, v22, s32, -v240
    v_exp_f32 v17, v17
    v_fma_f32 v23, v23, s32, -v240
    v_mfma_f32_32x32x16_bf16 v[0:15], a[112:115], a[16:19], v[0:15]
    v_exp_f32 v18, v18
    v_fma_f32 v24, v24, s32, -v240
    v_exp_f32 v19, v19
    s_waitcnt lgkmcnt(1)
    v_mfma_f32_32x32x16_bf16 v[0:15], a[144:147], a[248:251], v[0:15]
    ds_read_b128 a[248:251], v250 offset:16384
    v_fma_f32 v25, v25, s32, -v240
    v_cvt_pk_bf16_f32 v88, v16, v17
    v_exp_f32 v20, v20
    v_mfma_f32_32x32x16_bf16 v[0:15], a[116:119], a[20:23], v[0:15]
    s_add_u32 s35, s28, 4096
    buffer_store_dwordx4 v[208:211], v252, s[20:23], s35 offen offset:256 sc1
    v_fma_f32 v26, v26, s32, -v240
    v_exp_f32 v21, v21
    s_waitcnt lgkmcnt(1)
    v_mfma_f32_32x32x16_bf16 v[0:15], a[148:151], a[252:255], v[0:15]
    ds_read_b128 a[252:255], v251 offset:16384
    s_add_u32 s35, s28, 4096
    buffer_store_dwordx4 v[152:155], v252, s[20:23], s35 offen offset:384 sc1
    v_fma_f32 v27, v27, s32, -v240
    v_cvt_pk_bf16_f32 v89, v18, v19
    v_mfma_f32_32x32x16_bf16 v[0:15], a[120:123], a[24:27], v[0:15]
    s_add_u32 s35, s28, 8192
    buffer_store_dwordx4 v[212:215], v253, s[20:23], s35 offen offset:256 sc1
    v_exp_f32 v22, v22
    v_fma_f32 v28, v28, s32, -v240
    s_waitcnt lgkmcnt(1)
    v_mfma_f32_32x32x16_bf16 v[0:15], a[152:155], a[248:251], v[0:15]
    v_add_u32 v248, 32768, v248
    v_add_u32 v249, 32768, v249
    v_add_u32 v250, 32768, v250
    v_add_u32 v251, 32768, v251
    ds_read_b128 a[248:251], v248
    s_add_u32 s35, s28, 8192
    buffer_store_dwordx4 v[156:159], v253, s[20:23], s35 offen offset:384 sc1
    v_exp_f32 v23, v23
    v_mfma_f32_32x32x16_bf16 v[0:15], a[124:127], a[28:31], v[0:15]
    v_fma_f32 v29, v29, s32, -v240
    v_cvt_pk_bf16_f32 v90, v20, v21
    v_exp_f32 v24, v24
    v_fma_f32 v30, v30, s32, -v240
    v_exp_f32 v25, v25
    v_fma_f32 v31, v31, s32, -v240
    s_waitcnt lgkmcnt(1)
    v_mfma_f32_32x32x16_bf16 v[0:15], a[156:159], a[252:255], v[0:15]
    ds_read_b128 a[252:255], v249
    v_cvt_pk_bf16_f32 v91, v22, v23
    v_exp_f32 v26, v26
    v_exp_f32 v27, v27
    v_cvt_pk_bf16_f32 v92, v24, v25
    v_exp_f32 v28, v28
    v_mfma_f32_4x4x4_16b_bf16 v[232:235], v[236:237], v[86:87], v[232:235] cbsz:4 abid:1
    v_exp_f32 v29, v29
    v_cvt_pk_bf16_f32 v93, v26, v27
    v_mfma_f32_4x4x4_16b_bf16 v[232:235], v[236:237], v[88:89], v[232:235] cbsz:4 abid:2
    v_exp_f32 v30, v30
    v_exp_f32 v31, v31
    v_mfma_f32_4x4x4_16b_bf16 v[232:235], v[236:237], v[90:91], v[232:235] cbsz:4 abid:2
    v_cvt_pk_bf16_f32 v94, v28, v29
    v_cvt_pk_bf16_f32 v95, v30, v31
    v_mfma_f32_4x4x4_16b_bf16 v[232:235], v[236:237], v[92:93], v[232:235] cbsz:4 abid:2
    v_mfma_f32_32x32x16_bf16 v[16:31], a[96:99], a[32:35], 0
    v_max3_f32 v241, v0, v1, v241
    v_max3_f32 v241, v2, v3, v241
    v_max3_f32 v241, v4, v5, v241
    v_max3_f32 v241, v6, v7, v241
    s_waitcnt lgkmcnt(1)
    v_mfma_f32_32x32x16_bf16 v[16:31], a[128:131], a[248:251], v[16:31]
    ds_read_b128 a[248:251], v250
    v_max3_f32 v241, v8, v9, v241
    v_max3_f32 v241, v10, v11, v241
    v_max3_f32 v241, v12, v13, v241
    v_max3_f32 v241, v14, v15, v241
    v_mfma_f32_32x32x16_bf16 v[16:31], a[100:103], a[36:39], v[16:31]
    v_fma_f32 v254, v241, s32, -v238
    v_cmp_lt_f32 vcc, s33, v254
    v_fma_f32 v0, v0, s32, -v238
    v_fma_f32 v1, v1, s32, -v238
    s_waitcnt lgkmcnt(1)
    v_mfma_f32_32x32x16_bf16 v[16:31], a[132:135], a[252:255], v[16:31]
    ds_read_b128 a[252:255], v251
    v_fma_f32 v2, v2, s32, -v238
    v_fma_f32 v3, v3, s32, -v238
    v_fma_f32 v4, v4, s32, -v238
    v_fma_f32 v5, v5, s32, -v238
    v_mfma_f32_32x32x16_bf16 v[16:31], a[104:107], a[40:43], v[16:31]
    s_cbranch_vccnz L_stub_1_0_4
L_back_1_0_4:
    v_exp_f32 v0, v0
    v_fma_f32 v6, v6, s32, -v238
    v_exp_f32 v1, v1
    s_waitcnt lgkmcnt(1)
    v_mfma_f32_32x32x16_bf16 v[16:31], a[136:139], a[248:251], v[16:31]
    ds_read_b128 a[248:251], v248 offset:49152
    v_fma_f32 v7, v7, s32, -v238
    v_exp_f32 v2, v2
    v_fma_f32 v8, v8, s32, -v238
    v_mfma_f32_32x32x16_bf16 v[16:31], a[108:111], a[44:47], v[16:31]
    v_exp_f32 v3, v3
    v_fma_f32 v9, v9, s32, -v238
    v_cvt_pk_bf16_f32 v0, v0, v1
    s_waitcnt lgkmcnt(1)
    v_mfma_f32_32x32x16_bf16 v[16:31], a[140:143], a[252:255], v[16:31]
    ds_read_b128 a[252:255], v249 offset:49152
    v_accvgpr_write_b32 a192, v0
    v_exp_f32 v4, v4
    v_fma_f32 v10, v10, s32, -v238
    v_mfma_f32_32x32x16_bf16 v[16:31], a[112:115], a[48:51], v[16:31]
    v_exp_f32 v5, v5
    v_fma_f32 v11, v11, s32, -v238
    v_cvt_pk_bf16_f32 v2, v2, v3
    s_waitcnt lgkmcnt(1)
    v_mfma_f32_32x32x16_bf16 v[16:31], a[144:147], a[248:251], v[16:31]
    ds_read_b128 a[248:251], v250 offset:49152
    v_accvgpr_write_b32 a193, v2
    v_exp_f32 v6, v6
    v_fma_f32 v12, v12, s32, -v238
    v_mfma_f32_32x32x16_bf16 v[16:31], a[116:119], a[52:55], v[16:31]
    v_exp_f32 v7, v7
    v_fma_f32 v13, v13, s32, -v238
    v_cvt_pk_bf16_f32 v4, v4, v5
    s_waitcnt lgkmcnt(1)
    v_mfma_f32_32x32x16_bf16 v[16:31], a[148:151], a[252:255], v[16:31]
    ds_read_b128 a[252:255], v251 offset:49152
    v_accvgpr_write_b32 a194, v4
    v_exp_f32 v8, v8
    v_fma_f32 v14, v14, s32, -v238
    v_mfma_f32_32x32x16_bf16 v[16:31], a[120:123], a[56:59], v[16:31]
    v_exp_f32 v9, v9
    v_fma_f32 v15, v15, s32, -v238
    v_cvt_pk_bf16_f32 v6, v6, v7
    s_waitcnt lgkmcnt(1)
    v_mfma_f32_32x32x16_bf16 v[16:31], a[152:155], a[248:251], v[16:31]
    ds_read_b128 a[248:251], v248 offset:32768
    v_accvgpr_write_b32 a195, v6
    v_exp_f32 v10, v10
    v_exp_f32 v11, v11
    v_mfma_f32_32x32x16_bf16 v[16:31], a[124:127], a[60:63], v[16:31]
    v_cvt_pk_bf16_f32 v8, v8, v9
    v_accvgpr_write_b32 a196, v8
    v_exp_f32 v12, v12
    s_waitcnt lgkmcnt(1)
    v_mfma_f32_32x32x16_bf16 v[16:31], a[156:159], a[252:255], v[16:31]
    ds_read_b128 a[252:255], v249 offset:32768
    v_exp_f32 v13, v13
    v_cvt_pk_bf16_f32 v10, v10, v11
    v_accvgpr_write_b32 a197, v10
    v_mfma_f32_4x4x4_16b_bf16 v[232:235], v[236:237], v[94:95], v[232:235] cbsz:4 abid:2
    v_exp_f32 v14, v14
    v_exp_f32 v15, v15
    v_mfma_f32_4x4x4_16b_bf16 v[232:235], v[236:237], a[192:193], v[232:235] cbsz:4 abid:0
    v_cvt_pk_bf16_f32 v12, v12, v13
    v_accvgpr_write_b32 a198, v12
    v_mfma_f32_4x4x4_16b_bf16 v[232:235], v[236:237], a[194:195], v[232:235] cbsz:4 abid:0
    v_cvt_pk_bf16_f32 v14, v14, v15
    v_accvgpr_write_b32 a199, v14
    v_mfma_f32_4x4x4_16b_bf16 v[232:235], v[236:237], a[196:197], v[232:235] cbsz:4 abid:0
    v_mfma_f32_32x32x16_bf16 v[0:15], a[96:99], a[64:67], 0
    ds_read_b128 a[96:99], v244 offset:49152
    v_max3_f32 v242, v16, v17, v242
    v_max3_f32 v242, v18, v19, v242
    v_max3_f32 v242, v20, v21, v242
    s_waitcnt lgkmcnt(2)
    v_mfma_f32_32x32x16_bf16 v[0:15], a[128:131], a[248:251], v[0:15]
    ds_read_b128 a[248:251], v250 offset:32768
    ds_read_b128 a[128:131], v244 offset:57344
    v_max3_f32 v242, v22, v23, v242
    v_max3_f32 v242, v24, v25, v242
    v_max3_f32 v242, v26, v27, v242
    v_mfma_f32_32x32x16_bf16 v[0:15], a[100:103], a[68:71], v[0:15]
    ds_read_b128 a[100:103], v245 offset:49152
    v_max3_f32 v242, v28, v29, v242
    v_max3_f32 v242, v30, v31, v242
    v_fma_f32 v254, v242, s32, -v239
    v_cmp_lt_f32 vcc, s33, v254
    s_waitcnt lgkmcnt(4)
    v_mfma_f32_32x32x16_bf16 v[0:15], a[132:135], a[252:255], v[0:15]
    ds_read_b128 a[252:255], v251 offset:32768
    ds_read_b128 a[132:135], v245 offset:57344
    v_fma_f32 v16, v16, s32, -v239
    v_fma_f32 v17, v17, s32, -v239
    v_fma_f32 v18, v18, s32, -v239
    v_mfma_f32_32x32x16_bf16 v[0:15], a[104:107], a[72:75], v[0:15]
    ds_read_b128 a[104:107], v246 offset:49152
    v_fma_f32 v19, v19, s32, -v239
    v_fma_f32 v20, v20, s32, -v239
    v_fma_f32 v21, v21, s32, -v239
    s_waitcnt lgkmcnt(5)
    v_mfma_f32_32x32x16_bf16 v[0:15], a[136:139], a[248:251], v[0:15]
    ds_read_b128 a[248:251], v248 offset:16384
    ds_read_b128 a[136:139], v246 offset:57344
    s_cbranch_vccnz L_stub_1_1_4
L_back_1_1_4:
    v_exp_f32 v16, v16
    v_fma_f32 v22, v22, s32, -v239
    v_mfma_f32_32x32x16_bf16 v[0:15], a[108:111], a[76:79], v[0:15]
    ds_read_b128 a[108:111], v247 offset:49152
    s_add_u32 s35, s28, 12288
    buffer_store_dwordx4 v[216:219], v252, s[20:23], s35 offen offset:256 sc1
    v_exp_f32 v17, v17
    s_waitcnt lgkmcnt(5)
    v_mfma_f32_32x32x16_bf16 v[0:15], a[140:143], a[252:255], v[0:15]
    ds_read_b128 a[252:255], v249 offset:16384
    ds_read_b128 a[140:143], v247 offset:57344
    s_add_u32 s35, s28, 12288
    buffer_store_dwordx4 a[208:211], v252, s[20:23], s35 offen offset:384 sc1
    v_fma_f32 v23, v23, s32, -v239
    v_mfma_f32_32x32x16_bf16 v[0:15], a[112:115], a[80:83], v[0:15]
    ds_read_b128 a[112:115], v244 offset:53248
    s_add_u32 s35, s28, 16384
    buffer_store_dwordx4 v[220:223], v253, s[20:23], s35 offen offset:256 sc1
    v_exp_f32 v18, v18
    v_fma_f32 v24, v24, s32, -v239
    s_waitcnt lgkmcnt(5)
    v_mfma_f32_32x32x16_bf16 v[0:15], a[144:147], a[248:251], v[0:15]
    ds_read_b128 a[248:251], v250 offset:16384
    ds_read_b128 a[144:147], v244 offset:61440
    s_add_u32 s35, s28, 16384
    buffer_store_dwordx4 a[212:215], v253, s[20:23], s35 offen offset:384 sc1
    v_exp_f32 v19, v19
    v_fma_f32 v25, v25, s32, -v239
    v_mfma_f32_32x32x16_bf16 v[0:15], a[116:119], a[84:87], v[0:15]
    ds_read_b128 a[116:119], v245 offset:53248
    v_cvt_pk_bf16_f32 v96, v16, v17
    v_exp_f32 v20, v20
    v_fma_f32 v26, v26, s32, -v239
    s_waitcnt lgkmcnt(5)
    v_mfma_f32_32x32x16_bf16 v[0:15], a[148:151], a[252:255], v[0:15]
    ds_read_b128 a[252:255], v251 offset:16384
    ds_read_b128 a[148:151], v245 offset:61440
    v_exp_f32 v21, v21
    v_fma_f32 v27, v27, s32, -v239
    v_cvt_pk_bf16_f32 v97, v18, v19
    v_mfma_f32_32x32x16_bf16 v[0:15], a[120:123], a[88:91], v[0:15]
    ds_read_b128 a[120:123], v246 offset:53248
    v_exp_f32 v22, v22
    v_fma_f32 v28, v28, s32, -v239
    v_exp_f32 v23, v23
    s_waitcnt lgkmcnt(5)
    v_mfma_f32_32x32x16_bf16 v[0:15], a[152:155], a[248:251], v[0:15]
    v_subrev_u32 v248, 32768, v248
    v_subrev_u32 v249, 32768, v249
    v_subrev_u32 v250, 32768, v250
    v_subrev_u32 v251, 32768, v251
    ds_read_b128 a[248:251], v248
    ds_read_b128 a[152:155], v246 offset:61440
    v_fma_f32 v29, v29, s32, -v239
    v_cvt_pk_bf16_f32 v98, v20, v21
    v_mfma_f32_32x32x16_bf16 v[0:15], a[124:127], a[92:95], v[0:15]
    ds_read_b128 a[124:127], v247 offset:53248
    v_exp_f32 v24, v24
    v_fma_f32 v30, v30, s32, -v239
    v_exp_f32 v25, v25
    v_fma_f32 v31, v31, s32, -v239
    v_cvt_pk_bf16_f32 v99, v22, v23
    s_waitcnt lgkmcnt(5)
    v_mfma_f32_32x32x16_bf16 v[0:15], a[156:159], a[252:255], v[0:15]
    ds_read_b128 a[252:255], v249
    ds_read_b128 a[156:159], v247 offset:61440
    v_exp_f32 v26, v26
    v_exp_f32 v27, v27
    v_cvt_pk_bf16_f32 v100, v24, v25
    v_exp_f32 v28, v28
    v_mfma_f32_4x4x4_16b_bf16 v[232:235], v[236:237], a[198:199], v[232:235] cbsz:4 abid:0
    v_exp_f32 v29, v29
    v_cvt_pk_bf16_f32 v101, v26, v27
    v_mfma_f32_4x4x4_16b_bf16 v[232:235], v[236:237], v[96:97], v[232:235] cbsz:4 abid:1
    v_exp_f32 v30, v30
    v_exp_f32 v31, v31
    v_mfma_f32_4x4x4_16b_bf16 v[232:235], v[236:237], v[98:99], v[232:235] cbsz:4 abid:1
    v_cvt_pk_bf16_f32 v102, v28, v29
    v_cvt_pk_bf16_f32 v103, v30, v31
    v_mfma_f32_4x4x4_16b_bf16 v[232:235], v[236:237], v[100:101], v[232:235] cbsz:4 abid:1
    v_mfma_f32_32x32x16_bf16 v[16:31], a[96:99], a[0:3], 0
    s_waitcnt lgkmcnt(0)
    s_waitcnt vmcnt(32)
    s_barrier
    s_add_u32 m0, s30, 49152
    s_add_u32 s35, s25, 155648
    buffer_load_dwordx4 v252, s[12:15], s35 offen nt lds
    v_mfma_f32_32x32x16_bf16 v[16:31], a[128:131], a[248:251], v[16:31]
    ds_read_b128 a[248:251], v250
    s_add_u32 s35, s25, 187392
    buffer_load_dwordx4 v253, s[12:15], s35 offen offset:1024 nt lds
    v_max3_f32 v243, v0, v1, v243
    v_max3_f32 v243, v2, v3, v243
    v_mfma_f32_32x32x16_bf16 v[16:31], a[100:103], a[4:7], v[16:31]
    s_add_u32 s35, s25, 22528
    buffer_load_dwordx4 v252, s[12:15], s35 offen offset:2048 nt lds
    v_max3_f32 v243, v4, v5, v243
    v_max3_f32 v243, v6, v7, v243
    v_mfma_f32_32x32x16_bf16 v[16:31], a[132:135], a[252:255], v[16:31]
    ds_read_b128 a[252:255], v251
    s_add_u32 s35, s25, 54272
    buffer_load_dwordx4 v253, s[12:15], s35 offen offset:3072 nt lds
    v_max3_f32 v243, v8, v9, v243
    v_max3_f32 v243, v10, v11, v243
    v_mfma_f32_32x32x16_bf16 v[16:31], a[104:107], a[8:11], v[16:31]
    v_max3_f32 v243, v12, v13, v243
    v_max3_f32 v243, v14, v15, v243
    v_fma_f32 v254, v243, s32, -v240
    v_cmp_lt_f32 vcc, s33, v254
    s_waitcnt lgkmcnt(1)
    v_mfma_f32_32x32x16_bf16 v[16:31], a[136:139], a[248:251], v[16:31]
    ds_read_b128 a[248:251], v248 offset:16384
    v_fma_f32 v0, v0, s32, -v240
    v_fma_f32 v1, v1, s32, -v240
    v_fma_f32 v2, v2, s32, -v240
    v_fma_f32 v3, v3, s32, -v240
    v_mfma_f32_32x32x16_bf16 v[16:31], a[108:111], a[12:15], v[16:31]
    v_fma_f32 v4, v4, s32, -v240
    v_fma_f32 v5, v5, s32, -v240
    s_cbranch_vccnz L_stub_1_2_4
L_back_1_2_4:
    v_exp_f32 v0, v0
    s_waitcnt lgkmcnt(1)
    v_mfma_f32_32x32x16_bf16 v[16:31], a[140:143], a[252:255], v[16:31]
    ds_read_b128 a[252:255], v249 offset:16384
    v_fma_f32 v6, v6, s32, -v240
    v_exp_f32 v1, v1
    v_fma_f32 v7, v7, s32, -v240
    v_mfma_f32_32x32x16_bf16 v[16:31], a[112:115], a[16:19], v[16:31]
    v_exp_f32 v2, v2
    v_fma_f32 v8, v8, s32, -v240
    v_exp_f32 v3, v3
    s_waitcnt lgkmcnt(1)
    v_mfma_f32_32x32x16_bf16 v[16:31], a[144:147], a[248:251], v[16:31]
    ds_read_b128 a[248:251], v250 offset:16384
    v_fma_f32 v9, v9, s32, -v240
    v_cvt_pk_bf16_f32 v104, v0, v1
    v_exp_f32 v4, v4
    v_mfma_f32_32x32x16_bf16 v[16:31], a[116:119], a[20:23], v[16:31]
    v_fma_f32 v10, v10, s32, -v240
    v_exp_f32 v5, v5
    v_fma_f32 v11, v11, s32, -v240
    s_waitcnt lgkmcnt(1)
    v_mfma_f32_32x32x16_bf16 v[16:31], a[148:151], a[252:255], v[16:31]
    ds_read_b128 a[252:255], v251 offset:16384
    v_cvt_pk_bf16_f32 v105, v2, v3
    v_exp_f32 v6, v6
    v_fma_f32 v12, v12, s32, -v240
    v_mfma_f32_32x32x16_bf16 v[16:31], a[120:123], a[24:27], v[16:31]
    v_exp_f32 v7, v7
    v_fma_f32 v13, v13, s32, -v240
    v_cvt_pk_bf16_f32 v106, v4, v5
    s_waitcnt lgkmcnt(1)
    v_mfma_f32_32x32x16_bf16 v[16:31], a[152:155], a[248:251], v[16:31]
    v_add_u32 v248, 32768, v248
    v_add_u32 v249, 32768, v249
    v_add_u32 v250, 32768, v250
    v_add_u32 v251, 32768, v251
    ds_read_b128 a[248:251], v248
    v_exp_f32 v8, v8
    v_mfma_f32_32x32x16_bf16 v[16:31], a[124:127], a[28:31], v[16:31]
    v_fma_f32 v14, v14, s32, -v240
    v_exp_f32 v9, v9
    v_fma_f32 v15, v15, s32, -v240
    v_cvt_pk_bf16_f32 v107, v6, v7
    s_waitcnt lgkmcnt(1)
    v_mfma_f32_32x32x16_bf16 v[16:31], a[156:159], a[252:255], v[16:31]
    ds_read_b128 a[252:255], v249
    v_exp_f32 v10, v10
    v_exp_f32 v11, v11
    v_cvt_pk_bf16_f32 v108, v8, v9
    v_exp_f32 v12, v12
    v_mfma_f32_4x4x4_16b_bf16 v[232:235], v[236:237], v[102:103], v[232:235] cbsz:4 abid:1
    v_exp_f32 v13, v13
    v_cvt_pk_bf16_f32 v109, v10, v11
    v_mfma_f32_4x4x4_16b_bf16 v[232:235], v[236:237], v[104:105], v[232:235] cbsz:4 abid:2
    v_exp_f32 v14, v14
    v_exp_f32 v15, v15
    v_mfma_f32_4x4x4_16b_bf16 v[232:235], v[236:237], v[106:107], v[232:235] cbsz:4 abid:2
    v_cvt_pk_bf16_f32 v110, v12, v13
    v_cvt_pk_bf16_f32 v111, v14, v15
    v_mfma_f32_4x4x4_16b_bf16 v[232:235], v[236:237], v[108:109], v[232:235] cbsz:4 abid:2
    v_mfma_f32_32x32x16_bf16 v[0:15], a[96:99], a[32:35], 0
    v_max3_f32 v241, v16, v17, v241
    v_max3_f32 v241, v18, v19, v241
    v_max3_f32 v241, v20, v21, v241
    v_max3_f32 v241, v22, v23, v241
    s_waitcnt lgkmcnt(1)
    v_mfma_f32_32x32x16_bf16 v[0:15], a[128:131], a[248:251], v[0:15]
    ds_read_b128 a[248:251], v250
    v_max3_f32 v241, v24, v25, v241
    v_max3_f32 v241, v26, v27, v241
    v_max3_f32 v241, v28, v29, v241
    v_max3_f32 v241, v30, v31, v241
    v_mfma_f32_32x32x16_bf16 v[0:15], a[100:103], a[36:39], v[0:15]
    v_fma_f32 v254, v241, s32, -v238
    v_cmp_lt_f32 vcc, s33, v254
    v_fma_f32 v16, v16, s32, -v238
    v_fma_f32 v17, v17, s32, -v238
    s_waitcnt lgkmcnt(1)
    v_mfma_f32_32x32x16_bf16 v[0:15], a[132:135], a[252:255], v[0:15]
    ds_read_b128 a[252:255], v251
    v_fma_f32 v18, v18, s32, -v238
    v_fma_f32 v19, v19, s32, -v238
    v_fma_f32 v20, v20, s32, -v238
    v_fma_f32 v21, v21, s32, -v238
    v_mfma_f32_32x32x16_bf16 v[0:15], a[104:107], a[40:43], v[0:15]
    s_cbranch_vccnz L_stub_1_0_5
L_back_1_0_5:
    v_exp_f32 v16, v16
    v_fma_f32 v22, v22, s32, -v238
    v_exp_f32 v17, v17
    s_waitcnt lgkmcnt(1)
    v_mfma_f32_32x32x16_bf16 v[0:15], a[136:139], a[248:251], v[0:15]
    ds_read_b128 a[248:251], v248 offset:49152
    v_fma_f32 v23, v23, s32, -v238
    v_exp_f32 v18, v18
    v_fma_f32 v24, v24, s32, -v238
    v_mfma_f32_32x32x16_bf16 v[0:15], a[108:111], a[44:47], v[0:15]
    v_exp_f32 v19, v19
    v_fma_f32 v25, v25, s32, -v238
    v_cvt_pk_bf16_f32 v16, v16, v17
    s_waitcnt lgkmcnt(1)
    v_mfma_f32_32x32x16_bf16 v[0:15], a[140:143], a[252:255], v[0:15]
    ds_read_b128 a[252:255], v249 offset:49152
    v_accvgpr_write_b32 a200, v16
    v_exp_f32 v20, v20
    v_fma_f32 v26, v26, s32, -v238
    v_mfma_f32_32x32x16_bf16 v[0:15], a[112:115], a[48:51], v[0:15]
    v_exp_f32 v21, v21
    v_fma_f32 v27, v27, s32, -v238
    v_cvt_pk_bf16_f32 v18, v18, v19
    s_waitcnt lgkmcnt(1)
    v_mfma_f32_32x32x16_bf16 v[0:15], a[144:147], a[248:251], v[0:15]
    ds_read_b128 a[248:251], v250 offset:49152
    v_accvgpr_write_b32 a201, v18
    v_exp_f32 v22, v22
    v_fma_f32 v28, v28, s32, -v238
    v_mfma_f32_32x32x16_bf16 v[0:15], a[116:119], a[52:55], v[0:15]
    v_exp_f32 v23, v23
    v_fma_f32 v29, v29, s32, -v238
    v_cvt_pk_bf16_f32 v20, v20, v21
    s_waitcnt lgkmcnt(1)
    v_mfma_f32_32x32x16_bf16 v[0:15], a[148:151], a[252:255], v[0:15]
    ds_read_b128 a[252:255], v251 offset:49152
    v_accvgpr_write_b32 a202, v20
    v_exp_f32 v24, v24
    v_fma_f32 v30, v30, s32, -v238
    v_mfma_f32_32x32x16_bf16 v[0:15], a[120:123], a[56:59], v[0:15]
    v_exp_f32 v25, v25
    v_fma_f32 v31, v31, s32, -v238
    v_cvt_pk_bf16_f32 v22, v22, v23
    s_waitcnt lgkmcnt(1)
    v_mfma_f32_32x32x16_bf16 v[0:15], a[152:155], a[248:251], v[0:15]
    ds_read_b128 a[248:251], v248 offset:32768
    v_accvgpr_write_b32 a203, v22
    v_exp_f32 v26, v26
    v_exp_f32 v27, v27
    v_mfma_f32_32x32x16_bf16 v[0:15], a[124:127], a[60:63], v[0:15]
    v_cvt_pk_bf16_f32 v24, v24, v25
    v_accvgpr_write_b32 a204, v24
    v_exp_f32 v28, v28
    s_waitcnt lgkmcnt(1)
    v_mfma_f32_32x32x16_bf16 v[0:15], a[156:159], a[252:255], v[0:15]
    ds_read_b128 a[252:255], v249 offset:32768
    v_exp_f32 v29, v29
    v_cvt_pk_bf16_f32 v26, v26, v27
    v_accvgpr_write_b32 a205, v26
    v_mfma_f32_4x4x4_16b_bf16 v[232:235], v[236:237], v[110:111], v[232:235] cbsz:4 abid:2
    v_exp_f32 v30, v30
    v_exp_f32 v31, v31
    v_mfma_f32_4x4x4_16b_bf16 v[232:235], v[236:237], a[200:201], v[232:235] cbsz:4 abid:0
    v_cvt_pk_bf16_f32 v28, v28, v29
    v_accvgpr_write_b32 a206, v28
    v_mfma_f32_4x4x4_16b_bf16 v[232:235], v[236:237], a[202:203], v[232:235] cbsz:4 abid:0
    v_cvt_pk_bf16_f32 v30, v30, v31
    v_accvgpr_write_b32 a207, v30
    v_mfma_f32_4x4x4_16b_bf16 v[232:235], v[236:237], a[204:205], v[232:235] cbsz:4 abid:0
    v_mfma_f32_32x32x16_bf16 v[16:31], a[96:99], a[64:67], 0
    ds_read_b128 a[96:99], v244
    v_max3_f32 v242, v0, v1, v242
    v_max3_f32 v242, v2, v3, v242
    v_max3_f32 v242, v4, v5, v242
    s_waitcnt lgkmcnt(2)
    v_mfma_f32_32x32x16_bf16 v[16:31], a[128:131], a[248:251], v[16:31]
    ds_read_b128 a[248:251], v250 offset:32768
    ds_read_b128 a[128:131], v244 offset:8192
    v_max3_f32 v242, v6, v7, v242
    v_max3_f32 v242, v8, v9, v242
    v_max3_f32 v242, v10, v11, v242
    v_mfma_f32_32x32x16_bf16 v[16:31], a[100:103], a[68:71], v[16:31]
    ds_read_b128 a[100:103], v245
    v_max3_f32 v242, v12, v13, v242
    v_max3_f32 v242, v14, v15, v242
    v_fma_f32 v254, v242, s32, -v239
    v_cmp_lt_f32 vcc, s33, v254
    s_waitcnt lgkmcnt(4)
    v_mfma_f32_32x32x16_bf16 v[16:31], a[132:135], a[252:255], v[16:31]
    ds_read_b128 a[252:255], v251 offset:32768
    ds_read_b128 a[132:135], v245 offset:8192
    v_fma_f32 v0, v0, s32, -v239
    v_fma_f32 v1, v1, s32, -v239
    v_fma_f32 v2, v2, s32, -v239
    v_mfma_f32_32x32x16_bf16 v[16:31], a[104:107], a[72:75], v[16:31]
    ds_read_b128 a[104:107], v246
    v_fma_f32 v3, v3, s32, -v239
    v_fma_f32 v4, v4, s32, -v239
    v_fma_f32 v5, v5, s32, -v239
    s_waitcnt lgkmcnt(5)
    v_mfma_f32_32x32x16_bf16 v[16:31], a[136:139], a[248:251], v[16:31]
    ds_read_b128 a[248:251], v248 offset:16384
    ds_read_b128 a[136:139], v246 offset:8192
    s_cbranch_vccnz L_stub_1_1_5
L_back_1_1_5:
    v_exp_f32 v0, v0
    v_fma_f32 v6, v6, s32, -v239
    v_mfma_f32_32x32x16_bf16 v[16:31], a[108:111], a[76:79], v[16:31]
    ds_read_b128 a[108:111], v247
    v_exp_f32 v1, v1
    v_fma_f32 v7, v7, s32, -v239
    v_exp_f32 v2, v2
    s_waitcnt lgkmcnt(5)
    v_mfma_f32_32x32x16_bf16 v[16:31], a[140:143], a[252:255], v[16:31]
    ds_read_b128 a[252:255], v249 offset:16384
    ds_read_b128 a[140:143], v247 offset:8192
    v_fma_f32 v8, v8, s32, -v239
    v_exp_f32 v3, v3
    v_mfma_f32_32x32x16_bf16 v[16:31], a[112:115], a[80:83], v[16:31]
    ds_read_b128 a[112:115], v244 offset:4096
    v_fma_f32 v9, v9, s32, -v239
    v_cvt_pk_bf16_f32 v112, v0, v1
    v_exp_f32 v4, v4
    s_waitcnt lgkmcnt(5)
    v_mfma_f32_32x32x16_bf16 v[16:31], a[144:147], a[248:251], v[16:31]
    ds_read_b128 a[248:251], v250 offset:16384
    ds_read_b128 a[144:147], v244 offset:12288
    v_fma_f32 v10, v10, s32, -v239
    v_exp_f32 v5, v5
    v_fma_f32 v11, v11, s32, -v239
    v_mfma_f32_32x32x16_bf16 v[16:31], a[116:119], a[84:87], v[16:31]
    ds_read_b128 a[116:119], v245 offset:4096
    v_cvt_pk_bf16_f32 v113, v2, v3
    v_exp_f32 v6, v6
    v_fma_f32 v12, v12, s32, -v239
    s_waitcnt lgkmcnt(5)
    v_mfma_f32_32x32x16_bf16 v[16:31], a[148:151], a[252:255], v[16:31]
    ds_read_b128 a[252:255], v251 offset:16384
    ds_read_b128 a[148:151], v245 offset:12288
    v_exp_f32 v7, v7
    v_fma_f32 v13, v13, s32, -v239
    v_mfma_f32_32x32x16_bf16 v[16:31], a[120:123], a[88:91], v[16:31]
    ds_read_b128 a[120:123], v246 offset:4096
    v_cvt_pk_bf16_f32 v114, v4, v5
    v_exp_f32 v8, v8
    v_fma_f32 v14, v14, s32, -v239
    s_waitcnt lgkmcnt(5)
    v_mfma_f32_32x32x16_bf16 v[16:31], a[152:155], a[248:251], v[16:31]
    v_subrev_u32 v248, 32768, v248
    v_subrev_u32 v249, 32768, v249
    v_subrev_u32 v250, 32768, v250
    v_subrev_u32 v251, 32768, v251
    ds_read_b128 a[248:251], v248
    ds_read_b128 a[152:155], v246 offset:12288
    v_mfma_f32_32x32x16_bf16 v[16:31], a[124:127], a[92:95], v[16:31]
    ds_read_b128 a[124:127], v247 offset:4096
    v_exp_f32 v9, v9
    v_fma_f32 v15, v15, s32, -v239
    v_cvt_pk_bf16_f32 v115, v6, v7
    v_exp_f32 v10, v10
    s_waitcnt lgkmcnt(5)
    v_mfma_f32_32x32x16_bf16 v[16:31], a[156:159], a[252:255], v[16:31]
    ds_read_b128 a[252:255], v249
    ds_read_b128 a[156:159], v247 offset:12288
    v_exp_f32 v11, v11
    v_cvt_pk_bf16_f32 v116, v8, v9
    v_exp_f32 v12, v12
    v_mfma_f32_4x4x4_16b_bf16 v[232:235], v[236:237], a[206:207], v[232:235] cbsz:4 abid:0
    v_exp_f32 v13, v13
    v_cvt_pk_bf16_f32 v117, v10, v11
    v_mfma_f32_4x4x4_16b_bf16 v[232:235], v[236:237], v[112:113], v[232:235] cbsz:4 abid:1
    v_exp_f32 v14, v14
    v_exp_f32 v15, v15
    v_mfma_f32_4x4x4_16b_bf16 v[232:235], v[236:237], v[114:115], v[232:235] cbsz:4 abid:1
    v_cvt_pk_bf16_f32 v118, v12, v13
    v_cvt_pk_bf16_f32 v119, v14, v15
    v_mfma_f32_4x4x4_16b_bf16 v[232:235], v[236:237], v[116:117], v[232:235] cbsz:4 abid:1
    v_mfma_f32_32x32x16_bf16 v[0:15], a[96:99], a[0:3], 0
    s_waitcnt lgkmcnt(0)
    s_waitcnt vmcnt(24)
    s_barrier
    s_add_u32 m0, s30, 0
    s_add_u32 s35, s25, 159744
    buffer_load_dwordx4 v252, s[12:15], s35 offen nt lds
    v_mfma_f32_32x32x16_bf16 v[0:15], a[128:131], a[248:251], v[0:15]
    ds_read_b128 a[248:251], v250
    s_add_u32 s35, s25, 191488
    buffer_load_dwordx4 v253, s[12:15], s35 offen offset:1024 nt lds
    v_max3_f32 v243, v16, v17, v243
    v_max3_f32 v243, v18, v19, v243
    v_mfma_f32_32x32x16_bf16 v[0:15], a[100:103], a[4:7], v[0:15]
    s_add_u32 s35, s25, 26624
    buffer_load_dwordx4 v252, s[12:15], s35 offen offset:2048 nt lds
    v_max3_f32 v243, v20, v21, v243
    v_max3_f32 v243, v22, v23, v243
    v_mfma_f32_32x32x16_bf16 v[0:15], a[132:135], a[252:255], v[0:15]
    ds_read_b128 a[252:255], v251
    s_add_u32 s35, s25, 58368
    buffer_load_dwordx4 v253, s[12:15], s35 offen offset:3072 nt lds
    v_max3_f32 v243, v24, v25, v243
    v_max3_f32 v243, v26, v27, v243
    v_mfma_f32_32x32x16_bf16 v[0:15], a[104:107], a[8:11], v[0:15]
    v_max3_f32 v243, v28, v29, v243
    v_max3_f32 v243, v30, v31, v243
    v_fma_f32 v254, v243, s32, -v240
    v_cmp_lt_f32 vcc, s33, v254
    s_waitcnt lgkmcnt(1)
    v_mfma_f32_32x32x16_bf16 v[0:15], a[136:139], a[248:251], v[0:15]
    ds_read_b128 a[248:251], v248 offset:16384
    v_fma_f32 v16, v16, s32, -v240
    v_fma_f32 v17, v17, s32, -v240
    v_fma_f32 v18, v18, s32, -v240
    v_fma_f32 v19, v19, s32, -v240
    v_mfma_f32_32x32x16_bf16 v[0:15], a[108:111], a[12:15], v[0:15]
    v_fma_f32 v20, v20, s32, -v240
    v_fma_f32 v21, v21, s32, -v240
    s_cbranch_vccnz L_stub_1_2_5
L_back_1_2_5:
    v_exp_f32 v16, v16
    s_waitcnt lgkmcnt(1)
    v_mfma_f32_32x32x16_bf16 v[0:15], a[140:143], a[252:255], v[0:15]
    ds_read_b128 a[252:255], v249 offset:16384
    v_fma_f32 v22, v22, s32, -v240
    v_exp_f32 v17, v17
    v_fma_f32 v23, v23, s32, -v240
    v_mfma_f32_32x32x16_bf16 v[0:15], a[112:115], a[16:19], v[0:15]
    v_exp_f32 v18, v18
    v_fma_f32 v24, v24, s32, -v240
    v_exp_f32 v19, v19
    s_waitcnt lgkmcnt(1)
    v_mfma_f32_32x32x16_bf16 v[0:15], a[144:147], a[248:251], v[0:15]
    ds_read_b128 a[248:251], v250 offset:16384
    v_fma_f32 v25, v25, s32, -v240
    v_cvt_pk_bf16_f32 v120, v16, v17
    v_exp_f32 v20, v20
    v_mfma_f32_32x32x16_bf16 v[0:15], a[116:119], a[20:23], v[0:15]
    v_fma_f32 v26, v26, s32, -v240
    v_exp_f32 v21, v21
    v_fma_f32 v27, v27, s32, -v240
    s_waitcnt lgkmcnt(1)
    v_mfma_f32_32x32x16_bf16 v[0:15], a[148:151], a[252:255], v[0:15]
    ds_read_b128 a[252:255], v251 offset:16384
    v_cvt_pk_bf16_f32 v121, v18, v19
    v_exp_f32 v22, v22
    v_fma_f32 v28, v28, s32, -v240
    v_mfma_f32_32x32x16_bf16 v[0:15], a[120:123], a[24:27], v[0:15]
    v_exp_f32 v23, v23
    v_fma_f32 v29, v29, s32, -v240
    v_cvt_pk_bf16_f32 v122, v20, v21
    s_waitcnt lgkmcnt(1)
    v_mfma_f32_32x32x16_bf16 v[0:15], a[152:155], a[248:251], v[0:15]
    v_add_u32 v248, 32768, v248
    v_add_u32 v249, 32768, v249
    v_add_u32 v250, 32768, v250
    v_add_u32 v251, 32768, v251
    ds_read_b128 a[248:251], v248
    v_exp_f32 v24, v24
    v_mfma_f32_32x32x16_bf16 v[0:15], a[124:127], a[28:31], v[0:15]
    v_fma_f32 v30, v30, s32, -v240
    v_exp_f32 v25, v25
    v_fma_f32 v31, v31, s32, -v240
    v_cvt_pk_bf16_f32 v123, v22, v23
    s_waitcnt lgkmcnt(1)
    v_mfma_f32_32x32x16_bf16 v[0:15], a[156:159], a[252:255], v[0:15]
    ds_read_b128 a[252:255], v249
    v_exp_f32 v26, v26
    v_exp_f32 v27, v27
    v_cvt_pk_bf16_f32 v124, v24, v25
    v_exp_f32 v28, v28
    v_mfma_f32_4x4x4_16b_bf16 v[232:235], v[236:237], v[118:119], v[232:235] cbsz:4 abid:1
    v_exp_f32 v29, v29
    v_cvt_pk_bf16_f32 v125, v26, v27
    v_mfma_f32_4x4x4_16b_bf16 v[232:235], v[236:237], v[120:121], v[232:235] cbsz:4 abid:2
    v_exp_f32 v30, v30
    v_exp_f32 v31, v31
    v_mfma_f32_4x4x4_16b_bf16 v[232:235], v[236:237], v[122:123], v[232:235] cbsz:4 abid:2
    v_cvt_pk_bf16_f32 v126, v28, v29
    v_cvt_pk_bf16_f32 v127, v30, v31
    v_mfma_f32_4x4x4_16b_bf16 v[232:235], v[236:237], v[124:125], v[232:235] cbsz:4 abid:2
    v_mfma_f32_32x32x16_bf16 v[16:31], a[96:99], a[32:35], 0
    v_max3_f32 v241, v0, v1, v241
    v_max3_f32 v241, v2, v3, v241
    v_max3_f32 v241, v4, v5, v241
    v_max3_f32 v241, v6, v7, v241
    s_waitcnt lgkmcnt(1)
    v_mfma_f32_32x32x16_bf16 v[16:31], a[128:131], a[248:251], v[16:31]
    ds_read_b128 a[248:251], v250
    v_max3_f32 v241, v8, v9, v241
    v_max3_f32 v241, v10, v11, v241
    v_max3_f32 v241, v12, v13, v241
    v_max3_f32 v241, v14, v15, v241
    v_mfma_f32_32x32x16_bf16 v[16:31], a[100:103], a[36:39], v[16:31]
    v_fma_f32 v254, v241, s32, -v238
    v_cmp_lt_f32 vcc, s33, v254
    v_fma_f32 v0, v0, s32, -v238
    v_fma_f32 v1, v1, s32, -v238
    s_waitcnt lgkmcnt(1)
    v_mfma_f32_32x32x16_bf16 v[16:31], a[132:135], a[252:255], v[16:31]
    ds_read_b128 a[252:255], v251
    v_fma_f32 v2, v2, s32, -v238
    v_fma_f32 v3, v3, s32, -v238
    v_fma_f32 v4, v4, s32, -v238
    v_fma_f32 v5, v5, s32, -v238
    v_mfma_f32_32x32x16_bf16 v[16:31], a[104:107], a[40:43], v[16:31]
    s_cbranch_vccnz L_stub_1_0_6
L_back_1_0_6:
    v_exp_f32 v0, v0
    v_fma_f32 v6, v6, s32, -v238
    v_exp_f32 v1, v1
    s_waitcnt lgkmcnt(1)
    v_mfma_f32_32x32x16_bf16 v[16:31], a[136:139], a[248:251], v[16:31]
    ds_read_b128 a[248:251], v248 offset:49152
    v_fma_f32 v7, v7, s32, -v238
    v_exp_f32 v2, v2
    v_fma_f32 v8, v8, s32, -v238
    v_mfma_f32_32x32x16_bf16 v[16:31], a[108:111], a[44:47], v[16:31]
    v_exp_f32 v3, v3
    v_fma_f32 v9, v9, s32, -v238
    v_cvt_pk_bf16_f32 v0, v0, v1
    s_waitcnt lgkmcnt(1)
    v_mfma_f32_32x32x16_bf16 v[16:31], a[140:143], a[252:255], v[16:31]
    ds_read_b128 a[252:255], v249 offset:49152
    v_accvgpr_write_b32 a208, v0
    v_exp_f32 v4, v4
    v_fma_f32 v10, v10, s32, -v238
    v_mfma_f32_32x32x16_bf16 v[16:31], a[112:115], a[48:51], v[16:31]
    v_exp_f32 v5, v5
    v_fma_f32 v11, v11, s32, -v238
    v_cvt_pk_bf16_f32 v2, v2, v3
    s_waitcnt lgkmcnt(1)
    v_mfma_f32_32x32x16_bf16 v[16:31], a[144:147], a[248:251], v[16:31]
    ds_read_b128 a[248:251], v250 offset:49152
    v_accvgpr_write_b32 a209, v2
    v_exp_f32 v6, v6
    v_fma_f32 v12, v12, s32, -v238
    v_mfma_f32_32x32x16_bf16 v[16:31], a[116:119], a[52:55], v[16:31]
    v_exp_f32 v7, v7
    v_fma_f32 v13, v13, s32, -v238
    v_cvt_pk_bf16_f32 v4, v4, v5
    s_waitcnt lgkmcnt(1)
    v_mfma_f32_32x32x16_bf16 v[16:31], a[148:151], a[252:255], v[16:31]
    ds_read_b128 a[252:255], v251 offset:49152
    v_accvgpr_write_b32 a210, v4
    v_exp_f32 v8, v8
    v_fma_f32 v14, v14, s32, -v238
    v_mfma_f32_32x32x16_bf16 v[16:31], a[120:123], a[56:59], v[16:31]
    v_exp_f32 v9, v9
    v_fma_f32 v15, v15, s32, -v238
    v_cvt_pk_bf16_f32 v6, v6, v7
    s_waitcnt lgkmcnt(1)
    v_mfma_f32_32x32x16_bf16 v[16:31], a[152:155], a[248:251], v[16:31]
    ds_read_b128 a[248:251], v248 offset:32768
    v_accvgpr_write_b32 a211, v6
    v_exp_f32 v10, v10
    v_exp_f32 v11, v11
    v_mfma_f32_32x32x16_bf16 v[16:31], a[124:127], a[60:63], v[16:31]
    v_cvt_pk_bf16_f32 v8, v8, v9
    v_accvgpr_write_b32 a212, v8
    v_exp_f32 v12, v12
    s_waitcnt lgkmcnt(1)
    v_mfma_f32_32x32x16_bf16 v[16:31], a[156:159], a[252:255], v[16:31]
    ds_read_b128 a[252:255], v249 offset:32768
    v_exp_f32 v13, v13
    v_cvt_pk_bf16_f32 v10, v10, v11
    v_accvgpr_write_b32 a213, v10
    v_mfma_f32_4x4x4_16b_bf16 v[232:235], v[236:237], v[126:127], v[232:235] cbsz:4 abid:2
    v_exp_f32 v14, v14
    v_exp_f32 v15, v15
    v_mfma_f32_4x4x4_16b_bf16 v[232:235], v[236:237], a[208:209], v[232:235] cbsz:4 abid:0
    v_cvt_pk_bf16_f32 v12, v12, v13
    v_accvgpr_write_b32 a214, v12
    v_mfma_f32_4x4x4_16b_bf16 v[232:235], v[236:237], a[210:211], v[232:235] cbsz:4 abid:0
    v_cvt_pk_bf16_f32 v14, v14, v15
    v_accvgpr_write_b32 a215, v14
    v_mfma_f32_4x4x4_16b_bf16 v[232:235], v[236:237], a[212:213], v[232:235] cbsz:4 abid:0
    v_mfma_f32_32x32x16_bf16 v[0:15], a[96:99], a[64:67], 0
    ds_read_b128 a[96:99], v244 offset:16384
    v_max3_f32 v242, v16, v17, v242
    v_max3_f32 v242, v18, v19, v242
    v_max3_f32 v242, v20, v21, v242
    s_waitcnt lgkmcnt(2)
    v_mfma_f32_32x32x16_bf16 v[0:15], a[128:131], a[248:251], v[0:15]
    ds_read_b128 a[248:251], v250 offset:32768
    ds_read_b128 a[128:131], v244 offset:24576
    v_max3_f32 v242, v22, v23, v242
    v_max3_f32 v242, v24, v25, v242
    v_max3_f32 v242, v26, v27, v242
    v_mfma_f32_32x32x16_bf16 v[0:15], a[100:103], a[68:71], v[0:15]
    ds_read_b128 a[100:103], v245 offset:16384
    v_max3_f32 v242, v28, v29, v242
    v_max3_f32 v242, v30, v31, v242
    v_fma_f32 v254, v242, s32, -v239
    v_cmp_lt_f32 vcc, s33, v254
    s_waitcnt lgkmcnt(4)
    v_mfma_f32_32x32x16_bf16 v[0:15], a[132:135], a[252:255], v[0:15]
    ds_read_b128 a[252:255], v251 offset:32768
    ds_read_b128 a[132:135], v245 offset:24576
    v_fma_f32 v16, v16, s32, -v239
    v_fma_f32 v17, v17, s32, -v239
    v_fma_f32 v18, v18, s32, -v239
    v_mfma_f32_32x32x16_bf16 v[0:15], a[104:107], a[72:75], v[0:15]
    ds_read_b128 a[104:107], v246 offset:16384
    v_fma_f32 v19, v19, s32, -v239
    v_fma_f32 v20, v20, s32, -v239
    v_fma_f32 v21, v21, s32, -v239
    s_waitcnt lgkmcnt(5)
    v_mfma_f32_32x32x16_bf16 v[0:15], a[136:139], a[248:251], v[0:15]
    ds_read_b128 a[248:251], v248 offset:16384
    ds_read_b128 a[136:139], v246 offset:24576
    s_cbranch_vccnz L_stub_1_1_6
L_back_1_1_6:
    v_exp_f32 v16, v16
    v_fma_f32 v22, v22, s32, -v239
    v_mfma_f32_32x32x16_bf16 v[0:15], a[108:111], a[76:79], v[0:15]
    ds_read_b128 a[108:111], v247 offset:16384
    v_exp_f32 v17, v17
    v_fma_f32 v23, v23, s32, -v239
    v_exp_f32 v18, v18
    s_waitcnt lgkmcnt(5)
    v_mfma_f32_32x32x16_bf16 v[0:15], a[140:143], a[252:255], v[0:15]
    ds_read_b128 a[252:255], v249 offset:16384
    ds_read_b128 a[140:143], v247 offset:24576
    v_fma_f32 v24, v24, s32, -v239
    v_exp_f32 v19, v19
    v_mfma_f32_32x32x16_bf16 v[0:15], a[112:115], a[80:83], v[0:15]
    ds_read_b128 a[112:115], v244 offset:20480
    v_fma_f32 v25, v25, s32, -v239
    v_cvt_pk_bf16_f32 v128, v16, v17
    v_exp_f32 v20, v20
    s_waitcnt lgkmcnt(5)
    v_mfma_f32_32x32x16_bf16 v[0:15], a[144:147], a[248:251], v[0:15]
    ds_read_b128 a[248:251], v250 offset:16384
    ds_read_b128 a[144:147], v244 offset:28672
    v_fma_f32 v26, v26, s32, -v239
    v_exp_f32 v21, v21
    v_fma_f32 v27, v27, s32, -v239
    v_mfma_f32_32x32x16_bf16 v[0:15], a[116:119], a[84:87], v[0:15]
    ds_read_b128 a[116:119], v245 offset:20480
    v_cvt_pk_bf16_f32 v129, v18, v19
    v_exp_f32 v22, v22
    v_fma_f32 v28, v28, s32, -v239
    s_waitcnt lgkmcnt(5)
    v_mfma_f32_32x32x16_bf16 v[0:15], a[148:151], a[252:255], v[0:15]
    ds_read_b128 a[252:255], v251 offset:16384
    ds_read_b128 a[148:151], v245 offset:28672
    v_exp_f32 v23, v23
    v_fma_f32 v29, v29, s32, -v239
    v_mfma_f32_32x32x16_bf16 v[0:15], a[120:123], a[88:91], v[0:15]
    ds_read_b128 a[120:123], v246 offset:20480
    v_cvt_pk_bf16_f32 v130, v20, v21
    v_exp_f32 v24, v24
    v_fma_f32 v30, v30, s32, -v239
    s_waitcnt lgkmcnt(5)
    v_mfma_f32_32x32x16_bf16 v[0:15], a[152:155], a[248:251], v[0:15]
    v_subrev_u32 v248, 32768, v248
    v_subrev_u32 v249, 32768, v249
    v_subrev_u32 v250, 32768, v250
    v_subrev_u32 v251, 32768, v251
    ds_read_b128 a[248:251], v248
    ds_read_b128 a[152:155], v246 offset:28672
    v_mfma_f32_32x32x16_bf16 v[0:15], a[124:127], a[92:95], v[0:15]
    ds_read_b128 a[124:127], v247 offset:20480
    v_exp_f32 v25, v25
    v_fma_f32 v31, v31, s32, -v239
    v_cvt_pk_bf16_f32 v131, v22, v23
    v_exp_f32 v26, v26
    s_waitcnt lgkmcnt(5)
    v_mfma_f32_32x32x16_bf16 v[0:15], a[156:159], a[252:255], v[0:15]
    ds_read_b128 a[252:255], v249
    ds_read_b128 a[156:159], v247 offset:28672
    v_exp_f32 v27, v27
    v_cvt_pk_bf16_f32 v132, v24, v25
    v_exp_f32 v28, v28
    v_mfma_f32_4x4x4_16b_bf16 v[232:235], v[236:237], a[214:215], v[232:235] cbsz:4 abid:0
    v_exp_f32 v29, v29
    v_cvt_pk_bf16_f32 v133, v26, v27
    v_mfma_f32_4x4x4_16b_bf16 v[232:235], v[236:237], v[128:129], v[232:235] cbsz:4 abid:1
    v_exp_f32 v30, v30
    v_exp_f32 v31, v31
    v_mfma_f32_4x4x4_16b_bf16 v[232:235], v[236:237], v[130:131], v[232:235] cbsz:4 abid:1
    v_cvt_pk_bf16_f32 v134, v28, v29
    v_cvt_pk_bf16_f32 v135, v30, v31
    v_mfma_f32_4x4x4_16b_bf16 v[232:235], v[236:237], v[132:133], v[232:235] cbsz:4 abid:1
    v_mfma_f32_32x32x16_bf16 v[16:31], a[96:99], a[0:3], 0
    s_waitcnt lgkmcnt(0)
    s_waitcnt vmcnt(16)
    s_barrier
    s_add_u32 m0, s30, 16384
    s_add_u32 s35, s25, 163840
    buffer_load_dwordx4 v252, s[12:15], s35 offen nt lds
    v_mfma_f32_32x32x16_bf16 v[16:31], a[128:131], a[248:251], v[16:31]
    ds_read_b128 a[248:251], v250
    s_add_u32 s35, s25, 195584
    buffer_load_dwordx4 v253, s[12:15], s35 offen offset:1024 nt lds
    v_max3_f32 v243, v0, v1, v243
    v_max3_f32 v243, v2, v3, v243
    v_mfma_f32_32x32x16_bf16 v[16:31], a[100:103], a[4:7], v[16:31]
    s_add_u32 s35, s25, 30720
    buffer_load_dwordx4 v252, s[12:15], s35 offen offset:2048 nt lds
    v_max3_f32 v243, v4, v5, v243
    v_max3_f32 v243, v6, v7, v243
    v_mfma_f32_32x32x16_bf16 v[16:31], a[132:135], a[252:255], v[16:31]
    ds_read_b128 a[252:255], v251
    s_add_u32 s35, s25, 62464
    buffer_load_dwordx4 v253, s[12:15], s35 offen offset:3072 nt lds
    v_max3_f32 v243, v8, v9, v243
    v_max3_f32 v243, v10, v11, v243
    v_mfma_f32_32x32x16_bf16 v[16:31], a[104:107], a[8:11], v[16:31]
    v_max3_f32 v243, v12, v13, v243
    v_max3_f32 v243, v14, v15, v243
    v_fma_f32 v254, v243, s32, -v240
    v_cmp_lt_f32 vcc, s33, v254
    s_waitcnt lgkmcnt(1)
    v_mfma_f32_32x32x16_bf16 v[16:31], a[136:139], a[248:251], v[16:31]
    ds_read_b128 a[248:251], v248 offset:16384
    v_fma_f32 v0, v0, s32, -v240
    v_fma_f32 v1, v1, s32, -v240
    v_fma_f32 v2, v2, s32, -v240
    v_fma_f32 v3, v3, s32, -v240
    v_mfma_f32_32x32x16_bf16 v[16:31], a[108:111], a[12:15], v[16:31]
    v_fma_f32 v4, v4, s32, -v240
    v_fma_f32 v5, v5, s32, -v240
    s_cbranch_vccnz L_stub_1_2_6
L_back_1_2_6:
    v_exp_f32 v0, v0
    s_waitcnt lgkmcnt(1)
    v_mfma_f32_32x32x16_bf16 v[16:31], a[140:143], a[252:255], v[16:31]
    ds_read_b128 a[252:255], v249 offset:16384
    v_fma_f32 v6, v6, s32, -v240
    v_exp_f32 v1, v1
    v_fma_f32 v7, v7, s32, -v240
    v_mfma_f32_32x32x16_bf16 v[16:31], a[112:115], a[16:19], v[16:31]
    v_exp_f32 v2, v2
    v_fma_f32 v8, v8, s32, -v240
    v_exp_f32 v3, v3
    s_waitcnt lgkmcnt(1)
    v_mfma_f32_32x32x16_bf16 v[16:31], a[144:147], a[248:251], v[16:31]
    ds_read_b128 a[248:251], v250 offset:16384
    v_fma_f32 v9, v9, s32, -v240
    v_cvt_pk_bf16_f32 v136, v0, v1
    v_exp_f32 v4, v4
    v_mfma_f32_32x32x16_bf16 v[16:31], a[116:119], a[20:23], v[16:31]
    v_fma_f32 v10, v10, s32, -v240
    v_exp_f32 v5, v5
    v_fma_f32 v11, v11, s32, -v240
    s_waitcnt lgkmcnt(1)
    v_mfma_f32_32x32x16_bf16 v[16:31], a[148:151], a[252:255], v[16:31]
    ds_read_b128 a[252:255], v251 offset:16384
    v_cvt_pk_bf16_f32 v137, v2, v3
    v_exp_f32 v6, v6
    v_fma_f32 v12, v12, s32, -v240
    v_mfma_f32_32x32x16_bf16 v[16:31], a[120:123], a[24:27], v[16:31]
    v_exp_f32 v7, v7
    v_fma_f32 v13, v13, s32, -v240
    v_cvt_pk_bf16_f32 v138, v4, v5
    s_waitcnt lgkmcnt(1)
    v_mfma_f32_32x32x16_bf16 v[16:31], a[152:155], a[248:251], v[16:31]
    v_add_u32 v248, 32768, v248
    v_add_u32 v249, 32768, v249
    v_add_u32 v250, 32768, v250
    v_add_u32 v251, 32768, v251
    ds_read_b128 a[248:251], v248
    v_exp_f32 v8, v8
    v_mfma_f32_32x32x16_bf16 v[16:31], a[124:127], a[28:31], v[16:31]
    v_fma_f32 v14, v14, s32, -v240
    v_exp_f32 v9, v9
    v_fma_f32 v15, v15, s32, -v240
    v_cvt_pk_bf16_f32 v139, v6, v7
    s_waitcnt lgkmcnt(1)
    v_mfma_f32_32x32x16_bf16 v[16:31], a[156:159], a[252:255], v[16:31]
    ds_read_b128 a[252:255], v249
    v_exp_f32 v10, v10
    v_exp_f32 v11, v11
    v_cvt_pk_bf16_f32 v140, v8, v9
    v_exp_f32 v12, v12
    v_mfma_f32_4x4x4_16b_bf16 v[232:235], v[236:237], v[134:135], v[232:235] cbsz:4 abid:1
    v_exp_f32 v13, v13
    v_cvt_pk_bf16_f32 v141, v10, v11
    v_mfma_f32_4x4x4_16b_bf16 v[232:235], v[236:237], v[136:137], v[232:235] cbsz:4 abid:2
    v_exp_f32 v14, v14
    v_exp_f32 v15, v15
    v_mfma_f32_4x4x4_16b_bf16 v[232:235], v[236:237], v[138:139], v[232:235] cbsz:4 abid:2
    v_cvt_pk_bf16_f32 v142, v12, v13
    v_cvt_pk_bf16_f32 v143, v14, v15
    v_mfma_f32_4x4x4_16b_bf16 v[232:235], v[236:237], v[140:141], v[232:235] cbsz:4 abid:2
    v_mfma_f32_32x32x16_bf16 v[0:15], a[96:99], a[32:35], 0
    v_max3_f32 v241, v16, v17, v241
    v_max3_f32 v241, v18, v19, v241
    v_max3_f32 v241, v20, v21, v241
    v_max3_f32 v241, v22, v23, v241
    s_waitcnt lgkmcnt(1)
    v_mfma_f32_32x32x16_bf16 v[0:15], a[128:131], a[248:251], v[0:15]
    ds_read_b128 a[248:251], v250
    v_max3_f32 v241, v24, v25, v241
    v_max3_f32 v241, v26, v27, v241
    v_max3_f32 v241, v28, v29, v241
    v_max3_f32 v241, v30, v31, v241
    v_mfma_f32_32x32x16_bf16 v[0:15], a[100:103], a[36:39], v[0:15]
    v_fma_f32 v254, v241, s32, -v238
    v_cmp_lt_f32 vcc, s33, v254
    v_fma_f32 v16, v16, s32, -v238
    v_fma_f32 v17, v17, s32, -v238
    s_waitcnt lgkmcnt(1)
    v_mfma_f32_32x32x16_bf16 v[0:15], a[132:135], a[252:255], v[0:15]
    ds_read_b128 a[252:255], v251
    v_fma_f32 v18, v18, s32, -v238
    v_fma_f32 v19, v19, s32, -v238
    v_fma_f32 v20, v20, s32, -v238
    v_fma_f32 v21, v21, s32, -v238
    v_mfma_f32_32x32x16_bf16 v[0:15], a[104:107], a[40:43], v[0:15]
    s_cbranch_vccnz L_stub_1_0_7
L_back_1_0_7:
    v_exp_f32 v16, v16
    v_fma_f32 v22, v22, s32, -v238
    v_exp_f32 v17, v17
    s_waitcnt lgkmcnt(1)
    v_mfma_f32_32x32x16_bf16 v[0:15], a[136:139], a[248:251], v[0:15]
    ds_read_b128 a[248:251], v248 offset:49152
    v_fma_f32 v23, v23, s32, -v238
    v_exp_f32 v18, v18
    v_fma_f32 v24, v24, s32, -v238
    v_mfma_f32_32x32x16_bf16 v[0:15], a[108:111], a[44:47], v[0:15]
    v_exp_f32 v19, v19
    v_fma_f32 v25, v25, s32, -v238
    v_cvt_pk_bf16_f32 v16, v16, v17
    s_waitcnt lgkmcnt(1)
    v_mfma_f32_32x32x16_bf16 v[0:15], a[140:143], a[252:255], v[0:15]
    ds_read_b128 a[252:255], v249 offset:49152
    v_accvgpr_write_b32 a216, v16
    v_exp_f32 v20, v20
    v_fma_f32 v26, v26, s32, -v238
    v_mfma_f32_32x32x16_bf16 v[0:15], a[112:115], a[48:51], v[0:15]
    v_exp_f32 v21, v21
    v_fma_f32 v27, v27, s32, -v238
    v_cvt_pk_bf16_f32 v18, v18, v19
    s_waitcnt lgkmcnt(1)
    v_mfma_f32_32x32x16_bf16 v[0:15], a[144:147], a[248:251], v[0:15]
    ds_read_b128 a[248:251], v250 offset:49152
    v_accvgpr_write_b32 a217, v18
    v_exp_f32 v22, v22
    v_fma_f32 v28, v28, s32, -v238
    v_mfma_f32_32x32x16_bf16 v[0:15], a[116:119], a[52:55], v[0:15]
    v_exp_f32 v23, v23
    v_fma_f32 v29, v29, s32, -v238
    v_cvt_pk_bf16_f32 v20, v20, v21
    s_waitcnt lgkmcnt(1)
    v_mfma_f32_32x32x16_bf16 v[0:15], a[148:151], a[252:255], v[0:15]
    ds_read_b128 a[252:255], v251 offset:49152
    v_accvgpr_write_b32 a218, v20
    v_exp_f32 v24, v24
    v_fma_f32 v30, v30, s32, -v238
    v_mfma_f32_32x32x16_bf16 v[0:15], a[120:123], a[56:59], v[0:15]
    v_exp_f32 v25, v25
    v_fma_f32 v31, v31, s32, -v238
    v_cvt_pk_bf16_f32 v22, v22, v23
    s_waitcnt lgkmcnt(1)
    v_mfma_f32_32x32x16_bf16 v[0:15], a[152:155], a[248:251], v[0:15]
    ds_read_b128 a[248:251], v248 offset:32768
    v_accvgpr_write_b32 a219, v22
    v_exp_f32 v26, v26
    v_exp_f32 v27, v27
    v_mfma_f32_32x32x16_bf16 v[0:15], a[124:127], a[60:63], v[0:15]
    v_cvt_pk_bf16_f32 v24, v24, v25
    v_accvgpr_write_b32 a220, v24
    v_exp_f32 v28, v28
    s_waitcnt lgkmcnt(1)
    v_mfma_f32_32x32x16_bf16 v[0:15], a[156:159], a[252:255], v[0:15]
    ds_read_b128 a[252:255], v249 offset:32768
    v_exp_f32 v29, v29
    v_cvt_pk_bf16_f32 v26, v26, v27
    v_accvgpr_write_b32 a221, v26
    v_mfma_f32_4x4x4_16b_bf16 v[232:235], v[236:237], v[142:143], v[232:235] cbsz:4 abid:2
    v_exp_f32 v30, v30
    v_exp_f32 v31, v31
    v_mfma_f32_4x4x4_16b_bf16 v[232:235], v[236:237], a[216:217], v[232:235] cbsz:4 abid:0
    v_cvt_pk_bf16_f32 v28, v28, v29
    v_accvgpr_write_b32 a222, v28
    v_mfma_f32_4x4x4_16b_bf16 v[232:235], v[236:237], a[218:219], v[232:235] cbsz:4 abid:0
    v_cvt_pk_bf16_f32 v30, v30, v31
    v_accvgpr_write_b32 a223, v30
    v_mfma_f32_4x4x4_16b_bf16 v[232:235], v[236:237], a[220:221], v[232:235] cbsz:4 abid:0
    v_mfma_f32_32x32x16_bf16 v[16:31], a[96:99], a[64:67], 0
    ds_read_b128 a[96:99], v244 offset:32768
    v_max3_f32 v242, v0, v1, v242
    v_max3_f32 v242, v2, v3, v242
    v_max3_f32 v242, v4, v5, v242
    s_waitcnt lgkmcnt(2)
    v_mfma_f32_32x32x16_bf16 v[16:31], a[128:131], a[248:251], v[16:31]
    ds_read_b128 a[248:251], v250 offset:32768
    ds_read_b128 a[128:131], v244 offset:40960
    v_max3_f32 v242, v6, v7, v242
    v_max3_f32 v242, v8, v9, v242
    v_max3_f32 v242, v10, v11, v242
    v_mfma_f32_32x32x16_bf16 v[16:31], a[100:103], a[68:71], v[16:31]
    ds_read_b128 a[100:103], v245 offset:32768
    v_max3_f32 v242, v12, v13, v242
    v_max3_f32 v242, v14, v15, v242
    v_fma_f32 v254, v242, s32, -v239
    v_cmp_lt_f32 vcc, s33, v254
    s_waitcnt lgkmcnt(4)
    v_mfma_f32_32x32x16_bf16 v[16:31], a[132:135], a[252:255], v[16:31]
    ds_read_b128 a[252:255], v251 offset:32768
    ds_read_b128 a[132:135], v245 offset:40960
    v_fma_f32 v0, v0, s32, -v239
    v_fma_f32 v1, v1, s32, -v239
    v_fma_f32 v2, v2, s32, -v239
    v_mfma_f32_32x32x16_bf16 v[16:31], a[104:107], a[72:75], v[16:31]
    ds_read_b128 a[104:107], v246 offset:32768
    v_fma_f32 v3, v3, s32, -v239
    v_fma_f32 v4, v4, s32, -v239
    v_fma_f32 v5, v5, s32, -v239
    s_waitcnt lgkmcnt(5)
    v_mfma_f32_32x32x16_bf16 v[16:31], a[136:139], a[248:251], v[16:31]
    ds_read_b128 a[248:251], v248 offset:16384
    ds_read_b128 a[136:139], v246 offset:40960
    s_cbranch_vccnz L_stub_1_1_7
L_back_1_1_7:
    v_exp_f32 v0, v0
    v_fma_f32 v6, v6, s32, -v239
    v_mfma_f32_32x32x16_bf16 v[16:31], a[108:111], a[76:79], v[16:31]
    ds_read_b128 a[108:111], v247 offset:32768
    v_exp_f32 v1, v1
    v_fma_f32 v7, v7, s32, -v239
    v_exp_f32 v2, v2
    s_waitcnt lgkmcnt(5)
    v_mfma_f32_32x32x16_bf16 v[16:31], a[140:143], a[252:255], v[16:31]
    ds_read_b128 a[252:255], v249 offset:16384
    ds_read_b128 a[140:143], v247 offset:40960
    v_fma_f32 v8, v8, s32, -v239
    v_exp_f32 v3, v3
    v_mfma_f32_32x32x16_bf16 v[16:31], a[112:115], a[80:83], v[16:31]
    ds_read_b128 a[112:115], v244 offset:36864
    v_fma_f32 v9, v9, s32, -v239
    v_cvt_pk_bf16_f32 v144, v0, v1
    v_exp_f32 v4, v4
    s_waitcnt lgkmcnt(5)
    v_mfma_f32_32x32x16_bf16 v[16:31], a[144:147], a[248:251], v[16:31]
    ds_read_b128 a[248:251], v250 offset:16384
    ds_read_b128 a[144:147], v244 offset:45056
    v_fma_f32 v10, v10, s32, -v239
    v_exp_f32 v5, v5
    v_fma_f32 v11, v11, s32, -v239
    v_mfma_f32_32x32x16_bf16 v[16:31], a[116:119], a[84:87], v[16:31]
    ds_read_b128 a[116:119], v245 offset:36864
    v_cvt_pk_bf16_f32 v145, v2, v3
    v_exp_f32 v6, v6
    v_fma_f32 v12, v12, s32, -v239
    s_waitcnt lgkmcnt(5)
    v_mfma_f32_32x32x16_bf16 v[16:31], a[148:151], a[252:255], v[16:31]
    ds_read_b128 a[252:255], v251 offset:16384
    ds_read_b128 a[148:151], v245 offset:45056
    v_exp_f32 v7, v7
    v_fma_f32 v13, v13, s32, -v239
    v_mfma_f32_32x32x16_bf16 v[16:31], a[120:123], a[88:91], v[16:31]
    ds_read_b128 a[120:123], v246 offset:36864
    v_cvt_pk_bf16_f32 v146, v4, v5
    v_exp_f32 v8, v8
    v_fma_f32 v14, v14, s32, -v239
    s_waitcnt lgkmcnt(5)
    v_mfma_f32_32x32x16_bf16 v[16:31], a[152:155], a[248:251], v[16:31]
    v_subrev_u32 v248, 32768, v248
    v_subrev_u32 v249, 32768, v249
    v_subrev_u32 v250, 32768, v250
    v_subrev_u32 v251, 32768, v251
    ds_read_b128 a[248:251], v248
    ds_read_b128 a[152:155], v246 offset:45056
    v_mfma_f32_32x32x16_bf16 v[16:31], a[124:127], a[92:95], v[16:31]
    ds_read_b128 a[124:127], v247 offset:36864
    v_exp_f32 v9, v9
    v_fma_f32 v15, v15, s32, -v239
    v_cvt_pk_bf16_f32 v147, v6, v7
    v_exp_f32 v10, v10
    s_waitcnt lgkmcnt(5)
    v_mfma_f32_32x32x16_bf16 v[16:31], a[156:159], a[252:255], v[16:31]
    ds_read_b128 a[252:255], v249
    ds_read_b128 a[156:159], v247 offset:45056
    v_exp_f32 v11, v11
    v_cvt_pk_bf16_f32 v148, v8, v9
    v_exp_f32 v12, v12
    v_mfma_f32_4x4x4_16b_bf16 v[232:235], v[236:237], a[222:223], v[232:235] cbsz:4 abid:0
    v_exp_f32 v13, v13
    v_cvt_pk_bf16_f32 v149, v10, v11
    v_mfma_f32_4x4x4_16b_bf16 v[232:235], v[236:237], v[144:145], v[232:235] cbsz:4 abid:1
    v_exp_f32 v14, v14
    v_exp_f32 v15, v15
    v_mfma_f32_4x4x4_16b_bf16 v[232:235], v[236:237], v[146:147], v[232:235] cbsz:4 abid:1
    v_cvt_pk_bf16_f32 v150, v12, v13
    v_cvt_pk_bf16_f32 v151, v14, v15
    v_mfma_f32_4x4x4_16b_bf16 v[232:235], v[236:237], v[148:149], v[232:235] cbsz:4 abid:1
    v_mfma_f32_32x32x16_bf16 v[0:15], a[96:99], a[0:3], 0
    s_waitcnt lgkmcnt(0)
    s_waitcnt vmcnt(8)
    s_barrier
    s_add_u32 m0, s30, 32768
    s_add_u32 s35, s27, 69632
    buffer_load_dwordx4 v252, s[16:19], s35 offen nt lds
    v_mfma_f32_32x32x16_bf16 v[0:15], a[128:131], a[248:251], v[0:15]
    ds_read_b128 a[248:251], v250
    s_add_u32 s35, s27, 101376
    buffer_load_dwordx4 v253, s[16:19], s35 offen offset:1024 nt lds
    v_max3_f32 v243, v16, v17, v243
    v_max3_f32 v243, v18, v19, v243
    v_mfma_f32_32x32x16_bf16 v[0:15], a[100:103], a[4:7], v[0:15]
    s_add_u32 s35, s27, 133120
    buffer_load_dwordx4 v252, s[16:19], s35 offen offset:2048 nt lds
    v_max3_f32 v243, v20, v21, v243
    v_max3_f32 v243, v22, v23, v243
    v_mfma_f32_32x32x16_bf16 v[0:15], a[132:135], a[252:255], v[0:15]
    ds_read_b128 a[252:255], v251
    s_add_u32 s35, s27, 164864
    buffer_load_dwordx4 v253, s[16:19], s35 offen offset:3072 nt lds
    v_max3_f32 v243, v24, v25, v243
    v_max3_f32 v243, v26, v27, v243
    v_mfma_f32_32x32x16_bf16 v[0:15], a[104:107], a[8:11], v[0:15]
    v_max3_f32 v243, v28, v29, v243
    v_max3_f32 v243, v30, v31, v243
    v_fma_f32 v254, v243, s32, -v240
    v_cmp_lt_f32 vcc, s33, v254
    s_waitcnt lgkmcnt(1)
    v_mfma_f32_32x32x16_bf16 v[0:15], a[136:139], a[248:251], v[0:15]
    ds_read_b128 a[248:251], v248 offset:16384
    v_fma_f32 v16, v16, s32, -v240
    v_fma_f32 v17, v17, s32, -v240
    v_fma_f32 v18, v18, s32, -v240
    v_fma_f32 v19, v19, s32, -v240
    v_mfma_f32_32x32x16_bf16 v[0:15], a[108:111], a[12:15], v[0:15]
    v_fma_f32 v20, v20, s32, -v240
    v_fma_f32 v21, v21, s32, -v240
    s_cbranch_vccnz L_stub_1_2_7
L_back_1_2_7:
    v_exp_f32 v16, v16
    s_waitcnt lgkmcnt(1)
    v_mfma_f32_32x32x16_bf16 v[0:15], a[140:143], a[252:255], v[0:15]
    ds_read_b128 a[252:255], v249 offset:16384
    v_fma_f32 v22, v22, s32, -v240
    v_exp_f32 v17, v17
    v_fma_f32 v23, v23, s32, -v240
    v_mfma_f32_32x32x16_bf16 v[0:15], a[112:115], a[16:19], v[0:15]
    v_exp_f32 v18, v18
    v_fma_f32 v24, v24, s32, -v240
    v_exp_f32 v19, v19
    s_waitcnt lgkmcnt(1)
    v_mfma_f32_32x32x16_bf16 v[0:15], a[144:147], a[248:251], v[0:15]
    ds_read_b128 a[248:251], v250 offset:16384
    v_fma_f32 v25, v25, s32, -v240
    v_cvt_pk_bf16_f32 v152, v16, v17
    v_exp_f32 v20, v20
    v_mfma_f32_32x32x16_bf16 v[0:15], a[116:119], a[20:23], v[0:15]
    v_fma_f32 v26, v26, s32, -v240
    v_exp_f32 v21, v21
    v_fma_f32 v27, v27, s32, -v240
    s_waitcnt lgkmcnt(1)
    v_mfma_f32_32x32x16_bf16 v[0:15], a[148:151], a[252:255], v[0:15]
    ds_read_b128 a[252:255], v251 offset:16384
    v_cvt_pk_bf16_f32 v153, v18, v19
    v_exp_f32 v22, v22
    v_fma_f32 v28, v28, s32, -v240
    v_mfma_f32_32x32x16_bf16 v[0:15], a[120:123], a[24:27], v[0:15]
    v_exp_f32 v23, v23
    v_fma_f32 v29, v29, s32, -v240
    v_cvt_pk_bf16_f32 v154, v20, v21
    s_waitcnt lgkmcnt(1)
    v_mfma_f32_32x32x16_bf16 v[0:15], a[152:155], a[248:251], v[0:15]
    v_add_u32 v248, 32768, v248
    v_add_u32 v249, 32768, v249
    v_add_u32 v250, 32768, v250
    v_add_u32 v251, 32768, v251
    ds_read_b128 a[248:251], v248
    v_exp_f32 v24, v24
    v_mfma_f32_32x32x16_bf16 v[0:15], a[124:127], a[28:31], v[0:15]
    v_fma_f32 v30, v30, s32, -v240
    v_exp_f32 v25, v25
    v_fma_f32 v31, v31, s32, -v240
    v_cvt_pk_bf16_f32 v155, v22, v23
    s_waitcnt lgkmcnt(1)
    v_mfma_f32_32x32x16_bf16 v[0:15], a[156:159], a[252:255], v[0:15]
    ds_read_b128 a[252:255], v249
    v_exp_f32 v26, v26
    v_exp_f32 v27, v27
    v_cvt_pk_bf16_f32 v156, v24, v25
    v_exp_f32 v28, v28
    v_mfma_f32_4x4x4_16b_bf16 v[232:235], v[236:237], v[150:151], v[232:235] cbsz:4 abid:1
    v_exp_f32 v29, v29
    v_cvt_pk_bf16_f32 v157, v26, v27
    v_mfma_f32_4x4x4_16b_bf16 v[232:235], v[236:237], v[152:153], v[232:235] cbsz:4 abid:2
    v_exp_f32 v30, v30
    v_exp_f32 v31, v31
    v_mfma_f32_4x4x4_16b_bf16 v[232:235], v[236:237], v[154:155], v[232:235] cbsz:4 abid:2
    v_cvt_pk_bf16_f32 v158, v28, v29
    v_cvt_pk_bf16_f32 v159, v30, v31
    v_mfma_f32_4x4x4_16b_bf16 v[232:235], v[236:237], v[156:157], v[232:235] cbsz:4 abid:2
    v_mfma_f32_32x32x16_bf16 v[16:31], a[96:99], a[32:35], 0
    v_max3_f32 v241, v0, v1, v241
    v_max3_f32 v241, v2, v3, v241
    v_max3_f32 v241, v4, v5, v241
    v_max3_f32 v241, v6, v7, v241
    s_waitcnt lgkmcnt(1)
    v_mfma_f32_32x32x16_bf16 v[16:31], a[128:131], a[248:251], v[16:31]
    ds_read_b128 a[248:251], v250
    v_max3_f32 v241, v8, v9, v241
    v_max3_f32 v241, v10, v11, v241
    v_max3_f32 v241, v12, v13, v241
    v_max3_f32 v241, v14, v15, v241
    v_mfma_f32_32x32x16_bf16 v[16:31], a[100:103], a[36:39], v[16:31]
    v_fma_f32 v254, v241, s32, -v238
    v_cmp_lt_f32 vcc, s33, v254
    v_fma_f32 v0, v0, s32, -v238
    v_fma_f32 v1, v1, s32, -v238
    s_waitcnt lgkmcnt(1)
    v_mfma_f32_32x32x16_bf16 v[16:31], a[132:135], a[252:255], v[16:31]
    ds_read_b128 a[252:255], v251
    v_fma_f32 v2, v2, s32, -v238
    v_fma_f32 v3, v3, s32, -v238
    v_fma_f32 v4, v4, s32, -v238
    v_fma_f32 v5, v5, s32, -v238
    v_mfma_f32_32x32x16_bf16 v[16:31], a[104:107], a[40:43], v[16:31]
    s_cbranch_vccnz L_stub_1_0_8
L_back_1_0_8:
    v_exp_f32 v0, v0
    v_fma_f32 v6, v6, s32, -v238
    v_exp_f32 v1, v1
    s_waitcnt lgkmcnt(1)
    v_mfma_f32_32x32x16_bf16 v[16:31], a[136:139], a[248:251], v[16:31]
    ds_read_b128 a[248:251], v248 offset:49152
    v_fma_f32 v7, v7, s32, -v238
    v_exp_f32 v2, v2
    v_fma_f32 v8, v8, s32, -v238
    v_mfma_f32_32x32x16_bf16 v[16:31], a[108:111], a[44:47], v[16:31]
    v_exp_f32 v3, v3
    v_fma_f32 v9, v9, s32, -v238
    v_cvt_pk_bf16_f32 v0, v0, v1
    s_waitcnt lgkmcnt(1)
    v_mfma_f32_32x32x16_bf16 v[16:31], a[140:143], a[252:255], v[16:31]
    ds_read_b128 a[252:255], v249 offset:49152
    v_accvgpr_write_b32 a224, v0
    v_exp_f32 v4, v4
    v_fma_f32 v10, v10, s32, -v238
    v_mfma_f32_32x32x16_bf16 v[16:31], a[112:115], a[48:51], v[16:31]
    v_exp_f32 v5, v5
    v_fma_f32 v11, v11, s32, -v238
    v_cvt_pk_bf16_f32 v2, v2, v3
    s_waitcnt lgkmcnt(1)
    v_mfma_f32_32x32x16_bf16 v[16:31], a[144:147], a[248:251], v[16:31]
    ds_read_b128 a[248:251], v250 offset:49152
    v_accvgpr_write_b32 a225, v2
    v_exp_f32 v6, v6
    v_fma_f32 v12, v12, s32, -v238
    v_mfma_f32_32x32x16_bf16 v[16:31], a[116:119], a[52:55], v[16:31]
    v_exp_f32 v7, v7
    v_fma_f32 v13, v13, s32, -v238
    v_cvt_pk_bf16_f32 v4, v4, v5
    s_waitcnt lgkmcnt(1)
    v_mfma_f32_32x32x16_bf16 v[16:31], a[148:151], a[252:255], v[16:31]
    ds_read_b128 a[252:255], v251 offset:49152
    v_accvgpr_write_b32 a226, v4
    v_exp_f32 v8, v8
    v_fma_f32 v14, v14, s32, -v238
    v_mfma_f32_32x32x16_bf16 v[16:31], a[120:123], a[56:59], v[16:31]
    v_exp_f32 v9, v9
    v_fma_f32 v15, v15, s32, -v238
    v_cvt_pk_bf16_f32 v6, v6, v7
    s_waitcnt lgkmcnt(1)
    v_mfma_f32_32x32x16_bf16 v[16:31], a[152:155], a[248:251], v[16:31]
    ds_read_b128 a[248:251], v248 offset:32768
    v_accvgpr_write_b32 a227, v6
    v_exp_f32 v10, v10
    v_exp_f32 v11, v11
    v_mfma_f32_32x32x16_bf16 v[16:31], a[124:127], a[60:63], v[16:31]
    v_cvt_pk_bf16_f32 v8, v8, v9
    v_accvgpr_write_b32 a228, v8
    v_exp_f32 v12, v12
    s_waitcnt lgkmcnt(1)
    v_mfma_f32_32x32x16_bf16 v[16:31], a[156:159], a[252:255], v[16:31]
    ds_read_b128 a[252:255], v249 offset:32768
    v_exp_f32 v13, v13
    v_cvt_pk_bf16_f32 v10, v10, v11
    v_accvgpr_write_b32 a229, v10
    v_mfma_f32_4x4x4_16b_bf16 v[232:235], v[236:237], v[158:159], v[232:235] cbsz:4 abid:2
    v_exp_f32 v14, v14
    v_exp_f32 v15, v15
    v_mfma_f32_4x4x4_16b_bf16 v[232:235], v[236:237], a[224:225], v[232:235] cbsz:4 abid:0
    v_cvt_pk_bf16_f32 v12, v12, v13
    v_accvgpr_write_b32 a230, v12
    v_mfma_f32_4x4x4_16b_bf16 v[232:235], v[236:237], a[226:227], v[232:235] cbsz:4 abid:0
    v_cvt_pk_bf16_f32 v14, v14, v15
    v_accvgpr_write_b32 a231, v14
    v_mfma_f32_4x4x4_16b_bf16 v[232:235], v[236:237], a[228:229], v[232:235] cbsz:4 abid:0
    v_mfma_f32_32x32x16_bf16 v[0:15], a[96:99], a[64:67], 0
    ds_read_b128 a[96:99], v244 offset:49152
    v_max3_f32 v242, v16, v17, v242
    v_max3_f32 v242, v18, v19, v242
    v_max3_f32 v242, v20, v21, v242
    s_waitcnt lgkmcnt(2)
    v_mfma_f32_32x32x16_bf16 v[0:15], a[128:131], a[248:251], v[0:15]
    ds_read_b128 a[248:251], v250 offset:32768
    ds_read_b128 a[128:131], v244 offset:57344
    v_max3_f32 v242, v22, v23, v242
    v_max3_f32 v242, v24, v25, v242
    v_max3_f32 v242, v26, v27, v242
    v_mfma_f32_32x32x16_bf16 v[0:15], a[100:103], a[68:71], v[0:15]
    ds_read_b128 a[100:103], v245 offset:49152
    v_max3_f32 v242, v28, v29, v242
    v_max3_f32 v242, v30, v31, v242
    v_fma_f32 v254, v242, s32, -v239
    v_cmp_lt_f32 vcc, s33, v254
    s_waitcnt lgkmcnt(4)
    v_mfma_f32_32x32x16_bf16 v[0:15], a[132:135], a[252:255], v[0:15]
    ds_read_b128 a[252:255], v251 offset:32768
    ds_read_b128 a[132:135], v245 offset:57344
    v_fma_f32 v16, v16, s32, -v239
    v_fma_f32 v17, v17, s32, -v239
    v_fma_f32 v18, v18, s32, -v239
    v_mfma_f32_32x32x16_bf16 v[0:15], a[104:107], a[72:75], v[0:15]
    ds_read_b128 a[104:107], v246 offset:49152
    v_fma_f32 v19, v19, s32, -v239
    v_fma_f32 v20, v20, s32, -v239
    v_fma_f32 v21, v21, s32, -v239
    s_waitcnt lgkmcnt(5)
    v_mfma_f32_32x32x16_bf16 v[0:15], a[136:139], a[248:251], v[0:15]
    ds_read_b128 a[248:251], v248 offset:16384
    ds_read_b128 a[136:139], v246 offset:57344
    s_cbranch_vccnz L_stub_1_1_8
L_back_1_1_8:
    v_exp_f32 v16, v16
    v_fma_f32 v22, v22, s32, -v239
    v_mfma_f32_32x32x16_bf16 v[0:15], a[108:111], a[76:79], v[0:15]
    ds_read_b128 a[108:111], v247 offset:49152
    v_exp_f32 v17, v17
    v_fma_f32 v23, v23, s32, -v239
    v_exp_f32 v18, v18
    s_waitcnt lgkmcnt(5)
    v_mfma_f32_32x32x16_bf16 v[0:15], a[140:143], a[252:255], v[0:15]
    ds_read_b128 a[252:255], v249 offset:16384
    ds_read_b128 a[140:143], v247 offset:57344
    v_fma_f32 v24, v24, s32, -v239
    v_exp_f32 v19, v19
    v_mfma_f32_32x32x16_bf16 v[0:15], a[112:115], a[80:83], v[0:15]
    ds_read_b128 a[112:115], v244 offset:53248
    v_fma_f32 v25, v25, s32, -v239
    v_cvt_pk_bf16_f32 v160, v16, v17
    v_exp_f32 v20, v20
    s_waitcnt lgkmcnt(5)
    v_mfma_f32_32x32x16_bf16 v[0:15], a[144:147], a[248:251], v[0:15]
    ds_read_b128 a[248:251], v250 offset:16384
    ds_read_b128 a[144:147], v244 offset:61440
    v_fma_f32 v26, v26, s32, -v239
    v_exp_f32 v21, v21
    v_fma_f32 v27, v27, s32, -v239
    v_mfma_f32_32x32x16_bf16 v[0:15], a[116:119], a[84:87], v[0:15]
    ds_read_b128 a[116:119], v245 offset:53248
    v_cvt_pk_bf16_f32 v161, v18, v19
    v_exp_f32 v22, v22
    v_fma_f32 v28, v28, s32, -v239
    s_waitcnt lgkmcnt(5)
    v_mfma_f32_32x32x16_bf16 v[0:15], a[148:151], a[252:255], v[0:15]
    ds_read_b128 a[252:255], v251 offset:16384
    ds_read_b128 a[148:151], v245 offset:61440
    v_exp_f32 v23, v23
    v_fma_f32 v29, v29, s32, -v239
    v_mfma_f32_32x32x16_bf16 v[0:15], a[120:123], a[88:91], v[0:15]
    ds_read_b128 a[120:123], v246 offset:53248
    v_cvt_pk_bf16_f32 v162, v20, v21
    v_exp_f32 v24, v24
    v_fma_f32 v30, v30, s32, -v239
    s_waitcnt lgkmcnt(5)
    v_mfma_f32_32x32x16_bf16 v[0:15], a[152:155], a[248:251], v[0:15]
    v_subrev_u32 v248, 32768, v248
    v_subrev_u32 v249, 32768, v249
    v_subrev_u32 v250, 32768, v250
    v_subrev_u32 v251, 32768, v251
    ds_read_b128 a[248:251], v248
    ds_read_b128 a[152:155], v246 offset:61440
    v_mfma_f32_32x32x16_bf16 v[0:15], a[124:127], a[92:95], v[0:15]
    ds_read_b128 a[124:127], v247 offset:53248
    v_exp_f32 v25, v25
    v_fma_f32 v31, v31, s32, -v239
    v_cvt_pk_bf16_f32 v163, v22, v23
    v_exp_f32 v26, v26
    s_waitcnt lgkmcnt(5)
    v_mfma_f32_32x32x16_bf16 v[0:15], a[156:159], a[252:255], v[0:15]
    ds_read_b128 a[252:255], v249
    ds_read_b128 a[156:159], v247 offset:61440
    v_exp_f32 v27, v27
    v_cvt_pk_bf16_f32 v164, v24, v25
    v_exp_f32 v28, v28
    v_mfma_f32_4x4x4_16b_bf16 v[232:235], v[236:237], a[230:231], v[232:235] cbsz:4 abid:0
    v_exp_f32 v29, v29
    v_cvt_pk_bf16_f32 v165, v26, v27
    v_mfma_f32_4x4x4_16b_bf16 v[232:235], v[236:237], v[160:161], v[232:235] cbsz:4 abid:1
    v_exp_f32 v30, v30
    v_exp_f32 v31, v31
    v_mfma_f32_4x4x4_16b_bf16 v[232:235], v[236:237], v[162:163], v[232:235] cbsz:4 abid:1
    v_cvt_pk_bf16_f32 v166, v28, v29
    v_cvt_pk_bf16_f32 v167, v30, v31
    v_mfma_f32_4x4x4_16b_bf16 v[232:235], v[236:237], v[164:165], v[232:235] cbsz:4 abid:1
    v_mfma_f32_32x32x16_bf16 v[16:31], a[96:99], a[0:3], 0
    s_waitcnt lgkmcnt(0)
    s_waitcnt vmcnt(8)
    s_barrier
    s_add_u32 m0, s30, 49152
    s_add_u32 s35, s27, 77824
    buffer_load_dwordx4 v252, s[16:19], s35 offen nt lds
    v_mfma_f32_32x32x16_bf16 v[16:31], a[128:131], a[248:251], v[16:31]
    ds_read_b128 a[248:251], v250
    s_add_u32 s35, s27, 109568
    buffer_load_dwordx4 v253, s[16:19], s35 offen offset:1024 nt lds
    v_max3_f32 v243, v0, v1, v243
    v_max3_f32 v243, v2, v3, v243
    v_mfma_f32_32x32x16_bf16 v[16:31], a[100:103], a[4:7], v[16:31]
    s_add_u32 s35, s27, 141312
    buffer_load_dwordx4 v252, s[16:19], s35 offen offset:2048 nt lds
    v_max3_f32 v243, v4, v5, v243
    v_max3_f32 v243, v6, v7, v243
    v_mfma_f32_32x32x16_bf16 v[16:31], a[132:135], a[252:255], v[16:31]
    ds_read_b128 a[252:255], v251
    s_add_u32 s35, s27, 173056
    buffer_load_dwordx4 v253, s[16:19], s35 offen offset:3072 nt lds
    v_max3_f32 v243, v8, v9, v243
    v_max3_f32 v243, v10, v11, v243
    v_mfma_f32_32x32x16_bf16 v[16:31], a[104:107], a[8:11], v[16:31]
    v_max3_f32 v243, v12, v13, v243
    v_max3_f32 v243, v14, v15, v243
    v_fma_f32 v254, v243, s32, -v240
    v_cmp_lt_f32 vcc, s33, v254
    s_waitcnt lgkmcnt(1)
    v_mfma_f32_32x32x16_bf16 v[16:31], a[136:139], a[248:251], v[16:31]
    ds_read_b128 a[248:251], v248 offset:16384
    v_fma_f32 v0, v0, s32, -v240
    v_fma_f32 v1, v1, s32, -v240
    v_fma_f32 v2, v2, s32, -v240
    v_fma_f32 v3, v3, s32, -v240
    v_mfma_f32_32x32x16_bf16 v[16:31], a[108:111], a[12:15], v[16:31]
    v_fma_f32 v4, v4, s32, -v240
    v_fma_f32 v5, v5, s32, -v240
    s_cbranch_vccnz L_stub_1_2_8
L_back_1_2_8:
    v_exp_f32 v0, v0
    s_waitcnt lgkmcnt(1)
    v_mfma_f32_32x32x16_bf16 v[16:31], a[140:143], a[252:255], v[16:31]
    ds_read_b128 a[252:255], v249 offset:16384
    v_fma_f32 v6, v6, s32, -v240
    v_exp_f32 v1, v1
    v_fma_f32 v7, v7, s32, -v240
    v_mfma_f32_32x32x16_bf16 v[16:31], a[112:115], a[16:19], v[16:31]
    v_exp_f32 v2, v2
    v_fma_f32 v8, v8, s32, -v240
    v_exp_f32 v3, v3
    s_waitcnt lgkmcnt(1)
    v_mfma_f32_32x32x16_bf16 v[16:31], a[144:147], a[248:251], v[16:31]
    ds_read_b128 a[248:251], v250 offset:16384
    v_fma_f32 v9, v9, s32, -v240
    v_cvt_pk_bf16_f32 v168, v0, v1
    v_exp_f32 v4, v4
    v_mfma_f32_32x32x16_bf16 v[16:31], a[116:119], a[20:23], v[16:31]
    v_fma_f32 v10, v10, s32, -v240
    v_exp_f32 v5, v5
    v_fma_f32 v11, v11, s32, -v240
    s_waitcnt lgkmcnt(1)
    v_mfma_f32_32x32x16_bf16 v[16:31], a[148:151], a[252:255], v[16:31]
    ds_read_b128 a[252:255], v251 offset:16384
    v_cvt_pk_bf16_f32 v169, v2, v3
    v_exp_f32 v6, v6
    v_fma_f32 v12, v12, s32, -v240
    v_mfma_f32_32x32x16_bf16 v[16:31], a[120:123], a[24:27], v[16:31]
    v_exp_f32 v7, v7
    v_fma_f32 v13, v13, s32, -v240
    v_cvt_pk_bf16_f32 v170, v4, v5
    s_waitcnt lgkmcnt(1)
    v_mfma_f32_32x32x16_bf16 v[16:31], a[152:155], a[248:251], v[16:31]
    v_add_u32 v248, 32768, v248
    v_add_u32 v249, 32768, v249
    v_add_u32 v250, 32768, v250
    v_add_u32 v251, 32768, v251
    ds_read_b128 a[248:251], v248
    v_exp_f32 v8, v8
    v_mfma_f32_32x32x16_bf16 v[16:31], a[124:127], a[28:31], v[16:31]
    v_fma_f32 v14, v14, s32, -v240
    v_exp_f32 v9, v9
    v_fma_f32 v15, v15, s32, -v240
    v_cvt_pk_bf16_f32 v171, v6, v7
    s_waitcnt lgkmcnt(1)
    v_mfma_f32_32x32x16_bf16 v[16:31], a[156:159], a[252:255], v[16:31]
    ds_read_b128 a[252:255], v249
    v_exp_f32 v10, v10
    v_exp_f32 v11, v11
    v_cvt_pk_bf16_f32 v172, v8, v9
    v_exp_f32 v12, v12
    v_mfma_f32_4x4x4_16b_bf16 v[232:235], v[236:237], v[166:167], v[232:235] cbsz:4 abid:1
    v_exp_f32 v13, v13
    v_cvt_pk_bf16_f32 v173, v10, v11
    v_mfma_f32_4x4x4_16b_bf16 v[232:235], v[236:237], v[168:169], v[232:235] cbsz:4 abid:2
    v_exp_f32 v14, v14
    v_exp_f32 v15, v15
    v_mfma_f32_4x4x4_16b_bf16 v[232:235], v[236:237], v[170:171], v[232:235] cbsz:4 abid:2
    v_cvt_pk_bf16_f32 v174, v12, v13
    v_cvt_pk_bf16_f32 v175, v14, v15
    v_mfma_f32_4x4x4_16b_bf16 v[232:235], v[236:237], v[172:173], v[232:235] cbsz:4 abid:2
    v_mfma_f32_32x32x16_bf16 v[0:15], a[96:99], a[32:35], 0
    v_max3_f32 v241, v16, v17, v241
    v_max3_f32 v241, v18, v19, v241
    v_max3_f32 v241, v20, v21, v241
    v_max3_f32 v241, v22, v23, v241
    s_waitcnt lgkmcnt(1)
    v_mfma_f32_32x32x16_bf16 v[0:15], a[128:131], a[248:251], v[0:15]
    ds_read_b128 a[248:251], v250
    v_max3_f32 v241, v24, v25, v241
    v_max3_f32 v241, v26, v27, v241
    v_max3_f32 v241, v28, v29, v241
    v_max3_f32 v241, v30, v31, v241
    v_mfma_f32_32x32x16_bf16 v[0:15], a[100:103], a[36:39], v[0:15]
    v_fma_f32 v254, v241, s32, -v238
    v_cmp_lt_f32 vcc, s33, v254
    v_fma_f32 v16, v16, s32, -v238
    v_fma_f32 v17, v17, s32, -v238
    s_waitcnt lgkmcnt(1)
    v_mfma_f32_32x32x16_bf16 v[0:15], a[132:135], a[252:255], v[0:15]
    ds_read_b128 a[252:255], v251
    v_fma_f32 v18, v18, s32, -v238
    v_fma_f32 v19, v19, s32, -v238
    v_fma_f32 v20, v20, s32, -v238
    v_fma_f32 v21, v21, s32, -v238
    v_mfma_f32_32x32x16_bf16 v[0:15], a[104:107], a[40:43], v[0:15]
    s_cbranch_vccnz L_stub_1_0_9
L_back_1_0_9:
    v_exp_f32 v16, v16
    v_fma_f32 v22, v22, s32, -v238
    v_exp_f32 v17, v17
    s_waitcnt lgkmcnt(1)
    v_mfma_f32_32x32x16_bf16 v[0:15], a[136:139], a[248:251], v[0:15]
    ds_read_b128 a[248:251], v248 offset:49152
    v_fma_f32 v23, v23, s32, -v238
    v_exp_f32 v18, v18
    v_fma_f32 v24, v24, s32, -v238
    v_mfma_f32_32x32x16_bf16 v[0:15], a[108:111], a[44:47], v[0:15]
    v_exp_f32 v19, v19
    v_fma_f32 v25, v25, s32, -v238
    v_cvt_pk_bf16_f32 v16, v16, v17
    s_waitcnt lgkmcnt(1)
    v_mfma_f32_32x32x16_bf16 v[0:15], a[140:143], a[252:255], v[0:15]
    ds_read_b128 a[252:255], v249 offset:49152
    v_accvgpr_write_b32 a232, v16
    v_exp_f32 v20, v20
    v_fma_f32 v26, v26, s32, -v238
    v_mfma_f32_32x32x16_bf16 v[0:15], a[112:115], a[48:51], v[0:15]
    v_exp_f32 v21, v21
    v_fma_f32 v27, v27, s32, -v238
    v_cvt_pk_bf16_f32 v18, v18, v19
    s_waitcnt lgkmcnt(1)
    v_mfma_f32_32x32x16_bf16 v[0:15], a[144:147], a[248:251], v[0:15]
    ds_read_b128 a[248:251], v250 offset:49152
    v_accvgpr_write_b32 a233, v18
    v_exp_f32 v22, v22
    v_fma_f32 v28, v28, s32, -v238
    v_mfma_f32_32x32x16_bf16 v[0:15], a[116:119], a[52:55], v[0:15]
    v_exp_f32 v23, v23
    v_fma_f32 v29, v29, s32, -v238
    v_cvt_pk_bf16_f32 v20, v20, v21
    s_waitcnt lgkmcnt(1)
    v_mfma_f32_32x32x16_bf16 v[0:15], a[148:151], a[252:255], v[0:15]
    ds_read_b128 a[252:255], v251 offset:49152
    v_accvgpr_write_b32 a234, v20
    v_exp_f32 v24, v24
    v_fma_f32 v30, v30, s32, -v238
    v_mfma_f32_32x32x16_bf16 v[0:15], a[120:123], a[56:59], v[0:15]
    v_exp_f32 v25, v25
    v_fma_f32 v31, v31, s32, -v238
    v_cvt_pk_bf16_f32 v22, v22, v23
    s_waitcnt lgkmcnt(1)
    v_mfma_f32_32x32x16_bf16 v[0:15], a[152:155], a[248:251], v[0:15]
    ds_read_b128 a[248:251], v248 offset:32768
    v_accvgpr_write_b32 a235, v22
    v_exp_f32 v26, v26
    v_exp_f32 v27, v27
    v_mfma_f32_32x32x16_bf16 v[0:15], a[124:127], a[60:63], v[0:15]
    v_cvt_pk_bf16_f32 v24, v24, v25
    v_accvgpr_write_b32 a236, v24
    v_exp_f32 v28, v28
    s_waitcnt lgkmcnt(1)
    v_mfma_f32_32x32x16_bf16 v[0:15], a[156:159], a[252:255], v[0:15]
    ds_read_b128 a[252:255], v249 offset:32768
    v_exp_f32 v29, v29
    v_cvt_pk_bf16_f32 v26, v26, v27
    v_accvgpr_write_b32 a237, v26
    v_mfma_f32_4x4x4_16b_bf16 v[232:235], v[236:237], v[174:175], v[232:235] cbsz:4 abid:2
    v_exp_f32 v30, v30
    v_exp_f32 v31, v31
    v_mfma_f32_4x4x4_16b_bf16 v[232:235], v[236:237], a[232:233], v[232:235] cbsz:4 abid:0
    v_cvt_pk_bf16_f32 v28, v28, v29
    v_accvgpr_write_b32 a238, v28
    v_mfma_f32_4x4x4_16b_bf16 v[232:235], v[236:237], a[234:235], v[232:235] cbsz:4 abid:0
    v_cvt_pk_bf16_f32 v30, v30, v31
    v_accvgpr_write_b32 a239, v30
    v_mfma_f32_4x4x4_16b_bf16 v[232:235], v[236:237], a[236:237], v[232:235] cbsz:4 abid:0
    v_mfma_f32_32x32x16_bf16 v[16:31], a[96:99], a[64:67], 0
    ds_read_b128 a[96:99], v244
    v_max3_f32 v242, v0, v1, v242
    v_max3_f32 v242, v2, v3, v242
    v_max3_f32 v242, v4, v5, v242
    s_waitcnt lgkmcnt(2)
    v_mfma_f32_32x32x16_bf16 v[16:31], a[128:131], a[248:251], v[16:31]
    ds_read_b128 a[248:251], v250 offset:32768
    ds_read_b128 a[128:131], v244 offset:8192
    v_max3_f32 v242, v6, v7, v242
    v_max3_f32 v242, v8, v9, v242
    v_max3_f32 v242, v10, v11, v242
    v_mfma_f32_32x32x16_bf16 v[16:31], a[100:103], a[68:71], v[16:31]
    ds_read_b128 a[100:103], v245
    v_max3_f32 v242, v12, v13, v242
    v_max3_f32 v242, v14, v15, v242
    v_fma_f32 v254, v242, s32, -v239
    v_cmp_lt_f32 vcc, s33, v254
    s_waitcnt lgkmcnt(4)
    v_mfma_f32_32x32x16_bf16 v[16:31], a[132:135], a[252:255], v[16:31]
    ds_read_b128 a[252:255], v251 offset:32768
    ds_read_b128 a[132:135], v245 offset:8192
    v_fma_f32 v0, v0, s32, -v239
    v_fma_f32 v1, v1, s32, -v239
    v_fma_f32 v2, v2, s32, -v239
    v_mfma_f32_32x32x16_bf16 v[16:31], a[104:107], a[72:75], v[16:31]
    ds_read_b128 a[104:107], v246
    v_fma_f32 v3, v3, s32, -v239
    v_fma_f32 v4, v4, s32, -v239
    v_fma_f32 v5, v5, s32, -v239
    s_waitcnt lgkmcnt(5)
    v_mfma_f32_32x32x16_bf16 v[16:31], a[136:139], a[248:251], v[16:31]
    ds_read_b128 a[248:251], v248 offset:16384
    ds_read_b128 a[136:139], v246 offset:8192
    s_cbranch_vccnz L_stub_1_1_9
L_back_1_1_9:
    v_exp_f32 v0, v0
    v_fma_f32 v6, v6, s32, -v239
    v_mfma_f32_32x32x16_bf16 v[16:31], a[108:111], a[76:79], v[16:31]
    ds_read_b128 a[108:111], v247
    v_exp_f32 v1, v1
    v_fma_f32 v7, v7, s32, -v239
    v_exp_f32 v2, v2
    s_waitcnt lgkmcnt(5)
    v_mfma_f32_32x32x16_bf16 v[16:31], a[140:143], a[252:255], v[16:31]
    ds_read_b128 a[252:255], v249 offset:16384
    ds_read_b128 a[140:143], v247 offset:8192
    v_fma_f32 v8, v8, s32, -v239
    v_exp_f32 v3, v3
    v_mfma_f32_32x32x16_bf16 v[16:31], a[112:115], a[80:83], v[16:31]
    ds_read_b128 a[112:115], v244 offset:4096
    v_fma_f32 v9, v9, s32, -v239
    v_cvt_pk_bf16_f32 v176, v0, v1
    v_exp_f32 v4, v4
    s_waitcnt lgkmcnt(5)
    v_mfma_f32_32x32x16_bf16 v[16:31], a[144:147], a[248:251], v[16:31]
    ds_read_b128 a[248:251], v250 offset:16384
    ds_read_b128 a[144:147], v244 offset:12288
    v_fma_f32 v10, v10, s32, -v239
    v_exp_f32 v5, v5
    v_fma_f32 v11, v11, s32, -v239
    v_mfma_f32_32x32x16_bf16 v[16:31], a[116:119], a[84:87], v[16:31]
    ds_read_b128 a[116:119], v245 offset:4096
    v_cvt_pk_bf16_f32 v177, v2, v3
    v_exp_f32 v6, v6
    v_fma_f32 v12, v12, s32, -v239
    s_waitcnt lgkmcnt(5)
    v_mfma_f32_32x32x16_bf16 v[16:31], a[148:151], a[252:255], v[16:31]
    ds_read_b128 a[252:255], v251 offset:16384
    ds_read_b128 a[148:151], v245 offset:12288
    v_exp_f32 v7, v7
    v_fma_f32 v13, v13, s32, -v239
    v_mfma_f32_32x32x16_bf16 v[16:31], a[120:123], a[88:91], v[16:31]
    ds_read_b128 a[120:123], v246 offset:4096
    v_cvt_pk_bf16_f32 v178, v4, v5
    v_exp_f32 v8, v8
    v_fma_f32 v14, v14, s32, -v239
    s_waitcnt lgkmcnt(5)
    v_mfma_f32_32x32x16_bf16 v[16:31], a[152:155], a[248:251], v[16:31]
    v_subrev_u32 v248, 32768, v248
    v_subrev_u32 v249, 32768, v249
    v_subrev_u32 v250, 32768, v250
    v_subrev_u32 v251, 32768, v251
    ds_read_b128 a[248:251], v248
    ds_read_b128 a[152:155], v246 offset:12288
    v_mfma_f32_32x32x16_bf16 v[16:31], a[124:127], a[92:95], v[16:31]
    ds_read_b128 a[124:127], v247 offset:4096
    v_exp_f32 v9, v9
    v_fma_f32 v15, v15, s32, -v239
    v_cvt_pk_bf16_f32 v179, v6, v7
    v_exp_f32 v10, v10
    s_waitcnt lgkmcnt(5)
    v_mfma_f32_32x32x16_bf16 v[16:31], a[156:159], a[252:255], v[16:31]
    ds_read_b128 a[252:255], v249
    ds_read_b128 a[156:159], v247 offset:12288
    v_exp_f32 v11, v11
    v_cvt_pk_bf16_f32 v180, v8, v9
    v_exp_f32 v12, v12
    v_mfma_f32_4x4x4_16b_bf16 v[232:235], v[236:237], a[238:239], v[232:235] cbsz:4 abid:0
    v_exp_f32 v13, v13
    v_cvt_pk_bf16_f32 v181, v10, v11
    v_mfma_f32_4x4x4_16b_bf16 v[232:235], v[236:237], v[176:177], v[232:235] cbsz:4 abid:1
    v_exp_f32 v14, v14
    v_exp_f32 v15, v15
    v_mfma_f32_4x4x4_16b_bf16 v[232:235], v[236:237], v[178:179], v[232:235] cbsz:4 abid:1
    v_cvt_pk_bf16_f32 v182, v12, v13
    v_cvt_pk_bf16_f32 v183, v14, v15
    v_mfma_f32_4x4x4_16b_bf16 v[232:235], v[236:237], v[180:181], v[232:235] cbsz:4 abid:1
    v_mfma_f32_32x32x16_bf16 v[0:15], a[96:99], a[0:3], 0
    s_waitcnt lgkmcnt(0)
    s_waitcnt vmcnt(8)
    s_barrier
    s_add_u32 m0, s30, 0
    s_add_u32 s35, s27, 4096
    buffer_load_dwordx4 v252, s[16:19], s35 offen nt lds
    v_mfma_f32_32x32x16_bf16 v[0:15], a[128:131], a[248:251], v[0:15]
    ds_read_b128 a[248:251], v250
    s_add_u32 s35, s27, 35840
    buffer_load_dwordx4 v253, s[16:19], s35 offen offset:1024 nt lds
    v_max3_f32 v243, v16, v17, v243
    v_max3_f32 v243, v18, v19, v243
    v_mfma_f32_32x32x16_bf16 v[0:15], a[100:103], a[4:7], v[0:15]
    s_add_u32 s35, s27, 83968
    buffer_load_dwordx4 v252, s[16:19], s35 offen offset:2048 nt lds
    v_max3_f32 v243, v20, v21, v243
    v_max3_f32 v243, v22, v23, v243
    v_mfma_f32_32x32x16_bf16 v[0:15], a[132:135], a[252:255], v[0:15]
    ds_read_b128 a[252:255], v251
    s_add_u32 s35, s27, 115712
    buffer_load_dwordx4 v253, s[16:19], s35 offen offset:3072 nt lds
    v_max3_f32 v243, v24, v25, v243
    v_max3_f32 v243, v26, v27, v243
    v_mfma_f32_32x32x16_bf16 v[0:15], a[104:107], a[8:11], v[0:15]
    v_max3_f32 v243, v28, v29, v243
    v_max3_f32 v243, v30, v31, v243
    v_fma_f32 v254, v243, s32, -v240
    v_cmp_lt_f32 vcc, s33, v254
    s_waitcnt lgkmcnt(1)
    v_mfma_f32_32x32x16_bf16 v[0:15], a[136:139], a[248:251], v[0:15]
    ds_read_b128 a[248:251], v248 offset:16384
    v_fma_f32 v16, v16, s32, -v240
    v_fma_f32 v17, v17, s32, -v240
    v_fma_f32 v18, v18, s32, -v240
    v_fma_f32 v19, v19, s32, -v240
    v_mfma_f32_32x32x16_bf16 v[0:15], a[108:111], a[12:15], v[0:15]
    v_fma_f32 v20, v20, s32, -v240
    v_fma_f32 v21, v21, s32, -v240
    s_cbranch_vccnz L_stub_1_2_9
L_back_1_2_9:
    v_exp_f32 v16, v16
    s_waitcnt lgkmcnt(1)
    v_mfma_f32_32x32x16_bf16 v[0:15], a[140:143], a[252:255], v[0:15]
    ds_read_b128 a[252:255], v249 offset:16384
    v_fma_f32 v22, v22, s32, -v240
    v_exp_f32 v17, v17
    v_fma_f32 v23, v23, s32, -v240
    v_mfma_f32_32x32x16_bf16 v[0:15], a[112:115], a[16:19], v[0:15]
    v_exp_f32 v18, v18
    v_fma_f32 v24, v24, s32, -v240
    v_exp_f32 v19, v19
    s_waitcnt lgkmcnt(1)
    v_mfma_f32_32x32x16_bf16 v[0:15], a[144:147], a[248:251], v[0:15]
    ds_read_b128 a[248:251], v250 offset:16384
    v_fma_f32 v25, v25, s32, -v240
    v_cvt_pk_bf16_f32 v184, v16, v17
    v_exp_f32 v20, v20
    v_mfma_f32_32x32x16_bf16 v[0:15], a[116:119], a[20:23], v[0:15]
    v_fma_f32 v26, v26, s32, -v240
    v_exp_f32 v21, v21
    v_fma_f32 v27, v27, s32, -v240
    s_waitcnt lgkmcnt(1)
    v_mfma_f32_32x32x16_bf16 v[0:15], a[148:151], a[252:255], v[0:15]
    ds_read_b128 a[252:255], v251 offset:16384
    v_cvt_pk_bf16_f32 v185, v18, v19
    v_exp_f32 v22, v22
    v_fma_f32 v28, v28, s32, -v240
    v_mfma_f32_32x32x16_bf16 v[0:15], a[120:123], a[24:27], v[0:15]
    v_exp_f32 v23, v23
    v_fma_f32 v29, v29, s32, -v240
    v_cvt_pk_bf16_f32 v186, v20, v21
    s_waitcnt lgkmcnt(1)
    v_mfma_f32_32x32x16_bf16 v[0:15], a[152:155], a[248:251], v[0:15]
    v_add_u32 v248, 32768, v248
    v_add_u32 v249, 32768, v249
    v_add_u32 v250, 32768, v250
    v_add_u32 v251, 32768, v251
    ds_read_b128 a[248:251], v248
    v_exp_f32 v24, v24
    v_mfma_f32_32x32x16_bf16 v[0:15], a[124:127], a[28:31], v[0:15]
    v_fma_f32 v30, v30, s32, -v240
    v_exp_f32 v25, v25
    v_fma_f32 v31, v31, s32, -v240
    v_cvt_pk_bf16_f32 v187, v22, v23
    s_waitcnt lgkmcnt(1)
    v_mfma_f32_32x32x16_bf16 v[0:15], a[156:159], a[252:255], v[0:15]
    ds_read_b128 a[252:255], v249
    v_exp_f32 v26, v26
    v_exp_f32 v27, v27
    v_cvt_pk_bf16_f32 v188, v24, v25
    v_exp_f32 v28, v28
    v_mfma_f32_4x4x4_16b_bf16 v[232:235], v[236:237], v[182:183], v[232:235] cbsz:4 abid:1
    v_exp_f32 v29, v29
    v_cvt_pk_bf16_f32 v189, v26, v27
    v_mfma_f32_4x4x4_16b_bf16 v[232:235], v[236:237], v[184:185], v[232:235] cbsz:4 abid:2
    v_exp_f32 v30, v30
    v_exp_f32 v31, v31
    v_mfma_f32_4x4x4_16b_bf16 v[232:235], v[236:237], v[186:187], v[232:235] cbsz:4 abid:2
    v_cvt_pk_bf16_f32 v190, v28, v29
    v_cvt_pk_bf16_f32 v191, v30, v31
    v_mfma_f32_4x4x4_16b_bf16 v[232:235], v[236:237], v[188:189], v[232:235] cbsz:4 abid:2
    v_mfma_f32_32x32x16_bf16 v[16:31], a[96:99], a[32:35], 0
    v_max3_f32 v241, v0, v1, v241
    v_max3_f32 v241, v2, v3, v241
    v_max3_f32 v241, v4, v5, v241
    v_max3_f32 v241, v6, v7, v241
    s_waitcnt lgkmcnt(1)
    v_mfma_f32_32x32x16_bf16 v[16:31], a[128:131], a[248:251], v[16:31]
    ds_read_b128 a[248:251], v250
    v_max3_f32 v241, v8, v9, v241
    v_max3_f32 v241, v10, v11, v241
    v_max3_f32 v241, v12, v13, v241
    v_max3_f32 v241, v14, v15, v241
    v_mfma_f32_32x32x16_bf16 v[16:31], a[100:103], a[36:39], v[16:31]
    v_fma_f32 v254, v241, s32, -v238
    v_cmp_lt_f32 vcc, s33, v254
    v_fma_f32 v0, v0, s32, -v238
    v_fma_f32 v1, v1, s32, -v238
    s_waitcnt lgkmcnt(1)
    v_mfma_f32_32x32x16_bf16 v[16:31], a[132:135], a[252:255], v[16:31]
    ds_read_b128 a[252:255], v251
    v_fma_f32 v2, v2, s32, -v238
    v_fma_f32 v3, v3, s32, -v238
    v_fma_f32 v4, v4, s32, -v238
    v_fma_f32 v5, v5, s32, -v238
    v_mfma_f32_32x32x16_bf16 v[16:31], a[104:107], a[40:43], v[16:31]
    s_cbranch_vccnz L_stub_1_0_10
L_back_1_0_10:
    v_exp_f32 v0, v0
    v_fma_f32 v6, v6, s32, -v238
    v_exp_f32 v1, v1
    s_waitcnt lgkmcnt(1)
    v_mfma_f32_32x32x16_bf16 v[16:31], a[136:139], a[248:251], v[16:31]
    ds_read_b128 a[248:251], v248 offset:49152
    v_fma_f32 v7, v7, s32, -v238
    v_exp_f32 v2, v2
    v_fma_f32 v8, v8, s32, -v238
    v_mfma_f32_32x32x16_bf16 v[16:31], a[108:111], a[44:47], v[16:31]
    v_exp_f32 v3, v3
    v_fma_f32 v9, v9, s32, -v238
    v_cvt_pk_bf16_f32 v0, v0, v1
    s_waitcnt lgkmcnt(1)
    v_mfma_f32_32x32x16_bf16 v[16:31], a[140:143], a[252:255], v[16:31]
    ds_read_b128 a[252:255], v249 offset:49152
    v_accvgpr_write_b32 a240, v0
    v_exp_f32 v4, v4
    v_fma_f32 v10, v10, s32, -v238
    v_mfma_f32_32x32x16_bf16 v[16:31], a[112:115], a[48:51], v[16:31]
    v_exp_f32 v5, v5
    v_fma_f32 v11, v11, s32, -v238
    v_cvt_pk_bf16_f32 v2, v2, v3
    s_waitcnt lgkmcnt(1)
    v_mfma_f32_32x32x16_bf16 v[16:31], a[144:147], a[248:251], v[16:31]
    ds_read_b128 a[248:251], v250 offset:49152
    v_accvgpr_write_b32 a241, v2
    v_exp_f32 v6, v6
    v_fma_f32 v12, v12, s32, -v238
    v_mfma_f32_32x32x16_bf16 v[16:31], a[116:119], a[52:55], v[16:31]
    v_exp_f32 v7, v7
    v_fma_f32 v13, v13, s32, -v238
    v_cvt_pk_bf16_f32 v4, v4, v5
    s_waitcnt lgkmcnt(1)
    v_mfma_f32_32x32x16_bf16 v[16:31], a[148:151], a[252:255], v[16:31]
    ds_read_b128 a[252:255], v251 offset:49152
    v_accvgpr_write_b32 a242, v4
    v_exp_f32 v8, v8
    v_fma_f32 v14, v14, s32, -v238
    v_mfma_f32_32x32x16_bf16 v[16:31], a[120:123], a[56:59], v[16:31]
    v_exp_f32 v9, v9
    v_fma_f32 v15, v15, s32, -v238
    v_cvt_pk_bf16_f32 v6, v6, v7
    s_waitcnt lgkmcnt(1)
    v_mfma_f32_32x32x16_bf16 v[16:31], a[152:155], a[248:251], v[16:31]
    ds_read_b128 a[248:251], v248 offset:32768
    v_accvgpr_write_b32 a243, v6
    v_exp_f32 v10, v10
    v_exp_f32 v11, v11
    v_mfma_f32_32x32x16_bf16 v[16:31], a[124:127], a[60:63], v[16:31]
    v_cvt_pk_bf16_f32 v8, v8, v9
    v_accvgpr_write_b32 a244, v8
    v_exp_f32 v12, v12
    s_waitcnt lgkmcnt(1)
    v_mfma_f32_32x32x16_bf16 v[16:31], a[156:159], a[252:255], v[16:31]
    ds_read_b128 a[252:255], v249 offset:32768
    v_exp_f32 v13, v13
    v_cvt_pk_bf16_f32 v10, v10, v11
    v_accvgpr_write_b32 a245, v10
    v_mfma_f32_4x4x4_16b_bf16 v[232:235], v[236:237], v[190:191], v[232:235] cbsz:4 abid:2
    v_exp_f32 v14, v14
    v_exp_f32 v15, v15
    v_mfma_f32_4x4x4_16b_bf16 v[232:235], v[236:237], a[240:241], v[232:235] cbsz:4 abid:0
    v_cvt_pk_bf16_f32 v12, v12, v13
    v_accvgpr_write_b32 a246, v12
    v_mfma_f32_4x4x4_16b_bf16 v[232:235], v[236:237], a[242:243], v[232:235] cbsz:4 abid:0
    v_cvt_pk_bf16_f32 v14, v14, v15
    v_accvgpr_write_b32 a247, v14
    v_mfma_f32_4x4x4_16b_bf16 v[232:235], v[236:237], a[244:245], v[232:235] cbsz:4 abid:0
    v_mfma_f32_32x32x16_bf16 v[0:15], a[96:99], a[64:67], 0
    ds_read_b128 a[96:99], v244 offset:16384
    v_max3_f32 v242, v16, v17, v242
    v_max3_f32 v242, v18, v19, v242
    v_max3_f32 v242, v20, v21, v242
    s_waitcnt lgkmcnt(2)
    v_mfma_f32_32x32x16_bf16 v[0:15], a[128:131], a[248:251], v[0:15]
    ds_read_b128 a[248:251], v250 offset:32768
    ds_read_b128 a[128:131], v244 offset:24576
    v_max3_f32 v242, v22, v23, v242
    v_max3_f32 v242, v24, v25, v242
    v_max3_f32 v242, v26, v27, v242
    v_mfma_f32_32x32x16_bf16 v[0:15], a[100:103], a[68:71], v[0:15]
    ds_read_b128 a[100:103], v245 offset:16384
    v_max3_f32 v242, v28, v29, v242
    v_max3_f32 v242, v30, v31, v242
    v_fma_f32 v254, v242, s32, -v239
    v_cmp_lt_f32 vcc, s33, v254
    s_waitcnt lgkmcnt(4)
    v_mfma_f32_32x32x16_bf16 v[0:15], a[132:135], a[252:255], v[0:15]
    ds_read_b128 a[252:255], v251 offset:32768
    ds_read_b128 a[132:135], v245 offset:24576
    v_fma_f32 v16, v16, s32, -v239
    v_fma_f32 v17, v17, s32, -v239
    v_fma_f32 v18, v18, s32, -v239
    v_mfma_f32_32x32x16_bf16 v[0:15], a[104:107], a[72:75], v[0:15]
    ds_read_b128 a[104:107], v246 offset:16384
    v_fma_f32 v19, v19, s32, -v239
    v_fma_f32 v20, v20, s32, -v239
    v_fma_f32 v21, v21, s32, -v239
    s_waitcnt lgkmcnt(5)
    v_mfma_f32_32x32x16_bf16 v[0:15], a[136:139], a[248:251], v[0:15]
    ds_read_b128 a[248:251], v248 offset:16384
    ds_read_b128 a[136:139], v246 offset:24576
    s_cbranch_vccnz L_stub_1_1_10
L_back_1_1_10:
    v_exp_f32 v16, v16
    v_fma_f32 v22, v22, s32, -v239
    v_mfma_f32_32x32x16_bf16 v[0:15], a[108:111], a[76:79], v[0:15]
    ds_read_b128 a[108:111], v247 offset:16384
    v_exp_f32 v17, v17
    v_fma_f32 v23, v23, s32, -v239
    v_exp_f32 v18, v18
    s_waitcnt lgkmcnt(5)
    v_mfma_f32_32x32x16_bf16 v[0:15], a[140:143], a[252:255], v[0:15]
    ds_read_b128 a[252:255], v249 offset:16384
    ds_read_b128 a[140:143], v247 offset:24576
    v_fma_f32 v24, v24, s32, -v239
    v_exp_f32 v19, v19
    v_mfma_f32_32x32x16_bf16 v[0:15], a[112:115], a[80:83], v[0:15]
    ds_read_b128 a[112:115], v244 offset:20480
    v_fma_f32 v25, v25, s32, -v239
    v_cvt_pk_bf16_f32 v192, v16, v17
    v_exp_f32 v20, v20
    s_waitcnt lgkmcnt(5)
    v_mfma_f32_32x32x16_bf16 v[0:15], a[144:147], a[248:251], v[0:15]
    ds_read_b128 a[248:251], v250 offset:16384
    ds_read_b128 a[144:147], v244 offset:28672
    v_fma_f32 v26, v26, s32, -v239
    v_exp_f32 v21, v21
    v_fma_f32 v27, v27, s32, -v239
    v_mfma_f32_32x32x16_bf16 v[0:15], a[116:119], a[84:87], v[0:15]
    ds_read_b128 a[116:119], v245 offset:20480
    v_cvt_pk_bf16_f32 v193, v18, v19
    v_exp_f32 v22, v22
    v_fma_f32 v28, v28, s32, -v239
    s_waitcnt lgkmcnt(5)
    v_mfma_f32_32x32x16_bf16 v[0:15], a[148:151], a[252:255], v[0:15]
    ds_read_b128 a[252:255], v251 offset:16384
    ds_read_b128 a[148:151], v245 offset:28672
    v_exp_f32 v23, v23
    v_fma_f32 v29, v29, s32, -v239
    v_mfma_f32_32x32x16_bf16 v[0:15], a[120:123], a[88:91], v[0:15]
    ds_read_b128 a[120:123], v246 offset:20480
    v_cvt_pk_bf16_f32 v194, v20, v21
    v_exp_f32 v24, v24
    v_fma_f32 v30, v30, s32, -v239
    s_waitcnt lgkmcnt(5)
    v_mfma_f32_32x32x16_bf16 v[0:15], a[152:155], a[248:251], v[0:15]
    v_subrev_u32 v248, 32768, v248
    v_subrev_u32 v249, 32768, v249
    v_subrev_u32 v250, 32768, v250
    v_subrev_u32 v251, 32768, v251
    ds_read_b128 a[248:251], v248
    ds_read_b128 a[152:155], v246 offset:28672
    v_mfma_f32_32x32x16_bf16 v[0:15], a[124:127], a[92:95], v[0:15]
    ds_read_b128 a[124:127], v247 offset:20480
    v_exp_f32 v25, v25
    v_fma_f32 v31, v31, s32, -v239
    v_cvt_pk_bf16_f32 v195, v22, v23
    v_exp_f32 v26, v26
    s_waitcnt lgkmcnt(5)
    v_mfma_f32_32x32x16_bf16 v[0:15], a[156:159], a[252:255], v[0:15]
    ds_read_b128 a[252:255], v249
    ds_read_b128 a[156:159], v247 offset:28672
    v_exp_f32 v27, v27
    v_cvt_pk_bf16_f32 v196, v24, v25
    v_exp_f32 v28, v28
    v_mfma_f32_4x4x4_16b_bf16 v[232:235], v[236:237], a[246:247], v[232:235] cbsz:4 abid:0
    v_exp_f32 v29, v29
    v_cvt_pk_bf16_f32 v197, v26, v27
    v_mfma_f32_4x4x4_16b_bf16 v[232:235], v[236:237], v[192:193], v[232:235] cbsz:4 abid:1
    v_exp_f32 v30, v30
    v_exp_f32 v31, v31
    v_mfma_f32_4x4x4_16b_bf16 v[232:235], v[236:237], v[194:195], v[232:235] cbsz:4 abid:1
    v_cvt_pk_bf16_f32 v198, v28, v29
    v_cvt_pk_bf16_f32 v199, v30, v31
    v_mfma_f32_4x4x4_16b_bf16 v[232:235], v[236:237], v[196:197], v[232:235] cbsz:4 abid:1
    v_mfma_f32_32x32x16_bf16 v[16:31], a[96:99], a[0:3], 0
    s_waitcnt lgkmcnt(0)
    s_waitcnt vmcnt(8)
    s_barrier
    s_add_u32 m0, s30, 16384
    s_add_u32 s35, s27, 12288
    buffer_load_dwordx4 v252, s[16:19], s35 offen nt lds
    v_mfma_f32_32x32x16_bf16 v[16:31], a[128:131], a[248:251], v[16:31]
    ds_read_b128 a[248:251], v250
    s_add_u32 s35, s27, 44032
    buffer_load_dwordx4 v253, s[16:19], s35 offen offset:1024 nt lds
    v_max3_f32 v243, v0, v1, v243
    v_max3_f32 v243, v2, v3, v243
    v_mfma_f32_32x32x16_bf16 v[16:31], a[100:103], a[4:7], v[16:31]
    s_add_u32 s35, s27, 92160
    buffer_load_dwordx4 v252, s[16:19], s35 offen offset:2048 nt lds
    v_max3_f32 v243, v4, v5, v243
    v_max3_f32 v243, v6, v7, v243
    v_mfma_f32_32x32x16_bf16 v[16:31], a[132:135], a[252:255], v[16:31]
    ds_read_b128 a[252:255], v251
    s_add_u32 s35, s27, 123904
    buffer_load_dwordx4 v253, s[16:19], s35 offen offset:3072 nt lds
    v_max3_f32 v243, v8, v9, v243
    v_max3_f32 v243, v10, v11, v243
    v_mfma_f32_32x32x16_bf16 v[16:31], a[104:107], a[8:11], v[16:31]
    v_max3_f32 v243, v12, v13, v243
    v_max3_f32 v243, v14, v15, v243
    v_fma_f32 v254, v243, s32, -v240
    v_cmp_lt_f32 vcc, s33, v254
    s_waitcnt lgkmcnt(1)
    v_mfma_f32_32x32x16_bf16 v[16:31], a[136:139], a[248:251], v[16:31]
    ds_read_b128 a[248:251], v248 offset:16384
    v_fma_f32 v0, v0, s32, -v240
    v_fma_f32 v1, v1, s32, -v240
    v_fma_f32 v2, v2, s32, -v240
    v_fma_f32 v3, v3, s32, -v240
    v_mfma_f32_32x32x16_bf16 v[16:31], a[108:111], a[12:15], v[16:31]
    v_fma_f32 v4, v4, s32, -v240
    v_fma_f32 v5, v5, s32, -v240
    s_cbranch_vccnz L_stub_1_2_10
L_back_1_2_10:
    v_exp_f32 v0, v0
    s_waitcnt lgkmcnt(1)
    v_mfma_f32_32x32x16_bf16 v[16:31], a[140:143], a[252:255], v[16:31]
    ds_read_b128 a[252:255], v249 offset:16384
    v_fma_f32 v6, v6, s32, -v240
    v_exp_f32 v1, v1
    v_fma_f32 v7, v7, s32, -v240
    v_mfma_f32_32x32x16_bf16 v[16:31], a[112:115], a[16:19], v[16:31]
    v_exp_f32 v2, v2
    v_fma_f32 v8, v8, s32, -v240
    v_exp_f32 v3, v3
    s_waitcnt lgkmcnt(1)
    v_mfma_f32_32x32x16_bf16 v[16:31], a[144:147], a[248:251], v[16:31]
    ds_read_b128 a[248:251], v250 offset:16384
    v_fma_f32 v9, v9, s32, -v240
    v_cvt_pk_bf16_f32 v200, v0, v1
    v_exp_f32 v4, v4
    v_mfma_f32_32x32x16_bf16 v[16:31], a[116:119], a[20:23], v[16:31]
    v_fma_f32 v10, v10, s32, -v240
    v_exp_f32 v5, v5
    v_fma_f32 v11, v11, s32, -v240
    s_waitcnt lgkmcnt(1)
    v_mfma_f32_32x32x16_bf16 v[16:31], a[148:151], a[252:255], v[16:31]
    ds_read_b128 a[252:255], v251 offset:16384
    v_cvt_pk_bf16_f32 v201, v2, v3
    v_exp_f32 v6, v6
    v_fma_f32 v12, v12, s32, -v240
    v_mfma_f32_32x32x16_bf16 v[16:31], a[120:123], a[24:27], v[16:31]
    v_exp_f32 v7, v7
    v_fma_f32 v13, v13, s32, -v240
    v_cvt_pk_bf16_f32 v202, v4, v5
    s_waitcnt lgkmcnt(1)
    v_mfma_f32_32x32x16_bf16 v[16:31], a[152:155], a[248:251], v[16:31]
    v_add_u32 v248, 32768, v248
    v_add_u32 v249, 32768, v249
    v_add_u32 v250, 32768, v250
    v_add_u32 v251, 32768, v251
    ds_read_b128 a[248:251], v248
    v_exp_f32 v8, v8
    v_mfma_f32_32x32x16_bf16 v[16:31], a[124:127], a[28:31], v[16:31]
    v_fma_f32 v14, v14, s32, -v240
    v_exp_f32 v9, v9
    v_fma_f32 v15, v15, s32, -v240
    v_cvt_pk_bf16_f32 v203, v6, v7
    s_waitcnt lgkmcnt(1)
    v_mfma_f32_32x32x16_bf16 v[16:31], a[156:159], a[252:255], v[16:31]
    ds_read_b128 a[252:255], v249
    v_exp_f32 v10, v10
    v_exp_f32 v11, v11
    v_cvt_pk_bf16_f32 v204, v8, v9
    v_exp_f32 v12, v12
    v_mfma_f32_4x4x4_16b_bf16 v[232:235], v[236:237], v[198:199], v[232:235] cbsz:4 abid:1
    v_exp_f32 v13, v13
    v_cvt_pk_bf16_f32 v205, v10, v11
    v_mfma_f32_4x4x4_16b_bf16 v[232:235], v[236:237], v[200:201], v[232:235] cbsz:4 abid:2
    v_exp_f32 v14, v14
    v_exp_f32 v15, v15
    v_mfma_f32_4x4x4_16b_bf16 v[232:235], v[236:237], v[202:203], v[232:235] cbsz:4 abid:2
    v_cvt_pk_bf16_f32 v206, v12, v13
    v_cvt_pk_bf16_f32 v207, v14, v15
    v_mfma_f32_4x4x4_16b_bf16 v[232:235], v[236:237], v[204:205], v[232:235] cbsz:4 abid:2
    v_mfma_f32_32x32x16_bf16 v[0:15], a[96:99], a[32:35], 0
    v_max3_f32 v241, v16, v17, v241
    v_max3_f32 v241, v18, v19, v241
    v_max3_f32 v241, v20, v21, v241
    v_max3_f32 v241, v22, v23, v241
    s_waitcnt lgkmcnt(1)
    v_mfma_f32_32x32x16_bf16 v[0:15], a[128:131], a[248:251], v[0:15]
    ds_read_b128 a[248:251], v250
    v_max3_f32 v241, v24, v25, v241
    v_max3_f32 v241, v26, v27, v241
    v_max3_f32 v241, v28, v29, v241
    v_max3_f32 v241, v30, v31, v241
    v_mfma_f32_32x32x16_bf16 v[0:15], a[100:103], a[36:39], v[0:15]
    v_fma_f32 v254, v241, s32, -v238
    v_cmp_lt_f32 vcc, s33, v254
    v_fma_f32 v16, v16, s32, -v238
    v_fma_f32 v17, v17, s32, -v238
    s_waitcnt lgkmcnt(1)
    v_mfma_f32_32x32x16_bf16 v[0:15], a[132:135], a[252:255], v[0:15]
    ds_read_b128 a[252:255], v251
    v_fma_f32 v18, v18, s32, -v238
    v_fma_f32 v19, v19, s32, -v238
    v_fma_f32 v20, v20, s32, -v238
    v_fma_f32 v21, v21, s32, -v238
    v_mfma_f32_32x32x16_bf16 v[0:15], a[104:107], a[40:43], v[0:15]
    s_cbranch_vccnz L_stub_1_0_11
L_back_1_0_11:
    v_exp_f32 v16, v16
    v_fma_f32 v22, v22, s32, -v238
    v_exp_f32 v17, v17
    s_waitcnt lgkmcnt(1)
    v_mfma_f32_32x32x16_bf16 v[0:15], a[136:139], a[248:251], v[0:15]
    ds_read_b128 a[248:251], v248 offset:49152
    v_fma_f32 v23, v23, s32, -v238
    v_exp_f32 v18, v18
    v_fma_f32 v24, v24, s32, -v238
    v_mfma_f32_32x32x16_bf16 v[0:15], a[108:111], a[44:47], v[0:15]
    v_exp_f32 v19, v19
    v_fma_f32 v25, v25, s32, -v238
    v_cvt_pk_bf16_f32 v208, v16, v17
    s_waitcnt lgkmcnt(1)
    v_mfma_f32_32x32x16_bf16 v[0:15], a[140:143], a[252:255], v[0:15]
    ds_read_b128 a[252:255], v249 offset:49152
    v_exp_f32 v20, v20
    v_fma_f32 v26, v26, s32, -v238
    v_exp_f32 v21, v21
    v_mfma_f32_32x32x16_bf16 v[0:15], a[112:115], a[48:51], v[0:15]
    v_fma_f32 v27, v27, s32, -v238
    v_cvt_pk_bf16_f32 v209, v18, v19
    v_exp_f32 v22, v22
    s_waitcnt lgkmcnt(1)
    v_mfma_f32_32x32x16_bf16 v[0:15], a[144:147], a[248:251], v[0:15]
    ds_read_b128 a[248:251], v250 offset:49152
    v_fma_f32 v28, v28, s32, -v238
    v_exp_f32 v23, v23
    v_fma_f32 v29, v29, s32, -v238
    v_mfma_f32_32x32x16_bf16 v[0:15], a[116:119], a[52:55], v[0:15]
    v_cvt_pk_bf16_f32 v210, v20, v21
    v_exp_f32 v24, v24
    v_fma_f32 v30, v30, s32, -v238
    s_waitcnt lgkmcnt(1)
    v_mfma_f32_32x32x16_bf16 v[0:15], a[148:151], a[252:255], v[0:15]
    ds_read_b128 a[252:255], v251 offset:49152
    v_exp_f32 v25, v25
    v_fma_f32 v31, v31, s32, -v238
    v_cvt_pk_bf16_f32 v211, v22, v23
    v_mfma_f32_32x32x16_bf16 v[0:15], a[120:123], a[56:59], v[0:15]
    v_exp_f32 v26, v26
    v_exp_f32 v27, v27
    v_cvt_pk_bf16_f32 v212, v24, v25
    s_waitcnt lgkmcnt(1)
    v_mfma_f32_32x32x16_bf16 v[0:15], a[152:155], a[248:251], v[0:15]
    ds_read_b128 a[248:251], v248 offset:32768
    v_exp_f32 v28, v28
    v_mfma_f32_32x32x16_bf16 v[0:15], a[124:127], a[60:63], v[0:15]
    s_waitcnt lgkmcnt(1)
    v_mfma_f32_32x32x16_bf16 v[0:15], a[156:159], a[252:255], v[0:15]
    ds_read_b128 a[252:255], v249 offset:32768
    v_mfma_f32_4x4x4_16b_bf16 v[232:235], v[236:237], v[206:207], v[232:235] cbsz:4 abid:2
    v_exp_f32 v29, v29
    v_cvt_pk_bf16_f32 v213, v26, v27
    v_mfma_f32_4x4x4_16b_bf16 v[232:235], v[236:237], v[208:209], v[232:235] cbsz:4 abid:0
    v_exp_f32 v30, v30
    v_exp_f32 v31, v31
    v_mfma_f32_4x4x4_16b_bf16 v[232:235], v[236:237], v[210:211], v[232:235] cbsz:4 abid:0
    v_cvt_pk_bf16_f32 v214, v28, v29
    v_cvt_pk_bf16_f32 v215, v30, v31
    v_mfma_f32_4x4x4_16b_bf16 v[232:235], v[236:237], v[212:213], v[232:235] cbsz:4 abid:0
    v_mfma_f32_32x32x16_bf16 v[16:31], a[96:99], a[64:67], 0
    v_max3_f32 v242, v0, v1, v242
    v_max3_f32 v242, v2, v3, v242
    v_max3_f32 v242, v4, v5, v242
    v_max3_f32 v242, v6, v7, v242
    s_waitcnt lgkmcnt(1)
    v_mfma_f32_32x32x16_bf16 v[16:31], a[128:131], a[248:251], v[16:31]
    ds_read_b128 a[248:251], v250 offset:32768
    v_max3_f32 v242, v8, v9, v242
    v_max3_f32 v242, v10, v11, v242
    v_max3_f32 v242, v12, v13, v242
    v_max3_f32 v242, v14, v15, v242
    v_mfma_f32_32x32x16_bf16 v[16:31], a[100:103], a[68:71], v[16:31]
    v_fma_f32 v254, v242, s32, -v239
    v_cmp_lt_f32 vcc, s33, v254
    v_fma_f32 v0, v0, s32, -v239
    v_fma_f32 v1, v1, s32, -v239
    s_waitcnt lgkmcnt(1)
    v_mfma_f32_32x32x16_bf16 v[16:31], a[132:135], a[252:255], v[16:31]
    ds_read_b128 a[252:255], v251 offset:32768
    v_fma_f32 v2, v2, s32, -v239
    v_fma_f32 v3, v3, s32, -v239
    v_fma_f32 v4, v4, s32, -v239
    v_fma_f32 v5, v5, s32, -v239
    v_mfma_f32_32x32x16_bf16 v[16:31], a[104:107], a[72:75], v[16:31]
    s_cbranch_vccnz L_stub_1_1_11
L_back_1_1_11:
    v_exp_f32 v0, v0
    v_fma_f32 v6, v6, s32, -v239
    v_exp_f32 v1, v1
    s_waitcnt lgkmcnt(1)
    v_mfma_f32_32x32x16_bf16 v[16:31], a[136:139], a[248:251], v[16:31]
    ds_read_b128 a[248:251], v248 offset:16384
    v_fma_f32 v7, v7, s32, -v239
    v_exp_f32 v2, v2
    v_fma_f32 v8, v8, s32, -v239
    v_mfma_f32_32x32x16_bf16 v[16:31], a[108:111], a[76:79], v[16:31]
    v_exp_f32 v3, v3
    v_fma_f32 v9, v9, s32, -v239
    v_cvt_pk_bf16_f32 v216, v0, v1
    s_waitcnt lgkmcnt(1)
    v_mfma_f32_32x32x16_bf16 v[16:31], a[140:143], a[252:255], v[16:31]
    ds_read_b128 a[252:255], v249 offset:16384
    v_exp_f32 v4, v4
    v_fma_f32 v10, v10, s32, -v239
    v_exp_f32 v5, v5
    v_mfma_f32_32x32x16_bf16 v[16:31], a[112:115], a[80:83], v[16:31]
    v_fma_f32 v11, v11, s32, -v239
    v_cvt_pk_bf16_f32 v217, v2, v3
    v_exp_f32 v6, v6
    s_waitcnt lgkmcnt(1)
    v_mfma_f32_32x32x16_bf16 v[16:31], a[144:147], a[248:251], v[16:31]
    ds_read_b128 a[248:251], v250 offset:16384
    v_fma_f32 v12, v12, s32, -v239
    v_exp_f32 v7, v7
    v_fma_f32 v13, v13, s32, -v239
    v_mfma_f32_32x32x16_bf16 v[16:31], a[116:119], a[84:87], v[16:31]
    v_cvt_pk_bf16_f32 v218, v4, v5
    v_exp_f32 v8, v8
    v_fma_f32 v14, v14, s32, -v239
    s_waitcnt lgkmcnt(1)
    v_mfma_f32_32x32x16_bf16 v[16:31], a[148:151], a[252:255], v[16:31]
    ds_read_b128 a[252:255], v251 offset:16384
    v_exp_f32 v9, v9
    v_fma_f32 v15, v15, s32, -v239
    v_cvt_pk_bf16_f32 v219, v6, v7
    v_mfma_f32_32x32x16_bf16 v[16:31], a[120:123], a[88:91], v[16:31]
    v_exp_f32 v10, v10
    v_exp_f32 v11, v11
    v_cvt_pk_bf16_f32 v220, v8, v9
    s_waitcnt lgkmcnt(1)
    v_mfma_f32_32x32x16_bf16 v[16:31], a[152:155], a[248:251], v[16:31]
    v_exp_f32 v12, v12
    v_mfma_f32_32x32x16_bf16 v[16:31], a[124:127], a[92:95], v[16:31]
    s_waitcnt lgkmcnt(0)
    v_mfma_f32_32x32x16_bf16 v[16:31], a[156:159], a[252:255], v[16:31]
    v_mfma_f32_4x4x4_16b_bf16 v[232:235], v[236:237], v[214:215], v[232:235] cbsz:4 abid:0
    v_exp_f32 v13, v13
    v_cvt_pk_bf16_f32 v221, v10, v11
    v_mfma_f32_4x4x4_16b_bf16 v[232:235], v[236:237], v[216:217], v[232:235] cbsz:4 abid:1
    v_exp_f32 v14, v14
    v_exp_f32 v15, v15
    v_mfma_f32_4x4x4_16b_bf16 v[232:235], v[236:237], v[218:219], v[232:235] cbsz:4 abid:1
    v_cvt_pk_bf16_f32 v222, v12, v13
    v_cvt_pk_bf16_f32 v223, v14, v15
    v_mfma_f32_4x4x4_16b_bf16 v[232:235], v[236:237], v[220:221], v[232:235] cbsz:4 abid:1
    s_nop 1
    v_max3_f32 v243, v16, v17, v243
    v_max3_f32 v243, v18, v19, v243
    v_max3_f32 v243, v20, v21, v243
    v_max3_f32 v243, v22, v23, v243
    v_max3_f32 v243, v24, v25, v243
    v_max3_f32 v243, v26, v27, v243
    v_max3_f32 v243, v28, v29, v243
    v_max3_f32 v243, v30, v31, v243
    v_fma_f32 v254, v243, s32, -v240
    v_cmp_lt_f32 vcc, s33, v254
    v_fma_f32 v16, v16, s32, -v240
    v_fma_f32 v17, v17, s32, -v240
    v_fma_f32 v18, v18, s32, -v240
    v_fma_f32 v19, v19, s32, -v240
    v_fma_f32 v20, v20, s32, -v240
    v_fma_f32 v21, v21, s32, -v240
    s_cbranch_vccnz L_stub_1_2_11
L_back_1_2_11:
    v_exp_f32 v16, v16
    v_fma_f32 v22, v22, s32, -v240
    v_exp_f32 v17, v17
    v_fma_f32 v23, v23, s32, -v240
    v_exp_f32 v18, v18
    v_fma_f32 v24, v24, s32, -v240
    v_exp_f32 v19, v19
    v_fma_f32 v25, v25, s32, -v240
    v_cvt_pk_bf16_f32 v224, v16, v17
    v_exp_f32 v20, v20
    v_fma_f32 v26, v26, s32, -v240
    v_exp_f32 v21, v21
    v_fma_f32 v27, v27, s32, -v240
    v_cvt_pk_bf16_f32 v225, v18, v19
    v_exp_f32 v22, v22
    v_fma_f32 v28, v28, s32, -v240
    v_exp_f32 v23, v23
    v_fma_f32 v29, v29, s32, -v240
    v_cvt_pk_bf16_f32 v226, v20, v21
    v_exp_f32 v24, v24
    v_fma_f32 v30, v30, s32, -v240
    v_exp_f32 v25, v25
    v_fma_f32 v31, v31, s32, -v240
    v_cvt_pk_bf16_f32 v227, v22, v23
    v_exp_f32 v26, v26
    v_exp_f32 v27, v27
    v_cvt_pk_bf16_f32 v228, v24, v25
    v_exp_f32 v28, v28
    v_mfma_f32_4x4x4_16b_bf16 v[232:235], v[236:237], v[222:223], v[232:235] cbsz:4 abid:1
    v_exp_f32 v29, v29
    v_cvt_pk_bf16_f32 v229, v26, v27
    v_mfma_f32_4x4x4_16b_bf16 v[232:235], v[236:237], v[224:225], v[232:235] cbsz:4 abid:2
    v_exp_f32 v30, v30
    v_exp_f32 v31, v31
    v_mfma_f32_4x4x4_16b_bf16 v[232:235], v[236:237], v[226:227], v[232:235] cbsz:4 abid:2
    v_cvt_pk_bf16_f32 v230, v28, v29
    v_cvt_pk_bf16_f32 v231, v30, v31
    v_mfma_f32_4x4x4_16b_bf16 v[232:235], v[236:237], v[228:229], v[232:235] cbsz:4 abid:2
    s_nop 1
    v_mfma_f32_4x4x4_16b_bf16 v[232:235], v[236:237], v[230:231], v[232:235] cbsz:4 abid:2
    v_mbcnt_lo_u32_b32 v248, -1, 0
    v_mbcnt_hi_u32_b32 v248, -1, v248
    v_bfe_u32 v244, v248, 1, 1
    v_bfe_u32 v249, v248, 4, 1
    v_lshl_add_u32 v244, v249, 1, v244
    v_lshrrev_b32 v249, 5, v248
    v_xor_b32 v244, v244, v249
    v_lshlrev_b32 v244, 4, v244
    v_lshl_add_u32 v244, v249, 9, v244
    v_bfe_u32 v249, v248, 3, 1
    v_lshl_add_u32 v244, v249, 6, v244
    v_bfe_u32 v249, v248, 2, 2
    v_lshl_add_u32 v244, v249, 7, v244
    v_and_b32 v249, 1, v248
    v_lshl_add_u32 v244, v249, 3, v244
    v_xor_b32 v245, 32, v244
    v_xor_b32 v246, 64, v244
    v_xor_b32 v247, 0x60, v244
    ds_read_b64_tr_b16 a[248:249], v244 offset:32768
    ds_read_b64_tr_b16 a[250:251], v245 offset:33792
    ds_read_b64_tr_b16 a[252:253], v244 offset:34816
    ds_read_b64_tr_b16 a[254:255], v245 offset:35840
    v_fma_f32 v248, v241, s32, -v238
    v_ceil_f32 v248, v248
    v_add_f32 v248, v248, v238
    v_max_f32 v248, v248, v238
    v_mov_b32 v249, v248
    s_nop 1
    v_permlane32_swap_b32 v248, v249
    v_max_f32 v248, v248, v249
    v_sub_f32 v248, v248, v238
    v_cvt_pk_u8_f32 v248, v248, 0, 0
    v_mul_u32_u24 v241, s34, v248
    v_sub_u32 v248, 0, v248
    v_ldexp_f32 v248, v232, v248
    v_mov_b32 v249, v248
    s_nop 1
    v_permlane32_swap_b32 v248, v249
    v_add_f32 v248, v248, v249
    v_rcp_f32 v238, v248
    v_fma_f32 v248, v242, s32, -v239
    v_ceil_f32 v248, v248
    v_add_f32 v248, v248, v239
    v_max_f32 v248, v248, v239
    v_mov_b32 v249, v248
    s_nop 1
    v_permlane32_swap_b32 v248, v249
    v_max_f32 v248, v248, v249
    v_sub_f32 v248, v248, v239
    v_cvt_pk_u8_f32 v248, v248, 0, 0
    v_mul_u32_u24 v242, s34, v248
    v_sub_u32 v248, 0, v248
    v_ldexp_f32 v248, v233, v248
    v_mov_b32 v249, v248
    s_nop 1
    v_permlane32_swap_b32 v248, v249
    v_add_f32 v248, v248, v249
    v_rcp_f32 v239, v248
    v_fma_f32 v248, v243, s32, -v240
    v_ceil_f32 v248, v248
    v_add_f32 v248, v248, v240
    v_max_f32 v248, v248, v240
    v_mov_b32 v249, v248
    s_nop 1
    v_permlane32_swap_b32 v248, v249
    v_max_f32 v248, v248, v249
    v_sub_f32 v248, v248, v240
    v_cvt_pk_u8_f32 v248, v248, 0, 0
    v_mul_u32_u24 v243, s34, v248
    v_sub_u32 v248, 0, v248
    v_ldexp_f32 v248, v234, v248
    v_mov_b32 v249, v248
    s_nop 1
    v_permlane32_swap_b32 v248, v249
    v_add_f32 v248, v248, v249
    v_rcp_f32 v240, v248
    v_accvgpr_read_b32 v254, a160
    v_pk_sub_u16 v254, v254, v241 clamp
    v_accvgpr_write_b32 a160, v254
    v_accvgpr_read_b32 v254, a161
    v_pk_sub_u16 v254, v254, v241 clamp
    v_accvgpr_write_b32 a161, v254
    v_accvgpr_read_b32 v254, a162
    v_pk_sub_u16 v254, v254, v241 clamp
    v_accvgpr_write_b32 a162, v254
    v_accvgpr_read_b32 v254, a163
    v_pk_sub_u16 v254, v254, v241 clamp
    v_accvgpr_write_b32 a163, v254
    v_accvgpr_read_b32 v254, a164
    v_pk_sub_u16 v254, v254, v241 clamp
    v_accvgpr_write_b32 a164, v254
    v_accvgpr_read_b32 v254, a165
    v_pk_sub_u16 v254, v254, v241 clamp
    v_accvgpr_write_b32 a165, v254
    v_accvgpr_read_b32 v254, a166
    v_pk_sub_u16 v254, v254, v241 clamp
    v_accvgpr_write_b32 a166, v254
    v_accvgpr_read_b32 v254, a167
    v_pk_sub_u16 v254, v254, v241 clamp
    v_accvgpr_write_b32 a167, v254
    v_pk_sub_u16 v32, v32, v242 clamp
    v_pk_sub_u16 v33, v33, v242 clamp
    v_pk_sub_u16 v34, v34, v242 clamp
    v_pk_sub_u16 v35, v35, v242 clamp
    v_pk_sub_u16 v36, v36, v242 clamp
    v_pk_sub_u16 v37, v37, v242 clamp
    v_pk_sub_u16 v38, v38, v242 clamp
    v_pk_sub_u16 v39, v39, v242 clamp
    v_pk_sub_u16 v40, v40, v243 clamp
    v_pk_sub_u16 v41, v41, v243 clamp
    v_pk_sub_u16 v42, v42, v243 clamp
    v_pk_sub_u16 v43, v43, v243 clamp
    v_pk_sub_u16 v44, v44, v243 clamp
    v_pk_sub_u16 v45, v45, v243 clamp
    v_pk_sub_u16 v46, v46, v243 clamp
    v_pk_sub_u16 v47, v47, v243 clamp
    s_waitcnt lgkmcnt(2)
    v_mfma_f32_32x32x16_bf16 a[0:15], a[248:251], a[160:163], 0
    ds_read_b64_tr_b16 v[232:233], v246 offset:32768
    ds_read_b64_tr_b16 v[234:235], v247 offset:33792
    s_add_u32 m0, s31, 0
    s_add_u32 s35, s49, 69888
    buffer_load_dwordx4 v252, s[16:19], s35 offen nt lds
    v_mfma_f32_32x32x16_bf16 a[64:79], a[248:251], v[32:35], 0
    ds_read_b64_tr_b16 v[248:249], v246 offset:34816
    ds_read_b64_tr_b16 v[250:251], v247 offset:35840
    s_add_u32 m0, s31, 81920
    s_add_u32 s35, s49, 70016
    buffer_load_dwordx4 v252, s[16:19], s35 offen nt lds
    v_mfma_f32_32x32x16_bf16 a[128:143], a[248:251], v[40:43], 0
    ds_read_b64_tr_b16 a[248:249], v244 offset:40960
    ds_read_b64_tr_b16 a[250:251], v245 offset:41984
    s_add_u32 m0, s31, 0
    s_add_u32 s35, s49, 101632
    buffer_load_dwordx4 v253, s[16:19], s35 offen offset:1024 nt lds
    s_waitcnt lgkmcnt(6)
    v_mfma_f32_32x32x16_bf16 a[0:15], a[252:255], a[164:167], a[0:15]
    s_add_u32 m0, s31, 81920
    s_add_u32 s35, s49, 101760
    buffer_load_dwordx4 v253, s[16:19], s35 offen offset:1024 nt lds
    v_accvgpr_read_b32 v254, a168
    v_pk_sub_u16 v254, v254, v241 clamp
    v_accvgpr_write_b32 a168, v254
    v_mfma_f32_32x32x16_bf16 a[64:79], a[252:255], v[36:39], a[64:79]
    v_accvgpr_read_b32 v254, a169
    v_pk_sub_u16 v254, v254, v241 clamp
    v_accvgpr_write_b32 a169, v254
    v_accvgpr_read_b32 v254, a170
    v_pk_sub_u16 v254, v254, v241 clamp
    v_accvgpr_write_b32 a170, v254
    v_mfma_f32_32x32x16_bf16 a[128:143], a[252:255], v[44:47], a[128:143]
    ds_read_b64_tr_b16 a[252:253], v244 offset:43008
    ds_read_b64_tr_b16 a[254:255], v245 offset:44032
    v_accvgpr_read_b32 v254, a171
    v_pk_sub_u16 v254, v254, v241 clamp
    v_accvgpr_write_b32 a171, v254
    s_waitcnt lgkmcnt(6)
    v_mfma_f32_32x32x16_bf16 a[16:31], v[232:235], a[160:163], 0
    v_accvgpr_read_b32 v254, a172
    v_pk_sub_u16 v254, v254, v241 clamp
    v_accvgpr_write_b32 a172, v254
    v_accvgpr_read_b32 v254, a173
    v_pk_sub_u16 v254, v254, v241 clamp
    v_accvgpr_write_b32 a173, v254
    v_mfma_f32_32x32x16_bf16 a[80:95], v[232:235], v[32:35], 0
    v_accvgpr_read_b32 v254, a174
    v_pk_sub_u16 v254, v254, v241 clamp
    v_accvgpr_write_b32 a174, v254
    v_accvgpr_read_b32 v254, a175
    v_pk_sub_u16 v254, v254, v241 clamp
    v_accvgpr_write_b32 a175, v254
    v_mfma_f32_32x32x16_bf16 a[144:159], v[232:235], v[40:43], 0
    ds_read_b64_tr_b16 v[232:233], v246 offset:40960
    ds_read_b64_tr_b16 v[234:235], v247 offset:41984
    v_pk_sub_u16 v48, v48, v242 clamp
    v_pk_sub_u16 v49, v49, v242 clamp
    v_pk_sub_u16 v50, v50, v242 clamp
    s_waitcnt lgkmcnt(6)
    v_mfma_f32_32x32x16_bf16 a[16:31], v[248:251], a[164:167], a[16:31]
    v_pk_sub_u16 v51, v51, v242 clamp
    v_pk_sub_u16 v52, v52, v242 clamp
    v_pk_sub_u16 v53, v53, v242 clamp
    v_pk_sub_u16 v54, v54, v242 clamp
    v_pk_sub_u16 v55, v55, v242 clamp
    v_mfma_f32_32x32x16_bf16 a[80:95], v[248:251], v[36:39], a[80:95]
    v_pk_sub_u16 v56, v56, v243 clamp
    v_pk_sub_u16 v57, v57, v243 clamp
    v_pk_sub_u16 v58, v58, v243 clamp
    v_pk_sub_u16 v59, v59, v243 clamp
    v_pk_sub_u16 v60, v60, v243 clamp
    v_mfma_f32_32x32x16_bf16 a[144:159], v[248:251], v[44:47], a[144:159]
    ds_read_b64_tr_b16 v[248:249], v246 offset:43008
    ds_read_b64_tr_b16 v[250:251], v247 offset:44032
    v_pk_sub_u16 v61, v61, v243 clamp
    v_pk_sub_u16 v62, v62, v243 clamp
    v_pk_sub_u16 v63, v63, v243 clamp
    s_waitcnt lgkmcnt(6)
    v_mfma_f32_32x32x16_bf16 a[32:47], a[248:251], a[160:163], 0
    v_mfma_f32_32x32x16_bf16 a[96:111], a[248:251], v[32:35], 0
    v_mfma_f32_32x32x16_bf16 v[0:15], a[248:251], v[40:43], 0
    ds_read_b64_tr_b16 a[248:249], v244 offset:36864
    ds_read_b64_tr_b16 a[250:251], v245 offset:37888
    s_waitcnt lgkmcnt(6)
    v_mfma_f32_32x32x16_bf16 a[32:47], a[252:255], a[164:167], a[32:47]
    v_mfma_f32_32x32x16_bf16 a[96:111], a[252:255], v[36:39], a[96:111]
    v_mfma_f32_32x32x16_bf16 v[0:15], a[252:255], v[44:47], v[0:15]
    ds_read_b64_tr_b16 a[252:253], v244 offset:38912
    ds_read_b64_tr_b16 a[254:255], v245 offset:39936
    s_waitcnt lgkmcnt(6)
    v_mfma_f32_32x32x16_bf16 a[48:63], v[232:235], a[160:163], 0
    v_mfma_f32_32x32x16_bf16 a[112:127], v[232:235], v[32:35], 0
    v_mfma_f32_32x32x16_bf16 v[16:31], v[232:235], v[40:43], 0
    s_waitcnt vmcnt(12)
    s_barrier
    ds_read_b64_tr_b16 v[232:233], v246 offset:36864
    ds_read_b64_tr_b16 v[234:235], v247 offset:37888
    s_waitcnt lgkmcnt(6)
    v_mfma_f32_32x32x16_bf16 a[48:63], v[248:251], a[164:167], a[48:63]
    v_mfma_f32_32x32x16_bf16 a[112:127], v[248:251], v[36:39], a[112:127]
    v_mfma_f32_32x32x16_bf16 v[16:31], v[248:251], v[44:47], v[16:31]
    ds_read_b64_tr_b16 v[248:249], v246 offset:38912
    ds_read_b64_tr_b16 v[250:251], v247 offset:39936
    s_waitcnt lgkmcnt(6)
    v_mfma_f32_32x32x16_bf16 a[0:15], a[248:251], a[168:171], a[0:15]
    v_accvgpr_read_b32 v254, a176
    v_pk_sub_u16 v254, v254, v241 clamp
    v_accvgpr_write_b32 a176, v254
    v_accvgpr_read_b32 v254, a177
    v_pk_sub_u16 v254, v254, v241 clamp
    v_accvgpr_write_b32 a177, v254
    v_mfma_f32_32x32x16_bf16 a[64:79], a[248:251], v[48:51], a[64:79]
    v_accvgpr_read_b32 v254, a178
    v_pk_sub_u16 v254, v254, v241 clamp
    v_accvgpr_write_b32 a178, v254
    v_accvgpr_read_b32 v254, a179
    v_pk_sub_u16 v254, v254, v241 clamp
    v_accvgpr_write_b32 a179, v254
    v_mfma_f32_32x32x16_bf16 a[128:143], a[248:251], v[56:59], a[128:143]
    ds_read_b64_tr_b16 a[248:249], v244 offset:45056
    ds_read_b64_tr_b16 a[250:251], v245 offset:46080
    v_accvgpr_read_b32 v254, a180
    v_pk_sub_u16 v254, v254, v241 clamp
    v_accvgpr_write_b32 a180, v254
    s_waitcnt lgkmcnt(6)
    v_mfma_f32_32x32x16_bf16 a[0:15], a[252:255], a[172:175], a[0:15]
    v_accvgpr_read_b32 v254, a181
    v_pk_sub_u16 v254, v254, v241 clamp
    v_accvgpr_write_b32 a181, v254
    v_accvgpr_read_b32 v254, a182
    v_pk_sub_u16 v254, v254, v241 clamp
    v_accvgpr_write_b32 a182, v254
    v_mfma_f32_32x32x16_bf16 a[64:79], a[252:255], v[52:55], a[64:79]
    v_accvgpr_read_b32 v254, a183
    v_pk_sub_u16 v254, v254, v241 clamp
    v_accvgpr_write_b32 a183, v254
    v_pk_sub_u16 v64, v64, v242 clamp
    v_pk_sub_u16 v65, v65, v242 clamp
    v_mfma_f32_32x32x16_bf16 a[128:143], a[252:255], v[60:63], a[128:143]
    ds_read_b64_tr_b16 a[252:253], v244 offset:47104
    ds_read_b64_tr_b16 a[254:255], v245 offset:48128
    v_pk_sub_u16 v66, v66, v242 clamp
    v_pk_sub_u16 v67, v67, v242 clamp
    v_pk_sub_u16 v68, v68, v242 clamp
    s_waitcnt lgkmcnt(6)
    v_mfma_f32_32x32x16_bf16 a[16:31], v[232:235], a[168:171], a[16:31]
    v_pk_sub_u16 v69, v69, v242 clamp
    v_pk_sub_u16 v70, v70, v242 clamp
    v_pk_sub_u16 v71, v71, v242 clamp
    v_pk_sub_u16 v72, v72, v243 clamp
    v_pk_sub_u16 v73, v73, v243 clamp
    v_mfma_f32_32x32x16_bf16 a[80:95], v[232:235], v[48:51], a[80:95]
    v_pk_sub_u16 v74, v74, v243 clamp
    v_pk_sub_u16 v75, v75, v243 clamp
    v_pk_sub_u16 v76, v76, v243 clamp
    v_pk_sub_u16 v77, v77, v243 clamp
    v_pk_sub_u16 v78, v78, v243 clamp
    v_mfma_f32_32x32x16_bf16 a[144:159], v[232:235], v[56:59], a[144:159]
    ds_read_b64_tr_b16 v[232:233], v246 offset:45056
    ds_read_b64_tr_b16 v[234:235], v247 offset:46080
    v_pk_sub_u16 v79, v79, v243 clamp
    s_waitcnt lgkmcnt(6)
    v_mfma_f32_32x32x16_bf16 a[16:31], v[248:251], a[172:175], a[16:31]
    v_mfma_f32_32x32x16_bf16 a[80:95], v[248:251], v[52:55], a[80:95]
    v_mfma_f32_32x32x16_bf16 a[144:159], v[248:251], v[60:63], a[144:159]
    ds_read_b64_tr_b16 v[248:249], v246 offset:47104
    ds_read_b64_tr_b16 v[250:251], v247 offset:48128
    s_waitcnt lgkmcnt(6)
    v_mfma_f32_32x32x16_bf16 a[32:47], a[248:251], a[168:171], a[32:47]
    v_mfma_f32_32x32x16_bf16 a[96:111], a[248:251], v[48:51], a[96:111]
    v_mfma_f32_32x32x16_bf16 v[0:15], a[248:251], v[56:59], v[0:15]
    ds_read_b64_tr_b16 a[248:249], v244 offset:49152
    ds_read_b64_tr_b16 a[250:251], v245 offset:50176
    s_waitcnt lgkmcnt(6)
    v_mfma_f32_32x32x16_bf16 a[32:47], a[252:255], a[172:175], a[32:47]
    v_mfma_f32_32x32x16_bf16 a[96:111], a[252:255], v[52:55], a[96:111]
    s_add_u32 m0, s31, 0
    s_add_u32 s35, s49, 133376
    buffer_load_dwordx4 v252, s[16:19], s35 offen offset:2048 nt lds
    v_mfma_f32_32x32x16_bf16 v[0:15], a[252:255], v[60:63], v[0:15]
    ds_read_b64_tr_b16 a[252:253], v244 offset:51200
    ds_read_b64_tr_b16 a[254:255], v245 offset:52224
    s_add_u32 m0, s31, 81920
    s_add_u32 s35, s49, 133504
    buffer_load_dwordx4 v252, s[16:19], s35 offen offset:2048 nt lds
    s_waitcnt lgkmcnt(6)
    v_mfma_f32_32x32x16_bf16 a[48:63], v[232:235], a[168:171], a[48:63]
    s_add_u32 m0, s31, 0
    s_add_u32 s35, s49, 165120
    buffer_load_dwordx4 v253, s[16:19], s35 offen offset:3072 nt lds
    v_mfma_f32_32x32x16_bf16 a[112:127], v[232:235], v[48:51], a[112:127]
    s_add_u32 m0, s31, 81920
    s_add_u32 s35, s49, 165248
    buffer_load_dwordx4 v253, s[16:19], s35 offen offset:3072 nt lds
    v_mfma_f32_32x32x16_bf16 v[16:31], v[232:235], v[56:59], v[16:31]
    ds_read_b64_tr_b16 v[232:233], v246 offset:49152
    ds_read_b64_tr_b16 v[234:235], v247 offset:50176
    s_waitcnt lgkmcnt(6)
    v_mfma_f32_32x32x16_bf16 a[48:63], v[248:251], a[172:175], a[48:63]
    v_mfma_f32_32x32x16_bf16 a[112:127], v[248:251], v[52:55], a[112:127]
    v_mfma_f32_32x32x16_bf16 v[16:31], v[248:251], v[60:63], v[16:31]
    ds_read_b64_tr_b16 v[248:249], v246 offset:51200
    ds_read_b64_tr_b16 v[250:251], v247 offset:52224
    s_waitcnt lgkmcnt(6)
    v_mfma_f32_32x32x16_bf16 a[0:15], a[248:251], a[176:179], a[0:15]
    v_accvgpr_read_b32 v254, a184
    v_pk_sub_u16 v254, v254, v241 clamp
    v_accvgpr_write_b32 a184, v254
    v_accvgpr_read_b32 v254, a185
    v_pk_sub_u16 v254, v254, v241 clamp
    v_accvgpr_write_b32 a185, v254
    v_mfma_f32_32x32x16_bf16 a[64:79], a[248:251], v[64:67], a[64:79]
    v_accvgpr_read_b32 v254, a186
    v_pk_sub_u16 v254, v254, v241 clamp
    v_accvgpr_write_b32 a186, v254
    v_accvgpr_read_b32 v254, a187
    v_pk_sub_u16 v254, v254, v241 clamp
    v_accvgpr_write_b32 a187, v254
    v_mfma_f32_32x32x16_bf16 a[128:143], a[248:251], v[72:75], a[128:143]
    ds_read_b64_tr_b16 a[248:249], v244 offset:57344
    ds_read_b64_tr_b16 a[250:251], v245 offset:58368
    v_accvgpr_read_b32 v254, a188
    v_pk_sub_u16 v254, v254, v241 clamp
    v_accvgpr_write_b32 a188, v254
    s_waitcnt lgkmcnt(6)
    v_mfma_f32_32x32x16_bf16 a[0:15], a[252:255], a[180:183], a[0:15]
    v_accvgpr_read_b32 v254, a189
    v_pk_sub_u16 v254, v254, v241 clamp
    v_accvgpr_write_b32 a189, v254
    v_accvgpr_read_b32 v254, a190
    v_pk_sub_u16 v254, v254, v241 clamp
    v_accvgpr_write_b32 a190, v254
    v_mfma_f32_32x32x16_bf16 a[64:79], a[252:255], v[68:71], a[64:79]
    v_accvgpr_read_b32 v254, a191
    v_pk_sub_u16 v254, v254, v241 clamp
    v_accvgpr_write_b32 a191, v254
    v_pk_sub_u16 v80, v80, v242 clamp
    v_pk_sub_u16 v81, v81, v242 clamp
    v_mfma_f32_32x32x16_bf16 a[128:143], a[252:255], v[76:79], a[128:143]
    ds_read_b64_tr_b16 a[252:253], v244 offset:59392
    ds_read_b64_tr_b16 a[254:255], v245 offset:60416
    v_pk_sub_u16 v82, v82, v242 clamp
    v_pk_sub_u16 v83, v83, v242 clamp
    v_pk_sub_u16 v84, v84, v242 clamp
    s_waitcnt lgkmcnt(6)
    v_mfma_f32_32x32x16_bf16 a[16:31], v[232:235], a[176:179], a[16:31]
    v_pk_sub_u16 v85, v85, v242 clamp
    v_pk_sub_u16 v86, v86, v242 clamp
    v_pk_sub_u16 v87, v87, v242 clamp
    v_pk_sub_u16 v88, v88, v243 clamp
    v_pk_sub_u16 v89, v89, v243 clamp
    v_mfma_f32_32x32x16_bf16 a[80:95], v[232:235], v[64:67], a[80:95]
    v_pk_sub_u16 v90, v90, v243 clamp
    v_pk_sub_u16 v91, v91, v243 clamp
    v_pk_sub_u16 v92, v92, v243 clamp
    v_pk_sub_u16 v93, v93, v243 clamp
    v_pk_sub_u16 v94, v94, v243 clamp
    v_mfma_f32_32x32x16_bf16 a[144:159], v[232:235], v[72:75], a[144:159]
    ds_read_b64_tr_b16 v[232:233], v246 offset:57344
    ds_read_b64_tr_b16 v[234:235], v247 offset:58368
    v_pk_sub_u16 v95, v95, v243 clamp
    s_waitcnt lgkmcnt(6)
    v_mfma_f32_32x32x16_bf16 a[16:31], v[248:251], a[180:183], a[16:31]
    v_mfma_f32_32x32x16_bf16 a[80:95], v[248:251], v[68:71], a[80:95]
    v_mfma_f32_32x32x16_bf16 a[144:159], v[248:251], v[76:79], a[144:159]
    ds_read_b64_tr_b16 v[248:249], v246 offset:59392
    ds_read_b64_tr_b16 v[250:251], v247 offset:60416
    s_waitcnt lgkmcnt(6)
    v_mfma_f32_32x32x16_bf16 a[32:47], a[248:251], a[176:179], a[32:47]
    v_mfma_f32_32x32x16_bf16 a[96:111], a[248:251], v[64:67], a[96:111]
    v_mfma_f32_32x32x16_bf16 v[0:15], a[248:251], v[72:75], v[0:15]
    ds_read_b64_tr_b16 a[248:249], v244 offset:53248
    ds_read_b64_tr_b16 a[250:251], v245 offset:54272
    s_waitcnt lgkmcnt(6)
    v_mfma_f32_32x32x16_bf16 a[32:47], a[252:255], a[180:183], a[32:47]
    v_mfma_f32_32x32x16_bf16 a[96:111], a[252:255], v[68:71], a[96:111]
    v_mfma_f32_32x32x16_bf16 v[0:15], a[252:255], v[76:79], v[0:15]
    ds_read_b64_tr_b16 a[252:253], v244 offset:55296
    ds_read_b64_tr_b16 a[254:255], v245 offset:56320
    s_waitcnt lgkmcnt(6)
    v_mfma_f32_32x32x16_bf16 a[48:63], v[232:235], a[176:179], a[48:63]
    v_mfma_f32_32x32x16_bf16 a[112:127], v[232:235], v[64:67], a[112:127]
    v_mfma_f32_32x32x16_bf16 v[16:31], v[232:235], v[72:75], v[16:31]
    s_waitcnt vmcnt(12)
    s_barrier
    ds_read_b64_tr_b16 v[232:233], v246 offset:53248
    ds_read_b64_tr_b16 v[234:235], v247 offset:54272
    s_add_u32 m0, s30, 32768
    s_add_u32 s35, s27, 151552
    buffer_load_dwordx4 v252, s[16:19], s35 offen nt lds
    s_waitcnt lgkmcnt(6)
    v_mfma_f32_32x32x16_bf16 a[48:63], v[248:251], a[180:183], a[48:63]
    s_add_u32 s35, s27, 183296
    buffer_load_dwordx4 v253, s[16:19], s35 offen offset:1024 nt lds
    v_mfma_f32_32x32x16_bf16 a[112:127], v[248:251], v[68:71], a[112:127]
    s_add_u32 s35, s27, 18432
    buffer_load_dwordx4 v252, s[16:19], s35 offen offset:2048 nt lds
    v_mfma_f32_32x32x16_bf16 v[16:31], v[248:251], v[76:79], v[16:31]
    ds_read_b64_tr_b16 v[248:249], v246 offset:55296
    ds_read_b64_tr_b16 v[250:251], v247 offset:56320
    s_add_u32 s35, s27, 50176
    buffer_load_dwordx4 v253, s[16:19], s35 offen offset:3072 nt lds
    s_waitcnt lgkmcnt(6)
    v_mfma_f32_32x32x16_bf16 a[0:15], a[248:251], a[184:187], a[0:15]
    v_accvgpr_read_b32 v254, a192
    v_pk_sub_u16 v254, v254, v241 clamp
    v_accvgpr_write_b32 a192, v254
    v_accvgpr_read_b32 v254, a193
    v_pk_sub_u16 v254, v254, v241 clamp
    v_accvgpr_write_b32 a193, v254
    v_mfma_f32_32x32x16_bf16 a[64:79], a[248:251], v[80:83], a[64:79]
    v_accvgpr_read_b32 v254, a194
    v_pk_sub_u16 v254, v254, v241 clamp
    v_accvgpr_write_b32 a194, v254
    v_accvgpr_read_b32 v254, a195
    v_pk_sub_u16 v254, v254, v241 clamp
    v_accvgpr_write_b32 a195, v254
    v_mfma_f32_32x32x16_bf16 a[128:143], a[248:251], v[88:91], a[128:143]
    ds_read_b64_tr_b16 a[248:249], v244 offset:61440
    ds_read_b64_tr_b16 a[250:251], v245 offset:62464
    v_accvgpr_read_b32 v254, a196
    v_pk_sub_u16 v254, v254, v241 clamp
    v_accvgpr_write_b32 a196, v254
    s_waitcnt lgkmcnt(6)
    v_mfma_f32_32x32x16_bf16 a[0:15], a[252:255], a[188:191], a[0:15]
    v_accvgpr_read_b32 v254, a197
    v_pk_sub_u16 v254, v254, v241 clamp
    v_accvgpr_write_b32 a197, v254
    v_accvgpr_read_b32 v254, a198
    v_pk_sub_u16 v254, v254, v241 clamp
    v_accvgpr_write_b32 a198, v254
    v_mfma_f32_32x32x16_bf16 a[64:79], a[252:255], v[84:87], a[64:79]
    v_accvgpr_read_b32 v254, a199
    v_pk_sub_u16 v254, v254, v241 clamp
    v_accvgpr_write_b32 a199, v254
    v_pk_sub_u16 v96, v96, v242 clamp
    v_pk_sub_u16 v97, v97, v242 clamp
    v_mfma_f32_32x32x16_bf16 a[128:143], a[252:255], v[92:95], a[128:143]
    ds_read_b64_tr_b16 a[252:253], v244 offset:63488
    ds_read_b64_tr_b16 a[254:255], v245 offset:64512
    v_pk_sub_u16 v98, v98, v242 clamp
    v_pk_sub_u16 v99, v99, v242 clamp
    v_pk_sub_u16 v100, v100, v242 clamp
    s_waitcnt lgkmcnt(6)
    v_mfma_f32_32x32x16_bf16 a[16:31], v[232:235], a[184:187], a[16:31]
    v_pk_sub_u16 v101, v101, v242 clamp
    v_pk_sub_u16 v102, v102, v242 clamp
    v_pk_sub_u16 v103, v103, v242 clamp
    v_pk_sub_u16 v104, v104, v243 clamp
    v_pk_sub_u16 v105, v105, v243 clamp
    v_mfma_f32_32x32x16_bf16 a[80:95], v[232:235], v[80:83], a[80:95]
    v_pk_sub_u16 v106, v106, v243 clamp
    v_pk_sub_u16 v107, v107, v243 clamp
    v_pk_sub_u16 v108, v108, v243 clamp
    v_pk_sub_u16 v109, v109, v243 clamp
    v_pk_sub_u16 v110, v110, v243 clamp
    v_mfma_f32_32x32x16_bf16 a[144:159], v[232:235], v[88:91], a[144:159]
    ds_read_b64_tr_b16 v[232:233], v246 offset:61440
    ds_read_b64_tr_b16 v[234:235], v247 offset:62464
    v_pk_sub_u16 v111, v111, v243 clamp
    s_waitcnt lgkmcnt(6)
    v_mfma_f32_32x32x16_bf16 a[16:31], v[248:251], a[188:191], a[16:31]
    s_add_u32 m0, s31, 16384
    s_add_u32 s35, s49, 4352
    buffer_load_dwordx4 v252, s[16:19], s35 offen nt lds
    v_mfma_f32_32x32x16_bf16 a[80:95], v[248:251], v[84:87], a[80:95]
    s_add_u32 m0, s31, 49152
    s_add_u32 s35, s49, 4480
    buffer_load_dwordx4 v252, s[16:19], s35 offen nt lds
    v_mfma_f32_32x32x16_bf16 a[144:159], v[248:251], v[92:95], a[144:159]
    ds_read_b64_tr_b16 v[248:249], v246 offset:63488
    ds_read_b64_tr_b16 v[250:251], v247 offset:64512
    s_add_u32 m0, s31, 16384
    s_add_u32 s35, s49, 36096
    buffer_load_dwordx4 v253, s[16:19], s35 offen offset:1024 nt lds
    s_waitcnt lgkmcnt(6)
    v_mfma_f32_32x32x16_bf16 a[32:47], a[248:251], a[184:187], a[32:47]
    s_add_u32 m0, s31, 49152
    s_add_u32 s35, s49, 36224
    buffer_load_dwordx4 v253, s[16:19], s35 offen offset:1024 nt lds
    v_mfma_f32_32x32x16_bf16 a[96:111], a[248:251], v[80:83], a[96:111]
    v_mfma_f32_32x32x16_bf16 v[0:15], a[248:251], v[88:91], v[0:15]
    ds_read_b64_tr_b16 a[248:249], v244
    ds_read_b64_tr_b16 a[250:251], v245 offset:1024
    s_waitcnt lgkmcnt(6)
    v_mfma_f32_32x32x16_bf16 a[32:47], a[252:255], a[188:191], a[32:47]
    v_mfma_f32_32x32x16_bf16 a[96:111], a[252:255], v[84:87], a[96:111]
    v_mfma_f32_32x32x16_bf16 v[0:15], a[252:255], v[92:95], v[0:15]
    ds_read_b64_tr_b16 a[252:253], v244 offset:2048
    ds_read_b64_tr_b16 a[254:255], v245 offset:3072
    s_waitcnt lgkmcnt(6)
    v_mfma_f32_32x32x16_bf16 a[48:63], v[232:235], a[184:187], a[48:63]
    v_mfma_f32_32x32x16_bf16 a[112:127], v[232:235], v[80:83], a[112:127]
    v_mfma_f32_32x32x16_bf16 v[16:31], v[232:235], v[88:91], v[16:31]
    ds_read_b64_tr_b16 v[232:233], v246
    ds_read_b64_tr_b16 v[234:235], v247 offset:1024
    s_waitcnt lgkmcnt(6)
    v_mfma_f32_32x32x16_bf16 a[48:63], v[248:251], a[188:191], a[48:63]
    v_mfma_f32_32x32x16_bf16 a[112:127], v[248:251], v[84:87], a[112:127]
    v_mfma_f32_32x32x16_bf16 v[16:31], v[248:251], v[92:95], v[16:31]
    ds_read_b64_tr_b16 v[248:249], v246 offset:2048
    ds_read_b64_tr_b16 v[250:251], v247 offset:3072
    s_waitcnt lgkmcnt(6)
    v_mfma_f32_32x32x16_bf16 a[0:15], a[248:251], a[192:195], a[0:15]
    v_accvgpr_read_b32 v254, a200
    v_pk_sub_u16 v254, v254, v241 clamp
    v_accvgpr_write_b32 a200, v254
    v_accvgpr_read_b32 v254, a201
    v_pk_sub_u16 v254, v254, v241 clamp
    v_accvgpr_write_b32 a201, v254
    v_mfma_f32_32x32x16_bf16 a[64:79], a[248:251], v[96:99], a[64:79]
    v_accvgpr_read_b32 v254, a202
    v_pk_sub_u16 v254, v254, v241 clamp
    v_accvgpr_write_b32 a202, v254
    v_accvgpr_read_b32 v254, a203
    v_pk_sub_u16 v254, v254, v241 clamp
    v_accvgpr_write_b32 a203, v254
    v_mfma_f32_32x32x16_bf16 a[128:143], a[248:251], v[104:107], a[128:143]
    ds_read_b64_tr_b16 a[248:249], v244 offset:8192
    ds_read_b64_tr_b16 a[250:251], v245 offset:9216
    v_accvgpr_read_b32 v254, a204
    v_pk_sub_u16 v254, v254, v241 clamp
    v_accvgpr_write_b32 a204, v254
    s_waitcnt lgkmcnt(6)
    v_mfma_f32_32x32x16_bf16 a[0:15], a[252:255], a[196:199], a[0:15]
    v_accvgpr_read_b32 v254, a205
    v_pk_sub_u16 v254, v254, v241 clamp
    v_accvgpr_write_b32 a205, v254
    v_accvgpr_read_b32 v254, a206
    v_pk_sub_u16 v254, v254, v241 clamp
    v_accvgpr_write_b32 a206, v254
    v_mfma_f32_32x32x16_bf16 a[64:79], a[252:255], v[100:103], a[64:79]
    v_accvgpr_read_b32 v254, a207
    v_pk_sub_u16 v254, v254, v241 clamp
    v_accvgpr_write_b32 a207, v254
    v_pk_sub_u16 v112, v112, v242 clamp
    v_pk_sub_u16 v113, v113, v242 clamp
    v_mfma_f32_32x32x16_bf16 a[128:143], a[252:255], v[108:111], a[128:143]
    ds_read_b64_tr_b16 a[252:253], v244 offset:10240
    ds_read_b64_tr_b16 a[254:255], v245 offset:11264
    v_pk_sub_u16 v114, v114, v242 clamp
    v_pk_sub_u16 v115, v115, v242 clamp
    v_pk_sub_u16 v116, v116, v242 clamp
    s_waitcnt lgkmcnt(6)
    v_mfma_f32_32x32x16_bf16 a[16:31], v[232:235], a[192:195], a[16:31]
    v_pk_sub_u16 v117, v117, v242 clamp
    v_pk_sub_u16 v118, v118, v242 clamp
    v_pk_sub_u16 v119, v119, v242 clamp
    v_pk_sub_u16 v120, v120, v243 clamp
    v_pk_sub_u16 v121, v121, v243 clamp
    v_mfma_f32_32x32x16_bf16 a[80:95], v[232:235], v[96:99], a[80:95]
    v_pk_sub_u16 v122, v122, v243 clamp
    v_pk_sub_u16 v123, v123, v243 clamp
    v_pk_sub_u16 v124, v124, v243 clamp
    v_pk_sub_u16 v125, v125, v243 clamp
    v_pk_sub_u16 v126, v126, v243 clamp
    v_mfma_f32_32x32x16_bf16 a[144:159], v[232:235], v[104:107], a[144:159]
    ds_read_b64_tr_b16 v[232:233], v246 offset:8192
    ds_read_b64_tr_b16 v[234:235], v247 offset:9216
    v_pk_sub_u16 v127, v127, v243 clamp
    s_waitcnt lgkmcnt(6)
    v_mfma_f32_32x32x16_bf16 a[16:31], v[248:251], a[196:199], a[16:31]
    v_mfma_f32_32x32x16_bf16 a[80:95], v[248:251], v[100:103], a[80:95]
    v_mfma_f32_32x32x16_bf16 a[144:159], v[248:251], v[108:111], a[144:159]
    ds_read_b64_tr_b16 v[248:249], v246 offset:10240
    ds_read_b64_tr_b16 v[250:251], v247 offset:11264
    s_waitcnt lgkmcnt(6)
    v_mfma_f32_32x32x16_bf16 a[32:47], a[248:251], a[192:195], a[32:47]
    v_mfma_f32_32x32x16_bf16 a[96:111], a[248:251], v[96:99], a[96:111]
    v_mfma_f32_32x32x16_bf16 v[0:15], a[248:251], v[104:107], v[0:15]
    ds_read_b64_tr_b16 a[248:249], v244 offset:4096
    ds_read_b64_tr_b16 a[250:251], v245 offset:5120
    s_waitcnt lgkmcnt(6)
    v_mfma_f32_32x32x16_bf16 a[32:47], a[252:255], a[196:199], a[32:47]
    v_mfma_f32_32x32x16_bf16 a[96:111], a[252:255], v[100:103], a[96:111]
    v_mfma_f32_32x32x16_bf16 v[0:15], a[252:255], v[108:111], v[0:15]
    ds_read_b64_tr_b16 a[252:253], v244 offset:6144
    ds_read_b64_tr_b16 a[254:255], v245 offset:7168
    s_waitcnt lgkmcnt(6)
    v_mfma_f32_32x32x16_bf16 a[48:63], v[232:235], a[192:195], a[48:63]
    v_mfma_f32_32x32x16_bf16 a[112:127], v[232:235], v[96:99], a[112:127]
    v_mfma_f32_32x32x16_bf16 v[16:31], v[232:235], v[104:107], v[16:31]
    s_waitcnt vmcnt(16)
    s_barrier
    ds_read_b64_tr_b16 v[232:233], v246 offset:4096
    ds_read_b64_tr_b16 v[234:235], v247 offset:5120
    s_add_u32 m0, s30, 49152
    s_add_u32 s35, s27, 159744
    buffer_load_dwordx4 v252, s[16:19], s35 offen nt lds
    s_waitcnt lgkmcnt(6)
    v_mfma_f32_32x32x16_bf16 a[48:63], v[248:251], a[196:199], a[48:63]
    s_add_u32 s35, s27, 191488
    buffer_load_dwordx4 v253, s[16:19], s35 offen offset:1024 nt lds
    v_mfma_f32_32x32x16_bf16 a[112:127], v[248:251], v[100:103], a[112:127]
    s_add_u32 s35, s27, 26624
    buffer_load_dwordx4 v252, s[16:19], s35 offen offset:2048 nt lds
    v_mfma_f32_32x32x16_bf16 v[16:31], v[248:251], v[108:111], v[16:31]
    ds_read_b64_tr_b16 v[248:249], v246 offset:6144
    ds_read_b64_tr_b16 v[250:251], v247 offset:7168
    s_add_u32 s35, s27, 58368
    buffer_load_dwordx4 v253, s[16:19], s35 offen offset:3072 nt lds
    s_waitcnt lgkmcnt(6)
    v_mfma_f32_32x32x16_bf16 a[0:15], a[248:251], a[200:203], a[0:15]
    v_accvgpr_read_b32 v254, a208
    v_pk_sub_u16 v254, v254, v241 clamp
    v_accvgpr_write_b32 a208, v254
    v_accvgpr_read_b32 v254, a209
    v_pk_sub_u16 v254, v254, v241 clamp
    v_accvgpr_write_b32 a209, v254
    v_mfma_f32_32x32x16_bf16 a[64:79], a[248:251], v[112:115], a[64:79]
    v_accvgpr_read_b32 v254, a210
    v_pk_sub_u16 v254, v254, v241 clamp
    v_accvgpr_write_b32 a210, v254
    v_accvgpr_read_b32 v254, a211
    v_pk_sub_u16 v254, v254, v241 clamp
    v_accvgpr_write_b32 a211, v254
    v_mfma_f32_32x32x16_bf16 a[128:143], a[248:251], v[120:123], a[128:143]
    ds_read_b64_tr_b16 a[248:249], v244 offset:12288
    ds_read_b64_tr_b16 a[250:251], v245 offset:13312
    v_accvgpr_read_b32 v254, a212
    v_pk_sub_u16 v254, v254, v241 clamp
    v_accvgpr_write_b32 a212, v254
    s_waitcnt lgkmcnt(6)
    v_mfma_f32_32x32x16_bf16 a[0:15], a[252:255], a[204:207], a[0:15]
    v_accvgpr_read_b32 v254, a213
    v_pk_sub_u16 v254, v254, v241 clamp
    v_accvgpr_write_b32 a213, v254
    v_accvgpr_read_b32 v254, a214
    v_pk_sub_u16 v254, v254, v241 clamp
    v_accvgpr_write_b32 a214, v254
    v_mfma_f32_32x32x16_bf16 a[64:79], a[252:255], v[116:119], a[64:79]
    v_accvgpr_read_b32 v254, a215
    v_pk_sub_u16 v254, v254, v241 clamp
    v_accvgpr_write_b32 a215, v254
    v_pk_sub_u16 v128, v128, v242 clamp
    v_pk_sub_u16 v129, v129, v242 clamp
    v_mfma_f32_32x32x16_bf16 a[128:143], a[252:255], v[124:127], a[128:143]
    ds_read_b64_tr_b16 a[252:253], v244 offset:14336
    ds_read_b64_tr_b16 a[254:255], v245 offset:15360
    v_pk_sub_u16 v130, v130, v242 clamp
    v_pk_sub_u16 v131, v131, v242 clamp
    v_pk_sub_u16 v132, v132, v242 clamp
    s_waitcnt lgkmcnt(6)
    v_mfma_f32_32x32x16_bf16 a[16:31], v[232:235], a[200:203], a[16:31]
    v_pk_sub_u16 v133, v133, v242 clamp
    v_pk_sub_u16 v134, v134, v242 clamp
    v_pk_sub_u16 v135, v135, v242 clamp
    v_pk_sub_u16 v136, v136, v243 clamp
    v_pk_sub_u16 v137, v137, v243 clamp
    v_mfma_f32_32x32x16_bf16 a[80:95], v[232:235], v[112:115], a[80:95]
    v_pk_sub_u16 v138, v138, v243 clamp
    v_pk_sub_u16 v139, v139, v243 clamp
    v_pk_sub_u16 v140, v140, v243 clamp
    v_pk_sub_u16 v141, v141, v243 clamp
    v_pk_sub_u16 v142, v142, v243 clamp
    v_mfma_f32_32x32x16_bf16 a[144:159], v[232:235], v[120:123], a[144:159]
    ds_read_b64_tr_b16 v[232:233], v246 offset:12288
    ds_read_b64_tr_b16 v[234:235], v247 offset:13312
    v_pk_sub_u16 v143, v143, v243 clamp
    s_waitcnt lgkmcnt(6)
    v_mfma_f32_32x32x16_bf16 a[16:31], v[248:251], a[204:207], a[16:31]
    s_add_u32 m0, s31, 16384
    s_add_u32 s35, s49, 84224
    buffer_load_dwordx4 v252, s[16:19], s35 offen offset:2048 nt lds
    v_mfma_f32_32x32x16_bf16 a[80:95], v[248:251], v[116:119], a[80:95]
    s_add_u32 m0, s31, 49152
    s_add_u32 s35, s49, 84352
    buffer_load_dwordx4 v252, s[16:19], s35 offen offset:2048 nt lds
    v_mfma_f32_32x32x16_bf16 a[144:159], v[248:251], v[124:127], a[144:159]
    ds_read_b64_tr_b16 v[248:249], v246 offset:14336
    ds_read_b64_tr_b16 v[250:251], v247 offset:15360
    s_add_u32 m0, s31, 16384
    s_add_u32 s35, s49, 115968
    buffer_load_dwordx4 v253, s[16:19], s35 offen offset:3072 nt lds
    s_waitcnt lgkmcnt(6)
    v_mfma_f32_32x32x16_bf16 a[32:47], a[248:251], a[200:203], a[32:47]
    s_add_u32 m0, s31, 49152
    s_add_u32 s35, s49, 116096
    buffer_load_dwordx4 v253, s[16:19], s35 offen offset:3072 nt lds
    v_mfma_f32_32x32x16_bf16 a[96:111], a[248:251], v[112:115], a[96:111]
    v_mfma_f32_32x32x16_bf16 v[0:15], a[248:251], v[120:123], v[0:15]
    ds_read_b64_tr_b16 a[248:249], v244 offset:16384
    ds_read_b64_tr_b16 a[250:251], v245 offset:17408
    s_waitcnt lgkmcnt(6)
    v_mfma_f32_32x32x16_bf16 a[32:47], a[252:255], a[204:207], a[32:47]
    v_mfma_f32_32x32x16_bf16 a[96:111], a[252:255], v[116:119], a[96:111]
    v_mfma_f32_32x32x16_bf16 v[0:15], a[252:255], v[124:127], v[0:15]
    ds_read_b64_tr_b16 a[252:253], v244 offset:18432
    ds_read_b64_tr_b16 a[254:255], v245 offset:19456
    s_waitcnt lgkmcnt(6)
    v_mfma_f32_32x32x16_bf16 a[48:63], v[232:235], a[200:203], a[48:63]
    v_mfma_f32_32x32x16_bf16 a[112:127], v[232:235], v[112:115], a[112:127]
    v_mfma_f32_32x32x16_bf16 v[16:31], v[232:235], v[120:123], v[16:31]
    ds_read_b64_tr_b16 v[232:233], v246 offset:16384
    ds_read_b64_tr_b16 v[234:235], v247 offset:17408
    s_waitcnt lgkmcnt(6)
    v_mfma_f32_32x32x16_bf16 a[48:63], v[248:251], a[204:207], a[48:63]
    v_mfma_f32_32x32x16_bf16 a[112:127], v[248:251], v[116:119], a[112:127]
    v_mfma_f32_32x32x16_bf16 v[16:31], v[248:251], v[124:127], v[16:31]
    ds_read_b64_tr_b16 v[248:249], v246 offset:18432
    ds_read_b64_tr_b16 v[250:251], v247 offset:19456
    s_waitcnt lgkmcnt(6)
    v_mfma_f32_32x32x16_bf16 a[0:15], a[248:251], a[208:211], a[0:15]
    v_accvgpr_read_b32 v254, a216
    v_pk_sub_u16 v254, v254, v241 clamp
    v_accvgpr_write_b32 a216, v254
    v_accvgpr_read_b32 v254, a217
    v_pk_sub_u16 v254, v254, v241 clamp
    v_accvgpr_write_b32 a217, v254
    v_mfma_f32_32x32x16_bf16 a[64:79], a[248:251], v[128:131], a[64:79]
    v_accvgpr_read_b32 v254, a218
    v_pk_sub_u16 v254, v254, v241 clamp
    v_accvgpr_write_b32 a218, v254
    v_accvgpr_read_b32 v254, a219
    v_pk_sub_u16 v254, v254, v241 clamp
    v_accvgpr_write_b32 a219, v254
    v_mfma_f32_32x32x16_bf16 a[128:143], a[248:251], v[136:139], a[128:143]
    ds_read_b64_tr_b16 a[248:249], v244 offset:24576
    ds_read_b64_tr_b16 a[250:251], v245 offset:25600
    v_accvgpr_read_b32 v254, a220
    v_pk_sub_u16 v254, v254, v241 clamp
    v_accvgpr_write_b32 a220, v254
    s_waitcnt lgkmcnt(6)
    v_mfma_f32_32x32x16_bf16 a[0:15], a[252:255], a[212:215], a[0:15]
    v_accvgpr_read_b32 v254, a221
    v_pk_sub_u16 v254, v254, v241 clamp
    v_accvgpr_write_b32 a221, v254
    v_accvgpr_read_b32 v254, a222
    v_pk_sub_u16 v254, v254, v241 clamp
    v_accvgpr_write_b32 a222, v254
    v_mfma_f32_32x32x16_bf16 a[64:79], a[252:255], v[132:135], a[64:79]
    v_accvgpr_read_b32 v254, a223
    v_pk_sub_u16 v254, v254, v241 clamp
    v_accvgpr_write_b32 a223, v254
    v_pk_sub_u16 v144, v144, v242 clamp
    v_pk_sub_u16 v145, v145, v242 clamp
    v_mfma_f32_32x32x16_bf16 a[128:143], a[252:255], v[140:143], a[128:143]
    ds_read_b64_tr_b16 a[252:253], v244 offset:26624
    ds_read_b64_tr_b16 a[254:255], v245 offset:27648
    v_pk_sub_u16 v146, v146, v242 clamp
    v_pk_sub_u16 v147, v147, v242 clamp
    v_pk_sub_u16 v148, v148, v242 clamp
    s_waitcnt lgkmcnt(6)
    v_mfma_f32_32x32x16_bf16 a[16:31], v[232:235], a[208:211], a[16:31]
    v_pk_sub_u16 v149, v149, v242 clamp
    v_pk_sub_u16 v150, v150, v242 clamp
    v_pk_sub_u16 v151, v151, v242 clamp
    v_pk_sub_u16 v152, v152, v243 clamp
    v_pk_sub_u16 v153, v153, v243 clamp
    v_mfma_f32_32x32x16_bf16 a[80:95], v[232:235], v[128:131], a[80:95]
    v_pk_sub_u16 v154, v154, v243 clamp
    v_pk_sub_u16 v155, v155, v243 clamp
    v_pk_sub_u16 v156, v156, v243 clamp
    v_pk_sub_u16 v157, v157, v243 clamp
    v_pk_sub_u16 v158, v158, v243 clamp
    v_mfma_f32_32x32x16_bf16 a[144:159], v[232:235], v[136:139], a[144:159]
    ds_read_b64_tr_b16 v[232:233], v246 offset:24576
    ds_read_b64_tr_b16 v[234:235], v247 offset:25600
    v_pk_sub_u16 v159, v159, v243 clamp
    s_waitcnt lgkmcnt(6)
    v_mfma_f32_32x32x16_bf16 a[16:31], v[248:251], a[212:215], a[16:31]
    v_mfma_f32_32x32x16_bf16 a[80:95], v[248:251], v[132:135], a[80:95]
    v_mfma_f32_32x32x16_bf16 a[144:159], v[248:251], v[140:143], a[144:159]
    ds_read_b64_tr_b16 v[248:249], v246 offset:26624
    ds_read_b64_tr_b16 v[250:251], v247 offset:27648
    s_waitcnt lgkmcnt(6)
    v_mfma_f32_32x32x16_bf16 a[32:47], a[248:251], a[208:211], a[32:47]
    v_mfma_f32_32x32x16_bf16 a[96:111], a[248:251], v[128:131], a[96:111]
    v_mfma_f32_32x32x16_bf16 v[0:15], a[248:251], v[136:139], v[0:15]
    ds_read_b64_tr_b16 a[248:249], v244 offset:20480
    ds_read_b64_tr_b16 a[250:251], v245 offset:21504
    s_waitcnt lgkmcnt(6)
    v_mfma_f32_32x32x16_bf16 a[32:47], a[252:255], a[212:215], a[32:47]
    v_mfma_f32_32x32x16_bf16 a[96:111], a[252:255], v[132:135], a[96:111]
    v_mfma_f32_32x32x16_bf16 v[0:15], a[252:255], v[140:143], v[0:15]
    ds_read_b64_tr_b16 a[252:253], v244 offset:22528
    ds_read_b64_tr_b16 a[254:255], v245 offset:23552
    s_waitcnt lgkmcnt(6)
    v_mfma_f32_32x32x16_bf16 a[48:63], v[232:235], a[208:211], a[48:63]
    v_mfma_f32_32x32x16_bf16 a[112:127], v[232:235], v[128:131], a[112:127]
    v_mfma_f32_32x32x16_bf16 v[16:31], v[232:235], v[136:139], v[16:31]
    s_waitcnt vmcnt(12)
    s_barrier
    ds_read_b64_tr_b16 v[232:233], v246 offset:20480
    ds_read_b64_tr_b16 v[234:235], v247 offset:21504
    s_waitcnt lgkmcnt(6)
    v_mfma_f32_32x32x16_bf16 a[48:63], v[248:251], a[212:215], a[48:63]
    v_mfma_f32_32x32x16_bf16 a[112:127], v[248:251], v[132:135], a[112:127]
    v_mfma_f32_32x32x16_bf16 v[16:31], v[248:251], v[140:143], v[16:31]
    ds_read_b64_tr_b16 v[248:249], v246 offset:22528
    ds_read_b64_tr_b16 v[250:251], v247 offset:23552
    s_waitcnt lgkmcnt(6)
    v_mfma_f32_32x32x16_bf16 a[0:15], a[248:251], a[216:219], a[0:15]
    v_accvgpr_read_b32 v254, a224
    v_pk_sub_u16 v254, v254, v241 clamp
    v_accvgpr_write_b32 a224, v254
    v_accvgpr_read_b32 v254, a225
    v_pk_sub_u16 v254, v254, v241 clamp
    v_accvgpr_write_b32 a225, v254
    v_mfma_f32_32x32x16_bf16 a[64:79], a[248:251], v[144:147], a[64:79]
    s_add_u32 m0, s31, 32768
    s_add_u32 s35, s49, 151808
    buffer_load_dwordx4 v252, s[16:19], s35 offen nt lds
    v_accvgpr_read_b32 v254, a226
    v_pk_sub_u16 v254, v254, v241 clamp
    v_accvgpr_write_b32 a226, v254
    v_mfma_f32_32x32x16_bf16 a[128:143], a[248:251], v[152:155], a[128:143]
    ds_read_b64_tr_b16 a[248:249], v244 offset:28672
    ds_read_b64_tr_b16 a[250:251], v245 offset:29696
    s_add_u32 m0, s31, 65536
    s_add_u32 s35, s49, 151936
    buffer_load_dwordx4 v252, s[16:19], s35 offen nt lds
    s_waitcnt lgkmcnt(6)
    v_mfma_f32_32x32x16_bf16 a[0:15], a[252:255], a[220:223], a[0:15]
    s_add_u32 m0, s31, 32768
    s_add_u32 s35, s49, 183552
    buffer_load_dwordx4 v253, s[16:19], s35 offen offset:1024 nt lds
    v_accvgpr_read_b32 v254, a227
    v_pk_sub_u16 v254, v254, v241 clamp
    v_accvgpr_write_b32 a227, v254
    v_mfma_f32_32x32x16_bf16 a[64:79], a[252:255], v[148:151], a[64:79]
    s_add_u32 m0, s31, 65536
    s_add_u32 s35, s49, 183680
    buffer_load_dwordx4 v253, s[16:19], s35 offen offset:1024 nt lds
    v_accvgpr_read_b32 v254, a228
    v_pk_sub_u16 v254, v254, v241 clamp
    v_accvgpr_write_b32 a228, v254
    v_mfma_f32_32x32x16_bf16 a[128:143], a[252:255], v[156:159], a[128:143]
    ds_read_b64_tr_b16 a[252:253], v244 offset:30720
    ds_read_b64_tr_b16 a[254:255], v245 offset:31744
    v_accvgpr_read_b32 v254, a229
    v_pk_sub_u16 v254, v254, v241 clamp
    v_accvgpr_write_b32 a229, v254
    s_waitcnt lgkmcnt(6)
    v_mfma_f32_32x32x16_bf16 a[16:31], v[232:235], a[216:219], a[16:31]
    v_accvgpr_read_b32 v254, a230
    v_pk_sub_u16 v254, v254, v241 clamp
    v_accvgpr_write_b32 a230, v254
    v_accvgpr_read_b32 v254, a231
    v_pk_sub_u16 v254, v254, v241 clamp
    v_accvgpr_write_b32 a231, v254
    v_mfma_f32_32x32x16_bf16 a[80:95], v[232:235], v[144:147], a[80:95]
    v_pk_sub_u16 v160, v160, v242 clamp
    v_pk_sub_u16 v161, v161, v242 clamp
    v_pk_sub_u16 v162, v162, v242 clamp
    v_pk_sub_u16 v163, v163, v242 clamp
    v_pk_sub_u16 v164, v164, v242 clamp
    v_mfma_f32_32x32x16_bf16 a[144:159], v[232:235], v[152:155], a[144:159]
    ds_read_b64_tr_b16 v[232:233], v246 offset:28672
    ds_read_b64_tr_b16 v[234:235], v247 offset:29696
    v_pk_sub_u16 v165, v165, v242 clamp
    v_pk_sub_u16 v166, v166, v242 clamp
    v_pk_sub_u16 v167, v167, v242 clamp
    s_waitcnt lgkmcnt(6)
    v_mfma_f32_32x32x16_bf16 a[16:31], v[248:251], a[220:223], a[16:31]
    v_pk_sub_u16 v168, v168, v243 clamp
    v_pk_sub_u16 v169, v169, v243 clamp
    v_pk_sub_u16 v170, v170, v243 clamp
    v_pk_sub_u16 v171, v171, v243 clamp
    v_pk_sub_u16 v172, v172, v243 clamp
    v_mfma_f32_32x32x16_bf16 a[80:95], v[248:251], v[148:151], a[80:95]
    v_pk_sub_u16 v173, v173, v243 clamp
    v_pk_sub_u16 v174, v174, v243 clamp
    v_pk_sub_u16 v175, v175, v243 clamp
    v_mfma_f32_32x32x16_bf16 a[144:159], v[248:251], v[156:159], a[144:159]
    ds_read_b64_tr_b16 v[248:249], v246 offset:30720
    ds_read_b64_tr_b16 v[250:251], v247 offset:31744
    s_waitcnt lgkmcnt(6)
    v_mfma_f32_32x32x16_bf16 a[32:47], a[248:251], a[216:219], a[32:47]
    v_mfma_f32_32x32x16_bf16 a[96:111], a[248:251], v[144:147], a[96:111]
    v_mfma_f32_32x32x16_bf16 v[0:15], a[248:251], v[152:155], v[0:15]
    ds_read_b64_tr_b16 a[248:249], v244 offset:32768
    ds_read_b64_tr_b16 a[250:251], v245 offset:33792
    s_waitcnt lgkmcnt(6)
    v_mfma_f32_32x32x16_bf16 a[32:47], a[252:255], a[220:223], a[32:47]
    v_mfma_f32_32x32x16_bf16 a[96:111], a[252:255], v[148:151], a[96:111]
    v_mfma_f32_32x32x16_bf16 v[0:15], a[252:255], v[156:159], v[0:15]
    ds_read_b64_tr_b16 a[252:253], v244 offset:34816
    ds_read_b64_tr_b16 a[254:255], v245 offset:35840
    s_waitcnt lgkmcnt(6)
    v_mfma_f32_32x32x16_bf16 a[48:63], v[232:235], a[216:219], a[48:63]
    v_mfma_f32_32x32x16_bf16 a[112:127], v[232:235], v[144:147], a[112:127]
    v_mfma_f32_32x32x16_bf16 v[16:31], v[232:235], v[152:155], v[16:31]
    ds_read_b64_tr_b16 v[232:233], v246 offset:32768
    ds_read_b64_tr_b16 v[234:235], v247 offset:33792
    s_waitcnt lgkmcnt(6)
    v_mfma_f32_32x32x16_bf16 a[48:63], v[248:251], a[220:223], a[48:63]
    v_mfma_f32_32x32x16_bf16 a[112:127], v[248:251], v[148:151], a[112:127]
    v_mfma_f32_32x32x16_bf16 v[16:31], v[248:251], v[156:159], v[16:31]
    ds_read_b64_tr_b16 v[248:249], v246 offset:34816
    ds_read_b64_tr_b16 v[250:251], v247 offset:35840
    s_waitcnt lgkmcnt(6)
    v_mfma_f32_32x32x16_bf16 a[0:15], a[248:251], a[224:227], a[0:15]
    v_accvgpr_read_b32 v254, a232
    v_pk_sub_u16 v254, v254, v241 clamp
    v_accvgpr_write_b32 a232, v254
    v_accvgpr_read_b32 v254, a233
    v_pk_sub_u16 v254, v254, v241 clamp
    v_accvgpr_write_b32 a233, v254
    v_mfma_f32_32x32x16_bf16 a[64:79], a[248:251], v[160:163], a[64:79]
    v_accvgpr_read_b32 v254, a234
    v_pk_sub_u16 v254, v254, v241 clamp
    v_accvgpr_write_b32 a234, v254
    v_accvgpr_read_b32 v254, a235
    v_pk_sub_u16 v254, v254, v241 clamp
    v_accvgpr_write_b32 a235, v254
    v_mfma_f32_32x32x16_bf16 a[128:143], a[248:251], v[168:171], a[128:143]
    ds_read_b64_tr_b16 a[248:249], v244 offset:40960
    ds_read_b64_tr_b16 a[250:251], v245 offset:41984
    v_accvgpr_read_b32 v254, a236
    v_pk_sub_u16 v254, v254, v241 clamp
    v_accvgpr_write_b32 a236, v254
    s_waitcnt lgkmcnt(6)
    v_mfma_f32_32x32x16_bf16 a[0:15], a[252:255], a[228:231], a[0:15]
    v_accvgpr_read_b32 v254, a237
    v_pk_sub_u16 v254, v254, v241 clamp
    v_accvgpr_write_b32 a237, v254
    v_accvgpr_read_b32 v254, a238
    v_pk_sub_u16 v254, v254, v241 clamp
    v_accvgpr_write_b32 a238, v254
    v_mfma_f32_32x32x16_bf16 a[64:79], a[252:255], v[164:167], a[64:79]
    v_accvgpr_read_b32 v254, a239
    v_pk_sub_u16 v254, v254, v241 clamp
    v_accvgpr_write_b32 a239, v254
    v_pk_sub_u16 v176, v176, v242 clamp
    v_pk_sub_u16 v177, v177, v242 clamp
    v_mfma_f32_32x32x16_bf16 a[128:143], a[252:255], v[172:175], a[128:143]
    ds_read_b64_tr_b16 a[252:253], v244 offset:43008
    ds_read_b64_tr_b16 a[254:255], v245 offset:44032
    v_pk_sub_u16 v178, v178, v242 clamp
    v_pk_sub_u16 v179, v179, v242 clamp
    v_pk_sub_u16 v180, v180, v242 clamp
    s_waitcnt lgkmcnt(6)
    v_mfma_f32_32x32x16_bf16 a[16:31], v[232:235], a[224:227], a[16:31]
    v_pk_sub_u16 v181, v181, v242 clamp
    v_pk_sub_u16 v182, v182, v242 clamp
    v_pk_sub_u16 v183, v183, v242 clamp
    v_pk_sub_u16 v184, v184, v243 clamp
    v_pk_sub_u16 v185, v185, v243 clamp
    v_mfma_f32_32x32x16_bf16 a[80:95], v[232:235], v[160:163], a[80:95]
    v_pk_sub_u16 v186, v186, v243 clamp
    v_pk_sub_u16 v187, v187, v243 clamp
    v_pk_sub_u16 v188, v188, v243 clamp
    v_pk_sub_u16 v189, v189, v243 clamp
    v_pk_sub_u16 v190, v190, v243 clamp
    v_mfma_f32_32x32x16_bf16 a[144:159], v[232:235], v[168:171], a[144:159]
    ds_read_b64_tr_b16 v[232:233], v246 offset:40960
    ds_read_b64_tr_b16 v[234:235], v247 offset:41984
    v_pk_sub_u16 v191, v191, v243 clamp
    s_waitcnt lgkmcnt(6)
    v_mfma_f32_32x32x16_bf16 a[16:31], v[248:251], a[228:231], a[16:31]
    v_mfma_f32_32x32x16_bf16 a[80:95], v[248:251], v[164:167], a[80:95]
    v_mfma_f32_32x32x16_bf16 a[144:159], v[248:251], v[172:175], a[144:159]
    ds_read_b64_tr_b16 v[248:249], v246 offset:43008
    ds_read_b64_tr_b16 v[250:251], v247 offset:44032
    s_waitcnt lgkmcnt(6)
    v_mfma_f32_32x32x16_bf16 a[32:47], a[248:251], a[224:227], a[32:47]
    v_mfma_f32_32x32x16_bf16 a[96:111], a[248:251], v[160:163], a[96:111]
    v_mfma_f32_32x32x16_bf16 v[0:15], a[248:251], v[168:171], v[0:15]
    ds_read_b64_tr_b16 a[248:249], v244 offset:36864
    ds_read_b64_tr_b16 a[250:251], v245 offset:37888
    s_waitcnt lgkmcnt(6)
    v_mfma_f32_32x32x16_bf16 a[32:47], a[252:255], a[228:231], a[32:47]
    v_mfma_f32_32x32x16_bf16 a[96:111], a[252:255], v[164:167], a[96:111]
    v_mfma_f32_32x32x16_bf16 v[0:15], a[252:255], v[172:175], v[0:15]
    ds_read_b64_tr_b16 a[252:253], v244 offset:38912
    ds_read_b64_tr_b16 a[254:255], v245 offset:39936
    s_add_u32 m0, s31, 32768
    s_add_u32 s35, s49, 18688
    buffer_load_dwordx4 v252, s[16:19], s35 offen offset:2048 nt lds
    s_waitcnt lgkmcnt(6)
    v_mfma_f32_32x32x16_bf16 a[48:63], v[232:235], a[224:227], a[48:63]
    s_add_u32 m0, s31, 65536
    s_add_u32 s35, s49, 18816
    buffer_load_dwordx4 v252, s[16:19], s35 offen offset:2048 nt lds
    v_mfma_f32_32x32x16_bf16 a[112:127], v[232:235], v[160:163], a[112:127]
    s_add_u32 m0, s31, 32768
    s_add_u32 s35, s49, 50432
    buffer_load_dwordx4 v253, s[16:19], s35 offen offset:3072 nt lds
    v_mfma_f32_32x32x16_bf16 v[16:31], v[232:235], v[168:171], v[16:31]
    s_waitcnt vmcnt(11)
    s_barrier
    ds_read_b64_tr_b16 v[232:233], v246 offset:36864
    ds_read_b64_tr_b16 v[234:235], v247 offset:37888
    s_add_u32 m0, s31, 65536
    s_add_u32 s35, s49, 50560
    buffer_load_dwordx4 v253, s[16:19], s35 offen offset:3072 nt lds
    s_waitcnt lgkmcnt(6)
    v_mfma_f32_32x32x16_bf16 a[48:63], v[248:251], a[228:231], a[48:63]
    v_mfma_f32_32x32x16_bf16 a[112:127], v[248:251], v[164:167], a[112:127]
    v_mfma_f32_32x32x16_bf16 v[16:31], v[248:251], v[172:175], v[16:31]
    ds_read_b64_tr_b16 v[248:249], v246 offset:38912
    ds_read_b64_tr_b16 v[250:251], v247 offset:39936
    s_waitcnt lgkmcnt(6)
    v_mfma_f32_32x32x16_bf16 a[0:15], a[248:251], a[232:235], a[0:15]
    v_accvgpr_read_b32 v254, a240
    v_pk_sub_u16 v254, v254, v241 clamp
    v_accvgpr_write_b32 a240, v254
    v_accvgpr_read_b32 v254, a241
    v_pk_sub_u16 v254, v254, v241 clamp
    v_accvgpr_write_b32 a241, v254
    v_mfma_f32_32x32x16_bf16 a[64:79], a[248:251], v[176:179], a[64:79]
    v_accvgpr_read_b32 v254, a242
    v_pk_sub_u16 v254, v254, v241 clamp
    v_accvgpr_write_b32 a242, v254
    v_accvgpr_read_b32 v254, a243
    v_pk_sub_u16 v254, v254, v241 clamp
    v_accvgpr_write_b32 a243, v254
    v_mfma_f32_32x32x16_bf16 a[128:143], a[248:251], v[184:187], a[128:143]
    ds_read_b64_tr_b16 a[248:249], v244 offset:45056
    ds_read_b64_tr_b16 a[250:251], v245 offset:46080
    v_accvgpr_read_b32 v254, a244
    v_pk_sub_u16 v254, v254, v241 clamp
    v_accvgpr_write_b32 a244, v254
    s_waitcnt lgkmcnt(6)
    v_mfma_f32_32x32x16_bf16 a[0:15], a[252:255], a[236:239], a[0:15]
    v_accvgpr_read_b32 v254, a245
    v_pk_sub_u16 v254, v254, v241 clamp
    v_accvgpr_write_b32 a245, v254
    v_accvgpr_read_b32 v254, a246
    v_pk_sub_u16 v254, v254, v241 clamp
    v_accvgpr_write_b32 a246, v254
    v_mfma_f32_32x32x16_bf16 a[64:79], a[252:255], v[180:183], a[64:79]
    v_accvgpr_read_b32 v254, a247
    v_pk_sub_u16 v254, v254, v241 clamp
    v_accvgpr_write_b32 a247, v254
    v_pk_sub_u16 v192, v192, v242 clamp
    v_pk_sub_u16 v193, v193, v242 clamp
    v_mfma_f32_32x32x16_bf16 a[128:143], a[252:255], v[188:191], a[128:143]
    ds_read_b64_tr_b16 a[252:253], v244 offset:47104
    ds_read_b64_tr_b16 a[254:255], v245 offset:48128
    v_pk_sub_u16 v194, v194, v242 clamp
    v_pk_sub_u16 v195, v195, v242 clamp
    v_pk_sub_u16 v196, v196, v242 clamp
    s_waitcnt lgkmcnt(6)
    v_mfma_f32_32x32x16_bf16 a[16:31], v[232:235], a[232:235], a[16:31]
    v_pk_sub_u16 v197, v197, v242 clamp
    v_pk_sub_u16 v198, v198, v242 clamp
    v_pk_sub_u16 v199, v199, v242 clamp
    v_pk_sub_u16 v200, v200, v243 clamp
    v_pk_sub_u16 v201, v201, v243 clamp
    v_mfma_f32_32x32x16_bf16 a[80:95], v[232:235], v[176:179], a[80:95]
    v_pk_sub_u16 v202, v202, v243 clamp
    v_pk_sub_u16 v203, v203, v243 clamp
    v_pk_sub_u16 v204, v204, v243 clamp
    v_pk_sub_u16 v205, v205, v243 clamp
    v_pk_sub_u16 v206, v206, v243 clamp
    v_mfma_f32_32x32x16_bf16 a[144:159], v[232:235], v[184:187], a[144:159]
    ds_read_b64_tr_b16 v[232:233], v246 offset:45056
    ds_read_b64_tr_b16 v[234:235], v247 offset:46080
    v_pk_sub_u16 v207, v207, v243 clamp
    s_waitcnt lgkmcnt(6)
    v_mfma_f32_32x32x16_bf16 a[16:31], v[248:251], a[236:239], a[16:31]
    v_mfma_f32_32x32x16_bf16 a[80:95], v[248:251], v[180:183], a[80:95]
    v_mfma_f32_32x32x16_bf16 a[144:159], v[248:251], v[188:191], a[144:159]
    ds_read_b64_tr_b16 v[248:249], v246 offset:47104
    ds_read_b64_tr_b16 v[250:251], v247 offset:48128
    s_waitcnt lgkmcnt(6)
    v_mfma_f32_32x32x16_bf16 a[32:47], a[248:251], a[232:235], a[32:47]
    v_mfma_f32_32x32x16_bf16 a[96:111], a[248:251], v[176:179], a[96:111]
    v_mfma_f32_32x32x16_bf16 v[0:15], a[248:251], v[184:187], v[0:15]
    ds_read_b64_tr_b16 a[248:249], v244 offset:49152
    ds_read_b64_tr_b16 a[250:251], v245 offset:50176
    s_waitcnt lgkmcnt(6)
    v_mfma_f32_32x32x16_bf16 a[32:47], a[252:255], a[236:239], a[32:47]
    v_mfma_f32_32x32x16_bf16 a[96:111], a[252:255], v[180:183], a[96:111]
    v_mfma_f32_32x32x16_bf16 v[0:15], a[252:255], v[188:191], v[0:15]
    ds_read_b64_tr_b16 a[252:253], v244 offset:51200
    ds_read_b64_tr_b16 a[254:255], v245 offset:52224
    s_waitcnt lgkmcnt(6)
    v_mfma_f32_32x32x16_bf16 a[48:63], v[232:235], a[232:235], a[48:63]
    v_mfma_f32_32x32x16_bf16 a[112:127], v[232:235], v[176:179], a[112:127]
    v_mfma_f32_32x32x16_bf16 v[16:31], v[232:235], v[184:187], v[16:31]
    ds_read_b64_tr_b16 v[232:233], v246 offset:49152
    ds_read_b64_tr_b16 v[234:235], v247 offset:50176
    s_waitcnt lgkmcnt(6)
    v_mfma_f32_32x32x16_bf16 a[48:63], v[248:251], a[236:239], a[48:63]
    v_mfma_f32_32x32x16_bf16 a[112:127], v[248:251], v[180:183], a[112:127]
    v_mfma_f32_32x32x16_bf16 v[16:31], v[248:251], v[188:191], v[16:31]
    ds_read_b64_tr_b16 v[248:249], v246 offset:51200
    ds_read_b64_tr_b16 v[250:251], v247 offset:52224
    s_waitcnt lgkmcnt(6)
    v_mfma_f32_32x32x16_bf16 a[0:15], a[248:251], a[240:243], a[0:15]
    v_pk_sub_u16 v208, v208, v241 clamp
    v_pk_sub_u16 v209, v209, v241 clamp
    v_pk_sub_u16 v210, v210, v241 clamp
    v_pk_sub_u16 v211, v211, v241 clamp
    v_pk_sub_u16 v212, v212, v241 clamp
    v_mfma_f32_32x32x16_bf16 a[64:79], a[248:251], v[192:195], a[64:79]
    v_pk_sub_u16 v213, v213, v241 clamp
    v_pk_sub_u16 v214, v214, v241 clamp
    v_pk_sub_u16 v215, v215, v241 clamp
    v_pk_sub_u16 v216, v216, v242 clamp
    v_pk_sub_u16 v217, v217, v242 clamp
    v_mfma_f32_32x32x16_bf16 a[128:143], a[248:251], v[200:203], a[128:143]
    ds_read_b64_tr_b16 a[248:249], v244 offset:57344
    ds_read_b64_tr_b16 a[250:251], v245 offset:58368
    v_pk_sub_u16 v218, v218, v242 clamp
    v_pk_sub_u16 v219, v219, v242 clamp
    v_pk_sub_u16 v220, v220, v242 clamp
    s_waitcnt lgkmcnt(6)
    v_mfma_f32_32x32x16_bf16 a[0:15], a[252:255], a[244:247], a[0:15]
    v_pk_sub_u16 v221, v221, v242 clamp
    v_pk_sub_u16 v222, v222, v242 clamp
    v_pk_sub_u16 v223, v223, v242 clamp
    v_pk_sub_u16 v224, v224, v243 clamp
    v_pk_sub_u16 v225, v225, v243 clamp
    v_mfma_f32_32x32x16_bf16 a[64:79], a[252:255], v[196:199], a[64:79]
    v_pk_sub_u16 v226, v226, v243 clamp
    v_pk_sub_u16 v227, v227, v243 clamp
    v_pk_sub_u16 v228, v228, v243 clamp
    v_pk_sub_u16 v229, v229, v243 clamp
    v_pk_sub_u16 v230, v230, v243 clamp
    v_mfma_f32_32x32x16_bf16 a[128:143], a[252:255], v[204:207], a[128:143]
    ds_read_b64_tr_b16 a[252:253], v244 offset:59392
    ds_read_b64_tr_b16 a[254:255], v245 offset:60416
    v_pk_sub_u16 v231, v231, v243 clamp
    s_waitcnt lgkmcnt(6)
    v_mfma_f32_32x32x16_bf16 a[16:31], v[232:235], a[240:243], a[16:31]
    v_mfma_f32_32x32x16_bf16 a[80:95], v[232:235], v[192:195], a[80:95]
    v_mfma_f32_32x32x16_bf16 a[144:159], v[232:235], v[200:203], a[144:159]
    ds_read_b64_tr_b16 v[232:233], v246 offset:57344
    ds_read_b64_tr_b16 v[234:235], v247 offset:58368
    s_waitcnt lgkmcnt(6)
    v_mfma_f32_32x32x16_bf16 a[16:31], v[248:251], a[244:247], a[16:31]
    v_mfma_f32_32x32x16_bf16 a[80:95], v[248:251], v[196:199], a[80:95]
    v_mfma_f32_32x32x16_bf16 a[144:159], v[248:251], v[204:207], a[144:159]
    ds_read_b64_tr_b16 v[248:249], v246 offset:59392
    ds_read_b64_tr_b16 v[250:251], v247 offset:60416
    s_waitcnt lgkmcnt(6)
    v_mfma_f32_32x32x16_bf16 a[32:47], a[248:251], a[240:243], a[32:47]
    v_mfma_f32_32x32x16_bf16 a[96:111], a[248:251], v[192:195], a[96:111]
    v_mfma_f32_32x32x16_bf16 v[0:15], a[248:251], v[200:203], v[0:15]
    ds_read_b64_tr_b16 a[248:249], v244 offset:53248
    ds_read_b64_tr_b16 a[250:251], v245 offset:54272
    s_waitcnt lgkmcnt(6)
    v_mfma_f32_32x32x16_bf16 a[32:47], a[252:255], a[244:247], a[32:47]
    v_mfma_f32_32x32x16_bf16 a[96:111], a[252:255], v[196:199], a[96:111]
    v_mfma_f32_32x32x16_bf16 v[0:15], a[252:255], v[204:207], v[0:15]
    ds_read_b64_tr_b16 a[252:253], v244 offset:55296
    ds_read_b64_tr_b16 a[254:255], v245 offset:56320
    s_waitcnt lgkmcnt(6)
    v_mfma_f32_32x32x16_bf16 a[48:63], v[232:235], a[240:243], a[48:63]
    v_mfma_f32_32x32x16_bf16 a[112:127], v[232:235], v[192:195], a[112:127]
    v_mfma_f32_32x32x16_bf16 v[16:31], v[232:235], v[200:203], v[16:31]
    s_waitcnt vmcnt(9)
    s_waitcnt vmcnt(8)
    s_barrier
    ds_read_b64_tr_b16 v[232:233], v246 offset:53248
    ds_read_b64_tr_b16 v[234:235], v247 offset:54272
    s_waitcnt lgkmcnt(6)
    v_mfma_f32_32x32x16_bf16 a[48:63], v[248:251], a[244:247], a[48:63]
    v_mfma_f32_32x32x16_bf16 a[112:127], v[248:251], v[196:199], a[112:127]
    v_mfma_f32_32x32x16_bf16 v[16:31], v[248:251], v[204:207], v[16:31]
    ds_read_b64_tr_b16 v[248:249], v246 offset:55296
    ds_read_b64_tr_b16 v[250:251], v247 offset:56320
    s_waitcnt lgkmcnt(6)
    v_mfma_f32_32x32x16_bf16 a[0:15], a[248:251], v[208:211], a[0:15]
    v_mfma_f32_32x32x16_bf16 a[64:79], a[248:251], v[216:219], a[64:79]
    v_mfma_f32_32x32x16_bf16 a[128:143], a[248:251], v[224:227], a[128:143]
    ds_read_b64_tr_b16 a[248:249], v244 offset:61440
    ds_read_b64_tr_b16 a[250:251], v245 offset:62464
    s_waitcnt lgkmcnt(6)
    v_mfma_f32_32x32x16_bf16 a[0:15], a[252:255], v[212:215], a[0:15]
    v_mfma_f32_32x32x16_bf16 a[64:79], a[252:255], v[220:223], a[64:79]
    v_mfma_f32_32x32x16_bf16 a[128:143], a[252:255], v[228:231], a[128:143]
    ds_read_b64_tr_b16 a[252:253], v244 offset:63488
    ds_read_b64_tr_b16 a[254:255], v245 offset:64512
    s_waitcnt lgkmcnt(6)
    v_mfma_f32_32x32x16_bf16 a[16:31], v[232:235], v[208:211], a[16:31]
    v_mfma_f32_32x32x16_bf16 a[80:95], v[232:235], v[216:219], a[80:95]
    v_mfma_f32_32x32x16_bf16 a[144:159], v[232:235], v[224:227], a[144:159]
    ds_read_b64_tr_b16 v[232:233], v246 offset:61440
    ds_read_b64_tr_b16 v[234:235], v247 offset:62464
    s_waitcnt lgkmcnt(6)
    v_mfma_f32_32x32x16_bf16 a[16:31], v[248:251], v[212:215], a[16:31]
    v_mfma_f32_32x32x16_bf16 a[80:95], v[248:251], v[220:223], a[80:95]
    v_mfma_f32_32x32x16_bf16 a[144:159], v[248:251], v[228:231], a[144:159]
    ds_read_b64_tr_b16 v[248:249], v246 offset:63488
    ds_read_b64_tr_b16 v[250:251], v247 offset:64512
    s_waitcnt lgkmcnt(6)
    v_mfma_f32_32x32x16_bf16 a[32:47], a[248:251], v[208:211], a[32:47]
    v_mfma_f32_32x32x16_bf16 a[96:111], a[248:251], v[216:219], a[96:111]
    v_mfma_f32_32x32x16_bf16 v[0:15], a[248:251], v[224:227], v[0:15]
    s_waitcnt lgkmcnt(4)
    v_mfma_f32_32x32x16_bf16 a[32:47], a[252:255], v[212:215], a[32:47]
    v_mfma_f32_32x32x16_bf16 a[96:111], a[252:255], v[220:223], a[96:111]
    v_mfma_f32_32x32x16_bf16 v[0:15], a[252:255], v[228:231], v[0:15]
    s_waitcnt lgkmcnt(2)
    v_mfma_f32_32x32x16_bf16 a[48:63], v[232:235], v[208:211], a[48:63]
    v_mfma_f32_32x32x16_bf16 a[112:127], v[232:235], v[216:219], a[112:127]
    v_mfma_f32_32x32x16_bf16 v[16:31], v[232:235], v[224:227], v[16:31]
    s_waitcnt lgkmcnt(0)
    v_mfma_f32_32x32x16_bf16 a[48:63], v[248:251], v[212:215], a[48:63]
    v_mfma_f32_32x32x16_bf16 a[112:127], v[248:251], v[220:223], a[112:127]
    v_mfma_f32_32x32x16_bf16 v[16:31], v[248:251], v[228:231], v[16:31]
    v_add_u32 v244, 65536, v244
    v_add_u32 v245, 65536, v245
    v_add_u32 v246, 65536, v246
    v_add_u32 v247, 65536, v247
    ds_read_b64_tr_b16 a[248:249], v244
    ds_read_b64_tr_b16 a[250:251], v245 offset:1024
    ds_read_b64_tr_b16 a[252:253], v244 offset:2048
    ds_read_b64_tr_b16 a[254:255], v245 offset:3072
    v_mbcnt_lo_u32_b32 v248, -1, 0
    v_mbcnt_hi_u32_b32 v248, -1, v248
    v_bfe_u32 v250, v248, 2, 2
    v_bfe_u32 v249, v248, 1, 1
    v_lshl_add_u32 v250, v249, 2, v250
    v_lshlrev_b32 v250, 4, v250
    v_and_b32 v249, 31, v248
    v_lshl_add_u32 v250, v249, 7, v250
    v_lshl_add_u32 v251, v248, 4, s30
    v_lshrrev_b32 v248, 5, v248
    v_lshl_add_u32 v250, v248, 3, v250
    v_add_u32 v250, s30, v250
    v_subrev_u32 v243, s30, v251
    v_lshlrev_b32 v243, 2, v243
    v_accvgpr_read_b32 v232, a0
    v_accvgpr_read_b32 v233, a1
    v_accvgpr_read_b32 v234, a2
    v_accvgpr_read_b32 v235, a3
    v_mul_f32 v232, v238, v232
    v_mul_f32 v233, v238, v233
    v_mul_f32 v234, v238, v234
    v_mul_f32 v235, v238, v235
    v_cvt_pk_bf16_f32 v248, v232, v233
    v_cvt_pk_bf16_f32 v249, v234, v235
    ds_write_b64 v250, v[248:249]
    v_accvgpr_read_b32 v232, a4
    v_accvgpr_read_b32 v233, a5
    v_accvgpr_read_b32 v234, a6
    v_accvgpr_read_b32 v235, a7
    v_mul_f32 v232, v238, v232
    v_mul_f32 v233, v238, v233
    v_mul_f32 v234, v238, v234
    v_mul_f32 v235, v238, v235
    v_xor_b32 v242, 16, v250
    v_cvt_pk_bf16_f32 v248, v232, v233
    v_cvt_pk_bf16_f32 v249, v234, v235
    ds_write_b64 v242, v[248:249]
    v_accvgpr_read_b32 v232, a8
    v_accvgpr_read_b32 v233, a9
    v_accvgpr_read_b32 v234, a10
    v_accvgpr_read_b32 v235, a11
    v_mul_f32 v232, v238, v232
    v_mul_f32 v233, v238, v233
    v_mul_f32 v234, v238, v234
    v_mul_f32 v235, v238, v235
    v_xor_b32 v242, 32, v250
    v_cvt_pk_bf16_f32 v248, v232, v233
    v_cvt_pk_bf16_f32 v249, v234, v235
    ds_write_b64 v242, v[248:249]
    v_accvgpr_read_b32 v232, a12
    v_accvgpr_read_b32 v233, a13
    v_accvgpr_read_b32 v234, a14
    v_accvgpr_read_b32 v235, a15
    v_mul_f32 v232, v238, v232
    v_mul_f32 v233, v238, v233
    v_mul_f32 v234, v238, v234
    v_mul_f32 v235, v238, v235
    v_xor_b32 v242, 48, v250
    v_cvt_pk_bf16_f32 v248, v232, v233
    v_cvt_pk_bf16_f32 v249, v234, v235
    ds_write_b64 v242, v[248:249]
    v_accvgpr_read_b32 v232, a64
    v_accvgpr_read_b32 v233, a65
    v_accvgpr_read_b32 v234, a66
    v_accvgpr_read_b32 v235, a67
    v_mul_f32 v232, v239, v232
    v_mul_f32 v233, v239, v233
    v_mul_f32 v234, v239, v234
    v_mul_f32 v235, v239, v235
    v_cvt_pk_bf16_f32 v248, v232, v233
    v_cvt_pk_bf16_f32 v249, v234, v235
    ds_write_b64 v250, v[248:249] offset:16384
    v_accvgpr_read_b32 v232, a68
    v_accvgpr_read_b32 v233, a69
    v_accvgpr_read_b32 v234, a70
    v_accvgpr_read_b32 v235, a71
    v_mul_f32 v232, v239, v232
    v_mul_f32 v233, v239, v233
    v_mul_f32 v234, v239, v234
    v_mul_f32 v235, v239, v235
    v_xor_b32 v242, 16, v250
    v_cvt_pk_bf16_f32 v248, v232, v233
    v_cvt_pk_bf16_f32 v249, v234, v235
    ds_write_b64 v242, v[248:249] offset:16384
    v_accvgpr_read_b32 v232, a72
    v_accvgpr_read_b32 v233, a73
    v_accvgpr_read_b32 v234, a74
    v_accvgpr_read_b32 v235, a75
    v_mul_f32 v232, v239, v232
    v_mul_f32 v233, v239, v233
    v_mul_f32 v234, v239, v234
    v_mul_f32 v235, v239, v235
    v_xor_b32 v242, 32, v250
    v_cvt_pk_bf16_f32 v248, v232, v233
    v_cvt_pk_bf16_f32 v249, v234, v235
    ds_write_b64 v242, v[248:249] offset:16384
    v_accvgpr_read_b32 v232, a76
    v_accvgpr_read_b32 v233, a77
    v_accvgpr_read_b32 v234, a78
    v_accvgpr_read_b32 v235, a79
    v_mul_f32 v232, v239, v232
    v_mul_f32 v233, v239, v233
    v_mul_f32 v234, v239, v234
    v_mul_f32 v235, v239, v235
    v_xor_b32 v242, 48, v250
    v_cvt_pk_bf16_f32 v248, v232, v233
    v_cvt_pk_bf16_f32 v249, v234, v235
    ds_write_b64 v242, v[248:249] offset:16384
    v_accvgpr_read_b32 v232, a128
    v_accvgpr_read_b32 v233, a129
    v_accvgpr_read_b32 v234, a130
    v_accvgpr_read_b32 v235, a131
    v_mul_f32 v232, v240, v232
    v_mul_f32 v233, v240, v233
    v_mul_f32 v234, v240, v234
    v_mul_f32 v235, v240, v235
    v_cvt_pk_bf16_f32 v248, v232, v233
    v_cvt_pk_bf16_f32 v249, v234, v235
    ds_write_b64 v250, v[248:249] offset:32768
    v_accvgpr_read_b32 v232, a132
    v_accvgpr_read_b32 v233, a133
    v_accvgpr_read_b32 v234, a134
    v_accvgpr_read_b32 v235, a135
    v_mul_f32 v232, v240, v232
    v_mul_f32 v233, v240, v233
    v_mul_f32 v234, v240, v234
    v_mul_f32 v235, v240, v235
    v_xor_b32 v242, 16, v250
    v_cvt_pk_bf16_f32 v248, v232, v233
    v_cvt_pk_bf16_f32 v249, v234, v235
    ds_write_b64 v242, v[248:249] offset:32768
    v_accvgpr_read_b32 v232, a136
    v_accvgpr_read_b32 v233, a137
    v_accvgpr_read_b32 v234, a138
    v_accvgpr_read_b32 v235, a139
    v_mul_f32 v232, v240, v232
    v_mul_f32 v233, v240, v233
    v_mul_f32 v234, v240, v234
    v_mul_f32 v235, v240, v235
    v_xor_b32 v242, 32, v250
    v_cvt_pk_bf16_f32 v248, v232, v233
    v_cvt_pk_bf16_f32 v249, v234, v235
    ds_write_b64 v242, v[248:249] offset:32768
    v_accvgpr_read_b32 v232, a140
    v_accvgpr_read_b32 v233, a141
    v_accvgpr_read_b32 v234, a142
    v_accvgpr_read_b32 v235, a143
    v_mul_f32 v232, v240, v232
    v_mul_f32 v233, v240, v233
    v_mul_f32 v234, v240, v234
    v_mul_f32 v235, v240, v235
    v_xor_b32 v242, 48, v250
    v_cvt_pk_bf16_f32 v248, v232, v233
    v_cvt_pk_bf16_f32 v249, v234, v235
    s_waitcnt lgkmcnt(13)
    ds_write_b64 v242, v[248:249] offset:32768
    v_mfma_f32_32x32x16_bf16 a[0:15], a[248:251], a[160:163], 0
    v_accvgpr_read_b32 v232, a16
    v_accvgpr_read_b32 v233, a17
    v_accvgpr_read_b32 v234, a18
    v_accvgpr_read_b32 v235, a19
    v_mul_f32 v232, v238, v232
    v_mfma_f32_32x32x16_bf16 a[64:79], a[248:251], v[32:35], 0
    v_mul_f32 v233, v238, v233
    v_mul_f32 v234, v238, v234
    v_mul_f32 v235, v238, v235
    v_xor_b32 v242, 64, v250
    v_cvt_pk_bf16_f32 v248, v232, v233
    v_cvt_pk_bf16_f32 v249, v234, v235
    v_mfma_f32_32x32x16_bf16 a[128:143], a[248:251], v[40:43], 0
    ds_read_b64_tr_b16 a[248:249], v244 offset:4096
    s_waitcnt lgkmcnt(13)
    ds_read_b64_tr_b16 a[250:251], v245 offset:5120
    ds_write_b64 v242, v[248:249]
    v_accvgpr_read_b32 v232, a20
    v_mfma_f32_32x32x16_bf16 a[0:15], a[252:255], a[164:167], a[0:15]
    v_accvgpr_read_b32 v233, a21
    v_accvgpr_read_b32 v234, a22
    v_accvgpr_read_b32 v235, a23
    v_mul_f32 v232, v238, v232
    v_mul_f32 v233, v238, v233
    v_mfma_f32_32x32x16_bf16 a[64:79], a[252:255], v[36:39], a[64:79]
    v_mul_f32 v234, v238, v234
    v_mul_f32 v235, v238, v235
    v_xor_b32 v242, 80, v250
    v_cvt_pk_bf16_f32 v248, v232, v233
    v_cvt_pk_bf16_f32 v249, v234, v235
    v_mfma_f32_32x32x16_bf16 a[128:143], a[252:255], v[44:47], a[128:143]
    s_waitcnt lgkmcnt(13)
    ds_read_b64_tr_b16 a[252:253], v244 offset:6144
    ds_read_b64_tr_b16 a[254:255], v245 offset:7168
    s_waitcnt lgkmcnt(13)
    ds_write_b64 v242, v[248:249]
    s_waitcnt lgkmcnt(4)
    v_mfma_f32_32x32x16_bf16 a[0:15], a[248:251], a[168:171], a[0:15]
    s_waitcnt vmcnt(1)
    s_waitcnt vmcnt(0)
    s_barrier
    v_accvgpr_read_b32 v232, a24
    v_accvgpr_read_b32 v233, a25
    v_mfma_f32_32x32x16_bf16 a[64:79], a[248:251], v[48:51], a[64:79]
    v_accvgpr_read_b32 v234, a26
    v_accvgpr_read_b32 v235, a27
    v_mul_f32 v232, v238, v232
    v_mul_f32 v233, v238, v233
    v_mul_f32 v234, v238, v234
    v_mfma_f32_32x32x16_bf16 a[128:143], a[248:251], v[56:59], a[128:143]
    ds_read_b64_tr_b16 a[248:249], v244 offset:8192
    ds_read_b64_tr_b16 a[250:251], v245 offset:9216
    v_mul_f32 v235, v238, v235
    v_xor_b32 v242, 96, v250
    v_cvt_pk_bf16_f32 v248, v232, v233
    s_waitcnt lgkmcnt(3)
    v_mfma_f32_32x32x16_bf16 a[0:15], a[252:255], a[172:175], a[0:15]
    v_cvt_pk_bf16_f32 v249, v234, v235
    ds_write_b64 v242, v[248:249]
    v_accvgpr_read_b32 v232, a28
    v_accvgpr_read_b32 v233, a29
    v_accvgpr_read_b32 v234, a30
    v_mfma_f32_32x32x16_bf16 a[64:79], a[252:255], v[52:55], a[64:79]
    v_accvgpr_read_b32 v235, a31
    v_mul_f32 v232, v238, v232
    v_mul_f32 v233, v238, v233
    v_mul_f32 v234, v238, v234
    v_mul_f32 v235, v238, v235
    v_xor_b32 v242, 112, v250
    v_mfma_f32_32x32x16_bf16 a[128:143], a[252:255], v[60:63], a[128:143]
    ds_read_b64_tr_b16 a[252:253], v244 offset:10240
    ds_read_b64_tr_b16 a[254:255], v245 offset:11264
    v_cvt_pk_bf16_f32 v248, v232, v233
    v_cvt_pk_bf16_f32 v249, v234, v235
    ds_write_b64 v242, v[248:249]
    s_waitcnt lgkmcnt(4)
    v_mfma_f32_32x32x16_bf16 a[0:15], a[248:251], a[176:179], a[0:15]
    v_accvgpr_read_b32 v232, a80
    v_accvgpr_read_b32 v233, a81
    v_accvgpr_read_b32 v234, a82
    v_accvgpr_read_b32 v235, a83
    v_mul_f32 v232, v239, v232
    v_mfma_f32_32x32x16_bf16 a[64:79], a[248:251], v[64:67], a[64:79]
    v_mul_f32 v233, v239, v233
    v_mul_f32 v234, v239, v234
    v_mul_f32 v235, v239, v235
    v_xor_b32 v242, 64, v250
    v_cvt_pk_bf16_f32 v248, v232, v233
    v_cvt_pk_bf16_f32 v249, v234, v235
    v_mfma_f32_32x32x16_bf16 a[128:143], a[248:251], v[72:75], a[128:143]
    ds_read_b64_tr_b16 a[248:249], v244 offset:12288
    ds_read_b64_tr_b16 a[250:251], v245 offset:13312
    ds_write_b64 v242, v[248:249] offset:16384
    v_accvgpr_read_b32 v232, a84
    v_accvgpr_read_b32 v233, a85
    s_waitcnt lgkmcnt(4)
    v_mfma_f32_32x32x16_bf16 a[0:15], a[252:255], a[180:183], a[0:15]
    v_accvgpr_read_b32 v234, a86
    v_accvgpr_read_b32 v235, a87
    v_mul_f32 v232, v239, v232
    v_mul_f32 v233, v239, v233
    v_mul_f32 v234, v239, v234
    v_mfma_f32_32x32x16_bf16 a[64:79], a[252:255], v[68:71], a[64:79]
    v_mul_f32 v235, v239, v235
    v_xor_b32 v242, 80, v250
    v_cvt_pk_bf16_f32 v248, v232, v233
    v_cvt_pk_bf16_f32 v249, v234, v235
    ds_write_b64 v242, v[248:249] offset:16384
    v_mfma_f32_32x32x16_bf16 a[128:143], a[252:255], v[76:79], a[128:143]
    ds_read_b64_tr_b16 a[252:253], v244 offset:14336
    ds_read_b64_tr_b16 a[254:255], v245 offset:15360
    v_accvgpr_read_b32 v232, a88
    v_accvgpr_read_b32 v233, a89
    v_accvgpr_read_b32 v234, a90
    s_waitcnt lgkmcnt(4)
    v_mfma_f32_32x32x16_bf16 a[0:15], a[248:251], a[184:187], a[0:15]
    v_accvgpr_read_b32 v235, a91
    v_mul_f32 v232, v239, v232
    v_mul_f32 v233, v239, v233
    v_mul_f32 v234, v239, v234
    v_mul_f32 v235, v239, v235
    v_xor_b32 v242, 96, v250
    v_mfma_f32_32x32x16_bf16 a[64:79], a[248:251], v[80:83], a[64:79]
    v_cvt_pk_bf16_f32 v248, v232, v233
    v_cvt_pk_bf16_f32 v249, v234, v235
    ds_write_b64 v242, v[248:249] offset:16384
    v_accvgpr_read_b32 v232, a92
    v_accvgpr_read_b32 v233, a93
    v_mfma_f32_32x32x16_bf16 a[128:143], a[248:251], v[88:91], a[128:143]
    ds_read_b64_tr_b16 a[248:249], v244 offset:16384
    ds_read_b64_tr_b16 a[250:251], v245 offset:17408
    v_accvgpr_read_b32 v234, a94
    v_accvgpr_read_b32 v235, a95
    v_mul_f32 v232, v239, v232
    s_waitcnt lgkmcnt(3)
    v_mfma_f32_32x32x16_bf16 a[0:15], a[252:255], a[188:191], a[0:15]
    v_mul_f32 v233, v239, v233
    v_mul_f32 v234, v239, v234
    v_mul_f32 v235, v239, v235
    v_xor_b32 v242, 112, v250
    v_cvt_pk_bf16_f32 v248, v232, v233
    v_cvt_pk_bf16_f32 v249, v234, v235
    v_mfma_f32_32x32x16_bf16 a[64:79], a[252:255], v[84:87], a[64:79]
    ds_write_b64 v242, v[248:249] offset:16384
    v_accvgpr_read_b32 v232, a144
    v_accvgpr_read_b32 v233, a145
    v_accvgpr_read_b32 v234, a146
    v_accvgpr_read_b32 v235, a147
    v_mfma_f32_32x32x16_bf16 a[128:143], a[252:255], v[92:95], a[128:143]
    ds_read_b64_tr_b16 a[252:253], v244 offset:18432
    ds_read_b64_tr_b16 a[254:255], v245 offset:19456
    v_mul_f32 v232, v240, v232
    v_mul_f32 v233, v240, v233
    v_mul_f32 v234, v240, v234
    s_waitcnt lgkmcnt(3)
    v_mfma_f32_32x32x16_bf16 a[0:15], a[248:251], a[192:195], a[0:15]
    v_mul_f32 v235, v240, v235
    v_xor_b32 v242, 64, v250
    v_cvt_pk_bf16_f32 v248, v232, v233
    v_cvt_pk_bf16_f32 v249, v234, v235
    ds_write_b64 v242, v[248:249] offset:32768
    v_mfma_f32_32x32x16_bf16 a[64:79], a[248:251], v[96:99], a[64:79]
    v_accvgpr_read_b32 v232, a148
    v_accvgpr_read_b32 v233, a149
    v_accvgpr_read_b32 v234, a150
    v_accvgpr_read_b32 v235, a151
    v_mul_f32 v232, v240, v232
    v_mfma_f32_32x32x16_bf16 a[128:143], a[248:251], v[104:107], a[128:143]
    ds_read_b64_tr_b16 a[248:249], v244 offset:20480
    ds_read_b64_tr_b16 a[250:251], v245 offset:21504
    v_mul_f32 v233, v240, v233
    v_mul_f32 v234, v240, v234
    v_mul_f32 v235, v240, v235
    s_waitcnt lgkmcnt(3)
    v_mfma_f32_32x32x16_bf16 a[0:15], a[252:255], a[196:199], a[0:15]
    v_xor_b32 v242, 80, v250
    v_cvt_pk_bf16_f32 v248, v232, v233
    v_cvt_pk_bf16_f32 v249, v234, v235
    ds_write_b64 v242, v[248:249] offset:32768
    v_accvgpr_read_b32 v232, a152
    v_mfma_f32_32x32x16_bf16 a[64:79], a[252:255], v[100:103], a[64:79]
    v_accvgpr_read_b32 v233, a153
    v_accvgpr_read_b32 v234, a154
    v_accvgpr_read_b32 v235, a155
    v_mul_f32 v232, v240, v232
    v_mul_f32 v233, v240, v233
    v_mfma_f32_32x32x16_bf16 a[128:143], a[252:255], v[108:111], a[128:143]
    ds_read_b64_tr_b16 a[252:253], v244 offset:22528
    ds_read_b64_tr_b16 a[254:255], v245 offset:23552
    v_mul_f32 v234, v240, v234
    v_mul_f32 v235, v240, v235
    v_xor_b32 v242, 96, v250
    s_waitcnt lgkmcnt(3)
    v_mfma_f32_32x32x16_bf16 a[0:15], a[248:251], a[200:203], a[0:15]
    v_cvt_pk_bf16_f32 v248, v232, v233
    v_cvt_pk_bf16_f32 v249, v234, v235
    ds_write_b64 v242, v[248:249] offset:32768
    v_accvgpr_read_b32 v232, a156
    v_accvgpr_read_b32 v233, a157
    v_mfma_f32_32x32x16_bf16 a[64:79], a[248:251], v[112:115], a[64:79]
    v_accvgpr_read_b32 v234, a158
    v_accvgpr_read_b32 v235, a159
    v_mul_f32 v232, v240, v232
    v_mul_f32 v233, v240, v233
    v_mul_f32 v234, v240, v234
    v_mfma_f32_32x32x16_bf16 a[128:143], a[248:251], v[120:123], a[128:143]
    ds_read_b64_tr_b16 a[248:249], v244 offset:24576
    ds_read_b64_tr_b16 a[250:251], v245 offset:25600
    v_mul_f32 v235, v240, v235
    v_xor_b32 v242, 112, v250
    v_cvt_pk_bf16_f32 v248, v232, v233
    s_waitcnt lgkmcnt(3)
    v_mfma_f32_32x32x16_bf16 a[0:15], a[252:255], a[204:207], a[0:15]
    v_cvt_pk_bf16_f32 v249, v234, v235
    ds_write_b64 v242, v[248:249] offset:32768
    v_accvgpr_read_b32 v232, a32
    v_accvgpr_read_b32 v233, a33
    v_accvgpr_read_b32 v234, a34
    v_mfma_f32_32x32x16_bf16 a[64:79], a[252:255], v[116:119], a[64:79]
    v_accvgpr_read_b32 v235, a35
    v_mul_f32 v232, v238, v232
    v_mul_f32 v233, v238, v233
    v_mul_f32 v234, v238, v234
    v_mul_f32 v235, v238, v235
    v_cvt_pk_bf16_f32 v248, v232, v233
    v_mfma_f32_32x32x16_bf16 a[128:143], a[252:255], v[124:127], a[128:143]
    ds_read_b64_tr_b16 a[252:253], v244 offset:26624
    ds_read_b64_tr_b16 a[254:255], v245 offset:27648
    v_cvt_pk_bf16_f32 v249, v234, v235
    ds_write_b64 v250, v[248:249] offset:49152
    v_accvgpr_read_b32 v232, a36
    s_waitcnt lgkmcnt(4)
    v_mfma_f32_32x32x16_bf16 a[0:15], a[248:251], a[208:211], a[0:15]
    v_accvgpr_read_b32 v233, a37
    v_accvgpr_read_b32 v234, a38
    v_accvgpr_read_b32 v235, a39
    v_mul_f32 v232, v238, v232
    v_mul_f32 v233, v238, v233
    v_mfma_f32_32x32x16_bf16 a[64:79], a[248:251], v[128:131], a[64:79]
    v_mul_f32 v234, v238, v234
    v_mul_f32 v235, v238, v235
    v_xor_b32 v242, 16, v250
    v_cvt_pk_bf16_f32 v248, v232, v233
    v_cvt_pk_bf16_f32 v249, v234, v235
    v_mfma_f32_32x32x16_bf16 a[128:143], a[248:251], v[136:139], a[128:143]
    ds_read_b64_tr_b16 a[248:249], v244 offset:28672
    ds_read_b64_tr_b16 a[250:251], v245 offset:29696
    ds_write_b64 v242, v[248:249] offset:49152
    v_accvgpr_read_b32 v232, a40
    v_accvgpr_read_b32 v233, a41
    s_waitcnt lgkmcnt(4)
    v_mfma_f32_32x32x16_bf16 a[0:15], a[252:255], a[212:215], a[0:15]
    v_accvgpr_read_b32 v234, a42
    v_accvgpr_read_b32 v235, a43
    v_mul_f32 v232, v238, v232
    v_mul_f32 v233, v238, v233
    v_mul_f32 v234, v238, v234
    v_mfma_f32_32x32x16_bf16 a[64:79], a[252:255], v[132:135], a[64:79]
    v_mul_f32 v235, v238, v235
    v_xor_b32 v242, 32, v250
    v_cvt_pk_bf16_f32 v248, v232, v233
    v_cvt_pk_bf16_f32 v249, v234, v235
    ds_write_b64 v242, v[248:249] offset:49152
    v_mfma_f32_32x32x16_bf16 a[128:143], a[252:255], v[140:143], a[128:143]
    ds_read_b64_tr_b16 a[252:253], v244 offset:30720
    ds_read_b64_tr_b16 a[254:255], v245 offset:31744
    v_accvgpr_read_b32 v232, a44
    v_accvgpr_read_b32 v233, a45
    v_accvgpr_read_b32 v234, a46
    s_waitcnt lgkmcnt(4)
    v_mfma_f32_32x32x16_bf16 a[0:15], a[248:251], a[216:219], a[0:15]
    v_accvgpr_read_b32 v235, a47
    v_mul_f32 v232, v238, v232
    v_mul_f32 v233, v238, v233
    v_mul_f32 v234, v238, v234
    v_mul_f32 v235, v238, v235
    v_xor_b32 v242, 48, v250
    v_mfma_f32_32x32x16_bf16 a[64:79], a[248:251], v[144:147], a[64:79]
    v_cvt_pk_bf16_f32 v248, v232, v233
    v_cvt_pk_bf16_f32 v249, v234, v235
    ds_write_b64 v242, v[248:249] offset:49152
    v_accvgpr_read_b32 v232, a48
    v_accvgpr_read_b32 v233, a49
    v_mfma_f32_32x32x16_bf16 a[128:143], a[248:251], v[152:155], a[128:143]
    ds_read_b64_tr_b16 a[248:249], v244 offset:32768
    ds_read_b64_tr_b16 a[250:251], v245 offset:33792
    v_accvgpr_read_b32 v234, a50
    v_accvgpr_read_b32 v235, a51
    v_mul_f32 v232, v238, v232
    s_waitcnt lgkmcnt(3)
    v_mfma_f32_32x32x16_bf16 a[0:15], a[252:255], a[220:223], a[0:15]
    v_mul_f32 v233, v238, v233
    v_mul_f32 v234, v238, v234
    v_mul_f32 v235, v238, v235
    v_xor_b32 v242, 64, v250
    v_cvt_pk_bf16_f32 v248, v232, v233
    v_cvt_pk_bf16_f32 v249, v234, v235
    v_mfma_f32_32x32x16_bf16 a[64:79], a[252:255], v[148:151], a[64:79]
    ds_write_b64 v242, v[248:249] offset:49152
    v_accvgpr_read_b32 v232, a52
    v_accvgpr_read_b32 v233, a53
    v_accvgpr_read_b32 v234, a54
    v_accvgpr_read_b32 v235, a55
    v_mfma_f32_32x32x16_bf16 a[128:143], a[252:255], v[156:159], a[128:143]
    ds_read_b64_tr_b16 a[252:253], v244 offset:34816
    ds_read_b64_tr_b16 a[254:255], v245 offset:35840
    v_mul_f32 v232, v238, v232
    v_mul_f32 v233, v238, v233
    v_mul_f32 v234, v238, v234
    s_waitcnt lgkmcnt(3)
    v_mfma_f32_32x32x16_bf16 a[0:15], a[248:251], a[224:227], a[0:15]
    v_mul_f32 v235, v238, v235
    v_xor_b32 v242, 80, v250
    v_cvt_pk_bf16_f32 v248, v232, v233
    v_cvt_pk_bf16_f32 v249, v234, v235
    ds_write_b64 v242, v[248:249] offset:49152
    v_mfma_f32_32x32x16_bf16 a[64:79], a[248:251], v[160:163], a[64:79]
    v_accvgpr_read_b32 v232, a56
    v_accvgpr_read_b32 v233, a57
    v_accvgpr_read_b32 v234, a58
    v_accvgpr_read_b32 v235, a59
    v_mul_f32 v232, v238, v232
    v_mfma_f32_32x32x16_bf16 a[128:143], a[248:251], v[168:171], a[128:143]
    ds_read_b64_tr_b16 a[248:249], v244 offset:36864
    ds_read_b64_tr_b16 a[250:251], v245 offset:37888
    v_mul_f32 v233, v238, v233
    v_mul_f32 v234, v238, v234
    v_mul_f32 v235, v238, v235
    s_waitcnt lgkmcnt(3)
    v_mfma_f32_32x32x16_bf16 a[0:15], a[252:255], a[228:231], a[0:15]
    v_xor_b32 v242, 96, v250
    v_cvt_pk_bf16_f32 v248, v232, v233
    v_cvt_pk_bf16_f32 v249, v234, v235
    ds_write_b64 v242, v[248:249] offset:49152
    v_accvgpr_read_b32 v232, a60
    v_mfma_f32_32x32x16_bf16 a[64:79], a[252:255], v[164:167], a[64:79]
    v_accvgpr_read_b32 v233, a61
    v_accvgpr_read_b32 v234, a62
    v_accvgpr_read_b32 v235, a63
    v_mul_f32 v232, v238, v232
    v_mul_f32 v233, v238, v233
    v_mfma_f32_32x32x16_bf16 a[128:143], a[252:255], v[172:175], a[128:143]
    ds_read_b64_tr_b16 a[252:253], v244 offset:38912
    ds_read_b64_tr_b16 a[254:255], v245 offset:39936
    v_mul_f32 v234, v238, v234
    v_mul_f32 v235, v238, v235
    v_xor_b32 v242, 112, v250
    s_waitcnt lgkmcnt(3)
    v_mfma_f32_32x32x16_bf16 a[0:15], a[248:251], a[232:235], a[0:15]
    v_cvt_pk_bf16_f32 v248, v232, v233
    v_cvt_pk_bf16_f32 v249, v234, v235
    ds_write_b64 v242, v[248:249] offset:49152
    ds_read_b128 a[32:35], v251
    ds_read_b128 a[36:39], v251 offset:49152
    v_mfma_f32_32x32x16_bf16 a[64:79], a[248:251], v[176:179], a[64:79]
    ds_read_b128 a[40:43], v251 offset:1024
    s_add_u32 s35, s29, 69632
    s_waitcnt lgkmcnt(2)
    buffer_store_dwordx4 a[32:35], v252, s[20:23], s35 offen sc1
    v_mfma_f32_32x32x16_bf16 a[128:143], a[248:251], v[184:187], a[128:143]
    ds_read_b64_tr_b16 a[248:249], v244 offset:40960
    ds_read_b64_tr_b16 a[250:251], v245 offset:41984
    ds_read_b128 a[44:47], v251 offset:50176
    s_add_u32 s35, s29, 69632
    s_waitcnt lgkmcnt(4)
    buffer_store_dwordx4 a[36:39], v252, s[20:23], s35 offen offset:128 sc1
    v_mfma_f32_32x32x16_bf16 a[0:15], a[252:255], a[236:239], a[0:15]
    ds_read_b128 a[32:35], v251 offset:2048
    s_add_u32 s35, s29, 73728
    s_waitcnt lgkmcnt(4)
    buffer_store_dwordx4 a[40:43], v253, s[20:23], s35 offen sc1
    v_mfma_f32_32x32x16_bf16 a[64:79], a[252:255], v[180:183], a[64:79]
    ds_read_b128 a[36:39], v251 offset:51200
    s_add_u32 s35, s29, 73728
    s_waitcnt lgkmcnt(2)
    buffer_store_dwordx4 a[44:47], v253, s[20:23], s35 offen offset:128 sc1
    v_mfma_f32_32x32x16_bf16 a[128:143], a[252:255], v[188:191], a[128:143]
    ds_read_b64_tr_b16 a[252:253], v244 offset:43008
    ds_read_b64_tr_b16 a[254:255], v245 offset:44032
    ds_read_b128 a[40:43], v251 offset:3072
    s_add_u32 s35, s29, 77824
    s_waitcnt lgkmcnt(4)
    buffer_store_dwordx4 a[32:35], v252, s[20:23], s35 offen sc1
    v_mfma_f32_32x32x16_bf16 a[0:15], a[248:251], a[240:243], a[0:15]
    ds_read_b128 a[44:47], v251 offset:52224
    s_add_u32 s35, s29, 77824
    s_waitcnt lgkmcnt(4)
    buffer_store_dwordx4 a[36:39], v252, s[20:23], s35 offen offset:128 sc1
    v_mfma_f32_32x32x16_bf16 a[64:79], a[248:251], v[192:195], a[64:79]
    s_add_u32 s35, s29, 81920
    s_waitcnt lgkmcnt(1)
    buffer_store_dwordx4 a[40:43], v253, s[20:23], s35 offen sc1
    s_add_u32 s35, s29, 81920
    s_waitcnt lgkmcnt(0)
    buffer_store_dwordx4 a[44:47], v253, s[20:23], s35 offen offset:128 sc1
    v_mfma_f32_32x32x16_bf16 a[128:143], a[248:251], v[200:203], a[128:143]
    ds_read_b64_tr_b16 a[248:249], v244 offset:45056
    ds_read_b64_tr_b16 a[250:251], v245 offset:46080
    v_accvgpr_read_b32 v232, a96
    v_accvgpr_read_b32 v233, a97
    v_accvgpr_read_b32 v234, a98
    v_mfma_f32_32x32x16_bf16 a[0:15], a[252:255], a[244:247], a[0:15]
    v_accvgpr_read_b32 v235, a99
    v_mul_f32 v232, v239, v232
    v_mul_f32 v233, v239, v233
    v_mul_f32 v234, v239, v234
    v_mul_f32 v235, v239, v235
    v_cvt_pk_bf16_f32 v248, v232, v233
    v_mfma_f32_32x32x16_bf16 a[64:79], a[252:255], v[196:199], a[64:79]
    v_cvt_pk_bf16_f32 v249, v234, v235
    ds_write_b64 v250, v[248:249] offset:49152
    v_accvgpr_read_b32 v232, a100
    v_accvgpr_read_b32 v233, a101
    v_accvgpr_read_b32 v234, a102
    v_mfma_f32_32x32x16_bf16 a[128:143], a[252:255], v[204:207], a[128:143]
    ds_read_b64_tr_b16 a[252:253], v244 offset:47104
    ds_read_b64_tr_b16 a[254:255], v245 offset:48128
    v_accvgpr_read_b32 v235, a103
    v_mul_f32 v232, v239, v232
    v_mul_f32 v233, v239, v233
    s_waitcnt lgkmcnt(3)
    v_mfma_f32_32x32x16_bf16 a[0:15], a[248:251], v[208:211], a[0:15]
    v_mul_f32 v234, v239, v234
    v_mul_f32 v235, v239, v235
    v_xor_b32 v242, 16, v250
    v_cvt_pk_bf16_f32 v248, v232, v233
    v_cvt_pk_bf16_f32 v249, v234, v235
    v_mfma_f32_32x32x16_bf16 a[64:79], a[248:251], v[216:219], a[64:79]
    ds_write_b64 v242, v[248:249] offset:49152
    v_accvgpr_read_b32 v232, a104
    v_accvgpr_read_b32 v233, a105
    v_accvgpr_read_b32 v234, a106
    v_accvgpr_read_b32 v235, a107
    v_mfma_f32_32x32x16_bf16 a[128:143], a[248:251], v[224:227], a[128:143]
    ds_read_b64_tr_b16 a[248:249], v246
    ds_read_b64_tr_b16 a[250:251], v247 offset:1024
    v_mul_f32 v232, v239, v232
    v_mul_f32 v233, v239, v233
    v_mul_f32 v234, v239, v234
    s_waitcnt lgkmcnt(3)
    v_mfma_f32_32x32x16_bf16 a[0:15], a[252:255], v[212:215], a[0:15]
    v_mul_f32 v235, v239, v235
    v_xor_b32 v242, 32, v250
    v_cvt_pk_bf16_f32 v248, v232, v233
    v_cvt_pk_bf16_f32 v249, v234, v235
    ds_write_b64 v242, v[248:249] offset:49152
    v_mfma_f32_32x32x16_bf16 a[64:79], a[252:255], v[220:223], a[64:79]
    v_accvgpr_read_b32 v232, a108
    v_accvgpr_read_b32 v233, a109
    v_accvgpr_read_b32 v234, a110
    v_accvgpr_read_b32 v235, a111
    v_mul_f32 v232, v239, v232
    v_mfma_f32_32x32x16_bf16 a[128:143], a[252:255], v[228:231], a[128:143]
    ds_read_b64_tr_b16 a[252:253], v246 offset:2048
    ds_read_b64_tr_b16 a[254:255], v247 offset:3072
    v_mul_f32 v233, v239, v233
    v_mul_f32 v234, v239, v234
    v_mul_f32 v235, v239, v235
    s_waitcnt lgkmcnt(3)
    v_mfma_f32_32x32x16_bf16 a[16:31], a[248:251], a[160:163], 0
    v_xor_b32 v242, 48, v250
    v_cvt_pk_bf16_f32 v248, v232, v233
    v_cvt_pk_bf16_f32 v249, v234, v235
    ds_write_b64 v242, v[248:249] offset:49152
    v_accvgpr_read_b32 v232, a112
    v_mfma_f32_32x32x16_bf16 a[80:95], a[248:251], v[32:35], 0
    v_accvgpr_read_b32 v233, a113
    v_accvgpr_read_b32 v234, a114
    v_accvgpr_read_b32 v235, a115
    v_mul_f32 v232, v239, v232
    v_mul_f32 v233, v239, v233
    v_mfma_f32_32x32x16_bf16 a[144:159], a[248:251], v[40:43], 0
    ds_read_b64_tr_b16 a[248:249], v246 offset:4096
    ds_read_b64_tr_b16 a[250:251], v247 offset:5120
    v_mul_f32 v234, v239, v234
    v_mul_f32 v235, v239, v235
    v_xor_b32 v242, 64, v250
    s_waitcnt lgkmcnt(3)
    v_mfma_f32_32x32x16_bf16 a[16:31], a[252:255], a[164:167], a[16:31]
    v_cvt_pk_bf16_f32 v248, v232, v233
    v_cvt_pk_bf16_f32 v249, v234, v235
    ds_write_b64 v242, v[248:249] offset:49152
    v_accvgpr_read_b32 v232, a116
    v_accvgpr_read_b32 v233, a117
    v_mfma_f32_32x32x16_bf16 a[80:95], a[252:255], v[36:39], a[80:95]
    v_accvgpr_read_b32 v234, a118
    v_accvgpr_read_b32 v235, a119
    v_mul_f32 v232, v239, v232
    v_mul_f32 v233, v239, v233
    v_mul_f32 v234, v239, v234
    v_mfma_f32_32x32x16_bf16 a[144:159], a[252:255], v[44:47], a[144:159]
    ds_read_b64_tr_b16 a[252:253], v246 offset:6144
    ds_read_b64_tr_b16 a[254:255], v247 offset:7168
    v_mul_f32 v235, v239, v235
    v_xor_b32 v242, 80, v250
    v_cvt_pk_bf16_f32 v248, v232, v233
    s_waitcnt lgkmcnt(3)
    v_mfma_f32_32x32x16_bf16 a[16:31], a[248:251], a[168:171], a[16:31]
    v_cvt_pk_bf16_f32 v249, v234, v235
    ds_write_b64 v242, v[248:249] offset:49152
    v_accvgpr_read_b32 v232, a120
    v_accvgpr_read_b32 v233, a121
    v_accvgpr_read_b32 v234, a122
    v_mfma_f32_32x32x16_bf16 a[80:95], a[248:251], v[48:51], a[80:95]
    v_accvgpr_read_b32 v235, a123
    v_mul_f32 v232, v239, v232
    v_mul_f32 v233, v239, v233
    v_mul_f32 v234, v239, v234
    v_mul_f32 v235, v239, v235
    v_xor_b32 v242, 96, v250
    v_mfma_f32_32x32x16_bf16 a[144:159], a[248:251], v[56:59], a[144:159]
    ds_read_b64_tr_b16 a[248:249], v246 offset:8192
    ds_read_b64_tr_b16 a[250:251], v247 offset:9216
    v_cvt_pk_bf16_f32 v248, v232, v233
    v_cvt_pk_bf16_f32 v249, v234, v235
    ds_write_b64 v242, v[248:249] offset:49152
    s_waitcnt lgkmcnt(4)
    v_mfma_f32_32x32x16_bf16 a[16:31], a[252:255], a[172:175], a[16:31]
    v_accvgpr_read_b32 v232, a124
    v_accvgpr_read_b32 v233, a125
    v_accvgpr_read_b32 v234, a126
    v_accvgpr_read_b32 v235, a127
    v_mul_f32 v232, v239, v232
    v_mfma_f32_32x32x16_bf16 a[80:95], a[252:255], v[52:55], a[80:95]
    v_mul_f32 v233, v239, v233
    v_mul_f32 v234, v239, v234
    v_mul_f32 v235, v239, v235
    v_xor_b32 v242, 112, v250
    v_cvt_pk_bf16_f32 v248, v232, v233
    v_cvt_pk_bf16_f32 v249, v234, v235
    v_mfma_f32_32x32x16_bf16 a[144:159], a[252:255], v[60:63], a[144:159]
    ds_read_b64_tr_b16 a[252:253], v246 offset:10240
    ds_read_b64_tr_b16 a[254:255], v247 offset:11264
    ds_write_b64 v242, v[248:249] offset:49152
    ds_read_b128 a[32:35], v251 offset:16384
    ds_read_b128 a[36:39], v251 offset:49152
    s_waitcnt lgkmcnt(6)
    v_mfma_f32_32x32x16_bf16 a[16:31], a[248:251], a[176:179], a[16:31]
    ds_read_b128 a[40:43], v251 offset:17408
    s_add_u32 s35, s29, 86016
    s_waitcnt lgkmcnt(2)
    buffer_store_dwordx4 a[32:35], v252, s[20:23], s35 offen sc1
    v_mfma_f32_32x32x16_bf16 a[80:95], a[248:251], v[64:67], a[80:95]
    ds_read_b128 a[44:47], v251 offset:50176
    s_add_u32 s35, s29, 86016
    s_waitcnt lgkmcnt(2)
    buffer_store_dwordx4 a[36:39], v252, s[20:23], s35 offen offset:128 sc1
    v_mfma_f32_32x32x16_bf16 a[144:159], a[248:251], v[72:75], a[144:159]
    ds_read_b64_tr_b16 a[248:249], v246 offset:12288
    ds_read_b64_tr_b16 a[250:251], v247 offset:13312
    ds_read_b128 a[32:35], v251 offset:18432
    s_add_u32 s35, s29, 90112
    s_waitcnt lgkmcnt(4)
    buffer_store_dwordx4 a[40:43], v253, s[20:23], s35 offen sc1
    v_mfma_f32_32x32x16_bf16 a[16:31], a[252:255], a[180:183], a[16:31]
    ds_read_b128 a[36:39], v251 offset:51200
    s_add_u32 s35, s29, 90112
    s_waitcnt lgkmcnt(4)
    buffer_store_dwordx4 a[44:47], v253, s[20:23], s35 offen offset:128 sc1
    v_mfma_f32_32x32x16_bf16 a[80:95], a[252:255], v[68:71], a[80:95]
    ds_read_b128 a[40:43], v251 offset:19456
    s_add_u32 s35, s29, 94208
    s_waitcnt lgkmcnt(2)
    buffer_store_dwordx4 a[32:35], v252, s[20:23], s35 offen sc1
    v_mfma_f32_32x32x16_bf16 a[144:159], a[252:255], v[76:79], a[144:159]
    ds_read_b64_tr_b16 a[252:253], v246 offset:14336
    ds_read_b64_tr_b16 a[254:255], v247 offset:15360
    ds_read_b128 a[44:47], v251 offset:52224
    s_add_u32 s35, s29, 94208
    s_waitcnt lgkmcnt(4)
    buffer_store_dwordx4 a[36:39], v252, s[20:23], s35 offen offset:128 sc1
    v_mfma_f32_32x32x16_bf16 a[16:31], a[248:251], a[184:187], a[16:31]
    s_add_u32 s35, s29, 98304
    s_waitcnt lgkmcnt(3)
    buffer_store_dwordx4 a[40:43], v253, s[20:23], s35 offen sc1
    s_add_u32 s35, s29, 98304
    s_waitcnt lgkmcnt(0)
    buffer_store_dwordx4 a[44:47], v253, s[20:23], s35 offen offset:128 sc1
    v_mfma_f32_32x32x16_bf16 a[80:95], a[248:251], v[80:83], a[80:95]
    v_mul_f32 v0, v240, v0
    v_mul_f32 v1, v240, v1
    v_mul_f32 v2, v240, v2
    v_mul_f32 v3, v240, v3
    v_cvt_pk_bf16_f32 v248, v0, v1
    v_cvt_pk_bf16_f32 v249, v2, v3
    v_mfma_f32_32x32x16_bf16 a[144:159], a[248:251], v[88:91], a[144:159]
    ds_read_b64_tr_b16 a[248:249], v246 offset:16384
    ds_read_b64_tr_b16 a[250:251], v247 offset:17408
    ds_write_b64 v250, v[248:249] offset:49152
    v_mul_f32 v4, v240, v4
    v_mul_f32 v5, v240, v5
    v_mfma_f32_32x32x16_bf16 a[16:31], a[252:255], a[188:191], a[16:31]
    v_mul_f32 v6, v240, v6
    v_mul_f32 v7, v240, v7
    v_xor_b32 v242, 16, v250
    v_cvt_pk_bf16_f32 v248, v4, v5
    v_cvt_pk_bf16_f32 v249, v6, v7
    v_mfma_f32_32x32x16_bf16 a[80:95], a[252:255], v[84:87], a[80:95]
    ds_write_b64 v242, v[248:249] offset:49152
    v_mul_f32 v8, v240, v8
    v_mul_f32 v9, v240, v9
    v_mul_f32 v10, v240, v10
    v_mul_f32 v11, v240, v11
    v_xor_b32 v242, 32, v250
    v_mfma_f32_32x32x16_bf16 a[144:159], a[252:255], v[92:95], a[144:159]
    ds_read_b64_tr_b16 a[252:253], v246 offset:18432
    ds_read_b64_tr_b16 a[254:255], v247 offset:19456
    v_cvt_pk_bf16_f32 v248, v8, v9
    v_cvt_pk_bf16_f32 v249, v10, v11
    ds_write_b64 v242, v[248:249] offset:49152
    s_waitcnt lgkmcnt(5)
    v_mfma_f32_32x32x16_bf16 a[16:31], a[248:251], a[192:195], a[16:31]
    v_mul_f32 v12, v240, v12
    v_mul_f32 v13, v240, v13
    v_mul_f32 v14, v240, v14
    v_mul_f32 v15, v240, v15
    v_xor_b32 v242, 48, v250
    v_cvt_pk_bf16_f32 v248, v12, v13
    v_mfma_f32_32x32x16_bf16 a[80:95], a[248:251], v[96:99], a[80:95]
    v_cvt_pk_bf16_f32 v249, v14, v15
    ds_write_b64 v242, v[248:249] offset:49152
    v_mul_f32 v16, v240, v16
    v_mul_f32 v17, v240, v17
    v_mul_f32 v18, v240, v18
    v_mfma_f32_32x32x16_bf16 a[144:159], a[248:251], v[104:107], a[144:159]
    ds_read_b64_tr_b16 a[248:249], v246 offset:20480
    ds_read_b64_tr_b16 a[250:251], v247 offset:21504
    v_mul_f32 v19, v240, v19
    v_xor_b32 v242, 64, v250
    v_cvt_pk_bf16_f32 v248, v16, v17
    s_waitcnt lgkmcnt(4)
    v_mfma_f32_32x32x16_bf16 a[16:31], a[252:255], a[196:199], a[16:31]
    v_cvt_pk_bf16_f32 v249, v18, v19
    ds_write_b64 v242, v[248:249] offset:49152
    v_mul_f32 v20, v240, v20
    v_mul_f32 v21, v240, v21
    v_mul_f32 v22, v240, v22
    v_mfma_f32_32x32x16_bf16 a[80:95], a[252:255], v[100:103], a[80:95]
    v_mul_f32 v23, v240, v23
    v_xor_b32 v242, 80, v250
    v_cvt_pk_bf16_f32 v248, v20, v21
    v_cvt_pk_bf16_f32 v249, v22, v23
    ds_write_b64 v242, v[248:249] offset:49152
    v_mfma_f32_32x32x16_bf16 a[144:159], a[252:255], v[108:111], a[144:159]
    ds_read_b64_tr_b16 a[252:253], v246 offset:22528
    ds_read_b64_tr_b16 a[254:255], v247 offset:23552
    v_mul_f32 v24, v240, v24
    v_mul_f32 v25, v240, v25
    v_mul_f32 v26, v240, v26
    s_waitcnt lgkmcnt(4)
    v_mfma_f32_32x32x16_bf16 a[16:31], a[248:251], a[200:203], a[16:31]
    v_mul_f32 v27, v240, v27
    v_xor_b32 v242, 96, v250
    v_cvt_pk_bf16_f32 v248, v24, v25
    v_cvt_pk_bf16_f32 v249, v26, v27
    ds_write_b64 v242, v[248:249] offset:49152
    v_mfma_f32_32x32x16_bf16 a[80:95], a[248:251], v[112:115], a[80:95]
    v_mul_f32 v28, v240, v28
    v_mul_f32 v29, v240, v29
    v_mul_f32 v30, v240, v30
    v_mul_f32 v31, v240, v31
    v_xor_b32 v242, 112, v250
    v_cvt_pk_bf16_f32 v248, v28, v29
    v_mfma_f32_32x32x16_bf16 a[144:159], a[248:251], v[120:123], a[144:159]
    ds_read_b64_tr_b16 a[248:249], v246 offset:24576
    ds_read_b64_tr_b16 a[250:251], v247 offset:25600
    v_cvt_pk_bf16_f32 v249, v30, v31
    ds_write_b64 v242, v[248:249] offset:49152
    ds_read_b128 a[32:35], v251 offset:32768
    ds_read_b128 a[36:39], v251 offset:49152
    s_waitcnt lgkmcnt(6)
    v_mfma_f32_32x32x16_bf16 a[16:31], a[252:255], a[204:207], a[16:31]
    ds_read_b128 a[40:43], v251 offset:33792
    s_add_u32 s35, s75, 4096
    s_waitcnt lgkmcnt(2)
    buffer_store_dwordx4 a[32:35], v252, s[20:23], s35 offen sc1
    v_mfma_f32_32x32x16_bf16 a[80:95], a[252:255], v[116:119], a[80:95]
    ds_read_b128 a[44:47], v251 offset:50176
    s_add_u32 s35, s75, 4096
    s_waitcnt lgkmcnt(2)
    buffer_store_dwordx4 a[36:39], v252, s[20:23], s35 offen offset:128 sc1
    v_mfma_f32_32x32x16_bf16 a[144:159], a[252:255], v[124:127], a[144:159]
    ds_read_b64_tr_b16 a[252:253], v246 offset:26624
    ds_read_b64_tr_b16 a[254:255], v247 offset:27648
    ds_read_b128 a[32:35], v251 offset:34816
    s_add_u32 s35, s75, 12288
    s_waitcnt lgkmcnt(4)
    buffer_store_dwordx4 a[40:43], v253, s[20:23], s35 offen sc1
    v_mfma_f32_32x32x16_bf16 a[16:31], a[248:251], a[208:211], a[16:31]
    ds_read_b128 a[36:39], v251 offset:51200
    s_add_u32 s35, s75, 12288
    s_waitcnt lgkmcnt(4)
    buffer_store_dwordx4 a[44:47], v253, s[20:23], s35 offen offset:128 sc1
    v_mfma_f32_32x32x16_bf16 a[80:95], a[248:251], v[128:131], a[80:95]
    ds_read_b128 a[40:43], v251 offset:35840
    s_add_u32 s35, s75, 20480
    s_waitcnt lgkmcnt(2)
    buffer_store_dwordx4 a[32:35], v252, s[20:23], s35 offen sc1
    v_mfma_f32_32x32x16_bf16 a[144:159], a[248:251], v[136:139], a[144:159]
    ds_read_b64_tr_b16 a[248:249], v246 offset:28672
    ds_read_b64_tr_b16 a[250:251], v247 offset:29696
    ds_read_b128 a[44:47], v251 offset:52224
    s_add_u32 s35, s75, 20480
    s_waitcnt lgkmcnt(4)
    buffer_store_dwordx4 a[36:39], v252, s[20:23], s35 offen offset:128 sc1
    v_mfma_f32_32x32x16_bf16 a[16:31], a[252:255], a[212:215], a[16:31]
    s_add_u32 s35, s75, 28672
    s_waitcnt lgkmcnt(3)
    buffer_store_dwordx4 a[40:43], v253, s[20:23], s35 offen sc1
    s_add_u32 s35, s75, 28672
    s_waitcnt lgkmcnt(0)
    buffer_store_dwordx4 a[44:47], v253, s[20:23], s35 offen offset:128 sc1
    v_mfma_f32_32x32x16_bf16 a[80:95], a[252:255], v[132:135], a[80:95]
    v_mfma_f32_32x32x16_bf16 a[144:159], a[252:255], v[140:143], a[144:159]
    ds_read_b64_tr_b16 a[252:253], v246 offset:30720
    ds_read_b64_tr_b16 a[254:255], v247 offset:31744
    v_mfma_f32_32x32x16_bf16 a[16:31], a[248:251], a[216:219], a[16:31]
    v_mfma_f32_32x32x16_bf16 a[80:95], a[248:251], v[144:147], a[80:95]
    v_mfma_f32_32x32x16_bf16 a[144:159], a[248:251], v[152:155], a[144:159]
    ds_read_b64_tr_b16 a[248:249], v246 offset:32768
    ds_read_b64_tr_b16 a[250:251], v247 offset:33792
    s_waitcnt lgkmcnt(2)
    v_mfma_f32_32x32x16_bf16 a[16:31], a[252:255], a[220:223], a[16:31]
    v_mfma_f32_32x32x16_bf16 a[80:95], a[252:255], v[148:151], a[80:95]
    v_mfma_f32_32x32x16_bf16 a[144:159], a[252:255], v[156:159], a[144:159]
    ds_read_b64_tr_b16 a[252:253], v246 offset:34816
    ds_read_b64_tr_b16 a[254:255], v247 offset:35840
    s_waitcnt lgkmcnt(2)
    v_mfma_f32_32x32x16_bf16 a[16:31], a[248:251], a[224:227], a[16:31]
    v_mfma_f32_32x32x16_bf16 a[80:95], a[248:251], v[160:163], a[80:95]
    v_mfma_f32_32x32x16_bf16 a[144:159], a[248:251], v[168:171], a[144:159]
    ds_read_b64_tr_b16 a[248:249], v246 offset:36864
    ds_read_b64_tr_b16 a[250:251], v247 offset:37888
    s_waitcnt lgkmcnt(2)
    v_mfma_f32_32x32x16_bf16 a[16:31], a[252:255], a[228:231], a[16:31]
    v_mfma_f32_32x32x16_bf16 a[80:95], a[252:255], v[164:167], a[80:95]
    v_mfma_f32_32x32x16_bf16 a[144:159], a[252:255], v[172:175], a[144:159]
    ds_read_b64_tr_b16 a[252:253], v246 offset:38912
    ds_read_b64_tr_b16 a[254:255], v247 offset:39936
    s_waitcnt lgkmcnt(2)
    v_mfma_f32_32x32x16_bf16 a[16:31], a[248:251], a[232:235], a[16:31]
    v_mfma_f32_32x32x16_bf16 a[80:95], a[248:251], v[176:179], a[80:95]
    v_mfma_f32_32x32x16_bf16 a[144:159], a[248:251], v[184:187], a[144:159]
    ds_read_b64_tr_b16 a[248:249], v246 offset:40960
    ds_read_b64_tr_b16 a[250:251], v247 offset:41984
    s_waitcnt lgkmcnt(2)
    v_mfma_f32_32x32x16_bf16 a[16:31], a[252:255], a[236:239], a[16:31]
    v_mfma_f32_32x32x16_bf16 a[80:95], a[252:255], v[180:183], a[80:95]
    v_mfma_f32_32x32x16_bf16 a[144:159], a[252:255], v[188:191], a[144:159]
    ds_read_b64_tr_b16 a[252:253], v246 offset:43008
    ds_read_b64_tr_b16 a[254:255], v247 offset:44032
    s_waitcnt lgkmcnt(2)
    v_mfma_f32_32x32x16_bf16 a[16:31], a[248:251], a[240:243], a[16:31]
    v_mfma_f32_32x32x16_bf16 a[80:95], a[248:251], v[192:195], a[80:95]
    v_mfma_f32_32x32x16_bf16 a[144:159], a[248:251], v[200:203], a[144:159]
    ds_read_b64_tr_b16 a[248:249], v246 offset:45056
    ds_read_b64_tr_b16 a[250:251], v247 offset:46080
    s_waitcnt lgkmcnt(2)
    v_mfma_f32_32x32x16_bf16 a[16:31], a[252:255], a[244:247], a[16:31]
    v_mfma_f32_32x32x16_bf16 a[80:95], a[252:255], v[196:199], a[80:95]
    v_mfma_f32_32x32x16_bf16 a[144:159], a[252:255], v[204:207], a[144:159]
    ds_read_b64_tr_b16 a[252:253], v246 offset:47104
    ds_read_b64_tr_b16 a[254:255], v247 offset:48128
    s_waitcnt lgkmcnt(2)
    v_mfma_f32_32x32x16_bf16 a[16:31], a[248:251], v[208:211], a[16:31]
    v_mfma_f32_32x32x16_bf16 a[80:95], a[248:251], v[216:219], a[80:95]
    v_mfma_f32_32x32x16_bf16 a[144:159], a[248:251], v[224:227], a[144:159]
    v_add_u32 v244, 49152, v244
    v_add_u32 v245, 49152, v245
    v_add_u32 v246, 49152, v246
    v_add_u32 v247, 49152, v247
    ds_read_b64_tr_b16 a[248:249], v244 offset:32768
    ds_read_b64_tr_b16 a[250:251], v245 offset:33792
    s_waitcnt lgkmcnt(2)
    v_mfma_f32_32x32x16_bf16 a[16:31], a[252:255], v[212:215], a[16:31]
    v_mfma_f32_32x32x16_bf16 a[80:95], a[252:255], v[220:223], a[80:95]
    v_mfma_f32_32x32x16_bf16 a[144:159], a[252:255], v[228:231], a[144:159]
    ds_read_b64_tr_b16 a[252:253], v244 offset:34816
    ds_read_b64_tr_b16 a[254:255], v245 offset:35840
    v_add_u32 v255, 98304, v250
    v_add_u32 v241, 98304, v251
    s_waitcnt lgkmcnt(2)
    v_mfma_f32_32x32x16_bf16 a[32:47], a[248:251], a[160:163], 0
    v_mfma_f32_32x32x16_bf16 a[96:111], a[248:251], v[32:35], 0
    v_mfma_f32_32x32x16_bf16 v[0:15], a[248:251], v[40:43], 0
    ds_read_b64_tr_b16 a[248:249], v246 offset:32768
    ds_read_b64_tr_b16 a[250:251], v247 offset:33792
    s_waitcnt lgkmcnt(2)
    v_mfma_f32_32x32x16_bf16 a[32:47], a[252:255], a[164:167], a[32:47]
    v_mfma_f32_32x32x16_bf16 a[96:111], a[252:255], v[36:39], a[96:111]
    v_mfma_f32_32x32x16_bf16 v[0:15], a[252:255], v[44:47], v[0:15]
    ds_read_b64_tr_b16 a[252:253], v246 offset:34816
    ds_read_b64_tr_b16 a[254:255], v247 offset:35840
    s_waitcnt lgkmcnt(2)
    v_mfma_f32_32x32x16_bf16 a[48:63], a[248:251], a[160:163], 0
    s_barrier
    v_mfma_f32_32x32x16_bf16 a[112:127], a[248:251], v[32:35], 0
    v_accvgpr_read_b32 v232, a0
    v_accvgpr_read_b32 v233, a1
    v_accvgpr_read_b32 v234, a2
    v_accvgpr_read_b32 v235, a3
    v_mul_f32 v232, v238, v232
    v_mfma_f32_32x32x16_bf16 v[16:31], a[248:251], v[40:43], 0
    ds_read_b64_tr_b16 a[248:249], v244 offset:36864
    ds_read_b64_tr_b16 a[250:251], v245 offset:37888
    v_mul_f32 v233, v238, v233
    v_mul_f32 v234, v238, v234
    v_mul_f32 v235, v238, v235
    s_waitcnt lgkmcnt(2)
    v_mfma_f32_32x32x16_bf16 a[48:63], a[252:255], a[164:167], a[48:63]
    v_cvt_pk_bf16_f32 v248, v232, v233
    v_cvt_pk_bf16_f32 v249, v234, v235
    ds_write_b64 v255, v[248:249]
    v_accvgpr_read_b32 v232, a4
    v_accvgpr_read_b32 v233, a5
    v_mfma_f32_32x32x16_bf16 a[112:127], a[252:255], v[36:39], a[112:127]
    v_accvgpr_read_b32 v234, a6
    v_accvgpr_read_b32 v235, a7
    v_mul_f32 v232, v238, v232
    v_mul_f32 v233, v238, v233
    v_mul_f32 v234, v238, v234
    v_mfma_f32_32x32x16_bf16 v[16:31], a[252:255], v[44:47], v[16:31]
    ds_read_b64_tr_b16 a[252:253], v244 offset:38912
    ds_read_b64_tr_b16 a[254:255], v245 offset:39936
    v_mul_f32 v235, v238, v235
    v_xor_b32 v242, 16, v255
    v_cvt_pk_bf16_f32 v248, v232, v233
    s_waitcnt lgkmcnt(3)
    v_mfma_f32_32x32x16_bf16 a[32:47], a[248:251], a[168:171], a[32:47]
    v_cvt_pk_bf16_f32 v249, v234, v235
    ds_write_b64 v242, v[248:249]
    v_accvgpr_read_b32 v232, a8
    v_accvgpr_read_b32 v233, a9
    v_accvgpr_read_b32 v234, a10
    v_mfma_f32_32x32x16_bf16 a[96:111], a[248:251], v[48:51], a[96:111]
    v_accvgpr_read_b32 v235, a11
    v_mul_f32 v232, v238, v232
    v_mul_f32 v233, v238, v233
    v_mul_f32 v234, v238, v234
    v_mul_f32 v235, v238, v235
    v_xor_b32 v242, 32, v255
    v_mfma_f32_32x32x16_bf16 v[0:15], a[248:251], v[56:59], v[0:15]
    ds_read_b64_tr_b16 a[248:249], v246 offset:36864
    ds_read_b64_tr_b16 a[250:251], v247 offset:37888
    v_cvt_pk_bf16_f32 v248, v232, v233
    v_cvt_pk_bf16_f32 v249, v234, v235
    ds_write_b64 v242, v[248:249]
    s_waitcnt lgkmcnt(4)
    v_mfma_f32_32x32x16_bf16 a[32:47], a[252:255], a[172:175], a[32:47]
    v_accvgpr_read_b32 v232, a12
    v_accvgpr_read_b32 v233, a13
    v_accvgpr_read_b32 v234, a14
    v_accvgpr_read_b32 v235, a15
    v_mul_f32 v232, v238, v232
    v_mfma_f32_32x32x16_bf16 a[96:111], a[252:255], v[52:55], a[96:111]
    v_mul_f32 v233, v238, v233
    v_mul_f32 v234, v238, v234
    v_mul_f32 v235, v238, v235
    v_xor_b32 v242, 48, v255
    v_cvt_pk_bf16_f32 v248, v232, v233
    v_cvt_pk_bf16_f32 v249, v234, v235
    v_mfma_f32_32x32x16_bf16 v[0:15], a[252:255], v[60:63], v[0:15]
    ds_read_b64_tr_b16 a[252:253], v246 offset:38912
    ds_read_b64_tr_b16 a[254:255], v247 offset:39936
    ds_write_b64 v242, v[248:249]
    v_accvgpr_read_b32 v232, a16
    v_accvgpr_read_b32 v233, a17
    s_waitcnt lgkmcnt(4)
    v_mfma_f32_32x32x16_bf16 a[48:63], a[248:251], a[168:171], a[48:63]
    v_accvgpr_read_b32 v234, a18
    v_accvgpr_read_b32 v235, a19
    v_mul_f32 v232, v238, v232
    v_mul_f32 v233, v238, v233
    v_mul_f32 v234, v238, v234
    v_mfma_f32_32x32x16_bf16 a[112:127], a[248:251], v[48:51], a[112:127]
    v_mul_f32 v235, v238, v235
    v_xor_b32 v242, 64, v255
    v_cvt_pk_bf16_f32 v248, v232, v233
    v_cvt_pk_bf16_f32 v249, v234, v235
    ds_write_b64 v242, v[248:249]
    v_mfma_f32_32x32x16_bf16 v[16:31], a[248:251], v[56:59], v[16:31]
    ds_read_b64_tr_b16 a[248:249], v244 offset:40960
    ds_read_b64_tr_b16 a[250:251], v245 offset:41984
    v_accvgpr_read_b32 v232, a20
    v_accvgpr_read_b32 v233, a21
    v_accvgpr_read_b32 v234, a22
    s_waitcnt lgkmcnt(4)
    v_mfma_f32_32x32x16_bf16 a[48:63], a[252:255], a[172:175], a[48:63]
    v_accvgpr_read_b32 v235, a23
    v_mul_f32 v232, v238, v232
    v_mul_f32 v233, v238, v233
    v_mul_f32 v234, v238, v234
    v_mul_f32 v235, v238, v235
    v_xor_b32 v242, 80, v255
    v_mfma_f32_32x32x16_bf16 a[112:127], a[252:255], v[52:55], a[112:127]
    v_cvt_pk_bf16_f32 v248, v232, v233
    v_cvt_pk_bf16_f32 v249, v234, v235
    ds_write_b64 v242, v[248:249]
    v_accvgpr_read_b32 v232, a24
    v_accvgpr_read_b32 v233, a25
    v_mfma_f32_32x32x16_bf16 v[16:31], a[252:255], v[60:63], v[16:31]
    ds_read_b64_tr_b16 a[252:253], v244 offset:43008
    ds_read_b64_tr_b16 a[254:255], v245 offset:44032
    v_accvgpr_read_b32 v234, a26
    v_accvgpr_read_b32 v235, a27
    v_mul_f32 v232, v238, v232
    s_waitcnt lgkmcnt(3)
    v_mfma_f32_32x32x16_bf16 a[32:47], a[248:251], a[176:179], a[32:47]
    v_mul_f32 v233, v238, v233
    v_mul_f32 v234, v238, v234
    v_mul_f32 v235, v238, v235
    v_xor_b32 v242, 96, v255
    v_cvt_pk_bf16_f32 v248, v232, v233
    v_cvt_pk_bf16_f32 v249, v234, v235
    v_mfma_f32_32x32x16_bf16 a[96:111], a[248:251], v[64:67], a[96:111]
    ds_write_b64 v242, v[248:249]
    v_accvgpr_read_b32 v232, a28
    v_accvgpr_read_b32 v233, a29
    v_accvgpr_read_b32 v234, a30
    v_accvgpr_read_b32 v235, a31
    v_mfma_f32_32x32x16_bf16 v[0:15], a[248:251], v[72:75], v[0:15]
    ds_read_b64_tr_b16 a[248:249], v246 offset:40960
    ds_read_b64_tr_b16 a[250:251], v247 offset:41984
    v_mul_f32 v232, v238, v232
    v_mul_f32 v233, v238, v233
    v_mul_f32 v234, v238, v234
    s_waitcnt lgkmcnt(3)
    v_mfma_f32_32x32x16_bf16 a[32:47], a[252:255], a[180:183], a[32:47]
    v_mul_f32 v235, v238, v235
    v_xor_b32 v242, 112, v255
    v_cvt_pk_bf16_f32 v248, v232, v233
    v_cvt_pk_bf16_f32 v249, v234, v235
    ds_write_b64 v242, v[248:249]
    v_mfma_f32_32x32x16_bf16 a[96:111], a[252:255], v[68:71], a[96:111]
    v_mfma_f32_32x32x16_bf16 v[0:15], a[252:255], v[76:79], v[0:15]
    ds_read_b64_tr_b16 a[252:253], v246 offset:43008
    ds_read_b64_tr_b16 a[254:255], v247 offset:44032
    s_waitcnt lgkmcnt(3)
    v_mfma_f32_32x32x16_bf16 a[48:63], a[248:251], a[176:179], a[48:63]
    v_mfma_f32_32x32x16_bf16 a[112:127], a[248:251], v[64:67], a[112:127]
    v_mfma_f32_32x32x16_bf16 v[16:31], a[248:251], v[72:75], v[16:31]
    ds_read_b64_tr_b16 a[248:249], v244 offset:45056
    ds_read_b64_tr_b16 a[250:251], v245 offset:46080
    s_waitcnt lgkmcnt(2)
    v_mfma_f32_32x32x16_bf16 a[48:63], a[252:255], a[180:183], a[48:63]
    v_mfma_f32_32x32x16_bf16 a[112:127], a[252:255], v[68:71], a[112:127]
    v_mfma_f32_32x32x16_bf16 v[16:31], a[252:255], v[76:79], v[16:31]
    ds_read_b64_tr_b16 a[252:253], v244 offset:47104
    ds_read_b64_tr_b16 a[254:255], v245 offset:48128
    s_waitcnt lgkmcnt(2)
    v_mfma_f32_32x32x16_bf16 a[32:47], a[248:251], a[184:187], a[32:47]
    v_mfma_f32_32x32x16_bf16 a[96:111], a[248:251], v[80:83], a[96:111]
    v_mfma_f32_32x32x16_bf16 v[0:15], a[248:251], v[88:91], v[0:15]
    ds_read_b64_tr_b16 a[248:249], v246 offset:45056
    ds_read_b64_tr_b16 a[250:251], v247 offset:46080
    s_waitcnt lgkmcnt(2)
    v_mfma_f32_32x32x16_bf16 a[32:47], a[252:255], a[188:191], a[32:47]
    v_mfma_f32_32x32x16_bf16 a[96:111], a[252:255], v[84:87], a[96:111]
    v_mfma_f32_32x32x16_bf16 v[0:15], a[252:255], v[92:95], v[0:15]
    ds_read_b64_tr_b16 a[252:253], v246 offset:47104
    ds_read_b64_tr_b16 a[254:255], v247 offset:48128
    s_waitcnt lgkmcnt(2)
    v_mfma_f32_32x32x16_bf16 a[48:63], a[248:251], a[184:187], a[48:63]
    v_mfma_f32_32x32x16_bf16 a[112:127], a[248:251], v[80:83], a[112:127]
    v_mfma_f32_32x32x16_bf16 v[16:31], a[248:251], v[88:91], v[16:31]
    ds_read_b64_tr_b16 a[248:249], v244 offset:28672
    ds_read_b64_tr_b16 a[250:251], v245 offset:29696
    s_waitcnt lgkmcnt(2)
    v_mfma_f32_32x32x16_bf16 a[48:63], a[252:255], a[188:191], a[48:63]
    v_mfma_f32_32x32x16_bf16 a[112:127], a[252:255], v[84:87], a[112:127]
    v_mfma_f32_32x32x16_bf16 v[16:31], a[252:255], v[92:95], v[16:31]
    ds_read_b64_tr_b16 a[252:253], v244 offset:30720
    ds_read_b64_tr_b16 a[254:255], v245 offset:31744
    s_waitcnt lgkmcnt(2)
    v_mfma_f32_32x32x16_bf16 a[32:47], a[248:251], v[208:211], a[32:47]
    v_mfma_f32_32x32x16_bf16 a[96:111], a[248:251], v[216:219], a[96:111]
    v_mfma_f32_32x32x16_bf16 v[0:15], a[248:251], v[224:227], v[0:15]
    ds_read_b64_tr_b16 a[248:249], v246 offset:28672
    ds_read_b64_tr_b16 a[250:251], v247 offset:29696
    s_waitcnt lgkmcnt(2)
    v_mfma_f32_32x32x16_bf16 a[32:47], a[252:255], v[212:215], a[32:47]
    v_mfma_f32_32x32x16_bf16 a[96:111], a[252:255], v[220:223], a[96:111]
    v_mfma_f32_32x32x16_bf16 v[0:15], a[252:255], v[228:231], v[0:15]
    ds_read_b64_tr_b16 a[252:253], v246 offset:30720
    ds_read_b64_tr_b16 a[254:255], v247 offset:31744
    s_waitcnt lgkmcnt(2)
    v_mfma_f32_32x32x16_bf16 a[48:63], a[248:251], v[208:211], a[48:63]
    v_mfma_f32_32x32x16_bf16 a[112:127], a[248:251], v[216:219], a[112:127]
    v_mfma_f32_32x32x16_bf16 v[16:31], a[248:251], v[224:227], v[16:31]
    ds_read_b64_tr_b16 a[248:249], v244 offset:24576
    ds_read_b64_tr_b16 a[250:251], v245 offset:25600
    s_waitcnt lgkmcnt(2)
    v_mfma_f32_32x32x16_bf16 a[48:63], a[252:255], v[212:215], a[48:63]
    v_mfma_f32_32x32x16_bf16 a[112:127], a[252:255], v[220:223], a[112:127]
    v_mfma_f32_32x32x16_bf16 v[16:31], a[252:255], v[228:231], v[16:31]
    ds_read_b64_tr_b16 a[252:253], v244 offset:26624
    ds_read_b64_tr_b16 a[254:255], v245 offset:27648
    s_waitcnt lgkmcnt(2)
    v_mfma_f32_32x32x16_bf16 a[32:47], a[248:251], a[240:243], a[32:47]
    ds_read_b128 v[208:211], v241
    ds_read_b128 v[212:215], v241 offset:1024
    ds_read_b128 v[216:219], v241 offset:2048
    ds_read_b128 v[220:223], v241 offset:3072
    s_add_u32 s35, s29, 69632
    s_waitcnt lgkmcnt(3)
    buffer_store_dwordx4 v[208:211], v252, s[20:23], s35 offen offset:256 sc1
    v_mfma_f32_32x32x16_bf16 a[96:111], a[248:251], v[192:195], a[96:111]
    s_add_u32 s35, s29, 73728
    s_waitcnt lgkmcnt(2)
    buffer_store_dwordx4 v[212:215], v253, s[20:23], s35 offen offset:256 sc1
    s_add_u32 s35, s29, 77824
    s_waitcnt lgkmcnt(1)
    buffer_store_dwordx4 v[216:219], v252, s[20:23], s35 offen offset:256 sc1
    v_mfma_f32_32x32x16_bf16 v[0:15], a[248:251], v[200:203], v[0:15]
    ds_read_b64_tr_b16 a[248:249], v246 offset:24576
    ds_read_b64_tr_b16 a[250:251], v247 offset:25600
    s_add_u32 s35, s29, 81920
    s_waitcnt lgkmcnt(2)
    buffer_store_dwordx4 v[220:223], v253, s[20:23], s35 offen offset:256 sc1
    v_mfma_f32_32x32x16_bf16 a[32:47], a[252:255], a[244:247], a[32:47]
    v_accvgpr_read_b32 v232, a64
    v_accvgpr_read_b32 v233, a65
    v_accvgpr_read_b32 v234, a66
    v_accvgpr_read_b32 v235, a67
    v_mul_f32 v232, v239, v232
    v_mfma_f32_32x32x16_bf16 a[96:111], a[252:255], v[196:199], a[96:111]
    v_mul_f32 v233, v239, v233
    v_mul_f32 v234, v239, v234
    v_mul_f32 v235, v239, v235
    v_cvt_pk_bf16_f32 v248, v232, v233
    v_cvt_pk_bf16_f32 v249, v234, v235
    v_mfma_f32_32x32x16_bf16 v[0:15], a[252:255], v[204:207], v[0:15]
    ds_read_b64_tr_b16 a[252:253], v246 offset:26624
    ds_read_b64_tr_b16 a[254:255], v247 offset:27648
    ds_write_b64 v255, v[248:249]
    v_accvgpr_read_b32 v232, a68
    v_accvgpr_read_b32 v233, a69
    s_waitcnt lgkmcnt(3)
    v_mfma_f32_32x32x16_bf16 a[48:63], a[248:251], a[240:243], a[48:63]
    v_accvgpr_read_b32 v234, a70
    v_accvgpr_read_b32 v235, a71
    v_mul_f32 v232, v239, v232
    v_mul_f32 v233, v239, v233
    v_mul_f32 v234, v239, v234
    v_mfma_f32_32x32x16_bf16 a[112:127], a[248:251], v[192:195], a[112:127]
    v_mul_f32 v235, v239, v235
    v_xor_b32 v242, 16, v255
    v_cvt_pk_bf16_f32 v248, v232, v233
    v_cvt_pk_bf16_f32 v249, v234, v235
    ds_write_b64 v242, v[248:249]
    v_mfma_f32_32x32x16_bf16 v[16:31], a[248:251], v[200:203], v[16:31]
    ds_read_b64_tr_b16 a[248:249], v244 offset:20480
    ds_read_b64_tr_b16 a[250:251], v245 offset:21504
    v_accvgpr_read_b32 v232, a72
    v_accvgpr_read_b32 v233, a73
    v_accvgpr_read_b32 v234, a74
    s_waitcnt lgkmcnt(4)
    v_mfma_f32_32x32x16_bf16 a[48:63], a[252:255], a[244:247], a[48:63]
    v_accvgpr_read_b32 v235, a75
    v_mul_f32 v232, v239, v232
    v_mul_f32 v233, v239, v233
    v_mul_f32 v234, v239, v234
    v_mul_f32 v235, v239, v235
    v_xor_b32 v242, 32, v255
    v_mfma_f32_32x32x16_bf16 a[112:127], a[252:255], v[196:199], a[112:127]
    v_cvt_pk_bf16_f32 v248, v232, v233
    v_cvt_pk_bf16_f32 v249, v234, v235
    ds_write_b64 v242, v[248:249]
    v_accvgpr_read_b32 v232, a76
    v_accvgpr_read_b32 v233, a77
    v_mfma_f32_32x32x16_bf16 v[16:31], a[252:255], v[204:207], v[16:31]
    ds_read_b64_tr_b16 a[252:253], v244 offset:22528
    ds_read_b64_tr_b16 a[254:255], v245 offset:23552
    v_accvgpr_read_b32 v234, a78
    v_accvgpr_read_b32 v235, a79
    v_mul_f32 v232, v239, v232
    s_waitcnt lgkmcnt(3)
    v_mfma_f32_32x32x16_bf16 a[32:47], a[248:251], a[232:235], a[32:47]
    v_mul_f32 v233, v239, v233
    v_mul_f32 v234, v239, v234
    v_mul_f32 v235, v239, v235
    v_xor_b32 v242, 48, v255
    v_cvt_pk_bf16_f32 v248, v232, v233
    v_cvt_pk_bf16_f32 v249, v234, v235
    v_mfma_f32_32x32x16_bf16 a[96:111], a[248:251], v[176:179], a[96:111]
    ds_write_b64 v242, v[248:249]
    v_accvgpr_read_b32 v232, a80
    v_accvgpr_read_b32 v233, a81
    v_accvgpr_read_b32 v234, a82
    v_accvgpr_read_b32 v235, a83
    v_mfma_f32_32x32x16_bf16 v[0:15], a[248:251], v[184:187], v[0:15]
    ds_read_b64_tr_b16 a[248:249], v246 offset:20480
    ds_read_b64_tr_b16 a[250:251], v247 offset:21504
    v_mul_f32 v232, v239, v232
    v_mul_f32 v233, v239, v233
    v_mul_f32 v234, v239, v234
    s_waitcnt lgkmcnt(3)
    v_mfma_f32_32x32x16_bf16 a[32:47], a[252:255], a[236:239], a[32:47]
    v_mul_f32 v235, v239, v235
    v_xor_b32 v242, 64, v255
    v_cvt_pk_bf16_f32 v248, v232, v233
    v_cvt_pk_bf16_f32 v249, v234, v235
    ds_write_b64 v242, v[248:249]
    v_mfma_f32_32x32x16_bf16 a[96:111], a[252:255], v[180:183], a[96:111]
    v_accvgpr_read_b32 v232, a84
    v_accvgpr_read_b32 v233, a85
    v_accvgpr_read_b32 v234, a86
    v_accvgpr_read_b32 v235, a87
    v_mul_f32 v232, v239, v232
    v_mfma_f32_32x32x16_bf16 v[0:15], a[252:255], v[188:191], v[0:15]
    ds_read_b64_tr_b16 a[252:253], v246 offset:22528
    ds_read_b64_tr_b16 a[254:255], v247 offset:23552
    v_mul_f32 v233, v239, v233
    v_mul_f32 v234, v239, v234
    v_mul_f32 v235, v239, v235
    s_waitcnt lgkmcnt(3)
    v_mfma_f32_32x32x16_bf16 a[48:63], a[248:251], a[232:235], a[48:63]
    v_xor_b32 v242, 80, v255
    v_cvt_pk_bf16_f32 v248, v232, v233
    v_cvt_pk_bf16_f32 v249, v234, v235
    ds_write_b64 v242, v[248:249]
    v_accvgpr_read_b32 v232, a88
    v_mfma_f32_32x32x16_bf16 a[112:127], a[248:251], v[176:179], a[112:127]
    v_accvgpr_read_b32 v233, a89
    v_accvgpr_read_b32 v234, a90
    v_accvgpr_read_b32 v235, a91
    v_mul_f32 v232, v239, v232
    v_mul_f32 v233, v239, v233
    v_mfma_f32_32x32x16_bf16 v[16:31], a[248:251], v[184:187], v[16:31]
    ds_read_b64_tr_b16 a[248:249], v244 offset:16384
    ds_read_b64_tr_b16 a[250:251], v245 offset:17408
    v_mul_f32 v234, v239, v234
    v_mul_f32 v235, v239, v235
    v_xor_b32 v242, 96, v255
    s_waitcnt lgkmcnt(3)
    v_mfma_f32_32x32x16_bf16 a[48:63], a[252:255], a[236:239], a[48:63]
    v_cvt_pk_bf16_f32 v248, v232, v233
    v_cvt_pk_bf16_f32 v249, v234, v235
    ds_write_b64 v242, v[248:249]
    v_accvgpr_read_b32 v232, a92
    v_accvgpr_read_b32 v233, a93
    v_mfma_f32_32x32x16_bf16 a[112:127], a[252:255], v[180:183], a[112:127]
    v_accvgpr_read_b32 v234, a94
    v_accvgpr_read_b32 v235, a95
    v_mul_f32 v232, v239, v232
    v_mul_f32 v233, v239, v233
    v_mul_f32 v234, v239, v234
    v_mfma_f32_32x32x16_bf16 v[16:31], a[252:255], v[188:191], v[16:31]
    ds_read_b64_tr_b16 a[252:253], v244 offset:18432
    ds_read_b64_tr_b16 a[254:255], v245 offset:19456
    v_mul_f32 v235, v239, v235
    v_xor_b32 v242, 112, v255
    v_cvt_pk_bf16_f32 v248, v232, v233
    s_waitcnt lgkmcnt(3)
    v_mfma_f32_32x32x16_bf16 a[32:47], a[248:251], a[224:227], a[32:47]
    v_cvt_pk_bf16_f32 v249, v234, v235
    ds_write_b64 v242, v[248:249]
    ds_read_b128 v[224:227], v241
    ds_read_b128 v[228:231], v241 offset:1024
    ds_read_b128 a[240:243], v241 offset:2048
    v_mfma_f32_32x32x16_bf16 a[96:111], a[248:251], v[160:163], a[96:111]
    ds_read_b128 a[244:247], v241 offset:3072
    s_add_u32 s35, s29, 86016
    s_waitcnt lgkmcnt(3)
    buffer_store_dwordx4 v[224:227], v252, s[20:23], s35 offen offset:256 sc1
    s_add_u32 s35, s29, 90112
    s_waitcnt lgkmcnt(2)
    buffer_store_dwordx4 v[228:231], v253, s[20:23], s35 offen offset:256 sc1
    v_mfma_f32_32x32x16_bf16 v[0:15], a[248:251], v[168:171], v[0:15]
    ds_read_b64_tr_b16 a[248:249], v246 offset:16384
    ds_read_b64_tr_b16 a[250:251], v247 offset:17408
    s_add_u32 s35, s29, 94208
    s_waitcnt lgkmcnt(3)
    buffer_store_dwordx4 a[240:243], v252, s[20:23], s35 offen offset:256 sc1
    v_mfma_f32_32x32x16_bf16 a[32:47], a[252:255], a[228:231], a[32:47]
    s_add_u32 s35, s29, 98304
    s_waitcnt lgkmcnt(2)
    buffer_store_dwordx4 a[244:247], v253, s[20:23], s35 offen offset:256 sc1
    v_accvgpr_read_b32 v232, a128
    v_accvgpr_read_b32 v233, a129
    v_mfma_f32_32x32x16_bf16 a[96:111], a[252:255], v[164:167], a[96:111]
    v_accvgpr_read_b32 v234, a130
    v_accvgpr_read_b32 v235, a131
    v_mul_f32 v232, v240, v232
    v_mul_f32 v233, v240, v233
    v_mul_f32 v234, v240, v234
    v_mfma_f32_32x32x16_bf16 v[0:15], a[252:255], v[172:175], v[0:15]
    ds_read_b64_tr_b16 a[252:253], v246 offset:18432
    ds_read_b64_tr_b16 a[254:255], v247 offset:19456
    v_mul_f32 v235, v240, v235
    v_cvt_pk_bf16_f32 v248, v232, v233
    v_cvt_pk_bf16_f32 v249, v234, v235
    s_waitcnt lgkmcnt(2)
    v_mfma_f32_32x32x16_bf16 a[48:63], a[248:251], a[224:227], a[48:63]
    ds_write_b64 v255, v[248:249]
    v_accvgpr_read_b32 v232, a132
    v_accvgpr_read_b32 v233, a133
    v_accvgpr_read_b32 v234, a134
    v_accvgpr_read_b32 v235, a135
    v_mfma_f32_32x32x16_bf16 a[112:127], a[248:251], v[160:163], a[112:127]
    v_mul_f32 v232, v240, v232
    v_mul_f32 v233, v240, v233
    v_mul_f32 v234, v240, v234
    v_mul_f32 v235, v240, v235
    v_xor_b32 v242, 16, v255
    v_cvt_pk_bf16_f32 v248, v232, v233
    v_mfma_f32_32x32x16_bf16 v[16:31], a[248:251], v[168:171], v[16:31]
    ds_read_b64_tr_b16 a[248:249], v244 offset:12288
    ds_read_b64_tr_b16 a[250:251], v245 offset:13312
    v_cvt_pk_bf16_f32 v249, v234, v235
    ds_write_b64 v242, v[248:249]
    v_accvgpr_read_b32 v232, a136
    s_waitcnt lgkmcnt(4)
    v_mfma_f32_32x32x16_bf16 a[48:63], a[252:255], a[228:231], a[48:63]
    v_accvgpr_read_b32 v233, a137
    v_accvgpr_read_b32 v234, a138
    v_accvgpr_read_b32 v235, a139
    v_mul_f32 v232, v240, v232
    v_mul_f32 v233, v240, v233
    v_mfma_f32_32x32x16_bf16 a[112:127], a[252:255], v[164:167], a[112:127]
    v_mul_f32 v234, v240, v234
    v_mul_f32 v235, v240, v235
    v_xor_b32 v242, 32, v255
    v_cvt_pk_bf16_f32 v248, v232, v233
    v_cvt_pk_bf16_f32 v249, v234, v235
    v_mfma_f32_32x32x16_bf16 v[16:31], a[252:255], v[172:175], v[16:31]
    ds_read_b64_tr_b16 a[252:253], v244 offset:14336
    ds_read_b64_tr_b16 a[254:255], v245 offset:15360
    ds_write_b64 v242, v[248:249]
    v_accvgpr_read_b32 v232, a140
    v_accvgpr_read_b32 v233, a141
    s_waitcnt lgkmcnt(4)
    v_mfma_f32_32x32x16_bf16 a[32:47], a[248:251], a[216:219], a[32:47]
    v_accvgpr_read_b32 v234, a142
    v_accvgpr_read_b32 v235, a143
    v_mul_f32 v232, v240, v232
    v_mul_f32 v233, v240, v233
    v_mul_f32 v234, v240, v234
    v_mfma_f32_32x32x16_bf16 a[96:111], a[248:251], v[144:147], a[96:111]
    v_mul_f32 v235, v240, v235
    v_xor_b32 v242, 48, v255
    v_cvt_pk_bf16_f32 v248, v232, v233
    v_cvt_pk_bf16_f32 v249, v234, v235
    ds_write_b64 v242, v[248:249]
    v_mfma_f32_32x32x16_bf16 v[0:15], a[248:251], v[152:155], v[0:15]
    ds_read_b64_tr_b16 a[248:249], v246 offset:12288
    ds_read_b64_tr_b16 a[250:251], v247 offset:13312
    v_accvgpr_read_b32 v232, a144
    v_accvgpr_read_b32 v233, a145
    v_accvgpr_read_b32 v234, a146
    s_waitcnt lgkmcnt(4)
    v_mfma_f32_32x32x16_bf16 a[32:47], a[252:255], a[220:223], a[32:47]
    v_accvgpr_read_b32 v235, a147
    v_mul_f32 v232, v240, v232
    v_mul_f32 v233, v240, v233
    v_mul_f32 v234, v240, v234
    v_mul_f32 v235, v240, v235
    v_xor_b32 v242, 64, v255
    v_mfma_f32_32x32x16_bf16 a[96:111], a[252:255], v[148:151], a[96:111]
    v_cvt_pk_bf16_f32 v248, v232, v233
    v_cvt_pk_bf16_f32 v249, v234, v235
    ds_write_b64 v242, v[248:249]
    v_accvgpr_read_b32 v232, a148
    v_accvgpr_read_b32 v233, a149
    v_mfma_f32_32x32x16_bf16 v[0:15], a[252:255], v[156:159], v[0:15]
    ds_read_b64_tr_b16 a[252:253], v246 offset:14336
    ds_read_b64_tr_b16 a[254:255], v247 offset:15360
    v_accvgpr_read_b32 v234, a150
    v_accvgpr_read_b32 v235, a151
    v_mul_f32 v232, v240, v232
    s_waitcnt lgkmcnt(3)
    v_mfma_f32_32x32x16_bf16 a[48:63], a[248:251], a[216:219], a[48:63]
    v_mul_f32 v233, v240, v233
    v_mul_f32 v234, v240, v234
    v_mul_f32 v235, v240, v235
    v_xor_b32 v242, 80, v255
    v_cvt_pk_bf16_f32 v248, v232, v233
    v_cvt_pk_bf16_f32 v249, v234, v235
    v_mfma_f32_32x32x16_bf16 a[112:127], a[248:251], v[144:147], a[112:127]
    ds_write_b64 v242, v[248:249]
    v_accvgpr_read_b32 v232, a152
    v_accvgpr_read_b32 v233, a153
    v_accvgpr_read_b32 v234, a154
    v_accvgpr_read_b32 v235, a155
    v_mfma_f32_32x32x16_bf16 v[16:31], a[248:251], v[152:155], v[16:31]
    ds_read_b64_tr_b16 a[248:249], v244 offset:8192
    ds_read_b64_tr_b16 a[250:251], v245 offset:9216
    v_mul_f32 v232, v240, v232
    v_mul_f32 v233, v240, v233
    v_mul_f32 v234, v240, v234
    s_waitcnt lgkmcnt(3)
    v_mfma_f32_32x32x16_bf16 a[48:63], a[252:255], a[220:223], a[48:63]
    v_mul_f32 v235, v240, v235
    v_xor_b32 v242, 96, v255
    v_cvt_pk_bf16_f32 v248, v232, v233
    v_cvt_pk_bf16_f32 v249, v234, v235
    ds_write_b64 v242, v[248:249]
    v_mfma_f32_32x32x16_bf16 a[112:127], a[252:255], v[148:151], a[112:127]
    v_accvgpr_read_b32 v232, a156
    v_accvgpr_read_b32 v233, a157
    v_accvgpr_read_b32 v234, a158
    v_accvgpr_read_b32 v235, a159
    v_mul_f32 v232, v240, v232
    v_mfma_f32_32x32x16_bf16 v[16:31], a[252:255], v[156:159], v[16:31]
    ds_read_b64_tr_b16 a[252:253], v244 offset:10240
    ds_read_b64_tr_b16 a[254:255], v245 offset:11264
    v_mul_f32 v233, v240, v233
    v_mul_f32 v234, v240, v234
    v_mul_f32 v235, v240, v235
    s_waitcnt lgkmcnt(3)
    v_mfma_f32_32x32x16_bf16 a[32:47], a[248:251], a[208:211], a[32:47]
    v_xor_b32 v242, 112, v255
    v_cvt_pk_bf16_f32 v248, v232, v233
    v_cvt_pk_bf16_f32 v249, v234, v235
    ds_write_b64 v242, v[248:249]
    ds_read_b128 v[192:195], v241
    v_mfma_f32_32x32x16_bf16 a[96:111], a[248:251], v[128:131], a[96:111]
    ds_read_b128 v[196:199], v241 offset:1024
    ds_read_b128 v[200:203], v241 offset:2048
    ds_read_b128 v[204:207], v241 offset:3072
    s_add_u32 s35, s75, 4096
    s_waitcnt lgkmcnt(3)
    buffer_store_dwordx4 v[192:195], v252, s[20:23], s35 offen offset:256 sc1
    v_mfma_f32_32x32x16_bf16 v[0:15], a[248:251], v[136:139], v[0:15]
    ds_read_b64_tr_b16 a[248:249], v246 offset:8192
    ds_read_b64_tr_b16 a[250:251], v247 offset:9216
    s_add_u32 s35, s75, 12288
    s_waitcnt lgkmcnt(4)
    buffer_store_dwordx4 v[196:199], v253, s[20:23], s35 offen offset:256 sc1
    v_mfma_f32_32x32x16_bf16 a[32:47], a[252:255], a[212:215], a[32:47]
    s_add_u32 s35, s75, 20480
    s_waitcnt lgkmcnt(3)
    buffer_store_dwordx4 v[200:203], v252, s[20:23], s35 offen offset:256 sc1
    s_add_u32 s35, s75, 28672
    s_waitcnt lgkmcnt(2)
    buffer_store_dwordx4 v[204:207], v253, s[20:23], s35 offen offset:256 sc1
    v_mfma_f32_32x32x16_bf16 a[96:111], a[252:255], v[132:135], a[96:111]
    v_mfma_f32_32x32x16_bf16 v[0:15], a[252:255], v[140:143], v[0:15]
    ds_read_b64_tr_b16 a[252:253], v246 offset:10240
    ds_read_b64_tr_b16 a[254:255], v247 offset:11264
    s_waitcnt lgkmcnt(2)
    v_mfma_f32_32x32x16_bf16 a[48:63], a[248:251], a[208:211], a[48:63]
    v_mfma_f32_32x32x16_bf16 a[112:127], a[248:251], v[128:131], a[112:127]
    v_mfma_f32_32x32x16_bf16 v[16:31], a[248:251], v[136:139], v[16:31]
    ds_read_b64_tr_b16 a[248:249], v244 offset:4096
    ds_read_b64_tr_b16 a[250:251], v245 offset:5120
    s_waitcnt lgkmcnt(2)
    v_mfma_f32_32x32x16_bf16 a[48:63], a[252:255], a[212:215], a[48:63]
    v_mfma_f32_32x32x16_bf16 a[112:127], a[252:255], v[132:135], a[112:127]
    v_mfma_f32_32x32x16_bf16 v[16:31], a[252:255], v[140:143], v[16:31]
    ds_read_b64_tr_b16 a[252:253], v244 offset:6144
    ds_read_b64_tr_b16 a[254:255], v245 offset:7168
    s_waitcnt lgkmcnt(2)
    v_mfma_f32_32x32x16_bf16 a[32:47], a[248:251], a[200:203], a[32:47]
    v_mfma_f32_32x32x16_bf16 a[96:111], a[248:251], v[112:115], a[96:111]
    v_mfma_f32_32x32x16_bf16 v[0:15], a[248:251], v[120:123], v[0:15]
    ds_read_b64_tr_b16 a[248:249], v246 offset:4096
    ds_read_b64_tr_b16 a[250:251], v247 offset:5120
    s_waitcnt lgkmcnt(2)
    v_mfma_f32_32x32x16_bf16 a[32:47], a[252:255], a[204:207], a[32:47]
    v_mfma_f32_32x32x16_bf16 a[96:111], a[252:255], v[116:119], a[96:111]
    v_mfma_f32_32x32x16_bf16 v[0:15], a[252:255], v[124:127], v[0:15]
    ds_read_b64_tr_b16 a[252:253], v246 offset:6144
    ds_read_b64_tr_b16 a[254:255], v247 offset:7168
    s_waitcnt lgkmcnt(2)
    v_mfma_f32_32x32x16_bf16 a[48:63], a[248:251], a[200:203], a[48:63]
    v_mfma_f32_32x32x16_bf16 a[112:127], a[248:251], v[112:115], a[112:127]
    v_mfma_f32_32x32x16_bf16 v[16:31], a[248:251], v[120:123], v[16:31]
    ds_read_b64_tr_b16 a[248:249], v244
    ds_read_b64_tr_b16 a[250:251], v245 offset:1024
    s_waitcnt lgkmcnt(2)
    v_mfma_f32_32x32x16_bf16 a[48:63], a[252:255], a[204:207], a[48:63]
    v_mfma_f32_32x32x16_bf16 a[112:127], a[252:255], v[116:119], a[112:127]
    v_mfma_f32_32x32x16_bf16 v[16:31], a[252:255], v[124:127], v[16:31]
    ds_read_b64_tr_b16 a[252:253], v244 offset:2048
    ds_read_b64_tr_b16 a[254:255], v245 offset:3072
    s_waitcnt lgkmcnt(2)
    v_mfma_f32_32x32x16_bf16 a[32:47], a[248:251], a[192:195], a[32:47]
    v_mfma_f32_32x32x16_bf16 a[96:111], a[248:251], v[96:99], a[96:111]
    v_mfma_f32_32x32x16_bf16 v[0:15], a[248:251], v[104:107], v[0:15]
    ds_read_b64_tr_b16 a[248:249], v246
    ds_read_b64_tr_b16 a[250:251], v247 offset:1024
    s_waitcnt lgkmcnt(2)
    v_mfma_f32_32x32x16_bf16 a[32:47], a[252:255], a[196:199], a[32:47]
    v_mfma_f32_32x32x16_bf16 a[96:111], a[252:255], v[100:103], a[96:111]
    v_mfma_f32_32x32x16_bf16 v[0:15], a[252:255], v[108:111], v[0:15]
    ds_read_b64_tr_b16 a[252:253], v246 offset:2048
    ds_read_b64_tr_b16 a[254:255], v247 offset:3072
    s_waitcnt lgkmcnt(2)
    v_mfma_f32_32x32x16_bf16 a[48:63], a[248:251], a[192:195], a[48:63]
    v_mfma_f32_32x32x16_bf16 a[112:127], a[248:251], v[96:99], a[112:127]
    v_mfma_f32_32x32x16_bf16 v[16:31], a[248:251], v[104:107], v[16:31]
    s_waitcnt lgkmcnt(0)
    v_mfma_f32_32x32x16_bf16 a[48:63], a[252:255], a[196:199], a[48:63]
    v_mfma_f32_32x32x16_bf16 a[112:127], a[252:255], v[100:103], a[112:127]
    v_mfma_f32_32x32x16_bf16 v[16:31], a[252:255], v[108:111], v[16:31]
    s_barrier
    s_nop 0
    v_mul_f32 v0, v240, v0
    v_mul_f32 v1, v240, v1
    v_mul_f32 v2, v240, v2
    v_mul_f32 v3, v240, v3
    v_cvt_pk_bf16_f32 v248, v0, v1
    v_cvt_pk_bf16_f32 v249, v2, v3
    ds_write_b64 v255, v[248:249] offset:16384
    v_mul_f32 v4, v240, v4
    v_mul_f32 v5, v240, v5
    v_mul_f32 v6, v240, v6
    v_mul_f32 v7, v240, v7
    v_xor_b32 v242, 16, v255
    v_cvt_pk_bf16_f32 v248, v4, v5
    v_cvt_pk_bf16_f32 v249, v6, v7
    ds_write_b64 v242, v[248:249] offset:16384
    v_mul_f32 v8, v240, v8
    v_mul_f32 v9, v240, v9
    v_mul_f32 v10, v240, v10
    v_mul_f32 v11, v240, v11
    v_xor_b32 v242, 32, v255
    v_cvt_pk_bf16_f32 v248, v8, v9
    v_cvt_pk_bf16_f32 v249, v10, v11
    ds_write_b64 v242, v[248:249] offset:16384
    v_mul_f32 v12, v240, v12
    v_mul_f32 v13, v240, v13
    v_mul_f32 v14, v240, v14
    v_mul_f32 v15, v240, v15
    v_xor_b32 v242, 48, v255
    v_cvt_pk_bf16_f32 v248, v12, v13
    v_cvt_pk_bf16_f32 v249, v14, v15
    ds_write_b64 v242, v[248:249] offset:16384
    v_mul_f32 v16, v240, v16
    v_mul_f32 v17, v240, v17
    v_mul_f32 v18, v240, v18
    v_mul_f32 v19, v240, v19
    v_xor_b32 v242, 64, v255
    v_cvt_pk_bf16_f32 v248, v16, v17
    v_cvt_pk_bf16_f32 v249, v18, v19
    ds_write_b64 v242, v[248:249] offset:16384
    v_mul_f32 v20, v240, v20
    v_mul_f32 v21, v240, v21
    v_mul_f32 v22, v240, v22
    v_mul_f32 v23, v240, v23
    v_xor_b32 v242, 80, v255
    v_cvt_pk_bf16_f32 v248, v20, v21
    v_cvt_pk_bf16_f32 v249, v22, v23
    ds_write_b64 v242, v[248:249] offset:16384
    v_mul_f32 v24, v240, v24
    v_mul_f32 v25, v240, v25
    v_mul_f32 v26, v240, v26
    v_mul_f32 v27, v240, v27
    v_xor_b32 v242, 96, v255
    v_cvt_pk_bf16_f32 v248, v24, v25
    v_cvt_pk_bf16_f32 v249, v26, v27
    ds_write_b64 v242, v[248:249] offset:16384
    v_mul_f32 v28, v240, v28
    v_mul_f32 v29, v240, v29
    v_mul_f32 v30, v240, v30
    v_mul_f32 v31, v240, v31
    v_xor_b32 v242, 112, v255
    v_cvt_pk_bf16_f32 v248, v28, v29
    v_cvt_pk_bf16_f32 v249, v30, v31
    ds_write_b64 v242, v[248:249] offset:16384
    ds_read_b128 a[200:203], v241 offset:16384
    ds_read_b128 a[204:207], v241 offset:17408
    ds_read_b128 v[112:115], v241 offset:18432
    ds_read_b128 v[116:119], v241 offset:19456
    v_accvgpr_read_b32 v232, a96
    v_accvgpr_read_b32 v233, a97
    v_accvgpr_read_b32 v234, a98
    v_accvgpr_read_b32 v235, a99
    v_mul_f32 v232, v239, v232
    v_mul_f32 v233, v239, v233
    v_mul_f32 v234, v239, v234
    v_mul_f32 v235, v239, v235
    v_cvt_pk_bf16_f32 v248, v232, v233
    v_cvt_pk_bf16_f32 v249, v234, v235
    ds_write_b64 v255, v[248:249] offset:16384
    v_accvgpr_read_b32 v232, a100
    v_accvgpr_read_b32 v233, a101
    v_accvgpr_read_b32 v234, a102
    v_accvgpr_read_b32 v235, a103
    v_mul_f32 v232, v239, v232
    v_mul_f32 v233, v239, v233
    v_mul_f32 v234, v239, v234
    v_mul_f32 v235, v239, v235
    v_xor_b32 v242, 16, v255
    v_cvt_pk_bf16_f32 v248, v232, v233
    v_cvt_pk_bf16_f32 v249, v234, v235
    s_add_u32 s35, s75, 4096
    s_waitcnt lgkmcnt(4)
    buffer_store_dwordx4 a[200:203], v252, s[20:23], s35 offen offset:384 sc1
    ds_write_b64 v242, v[248:249] offset:16384
    v_accvgpr_read_b32 v232, a104
    v_accvgpr_read_b32 v233, a105
    v_accvgpr_read_b32 v234, a106
    v_accvgpr_read_b32 v235, a107
    v_mul_f32 v232, v239, v232
    v_mul_f32 v233, v239, v233
    v_mul_f32 v234, v239, v234
    v_mul_f32 v235, v239, v235
    v_xor_b32 v242, 32, v255
    v_cvt_pk_bf16_f32 v248, v232, v233
    v_cvt_pk_bf16_f32 v249, v234, v235
    ds_write_b64 v242, v[248:249] offset:16384
    v_accvgpr_read_b32 v232, a108
    v_accvgpr_read_b32 v233, a109
    v_accvgpr_read_b32 v234, a110
    v_accvgpr_read_b32 v235, a111
    v_mul_f32 v232, v239, v232
    v_mul_f32 v233, v239, v233
    v_mul_f32 v234, v239, v234
    v_mul_f32 v235, v239, v235
    s_add_u32 s35, s75, 12288
    s_waitcnt lgkmcnt(5)
    buffer_store_dwordx4 a[204:207], v253, s[20:23], s35 offen offset:384 sc1
    v_xor_b32 v242, 48, v255
    v_cvt_pk_bf16_f32 v248, v232, v233
    v_cvt_pk_bf16_f32 v249, v234, v235
    ds_write_b64 v242, v[248:249] offset:16384
    v_accvgpr_read_b32 v232, a112
    v_accvgpr_read_b32 v233, a113
    v_accvgpr_read_b32 v234, a114
    v_accvgpr_read_b32 v235, a115
    v_mul_f32 v232, v239, v232
    v_mul_f32 v233, v239, v233
    v_mul_f32 v234, v239, v234
    v_mul_f32 v235, v239, v235
    v_xor_b32 v242, 64, v255
    v_cvt_pk_bf16_f32 v248, v232, v233
    v_cvt_pk_bf16_f32 v249, v234, v235
    ds_write_b64 v242, v[248:249] offset:16384
    v_accvgpr_read_b32 v232, a116
    v_accvgpr_read_b32 v233, a117
    v_accvgpr_read_b32 v234, a118
    v_accvgpr_read_b32 v235, a119
    v_mul_f32 v232, v239, v232
    s_add_u32 s35, s75, 20480
    s_waitcnt lgkmcnt(6)
    buffer_store_dwordx4 v[112:115], v252, s[20:23], s35 offen offset:384 sc1
    v_mul_f32 v233, v239, v233
    v_mul_f32 v234, v239, v234
    v_mul_f32 v235, v239, v235
    v_xor_b32 v242, 80, v255
    v_cvt_pk_bf16_f32 v248, v232, v233
    v_cvt_pk_bf16_f32 v249, v234, v235
    ds_write_b64 v242, v[248:249] offset:16384
    v_accvgpr_read_b32 v232, a120
    v_accvgpr_read_b32 v233, a121
    v_accvgpr_read_b32 v234, a122
    v_accvgpr_read_b32 v235, a123
    v_mul_f32 v232, v239, v232
    v_mul_f32 v233, v239, v233
    v_mul_f32 v234, v239, v234
    v_mul_f32 v235, v239, v235
    v_xor_b32 v242, 96, v255
    v_cvt_pk_bf16_f32 v248, v232, v233
    v_cvt_pk_bf16_f32 v249, v234, v235
    ds_write_b64 v242, v[248:249] offset:16384
    v_accvgpr_read_b32 v232, a124
    v_accvgpr_read_b32 v233, a125
    s_add_u32 s35, s75, 28672
    s_waitcnt lgkmcnt(7)
    buffer_store_dwordx4 v[116:119], v253, s[20:23], s35 offen offset:384 sc1
    v_accvgpr_read_b32 v234, a126
    v_accvgpr_read_b32 v235, a127
    v_mul_f32 v232, v239, v232
    v_mul_f32 v233, v239, v233
    v_mul_f32 v234, v239, v234
    v_mul_f32 v235, v239, v235
    v_xor_b32 v242, 112, v255
    v_cvt_pk_bf16_f32 v248, v232, v233
    v_cvt_pk_bf16_f32 v249, v234, v235
    ds_write_b64 v242, v[248:249] offset:16384
    ds_read_b128 v[128:131], v241 offset:16384
    ds_read_b128 v[132:135], v241 offset:17408
    ds_read_b128 v[136:139], v241 offset:18432
    ds_read_b128 v[140:143], v241 offset:19456
    v_accvgpr_read_b32 v232, a32
    v_accvgpr_read_b32 v233, a33
    v_accvgpr_read_b32 v234, a34
    v_accvgpr_read_b32 v235, a35
    v_mul_f32 v232, v238, v232
    v_mul_f32 v233, v238, v233
    v_mul_f32 v234, v238, v234
    v_mul_f32 v235, v238, v235
    v_cvt_pk_bf16_f32 v248, v232, v233
    v_cvt_pk_bf16_f32 v249, v234, v235
    ds_write_b64 v255, v[248:249] offset:16384
    v_accvgpr_read_b32 v232, a36
    v_accvgpr_read_b32 v233, a37
    v_accvgpr_read_b32 v234, a38
    v_accvgpr_read_b32 v235, a39
    v_mul_f32 v232, v238, v232
    v_mul_f32 v233, v238, v233
    v_mul_f32 v234, v238, v234
    v_mul_f32 v235, v238, v235
    v_xor_b32 v242, 16, v255
    v_cvt_pk_bf16_f32 v248, v232, v233
    v_cvt_pk_bf16_f32 v249, v234, v235
    s_add_u32 s35, s29, 86016
    s_waitcnt lgkmcnt(4)
    buffer_store_dwordx4 v[128:131], v252, s[20:23], s35 offen offset:384 sc1
    ds_write_b64 v242, v[248:249] offset:16384
    v_accvgpr_read_b32 v232, a40
    v_accvgpr_read_b32 v233, a41
    v_accvgpr_read_b32 v234, a42
    v_accvgpr_read_b32 v235, a43
    v_mul_f32 v232, v238, v232
    v_mul_f32 v233, v238, v233
    v_mul_f32 v234, v238, v234
    v_mul_f32 v235, v238, v235
    v_xor_b32 v242, 32, v255
    v_cvt_pk_bf16_f32 v248, v232, v233
    v_cvt_pk_bf16_f32 v249, v234, v235
    ds_write_b64 v242, v[248:249] offset:16384
    v_accvgpr_read_b32 v232, a44
    v_accvgpr_read_b32 v233, a45
    v_accvgpr_read_b32 v234, a46
    v_accvgpr_read_b32 v235, a47
    v_mul_f32 v232, v238, v232
    v_mul_f32 v233, v238, v233
    v_mul_f32 v234, v238, v234
    v_mul_f32 v235, v238, v235
    s_add_u32 s35, s29, 90112
    s_waitcnt lgkmcnt(5)
    buffer_store_dwordx4 v[132:135], v253, s[20:23], s35 offen offset:384 sc1
    v_xor_b32 v242, 48, v255
    v_cvt_pk_bf16_f32 v248, v232, v233
    v_cvt_pk_bf16_f32 v249, v234, v235
    ds_write_b64 v242, v[248:249] offset:16384
    v_accvgpr_read_b32 v232, a48
    v_accvgpr_read_b32 v233, a49
    v_accvgpr_read_b32 v234, a50
    v_accvgpr_read_b32 v235, a51
    v_mul_f32 v232, v238, v232
    v_mul_f32 v233, v238, v233
    v_mul_f32 v234, v238, v234
    v_mul_f32 v235, v238, v235
    v_xor_b32 v242, 64, v255
    v_cvt_pk_bf16_f32 v248, v232, v233
    v_cvt_pk_bf16_f32 v249, v234, v235
    ds_write_b64 v242, v[248:249] offset:16384
    v_accvgpr_read_b32 v232, a52
    v_accvgpr_read_b32 v233, a53
    v_accvgpr_read_b32 v234, a54
    v_accvgpr_read_b32 v235, a55
    v_mul_f32 v232, v238, v232
    s_add_u32 s35, s29, 94208
    s_waitcnt lgkmcnt(6)
    buffer_store_dwordx4 v[136:139], v252, s[20:23], s35 offen offset:384 sc1
    v_mul_f32 v233, v238, v233
    v_mul_f32 v234, v238, v234
    v_mul_f32 v235, v238, v235
    v_xor_b32 v242, 80, v255
    v_cvt_pk_bf16_f32 v248, v232, v233
    v_cvt_pk_bf16_f32 v249, v234, v235
    ds_write_b64 v242, v[248:249] offset:16384
    v_accvgpr_read_b32 v232, a56
    v_accvgpr_read_b32 v233, a57
    v_accvgpr_read_b32 v234, a58
    v_accvgpr_read_b32 v235, a59
    v_mul_f32 v232, v238, v232
    v_mul_f32 v233, v238, v233
    v_mul_f32 v234, v238, v234
    v_mul_f32 v235, v238, v235
    v_xor_b32 v242, 96, v255
    v_cvt_pk_bf16_f32 v248, v232, v233
    v_cvt_pk_bf16_f32 v249, v234, v235
    ds_write_b64 v242, v[248:249] offset:16384
    v_accvgpr_read_b32 v232, a60
    v_accvgpr_read_b32 v233, a61
    s_add_u32 s35, s29, 98304
    s_waitcnt lgkmcnt(7)
    buffer_store_dwordx4 v[140:143], v253, s[20:23], s35 offen offset:384 sc1
    v_accvgpr_read_b32 v234, a62
    v_accvgpr_read_b32 v235, a63
    v_mul_f32 v232, v238, v232
    v_mul_f32 v233, v238, v233
    v_mul_f32 v234, v238, v234
    v_mul_f32 v235, v238, v235
    v_xor_b32 v242, 112, v255
    v_cvt_pk_bf16_f32 v248, v232, v233
    v_cvt_pk_bf16_f32 v249, v234, v235
    ds_write_b64 v242, v[248:249] offset:16384
    ds_read_b128 v[152:155], v241 offset:16384
    ds_read_b128 v[156:159], v241 offset:17408
    ds_read_b128 a[208:211], v241 offset:18432
    ds_read_b128 a[212:215], v241 offset:19456
    s_add_u32 s35, s29, 69632
    s_waitcnt lgkmcnt(3)
    buffer_store_dwordx4 v[152:155], v252, s[20:23], s35 offen offset:384 sc1
    s_add_u32 s35, s29, 73728
    s_waitcnt lgkmcnt(2)
    buffer_store_dwordx4 v[156:159], v253, s[20:23], s35 offen offset:384 sc1
    s_add_u32 s35, s29, 77824
    s_waitcnt lgkmcnt(1)
    buffer_store_dwordx4 a[208:211], v252, s[20:23], s35 offen offset:384 sc1
    s_add_u32 s35, s29, 81920
    s_waitcnt lgkmcnt(0)
    buffer_store_dwordx4 a[212:215], v253, s[20:23], s35 offen offset:384 sc1
L_end:
    s_endpgm
L_stub_0_0_1:
    s_call_b64 s[54:55], L_slowA_0_16
    s_call_b64 s[54:55], L_slowB_0_0
    s_branch L_back_0_0_1
L_stub_0_1_1:
    s_call_b64 s[54:55], L_slowA_1_0
    s_call_b64 s[54:55], L_slowB_1_0
    s_branch L_back_0_1_1
L_stub_0_2_1:
    s_call_b64 s[54:55], L_slowA_2_16
    s_call_b64 s[54:55], L_slowB_2_0
    s_branch L_back_0_2_1
L_stub_0_0_2:
    s_call_b64 s[54:55], L_slowA_0_0
    s_call_b64 s[54:55], L_slowB_0_1
    s_branch L_back_0_0_2
L_stub_0_1_2:
    s_call_b64 s[54:55], L_slowA_1_16
    s_call_b64 s[54:55], L_slowB_1_1
    s_branch L_back_0_1_2
L_stub_0_2_2:
    s_call_b64 s[54:55], L_slowA_2_0
    s_call_b64 s[54:55], L_slowB_2_1
    s_branch L_back_0_2_2
L_stub_0_0_3:
    s_call_b64 s[54:55], L_slowA_0_16
    s_call_b64 s[54:55], L_slowB_0_2
    s_branch L_back_0_0_3
L_stub_0_1_3:
    s_call_b64 s[54:55], L_slowA_1_0
    s_call_b64 s[54:55], L_slowB_1_2
    s_branch L_back_0_1_3
L_stub_0_2_3:
    s_call_b64 s[54:55], L_slowA_2_16
    s_call_b64 s[54:55], L_slowB_2_2
    s_branch L_back_0_2_3
L_stub_0_0_4:
    s_call_b64 s[54:55], L_slowA_0_0
    s_call_b64 s[54:55], L_slowB_0_3
    s_branch L_back_0_0_4
L_stub_0_1_4:
    s_call_b64 s[54:55], L_slowA_1_16
    s_call_b64 s[54:55], L_slowB_1_3
    s_branch L_back_0_1_4
L_stub_0_2_4:
    s_call_b64 s[54:55], L_slowA_2_0
    s_call_b64 s[54:55], L_slowB_2_3
    s_branch L_back_0_2_4
L_stub_0_0_5:
    s_call_b64 s[54:55], L_slowA_0_16
    s_call_b64 s[54:55], L_slowB_0_4
    s_branch L_back_0_0_5
L_stub_0_1_5:
    s_call_b64 s[54:55], L_slowA_1_0
    s_call_b64 s[54:55], L_slowB_1_4
    s_branch L_back_0_1_5
L_stub_0_2_5:
    s_call_b64 s[54:55], L_slowA_2_16
    s_call_b64 s[54:55], L_slowB_2_4
    s_branch L_back_0_2_5
L_stub_0_0_6:
    s_call_b64 s[54:55], L_slowA_0_0
    s_call_b64 s[54:55], L_slowB_0_5
    s_branch L_back_0_0_6
L_stub_0_1_6:
    s_call_b64 s[54:55], L_slowA_1_16
    s_call_b64 s[54:55], L_slowB_1_5
    s_branch L_back_0_1_6
L_stub_0_2_6:
    s_call_b64 s[54:55], L_slowA_2_0
    s_call_b64 s[54:55], L_slowB_2_5
    s_branch L_back_0_2_6
L_stub_0_0_7:
    s_call_b64 s[54:55], L_slowA_0_16
    s_call_b64 s[54:55], L_slowB_0_6
    s_branch L_back_0_0_7
L_stub_0_1_7:
    s_call_b64 s[54:55], L_slowA_1_0
    s_call_b64 s[54:55], L_slowB_1_6
    s_branch L_back_0_1_7
L_stub_0_2_7:
    s_call_b64 s[54:55], L_slowA_2_16
    s_call_b64 s[54:55], L_slowB_2_6
    s_branch L_back_0_2_7
L_stub_0_0_8:
    s_call_b64 s[54:55], L_slowA_0_0
    s_call_b64 s[54:55], L_slowB_0_7
    s_branch L_back_0_0_8
L_stub_0_1_8:
    s_call_b64 s[54:55], L_slowA_1_16
    s_call_b64 s[54:55], L_slowB_1_7
    s_branch L_back_0_1_8
L_stub_0_2_8:
    s_call_b64 s[54:55], L_slowA_2_0
    s_call_b64 s[54:55], L_slowB_2_7
    s_branch L_back_0_2_8
L_stub_0_0_9:
    s_call_b64 s[54:55], L_slowA_0_16
    s_call_b64 s[54:55], L_slowB_0_8
    s_branch L_back_0_0_9
L_stub_0_1_9:
    s_call_b64 s[54:55], L_slowA_1_0
    s_call_b64 s[54:55], L_slowB_1_8
    s_branch L_back_0_1_9
L_stub_0_2_9:
    s_call_b64 s[54:55], L_slowA_2_16
    s_call_b64 s[54:55], L_slowB_2_8
    s_branch L_back_0_2_9
L_stub_0_0_10:
    s_call_b64 s[54:55], L_slowA_0_0
    s_call_b64 s[54:55], L_slowB_0_9
    s_branch L_back_0_0_10
L_stub_0_1_10:
    s_call_b64 s[54:55], L_slowA_1_16
    s_call_b64 s[54:55], L_slowB_1_9
    s_branch L_back_0_1_10
L_stub_0_2_10:
    s_call_b64 s[54:55], L_slowA_2_0
    s_call_b64 s[54:55], L_slowB_2_9
    s_branch L_back_0_2_10
L_stub_0_0_11:
    s_call_b64 s[54:55], L_slowA_0_16
    s_call_b64 s[54:55], L_slowB_0_10
    s_branch L_back_0_0_11
L_stub_0_1_11:
    s_call_b64 s[54:55], L_slowA_1_0
    s_call_b64 s[54:55], L_slowB_1_10
    s_branch L_back_0_1_11
L_stub_0_2_11:
    s_call_b64 s[54:55], L_slowA_2_16
    s_call_b64 s[54:55], L_slowB_2_10
    s_branch L_back_0_2_11
L_stub_1_0_1:
    s_call_b64 s[54:55], L_slowA_0_16
    s_call_b64 s[54:55], L_slowB_0_0
    s_branch L_back_1_0_1
L_stub_1_1_1:
    s_call_b64 s[54:55], L_slowA_1_0
    s_call_b64 s[54:55], L_slowB_1_0
    s_branch L_back_1_1_1
L_stub_1_2_1:
    s_call_b64 s[54:55], L_slowA_2_16
    s_call_b64 s[54:55], L_slowB_2_0
    s_branch L_back_1_2_1
L_stub_1_0_2:
    s_call_b64 s[54:55], L_slowA_0_0
    s_call_b64 s[54:55], L_slowB_0_1
    s_branch L_back_1_0_2
L_stub_1_1_2:
    s_call_b64 s[54:55], L_slowA_1_16
    s_call_b64 s[54:55], L_slowB_1_1
    s_branch L_back_1_1_2
L_stub_1_2_2:
    s_call_b64 s[54:55], L_slowA_2_0
    s_call_b64 s[54:55], L_slowB_2_1
    s_branch L_back_1_2_2
L_stub_1_0_3:
    s_call_b64 s[54:55], L_slowA_0_16
    s_call_b64 s[54:55], L_slowB_0_2
    s_branch L_back_1_0_3
L_stub_1_1_3:
    s_call_b64 s[54:55], L_slowA_1_0
    s_call_b64 s[54:55], L_slowB_1_2
    s_branch L_back_1_1_3
L_stub_1_2_3:
    s_call_b64 s[54:55], L_slowA_2_16
    s_call_b64 s[54:55], L_slowB_2_2
    s_branch L_back_1_2_3
L_stub_1_0_4:
    s_call_b64 s[54:55], L_slowA_0_0
    s_call_b64 s[54:55], L_slowB_0_3
    s_branch L_back_1_0_4
L_stub_1_1_4:
    s_call_b64 s[54:55], L_slowA_1_16
    s_call_b64 s[54:55], L_slowB_1_3
    s_branch L_back_1_1_4
L_stub_1_2_4:
    s_call_b64 s[54:55], L_slowA_2_0
    s_call_b64 s[54:55], L_slowB_2_3
    s_branch L_back_1_2_4
L_stub_1_0_5:
    s_call_b64 s[54:55], L_slowA_0_16
    s_call_b64 s[54:55], L_slowB_0_4
    s_branch L_back_1_0_5
L_stub_1_1_5:
    s_call_b64 s[54:55], L_slowA_1_0
    s_call_b64 s[54:55], L_slowB_1_4
    s_branch L_back_1_1_5
L_stub_1_2_5:
    s_call_b64 s[54:55], L_slowA_2_16
    s_call_b64 s[54:55], L_slowB_2_4
    s_branch L_back_1_2_5
L_stub_1_0_6:
    s_call_b64 s[54:55], L_slowA_0_0
    s_call_b64 s[54:55], L_slowB_0_5
    s_branch L_back_1_0_6
L_stub_1_1_6:
    s_call_b64 s[54:55], L_slowA_1_16
    s_call_b64 s[54:55], L_slowB_1_5
    s_branch L_back_1_1_6
L_stub_1_2_6:
    s_call_b64 s[54:55], L_slowA_2_0
    s_call_b64 s[54:55], L_slowB_2_5
    s_branch L_back_1_2_6
L_stub_1_0_7:
    s_call_b64 s[54:55], L_slowA_0_16
    s_call_b64 s[54:55], L_slowB_0_6
    s_branch L_back_1_0_7
L_stub_1_1_7:
    s_call_b64 s[54:55], L_slowA_1_0
    s_call_b64 s[54:55], L_slowB_1_6
    s_branch L_back_1_1_7
L_stub_1_2_7:
    s_call_b64 s[54:55], L_slowA_2_16
    s_call_b64 s[54:55], L_slowB_2_6
    s_branch L_back_1_2_7
L_stub_1_0_8:
    s_call_b64 s[54:55], L_slowA_0_0
    s_call_b64 s[54:55], L_slowB_0_7
    s_branch L_back_1_0_8
L_stub_1_1_8:
    s_call_b64 s[54:55], L_slowA_1_16
    s_call_b64 s[54:55], L_slowB_1_7
    s_branch L_back_1_1_8
L_stub_1_2_8:
    s_call_b64 s[54:55], L_slowA_2_0
    s_call_b64 s[54:55], L_slowB_2_7
    s_branch L_back_1_2_8
L_stub_1_0_9:
    s_call_b64 s[54:55], L_slowA_0_16
    s_call_b64 s[54:55], L_slowB_0_8
    s_branch L_back_1_0_9
L_stub_1_1_9:
    s_call_b64 s[54:55], L_slowA_1_0
    s_call_b64 s[54:55], L_slowB_1_8
    s_branch L_back_1_1_9
L_stub_1_2_9:
    s_call_b64 s[54:55], L_slowA_2_16
    s_call_b64 s[54:55], L_slowB_2_8
    s_branch L_back_1_2_9
L_stub_1_0_10:
    s_call_b64 s[54:55], L_slowA_0_0
    s_call_b64 s[54:55], L_slowB_0_9
    s_branch L_back_1_0_10
L_stub_1_1_10:
    s_call_b64 s[54:55], L_slowA_1_16
    s_call_b64 s[54:55], L_slowB_1_9
    s_branch L_back_1_1_10
L_stub_1_2_10:
    s_call_b64 s[54:55], L_slowA_2_0
    s_call_b64 s[54:55], L_slowB_2_9
    s_branch L_back_1_2_10
L_stub_1_0_11:
    s_call_b64 s[54:55], L_slowA_0_16
    s_call_b64 s[54:55], L_slowB_0_10
    s_branch L_back_1_0_11
L_stub_1_1_11:
    s_call_b64 s[54:55], L_slowA_1_0
    s_call_b64 s[54:55], L_slowB_1_10
    s_branch L_back_1_1_11
L_stub_1_2_11:
    s_call_b64 s[54:55], L_slowA_2_16
    s_call_b64 s[54:55], L_slowB_2_10
    s_branch L_back_1_2_11
L_slowA_0_0:
    s_nop 7
    v_fma_f32 v254, v241, s32, -v238
    v_ceil_f32 v254, v254
    v_max_f32 v254, 0, v254
    v_add_f32 v238, v238, v254
    v_sub_f32 v0, v0, v254
    v_sub_f32 v1, v1, v254
    v_sub_f32 v2, v2, v254
    v_sub_f32 v3, v3, v254
    v_sub_f32 v4, v4, v254
    v_sub_f32 v5, v5, v254
    v_cvt_pk_u8_f32 v254, v254, 0, 0
    v_mul_u32_u24 v255, s34, v254
    v_sub_u32 v254, 0, v254
    v_ldexp_f32 v232, v232, v254
    s_setpc_b64 s[54:55]
L_slowA_0_16:
    s_nop 7
    v_fma_f32 v254, v241, s32, -v238
    v_ceil_f32 v254, v254
    v_max_f32 v254, 0, v254
    v_add_f32 v238, v238, v254
    v_sub_f32 v16, v16, v254
    v_sub_f32 v17, v17, v254
    v_sub_f32 v18, v18, v254
    v_sub_f32 v19, v19, v254
    v_sub_f32 v20, v20, v254
    v_sub_f32 v21, v21, v254
    v_cvt_pk_u8_f32 v254, v254, 0, 0
    v_mul_u32_u24 v255, s34, v254
    v_sub_u32 v254, 0, v254
    v_ldexp_f32 v232, v232, v254
    s_setpc_b64 s[54:55]
L_slowB_0_10:
    v_accvgpr_read_b32 v254, a240
    v_pk_sub_u16 v254, v254, v255 clamp
    v_accvgpr_write_b32 a240, v254
    v_accvgpr_read_b32 v254, a241
    v_pk_sub_u16 v254, v254, v255 clamp
    v_accvgpr_write_b32 a241, v254
    v_accvgpr_read_b32 v254, a242
    v_pk_sub_u16 v254, v254, v255 clamp
    v_accvgpr_write_b32 a242, v254
    v_accvgpr_read_b32 v254, a243
    v_pk_sub_u16 v254, v254, v255 clamp
    v_accvgpr_write_b32 a243, v254
    v_accvgpr_read_b32 v254, a244
    v_pk_sub_u16 v254, v254, v255 clamp
    v_accvgpr_write_b32 a244, v254
    v_accvgpr_read_b32 v254, a245
    v_pk_sub_u16 v254, v254, v255 clamp
    v_accvgpr_write_b32 a245, v254
    v_accvgpr_read_b32 v254, a246
    v_pk_sub_u16 v254, v254, v255 clamp
    v_accvgpr_write_b32 a246, v254
    v_accvgpr_read_b32 v254, a247
    v_pk_sub_u16 v254, v254, v255 clamp
    v_accvgpr_write_b32 a247, v254
L_slowB_0_9:
    v_accvgpr_read_b32 v254, a232
    v_pk_sub_u16 v254, v254, v255 clamp
    v_accvgpr_write_b32 a232, v254
    v_accvgpr_read_b32 v254, a233
    v_pk_sub_u16 v254, v254, v255 clamp
    v_accvgpr_write_b32 a233, v254
    v_accvgpr_read_b32 v254, a234
    v_pk_sub_u16 v254, v254, v255 clamp
    v_accvgpr_write_b32 a234, v254
    v_accvgpr_read_b32 v254, a235
    v_pk_sub_u16 v254, v254, v255 clamp
    v_accvgpr_write_b32 a235, v254
    v_accvgpr_read_b32 v254, a236
    v_pk_sub_u16 v254, v254, v255 clamp
    v_accvgpr_write_b32 a236, v254
    v_accvgpr_read_b32 v254, a237
    v_pk_sub_u16 v254, v254, v255 clamp
    v_accvgpr_write_b32 a237, v254
    v_accvgpr_read_b32 v254, a238
    v_pk_sub_u16 v254, v254, v255 clamp
    v_accvgpr_write_b32 a238, v254
    v_accvgpr_read_b32 v254, a239
    v_pk_sub_u16 v254, v254, v255 clamp
    v_accvgpr_write_b32 a239, v254
L_slowB_0_8:
    v_accvgpr_read_b32 v254, a224
    v_pk_sub_u16 v254, v254, v255 clamp
    v_accvgpr_write_b32 a224, v254
    v_accvgpr_read_b32 v254, a225
    v_pk_sub_u16 v254, v254, v255 clamp
    v_accvgpr_write_b32 a225, v254
    v_accvgpr_read_b32 v254, a226
    v_pk_sub_u16 v254, v254, v255 clamp
    v_accvgpr_write_b32 a226, v254
    v_accvgpr_read_b32 v254, a227
    v_pk_sub_u16 v254, v254, v255 clamp
    v_accvgpr_write_b32 a227, v254
    v_accvgpr_read_b32 v254, a228
    v_pk_sub_u16 v254, v254, v255 clamp
    v_accvgpr_write_b32 a228, v254
    v_accvgpr_read_b32 v254, a229
    v_pk_sub_u16 v254, v254, v255 clamp
    v_accvgpr_write_b32 a229, v254
    v_accvgpr_read_b32 v254, a230
    v_pk_sub_u16 v254, v254, v255 clamp
    v_accvgpr_write_b32 a230, v254
    v_accvgpr_read_b32 v254, a231
    v_pk_sub_u16 v254, v254, v255 clamp
    v_accvgpr_write_b32 a231, v254
L_slowB_0_7:
    v_accvgpr_read_b32 v254, a216
    v_pk_sub_u16 v254, v254, v255 clamp
    v_accvgpr_write_b32 a216, v254
    v_accvgpr_read_b32 v254, a217
    v_pk_sub_u16 v254, v254, v255 clamp
    v_accvgpr_write_b32 a217, v254
    v_accvgpr_read_b32 v254, a218
    v_pk_sub_u16 v254, v254, v255 clamp
    v_accvgpr_write_b32 a218, v254
    v_accvgpr_read_b32 v254, a219
    v_pk_sub_u16 v254, v254, v255 clamp
    v_accvgpr_write_b32 a219, v254
    v_accvgpr_read_b32 v254, a220
    v_pk_sub_u16 v254, v254, v255 clamp
    v_accvgpr_write_b32 a220, v254
    v_accvgpr_read_b32 v254, a221
    v_pk_sub_u16 v254, v254, v255 clamp
    v_accvgpr_write_b32 a221, v254
    v_accvgpr_read_b32 v254, a222
    v_pk_sub_u16 v254, v254, v255 clamp
    v_accvgpr_write_b32 a222, v254
    v_accvgpr_read_b32 v254, a223
    v_pk_sub_u16 v254, v254, v255 clamp
    v_accvgpr_write_b32 a223, v254
L_slowB_0_6:
    v_accvgpr_read_b32 v254, a208
    v_pk_sub_u16 v254, v254, v255 clamp
    v_accvgpr_write_b32 a208, v254
    v_accvgpr_read_b32 v254, a209
    v_pk_sub_u16 v254, v254, v255 clamp
    v_accvgpr_write_b32 a209, v254
    v_accvgpr_read_b32 v254, a210
    v_pk_sub_u16 v254, v254, v255 clamp
    v_accvgpr_write_b32 a210, v254
    v_accvgpr_read_b32 v254, a211
    v_pk_sub_u16 v254, v254, v255 clamp
    v_accvgpr_write_b32 a211, v254
    v_accvgpr_read_b32 v254, a212
    v_pk_sub_u16 v254, v254, v255 clamp
    v_accvgpr_write_b32 a212, v254
    v_accvgpr_read_b32 v254, a213
    v_pk_sub_u16 v254, v254, v255 clamp
    v_accvgpr_write_b32 a213, v254
    v_accvgpr_read_b32 v254, a214
    v_pk_sub_u16 v254, v254, v255 clamp
    v_accvgpr_write_b32 a214, v254
    v_accvgpr_read_b32 v254, a215
    v_pk_sub_u16 v254, v254, v255 clamp
    v_accvgpr_write_b32 a215, v254
L_slowB_0_5:
    v_accvgpr_read_b32 v254, a200
    v_pk_sub_u16 v254, v254, v255 clamp
    v_accvgpr_write_b32 a200, v254
    v_accvgpr_read_b32 v254, a201
    v_pk_sub_u16 v254, v254, v255 clamp
    v_accvgpr_write_b32 a201, v254
    v_accvgpr_read_b32 v254, a202
    v_pk_sub_u16 v254, v254, v255 clamp
    v_accvgpr_write_b32 a202, v254
    v_accvgpr_read_b32 v254, a203
    v_pk_sub_u16 v254, v254, v255 clamp
    v_accvgpr_write_b32 a203, v254
    v_accvgpr_read_b32 v254, a204
    v_pk_sub_u16 v254, v254, v255 clamp
    v_accvgpr_write_b32 a204, v254
    v_accvgpr_read_b32 v254, a205
    v_pk_sub_u16 v254, v254, v255 clamp
    v_accvgpr_write_b32 a205, v254
    v_accvgpr_read_b32 v254, a206
    v_pk_sub_u16 v254, v254, v255 clamp
    v_accvgpr_write_b32 a206, v254
    v_accvgpr_read_b32 v254, a207
    v_pk_sub_u16 v254, v254, v255 clamp
    v_accvgpr_write_b32 a207, v254
L_slowB_0_4:
    v_accvgpr_read_b32 v254, a192
    v_pk_sub_u16 v254, v254, v255 clamp
    v_accvgpr_write_b32 a192, v254
    v_accvgpr_read_b32 v254, a193
    v_pk_sub_u16 v254, v254, v255 clamp
    v_accvgpr_write_b32 a193, v254
    v_accvgpr_read_b32 v254, a194
    v_pk_sub_u16 v254, v254, v255 clamp
    v_accvgpr_write_b32 a194, v254
    v_accvgpr_read_b32 v254, a195
    v_pk_sub_u16 v254, v254, v255 clamp
    v_accvgpr_write_b32 a195, v254
    v_accvgpr_read_b32 v254, a196
    v_pk_sub_u16 v254, v254, v255 clamp
    v_accvgpr_write_b32 a196, v254
    v_accvgpr_read_b32 v254, a197
    v_pk_sub_u16 v254, v254, v255 clamp
    v_accvgpr_write_b32 a197, v254
    v_accvgpr_read_b32 v254, a198
    v_pk_sub_u16 v254, v254, v255 clamp
    v_accvgpr_write_b32 a198, v254
    v_accvgpr_read_b32 v254, a199
    v_pk_sub_u16 v254, v254, v255 clamp
    v_accvgpr_write_b32 a199, v254
L_slowB_0_3:
    v_accvgpr_read_b32 v254, a184
    v_pk_sub_u16 v254, v254, v255 clamp
    v_accvgpr_write_b32 a184, v254
    v_accvgpr_read_b32 v254, a185
    v_pk_sub_u16 v254, v254, v255 clamp
    v_accvgpr_write_b32 a185, v254
    v_accvgpr_read_b32 v254, a186
    v_pk_sub_u16 v254, v254, v255 clamp
    v_accvgpr_write_b32 a186, v254
    v_accvgpr_read_b32 v254, a187
    v_pk_sub_u16 v254, v254, v255 clamp
    v_accvgpr_write_b32 a187, v254
    v_accvgpr_read_b32 v254, a188
    v_pk_sub_u16 v254, v254, v255 clamp
    v_accvgpr_write_b32 a188, v254
    v_accvgpr_read_b32 v254, a189
    v_pk_sub_u16 v254, v254, v255 clamp
    v_accvgpr_write_b32 a189, v254
    v_accvgpr_read_b32 v254, a190
    v_pk_sub_u16 v254, v254, v255 clamp
    v_accvgpr_write_b32 a190, v254
    v_accvgpr_read_b32 v254, a191
    v_pk_sub_u16 v254, v254, v255 clamp
    v_accvgpr_write_b32 a191, v254
L_slowB_0_2:
    v_accvgpr_read_b32 v254, a176
    v_pk_sub_u16 v254, v254, v255 clamp
    v_accvgpr_write_b32 a176, v254
    v_accvgpr_read_b32 v254, a177
    v_pk_sub_u16 v254, v254, v255 clamp
    v_accvgpr_write_b32 a177, v254
    v_accvgpr_read_b32 v254, a178
    v_pk_sub_u16 v254, v254, v255 clamp
    v_accvgpr_write_b32 a178, v254
    v_accvgpr_read_b32 v254, a179
    v_pk_sub_u16 v254, v254, v255 clamp
    v_accvgpr_write_b32 a179, v254
    v_accvgpr_read_b32 v254, a180
    v_pk_sub_u16 v254, v254, v255 clamp
    v_accvgpr_write_b32 a180, v254
    v_accvgpr_read_b32 v254, a181
    v_pk_sub_u16 v254, v254, v255 clamp
    v_accvgpr_write_b32 a181, v254
    v_accvgpr_read_b32 v254, a182
    v_pk_sub_u16 v254, v254, v255 clamp
    v_accvgpr_write_b32 a182, v254
    v_accvgpr_read_b32 v254, a183
    v_pk_sub_u16 v254, v254, v255 clamp
    v_accvgpr_write_b32 a183, v254
L_slowB_0_1:
    v_accvgpr_read_b32 v254, a168
    v_pk_sub_u16 v254, v254, v255 clamp
    v_accvgpr_write_b32 a168, v254
    v_accvgpr_read_b32 v254, a169
    v_pk_sub_u16 v254, v254, v255 clamp
    v_accvgpr_write_b32 a169, v254
    v_accvgpr_read_b32 v254, a170
    v_pk_sub_u16 v254, v254, v255 clamp
    v_accvgpr_write_b32 a170, v254
    v_accvgpr_read_b32 v254, a171
    v_pk_sub_u16 v254, v254, v255 clamp
    v_accvgpr_write_b32 a171, v254
    v_accvgpr_read_b32 v254, a172
    v_pk_sub_u16 v254, v254, v255 clamp
    v_accvgpr_write_b32 a172, v254
    v_accvgpr_read_b32 v254, a173
    v_pk_sub_u16 v254, v254, v255 clamp
    v_accvgpr_write_b32 a173, v254
    v_accvgpr_read_b32 v254, a174
    v_pk_sub_u16 v254, v254, v255 clamp
    v_accvgpr_write_b32 a174, v254
    v_accvgpr_read_b32 v254, a175
    v_pk_sub_u16 v254, v254, v255 clamp
    v_accvgpr_write_b32 a175, v254
L_slowB_0_0:
    v_accvgpr_read_b32 v254, a160
    v_pk_sub_u16 v254, v254, v255 clamp
    v_accvgpr_write_b32 a160, v254
    v_accvgpr_read_b32 v254, a161
    v_pk_sub_u16 v254, v254, v255 clamp
    v_accvgpr_write_b32 a161, v254
    v_accvgpr_read_b32 v254, a162
    v_pk_sub_u16 v254, v254, v255 clamp
    v_accvgpr_write_b32 a162, v254
    v_accvgpr_read_b32 v254, a163
    v_pk_sub_u16 v254, v254, v255 clamp
    v_accvgpr_write_b32 a163, v254
    v_accvgpr_read_b32 v254, a164
    v_pk_sub_u16 v254, v254, v255 clamp
    v_accvgpr_write_b32 a164, v254
    v_accvgpr_read_b32 v254, a165
    v_pk_sub_u16 v254, v254, v255 clamp
    v_accvgpr_write_b32 a165, v254
    v_accvgpr_read_b32 v254, a166
    v_pk_sub_u16 v254, v254, v255 clamp
    v_accvgpr_write_b32 a166, v254
    v_accvgpr_read_b32 v254, a167
    v_pk_sub_u16 v254, v254, v255 clamp
    v_accvgpr_write_b32 a167, v254
    s_nop 1
    s_setpc_b64 s[54:55]
L_slowA_1_0:
    s_nop 7
    v_fma_f32 v254, v242, s32, -v239
    v_ceil_f32 v254, v254
    v_max_f32 v254, 0, v254
    v_add_f32 v239, v239, v254
    v_sub_f32 v0, v0, v254
    v_sub_f32 v1, v1, v254
    v_sub_f32 v2, v2, v254
    v_sub_f32 v3, v3, v254
    v_sub_f32 v4, v4, v254
    v_sub_f32 v5, v5, v254
    v_cvt_pk_u8_f32 v254, v254, 0, 0
    v_mul_u32_u24 v255, s34, v254
    v_sub_u32 v254, 0, v254
    v_ldexp_f32 v233, v233, v254
    s_setpc_b64 s[54:55]
L_slowA_1_16:
    s_nop 7
    v_fma_f32 v254, v242, s32, -v239
    v_ceil_f32 v254, v254
    v_max_f32 v254, 0, v254
    v_add_f32 v239, v239, v254
    v_sub_f32 v16, v16, v254
    v_sub_f32 v17, v17, v254
    v_sub_f32 v18, v18, v254
    v_sub_f32 v19, v19, v254
    v_sub_f32 v20, v20, v254
    v_sub_f32 v21, v21, v254
    v_cvt_pk_u8_f32 v254, v254, 0, 0
    v_mul_u32_u24 v255, s34, v254
    v_sub_u32 v254, 0, v254
    v_ldexp_f32 v233, v233, v254
    s_setpc_b64 s[54:55]
L_slowB_1_10:
    v_pk_sub_u16 v192, v192, v255 clamp
    v_pk_sub_u16 v193, v193, v255 clamp
    v_pk_sub_u16 v194, v194, v255 clamp
    v_pk_sub_u16 v195, v195, v255 clamp
    v_pk_sub_u16 v196, v196, v255 clamp
    v_pk_sub_u16 v197, v197, v255 clamp
    v_pk_sub_u16 v198, v198, v255 clamp
    v_pk_sub_u16 v199, v199, v255 clamp
L_slowB_1_9:
    v_pk_sub_u16 v176, v176, v255 clamp
    v_pk_sub_u16 v177, v177, v255 clamp
    v_pk_sub_u16 v178, v178, v255 clamp
    v_pk_sub_u16 v179, v179, v255 clamp
    v_pk_sub_u16 v180, v180, v255 clamp
    v_pk_sub_u16 v181, v181, v255 clamp
    v_pk_sub_u16 v182, v182, v255 clamp
    v_pk_sub_u16 v183, v183, v255 clamp
L_slowB_1_8:
    v_pk_sub_u16 v160, v160, v255 clamp
    v_pk_sub_u16 v161, v161, v255 clamp
    v_pk_sub_u16 v162, v162, v255 clamp
    v_pk_sub_u16 v163, v163, v255 clamp
    v_pk_sub_u16 v164, v164, v255 clamp
    v_pk_sub_u16 v165, v165, v255 clamp
    v_pk_sub_u16 v166, v166, v255 clamp
    v_pk_sub_u16 v167, v167, v255 clamp
L_slowB_1_7:
    v_pk_sub_u16 v144, v144, v255 clamp
    v_pk_sub_u16 v145, v145, v255 clamp
    v_pk_sub_u16 v146, v146, v255 clamp
    v_pk_sub_u16 v147, v147, v255 clamp
    v_pk_sub_u16 v148, v148, v255 clamp
    v_pk_sub_u16 v149, v149, v255 clamp
    v_pk_sub_u16 v150, v150, v255 clamp
    v_pk_sub_u16 v151, v151, v255 clamp
L_slowB_1_6:
    v_pk_sub_u16 v128, v128, v255 clamp
    v_pk_sub_u16 v129, v129, v255 clamp
    v_pk_sub_u16 v130, v130, v255 clamp
    v_pk_sub_u16 v131, v131, v255 clamp
    v_pk_sub_u16 v132, v132, v255 clamp
    v_pk_sub_u16 v133, v133, v255 clamp
    v_pk_sub_u16 v134, v134, v255 clamp
    v_pk_sub_u16 v135, v135, v255 clamp
L_slowB_1_5:
    v_pk_sub_u16 v112, v112, v255 clamp
    v_pk_sub_u16 v113, v113, v255 clamp
    v_pk_sub_u16 v114, v114, v255 clamp
    v_pk_sub_u16 v115, v115, v255 clamp
    v_pk_sub_u16 v116, v116, v255 clamp
    v_pk_sub_u16 v117, v117, v255 clamp
    v_pk_sub_u16 v118, v118, v255 clamp
    v_pk_sub_u16 v119, v119, v255 clamp
L_slowB_1_4:
    v_pk_sub_u16 v96, v96, v255 clamp
    v_pk_sub_u16 v97, v97, v255 clamp
    v_pk_sub_u16 v98, v98, v255 clamp
    v_pk_sub_u16 v99, v99, v255 clamp
    v_pk_sub_u16 v100, v100, v255 clamp
    v_pk_sub_u16 v101, v101, v255 clamp
    v_pk_sub_u16 v102, v102, v255 clamp
    v_pk_sub_u16 v103, v103, v255 clamp
L_slowB_1_3:
    v_pk_sub_u16 v80, v80, v255 clamp
    v_pk_sub_u16 v81, v81, v255 clamp
    v_pk_sub_u16 v82, v82, v255 clamp
    v_pk_sub_u16 v83, v83, v255 clamp
    v_pk_sub_u16 v84, v84, v255 clamp
    v_pk_sub_u16 v85, v85, v255 clamp
    v_pk_sub_u16 v86, v86, v255 clamp
    v_pk_sub_u16 v87, v87, v255 clamp
L_slowB_1_2:
    v_pk_sub_u16 v64, v64, v255 clamp
    v_pk_sub_u16 v65, v65, v255 clamp
    v_pk_sub_u16 v66, v66, v255 clamp
    v_pk_sub_u16 v67, v67, v255 clamp
    v_pk_sub_u16 v68, v68, v255 clamp
    v_pk_sub_u16 v69, v69, v255 clamp
    v_pk_sub_u16 v70, v70, v255 clamp
    v_pk_sub_u16 v71, v71, v255 clamp
L_slowB_1_1:
    v_pk_sub_u16 v48, v48, v255 clamp
    v_pk_sub_u16 v49, v49, v255 clamp
    v_pk_sub_u16 v50, v50, v255 clamp
    v_pk_sub_u16 v51, v51, v255 clamp
    v_pk_sub_u16 v52, v52, v255 clamp
    v_pk_sub_u16 v53, v53, v255 clamp
    v_pk_sub_u16 v54, v54, v255 clamp
    v_pk_sub_u16 v55, v55, v255 clamp
L_slowB_1_0:
    v_pk_sub_u16 v32, v32, v255 clamp
    v_pk_sub_u16 v33, v33, v255 clamp
    v_pk_sub_u16 v34, v34, v255 clamp
    v_pk_sub_u16 v35, v35, v255 clamp
    v_pk_sub_u16 v36, v36, v255 clamp
    v_pk_sub_u16 v37, v37, v255 clamp
    v_pk_sub_u16 v38, v38, v255 clamp
    v_pk_sub_u16 v39, v39, v255 clamp
    s_nop 1
    s_setpc_b64 s[54:55]
L_slowA_2_0:
    s_nop 7
    v_fma_f32 v254, v243, s32, -v240
    v_ceil_f32 v254, v254
    v_max_f32 v254, 0, v254
    v_add_f32 v240, v240, v254
    v_sub_f32 v0, v0, v254
    v_sub_f32 v1, v1, v254
    v_sub_f32 v2, v2, v254
    v_sub_f32 v3, v3, v254
    v_sub_f32 v4, v4, v254
    v_sub_f32 v5, v5, v254
    v_cvt_pk_u8_f32 v254, v254, 0, 0
    v_mul_u32_u24 v255, s34, v254
    v_sub_u32 v254, 0, v254
    v_ldexp_f32 v234, v234, v254
    s_setpc_b64 s[54:55]
L_slowA_2_16:
    s_nop 7
    v_fma_f32 v254, v243, s32, -v240
    v_ceil_f32 v254, v254
    v_max_f32 v254, 0, v254
    v_add_f32 v240, v240, v254
    v_sub_f32 v16, v16, v254
    v_sub_f32 v17, v17, v254
    v_sub_f32 v18, v18, v254
    v_sub_f32 v19, v19, v254
    v_sub_f32 v20, v20, v254
    v_sub_f32 v21, v21, v254
    v_cvt_pk_u8_f32 v254, v254, 0, 0
    v_mul_u32_u24 v255, s34, v254
    v_sub_u32 v254, 0, v254
    v_ldexp_f32 v234, v234, v254
    s_setpc_b64 s[54:55]
L_slowB_2_10:
    v_pk_sub_u16 v200, v200, v255 clamp
    v_pk_sub_u16 v201, v201, v255 clamp
    v_pk_sub_u16 v202, v202, v255 clamp
    v_pk_sub_u16 v203, v203, v255 clamp
    v_pk_sub_u16 v204, v204, v255 clamp
    v_pk_sub_u16 v205, v205, v255 clamp
    v_pk_sub_u16 v206, v206, v255 clamp
    v_pk_sub_u16 v207, v207, v255 clamp
L_slowB_2_9:
    v_pk_sub_u16 v184, v184, v255 clamp
    v_pk_sub_u16 v185, v185, v255 clamp
    v_pk_sub_u16 v186, v186, v255 clamp
    v_pk_sub_u16 v187, v187, v255 clamp
    v_pk_sub_u16 v188, v188, v255 clamp
    v_pk_sub_u16 v189, v189, v255 clamp
    v_pk_sub_u16 v190, v190, v255 clamp
    v_pk_sub_u16 v191, v191, v255 clamp
L_slowB_2_8:
    v_pk_sub_u16 v168, v168, v255 clamp
    v_pk_sub_u16 v169, v169, v255 clamp
    v_pk_sub_u16 v170, v170, v255 clamp
    v_pk_sub_u16 v171, v171, v255 clamp
    v_pk_sub_u16 v172, v172, v255 clamp
    v_pk_sub_u16 v173, v173, v255 clamp
    v_pk_sub_u16 v174, v174, v255 clamp
    v_pk_sub_u16 v175, v175, v255 clamp
L_slowB_2_7:
    v_pk_sub_u16 v152, v152, v255 clamp
    v_pk_sub_u16 v153, v153, v255 clamp
    v_pk_sub_u16 v154, v154, v255 clamp
    v_pk_sub_u16 v155, v155, v255 clamp
    v_pk_sub_u16 v156, v156, v255 clamp
    v_pk_sub_u16 v157, v157, v255 clamp
    v_pk_sub_u16 v158, v158, v255 clamp
    v_pk_sub_u16 v159, v159, v255 clamp
L_slowB_2_6:
    v_pk_sub_u16 v136, v136, v255 clamp
    v_pk_sub_u16 v137, v137, v255 clamp
    v_pk_sub_u16 v138, v138, v255 clamp
    v_pk_sub_u16 v139, v139, v255 clamp
    v_pk_sub_u16 v140, v140, v255 clamp
    v_pk_sub_u16 v141, v141, v255 clamp
    v_pk_sub_u16 v142, v142, v255 clamp
    v_pk_sub_u16 v143, v143, v255 clamp
L_slowB_2_5:
    v_pk_sub_u16 v120, v120, v255 clamp
    v_pk_sub_u16 v121, v121, v255 clamp
    v_pk_sub_u16 v122, v122, v255 clamp
    v_pk_sub_u16 v123, v123, v255 clamp
    v_pk_sub_u16 v124, v124, v255 clamp
    v_pk_sub_u16 v125, v125, v255 clamp
    v_pk_sub_u16 v126, v126, v255 clamp
    v_pk_sub_u16 v127, v127, v255 clamp
L_slowB_2_4:
    v_pk_sub_u16 v104, v104, v255 clamp
    v_pk_sub_u16 v105, v105, v255 clamp
    v_pk_sub_u16 v106, v106, v255 clamp
    v_pk_sub_u16 v107, v107, v255 clamp
    v_pk_sub_u16 v108, v108, v255 clamp
    v_pk_sub_u16 v109, v109, v255 clamp
    v_pk_sub_u16 v110, v110, v255 clamp
    v_pk_sub_u16 v111, v111, v255 clamp
L_slowB_2_3:
    v_pk_sub_u16 v88, v88, v255 clamp
    v_pk_sub_u16 v89, v89, v255 clamp
    v_pk_sub_u16 v90, v90, v255 clamp
    v_pk_sub_u16 v91, v91, v255 clamp
    v_pk_sub_u16 v92, v92, v255 clamp
    v_pk_sub_u16 v93, v93, v255 clamp
    v_pk_sub_u16 v94, v94, v255 clamp
    v_pk_sub_u16 v95, v95, v255 clamp
L_slowB_2_2:
    v_pk_sub_u16 v72, v72, v255 clamp
    v_pk_sub_u16 v73, v73, v255 clamp
    v_pk_sub_u16 v74, v74, v255 clamp
    v_pk_sub_u16 v75, v75, v255 clamp
    v_pk_sub_u16 v76, v76, v255 clamp
    v_pk_sub_u16 v77, v77, v255 clamp
    v_pk_sub_u16 v78, v78, v255 clamp
    v_pk_sub_u16 v79, v79, v255 clamp
L_slowB_2_1:
    v_pk_sub_u16 v56, v56, v255 clamp
    v_pk_sub_u16 v57, v57, v255 clamp
    v_pk_sub_u16 v58, v58, v255 clamp
    v_pk_sub_u16 v59, v59, v255 clamp
    v_pk_sub_u16 v60, v60, v255 clamp
    v_pk_sub_u16 v61, v61, v255 clamp
    v_pk_sub_u16 v62, v62, v255 clamp
    v_pk_sub_u16 v63, v63, v255 clamp
L_slowB_2_0:
    v_pk_sub_u16 v40, v40, v255 clamp
    v_pk_sub_u16 v41, v41, v255 clamp
    v_pk_sub_u16 v42, v42, v255 clamp
    v_pk_sub_u16 v43, v43, v255 clamp
    v_pk_sub_u16 v44, v44, v255 clamp
    v_pk_sub_u16 v45, v45, v255 clamp
    v_pk_sub_u16 v46, v46, v255 clamp
    v_pk_sub_u16 v47, v47, v255 clamp
    s_nop 1
    s_setpc_b64 s[54:55]
.section .rodata,"a"
.p2align 6
.amdhsa_kernel standalone__mha_softmax__near_ridge_kernel
  .amdhsa_next_free_vgpr 512
  .amdhsa_next_free_sgpr 84
  .amdhsa_accum_offset 256
  .amdhsa_group_segment_fixed_size 0
  .amdhsa_kernarg_size 48
  .amdhsa_user_sgpr_count 2
  .amdhsa_user_sgpr_kernarg_segment_ptr 1
  .amdhsa_system_sgpr_workgroup_id_x 1
.end_amdhsa_kernel
```
